```python
import torch

def _softmax(x, axis=-1):
    return torch.softmax(x, dim=axis)
def _gelu(x):
    return torch.nn.functional.gelu(x, approximate="tanh")
def _silu(x):
    return torch.nn.functional.silu(x)
def _sigmoid(x):
    return torch.sigmoid(x)
def _layernorm(x, axis=-1, eps=1e-5):
    m = x.mean(dim=axis, keepdim=True)
    v = x.var(dim=axis, keepdim=True, unbiased=False)
    return (x - m) / torch.sqrt(v + eps)
def _scatter_add(tgt, idx, src, axis=0):
    return tgt.clone().index_add_(axis, idx, src)
def _segment_sum(src, seg, n):
    out = torch.zeros((n,) + src.shape[1:], dtype=src.dtype)
    return out.index_add_(0, seg, src)
def _pad(x, pw):
    flat = tuple(v for pair in reversed(pw) for v in pair)
    return torch.nn.functional.pad(x, flat)

kernel_name = 'standalone__mha_block_cached__near_ridge'

def setup_inputs():

    _w = (lambda a: (lambda t: t.to(torch.bfloat16) if t.is_floating_point() else t)(torch.as_tensor(a)))
    B, Sq, D = 16, 240, 448
    H, Sk, Dh = 16, 512, 256
    return {
        "x": _w((lambda *s: torch.randn(*s, dtype=torch.bfloat16) * 0.8)(B, Sq, D)),
        "k_cache": _w((lambda *s: torch.randn(*s, dtype=torch.bfloat16) * 0.8)(B, H, Sk, Dh)),
        "v_cache": _w((lambda *s: torch.randn(*s, dtype=torch.bfloat16) * 0.05)(B, H, Sk, Dh)),
        "wq": _w((lambda *s: torch.randn(*s, dtype=torch.bfloat16) * 0.8)(D, H * Dh) * (D ** -0.5)),
        "wo": _w((lambda *s: torch.randn(*s, dtype=torch.bfloat16) * 0.05)(H * Dh, D) * ((H * Dh) ** -0.5)),
    }

def reference(x, k_cache, v_cache, wq, wo):
    B, Sq, D = x.shape
    H, Dh = 16, 256
    q = (lambda x, *d: x.permute(*d))((x @ wq).reshape(B, Sq, H, Dh), 0, 2, 1, 3)
    scores = torch.einsum("bhqd,bhkd->bhqk", q, k_cache) * (Dh ** -0.5)
    p = _softmax(scores, axis=-1)
    o = torch.einsum("bhqk,bhkd->bhqd", p, v_cache)
    return (lambda x, *d: x.permute(*d))(o, 0, 2, 1, 3).reshape(B, Sq, H * Dh) @ wo
```

```asm
; @launch kernel=attn_kernel grid=(256,1,1) block=(256,1,1) lds=163840
.amdgcn_target "amdgcn-amd-amdhsa--gfx950"
.text
.globl attn_kernel
.p2align 8
.type attn_kernel,@function
attn_kernel:
 s_cmp_ge_u32 s2, 256
 s_cbranch_scc1 L_end1
 s_load_dwordx16 s[4:19], s[0:1], 0
 s_memrealtime s[98:99]
 v_lshrrev_b32 v249, 6, v0
 s_nop 0
 v_readfirstlane_b32 s48, v249
 s_bfe_u32 s51, s2, 0x10002
 s_lshl_b32 s51, s51, 3
 s_bfe_u32 s52, s2, 0x30004
 s_add_u32 s50, s51, s52
 s_and_b32 s51, s2, 3
 s_lshl_b32 s51, s51, 1
 s_lshr_b32 s52, s2, 7
 s_add_u32 s61, s51, s52
 s_bfe_u32 s81, s2, 0x10003
 s_lshr_b32 s79, s48, 1
 s_and_b32 s80, s48, 1
 s_lshl_b32 s49, s61, 1
 s_add_u32 s49, s49, s79
 s_lshl_b32 s71, s79, 14
 s_lshl_b32 s51, s80, 10
 s_add_u32 s59, s71, s51
 s_lshl_b32 s52, s79, 13
 s_add_u32 s72, s51, s52
 s_lshl_b32 s56, s80, 17
 s_lshl_b32 s51, s49, 9
 s_add_u32 s56, s56, s51
 v_mbcnt_lo_u32_b32 v249, -1, 0
 v_mbcnt_hi_u32_b32 v249, -1, v249
 v_bfe_u32 v250, v249, 2, 3
 v_lshrrev_b32 v251, 2, v250
 v_lshlrev_b32 v251, 3, v251
 v_and_b32 v250, 3, v250
 v_add_u32 v250, v250, v251
 v_lshlrev_b32 v253, 13, v250
 v_lshrrev_b32 v250, 5, v249
 v_lshl_add_u32 v253, v250, 6, v253
 v_bfe_u32 v250, v249, 4, 1
 v_lshlrev_b32 v250, 1, v250
 v_xor_b32 v250, v250, v249
 v_and_b32 v250, 3, v250
 v_lshl_add_u32 v253, v250, 4, v253
 v_mbcnt_lo_u32_b32 v249, -1, 0
 v_mbcnt_hi_u32_b32 v249, -1, v249
 v_bfe_u32 v250, v249, 2, 3
 v_mul_u32_u24 v244, 896, v250
 v_lshrrev_b32 v250, 5, v249
 v_lshl_add_u32 v244, v250, 6, v244
 v_xor_b32 v250, s80, v249
 v_and_b32 v250, 3, v250
 v_lshl_add_u32 v244, v250, 4, v244
 s_lshl_b32 s51, s81, 4
 s_add_u32 s51, s51, s80
 s_lshl_b32 s52, s79, 3
 s_add_u32 s51, s51, s52
 s_mul_i32 s51, s51, 7168
 v_add_u32 v244, s51, v244
 v_add_u32 v245, 14336, v244
 v_add_u32 v246, 28672, v244
 v_add_u32 v247, 43008, v244
 s_mul_i32 s52, s50, 215040
 s_waitcnt lgkmcnt(0)
 s_mov_b32 s32, s10
 s_and_b32 s33, s11, 0xffff
 s_mov_b32 s34, 3670016
 s_mov_b32 s35, 0x20000
 s_add_u32 s20, s4, s52
 s_addc_u32 s21, s5, 0
 s_and_b32 s21, s21, 0xffff
 s_mov_b32 s22, 215040
 s_mov_b32 s23, 0x20000
 s_add_u32 s51, s56, 0
 s_add_u32 m0, s59, 0
 s_nop 0
 buffer_load_dwordx4 v253, s[32:35], s51 offen offset:0 lds
 s_add_u32 m0, s59, 8064
 s_nop 0
 buffer_load_dwordx4 v253, s[32:35], s51 offen offset:128 lds
 s_add_u32 s51, s56, 32768
 s_add_u32 m0, s59, 2048
 s_nop 0
 buffer_load_dwordx4 v253, s[32:35], s51 offen offset:0 lds
 s_add_u32 m0, s59, 10112
 s_nop 0
 buffer_load_dwordx4 v253, s[32:35], s51 offen offset:128 lds
 s_add_u32 s51, s56, 262144
 s_add_u32 m0, s59, 4096
 s_nop 0
 buffer_load_dwordx4 v253, s[32:35], s51 offen offset:0 lds
 s_add_u32 m0, s59, 12160
 s_nop 0
 buffer_load_dwordx4 v253, s[32:35], s51 offen offset:128 lds
 s_add_u32 s51, s56, 294912
 s_add_u32 m0, s59, 6144
 s_nop 0
 buffer_load_dwordx4 v253, s[32:35], s51 offen offset:0 lds
 s_add_u32 m0, s59, 14208
 s_nop 0
 buffer_load_dwordx4 v253, s[32:35], s51 offen offset:128 lds
 s_add_u32 m0, s72, 131072
 s_nop 0
 buffer_load_dwordx4 v244, s[20:23], 0 offen offset:0 lds
 s_add_u32 m0, s72, 133120
 s_nop 0
 buffer_load_dwordx4 v245, s[20:23], 0 offen offset:0 lds
 s_add_u32 m0, s72, 135168
 s_nop 0
 buffer_load_dwordx4 v246, s[20:23], 0 offen offset:0 lds
 s_add_u32 m0, s72, 137216
 s_nop 0
 buffer_load_dwordx4 v247, s[20:23], 0 offen offset:0 lds
 s_add_u32 s51, s56, 524288
 s_add_u32 m0, s59, 32768
 s_nop 0
 buffer_load_dwordx4 v253, s[32:35], s51 offen offset:0 lds
 s_add_u32 m0, s59, 40832
 s_nop 0
 buffer_load_dwordx4 v253, s[32:35], s51 offen offset:128 lds
 s_add_u32 s51, s56, 557056
 s_add_u32 m0, s59, 34816
 s_nop 0
 buffer_load_dwordx4 v253, s[32:35], s51 offen offset:0 lds
 s_add_u32 m0, s59, 42880
 s_nop 0
 buffer_load_dwordx4 v253, s[32:35], s51 offen offset:128 lds
 s_add_u32 s51, s56, 786432
 s_add_u32 m0, s59, 36864
 s_nop 0
 buffer_load_dwordx4 v253, s[32:35], s51 offen offset:0 lds
 s_add_u32 m0, s59, 44928
 s_nop 0
 buffer_load_dwordx4 v253, s[32:35], s51 offen offset:128 lds
 s_add_u32 s51, s56, 819200
 s_add_u32 m0, s59, 38912
 s_nop 0
 buffer_load_dwordx4 v253, s[32:35], s51 offen offset:0 lds
 s_add_u32 m0, s59, 46976
 s_nop 0
 buffer_load_dwordx4 v253, s[32:35], s51 offen offset:128 lds
 s_add_u32 m0, s72, 147328
 s_nop 0
 buffer_load_dwordx4 v244, s[20:23], 0 offen offset:128 lds
 s_add_u32 m0, s72, 149376
 s_nop 0
 buffer_load_dwordx4 v245, s[20:23], 0 offen offset:128 lds
 s_add_u32 m0, s72, 151424
 s_nop 0
 buffer_load_dwordx4 v246, s[20:23], 0 offen offset:128 lds
 s_add_u32 m0, s72, 153472
 s_nop 0
 buffer_load_dwordx4 v247, s[20:23], 0 offen offset:128 lds
 s_lshl_b32 s51, s50, 4
 s_add_u32 s51, s51, s49
 s_lshl_b32 s52, s51, 18
 s_add_u32 s24, s6, s52
 s_addc_u32 s25, s7, 0
 s_and_b32 s25, s25, 0xffff
 s_mov_b32 s26, 262144
 s_mov_b32 s27, 0x20000
 s_add_u32 s28, s8, s52
 s_addc_u32 s29, s9, 0
 s_and_b32 s29, s29, 0xffff
 s_mov_b32 s30, 262144
 s_mov_b32 s31, 0x20000
 s_mov_b32 s36, s12
 s_and_b32 s37, s13, 0xffff
 s_mov_b32 s38, 3670016
 s_mov_b32 s39, 0x20000
 s_lshl_b32 s51, s50, 3
 s_add_u32 s51, s51, s61
 s_mul_i32 s52, s51, 229376
 s_add_u32 s40, s18, s52
 s_addc_u32 s41, s19, 0
 s_and_b32 s41, s41, 0xffff
 s_mov_b32 s42, 229376
 s_mov_b32 s43, 0x20000
 s_mov_b32 s62, 0x3db8aa3b
 s_mov_b32 s63, 0x41000000
 s_mov_b32 s68, 0xffff0000
 s_lshl_b32 s51, s81, 2
 s_add_u32 s51, s51, s48
 s_mov_b32 s64, 0xff61b1e6
 s_mov_b32 s73, s64
 s_cmp_eq_u32 s51, 5
 s_cselect_b32 s73, 0x7149f2ca, s73
 s_cmp_eq_u32 s51, 7
 s_cselect_b32 s64, 0x7149f2ca, s64
 s_mov_b32 s60, 14336
 s_cselect_b32 s60, 0x40000000, s60
 s_lshl_b32 s51, s49, 1
 s_add_u32 s51, s51, s80
 s_mul_i32 s82, s51, 114688
 s_add_u32 s83, s82, 14336
 s_add_u32 s84, s82, 28672
 s_add_u32 s85, s82, 43008
 s_add_u32 s86, s82, 57344
 s_add_u32 s87, s82, 71680
 s_add_u32 s88, s82, 86016
 s_add_u32 s89, s82, 100352
 s_lshl_b32 s54, s80, 12
 s_mov_b32 s55, s54
 s_add_u32 s53, s54, 8192
 s_mov_b32 s58, s53
 s_add_u32 s69, s71, s54
 s_lshl_b32 s51, s80, 13
 s_add_u32 s70, s71, s51
 s_lshl_b32 s51, s81, 2
 s_lshl_b32 s52, s80, 1
 s_add_u32 s51, s51, s52
 s_add_u32 s51, s51, s79
 s_mul_i32 s65, s51, 28672
 v_mbcnt_lo_u32_b32 v249, -1, 0
 v_mbcnt_hi_u32_b32 v249, -1, v249
 v_bfe_u32 v250, v249, 3, 1
 v_lshlrev_b32 v254, 10, v250
 v_and_b32 v251, 7, v249
 v_lshl_add_u32 v254, v251, 6, v254
 v_lshrrev_b32 v251, 4, v249
 v_xor_b32 v250, v250, v251
 v_lshl_add_u32 v254, v250, 4, v254
 s_lshl_b32 s51, s80, 13
 s_lshl_b32 s52, s79, 12
 s_add_u32 s51, s51, s52
 s_add_u32 s51, s51, 98304
 v_add_u32 v254, s51, v254
 v_xor_b32 v255, 0x1000, v254
 v_mbcnt_lo_u32_b32 v249, -1, 0
 v_mbcnt_hi_u32_b32 v249, -1, v249
 v_lshrrev_b32 v250, 5, v249
 v_lshlrev_b32 v241, 10, v250
 v_bfe_u32 v250, v249, 2, 3
 v_lshl_add_u32 v241, v250, 6, v241
 v_bfe_u32 v250, v249, 4, 1
 v_lshlrev_b32 v250, 1, v250
 v_bfe_u32 v251, v249, 1, 1
 v_xor_b32 v250, v250, v251
 v_lshl_add_u32 v241, v250, 4, v241
 v_and_b32 v250, 1, v249
 v_lshl_add_u32 v241, v250, 3, v241
 v_add_u32 v241, s71, v241
 v_xor_b32 v242, 32, v241
 s_waitcnt vmcnt(12)
 s_barrier
 ds_read_b64_tr_b16 v[224:225], v241 offset:0
 ds_read_b64_tr_b16 v[226:227], v241 offset:2048
 ds_read_b128 a[0:3], v254 offset:32768
 ds_read_b128 a[4:7], v254 offset:34816
 ds_read_b128 a[8:11], v255 offset:32768
 ds_read_b128 a[12:15], v255 offset:34816
 ds_read_b64_tr_b16 v[228:229], v242 offset:0
 ds_read_b64_tr_b16 v[230:231], v242 offset:2048
 ds_read_b64_tr_b16 v[232:233], v241 offset:512
 ds_read_b64_tr_b16 v[234:235], v241 offset:2560
 ds_read_b64_tr_b16 v[236:237], v242 offset:512
 ds_read_b64_tr_b16 v[238:239], v242 offset:2560
 ds_read_b128 a[16:19], v254 offset:33280
 ds_read_b128 a[20:23], v254 offset:35328
 ds_read_b128 a[24:27], v255 offset:33280
 ds_read_b128 a[28:31], v255 offset:35328
 s_waitcnt lgkmcnt(14)
 s_waitcnt lgkmcnt(10)
 v_mfma_f32_16x16x32_bf16 v[128:131], v[224:227], a[0:3], 0
 s_add_u32 m0, s72, 98048
 v_mfma_f32_16x16x32_bf16 v[132:135], v[224:227], a[4:7], 0
 buffer_load_dwordx4 v244, s[20:23], 0 offen offset:256 lds
 v_mfma_f32_16x16x32_bf16 v[136:139], v[224:227], a[8:11], 0
 s_waitcnt lgkmcnt(8)
 s_add_u32 m0, s72, 100096
 v_mfma_f32_16x16x32_bf16 v[140:143], v[224:227], a[12:15], 0
 ds_read_b64_tr_b16 v[224:225], v241 offset:4096
 ds_read_b64_tr_b16 v[226:227], v241 offset:6144
 v_mfma_f32_16x16x32_bf16 v[144:147], v[228:231], a[0:3], 0
 buffer_load_dwordx4 v245, s[20:23], 0 offen offset:256 lds
 s_add_u32 m0, s72, 102144
 v_mfma_f32_16x16x32_bf16 v[148:151], v[228:231], a[4:7], 0
 buffer_load_dwordx4 v246, s[20:23], 0 offen offset:256 lds
 v_mfma_f32_16x16x32_bf16 v[152:155], v[228:231], a[8:11], 0
 s_waitcnt lgkmcnt(8)
 s_add_u32 m0, s72, 104192
 v_mfma_f32_16x16x32_bf16 v[156:159], v[228:231], a[12:15], 0
 ds_read_b64_tr_b16 v[228:229], v242 offset:4096
 ds_read_b64_tr_b16 v[230:231], v242 offset:6144
 v_mfma_f32_16x16x32_bf16 v[160:163], v[232:235], a[0:3], 0
 buffer_load_dwordx4 v247, s[20:23], 0 offen offset:256 lds
 v_mfma_f32_16x16x32_bf16 v[164:167], v[232:235], a[4:7], 0
 s_add_u32 m0, s72, 114304
 v_mfma_f32_16x16x32_bf16 v[168:171], v[232:235], a[8:11], 0
 s_waitcnt lgkmcnt(2)
 buffer_load_dwordx4 v244, s[20:23], 0 offen offset:384 lds
 v_mfma_f32_16x16x32_bf16 v[172:175], v[232:235], a[12:15], 0
 ds_read_b64_tr_b16 v[232:233], v241 offset:4608
 ds_read_b64_tr_b16 v[234:235], v241 offset:6656
 v_mfma_f32_16x16x32_bf16 v[176:179], v[236:239], a[0:3], 0
 s_add_u32 m0, s72, 116352
 s_nop 0
 buffer_load_dwordx4 v245, s[20:23], 0 offen offset:384 lds
 v_mfma_f32_16x16x32_bf16 v[180:183], v[236:239], a[4:7], 0
 s_add_u32 m0, s72, 118400
 v_mfma_f32_16x16x32_bf16 v[184:187], v[236:239], a[8:11], 0
 buffer_load_dwordx4 v246, s[20:23], 0 offen offset:384 lds
 v_mfma_f32_16x16x32_bf16 v[188:191], v[236:239], a[12:15], 0
 ds_read_b64_tr_b16 v[236:237], v242 offset:4608
 ds_read_b64_tr_b16 v[238:239], v242 offset:6656
 v_mfma_f32_16x16x32_bf16 v[128:131], v[224:227], a[16:19], v[128:131]
 s_add_u32 m0, s72, 120448
 v_mfma_f32_16x16x32_bf16 v[132:135], v[224:227], a[20:23], v[132:135]
 buffer_load_dwordx4 v247, s[20:23], 0 offen offset:384 lds
 v_mfma_f32_16x16x32_bf16 v[136:139], v[224:227], a[24:27], v[136:139]
 s_waitcnt lgkmcnt(2)
 s_add_u32 s51, s56, 1048576
 v_mfma_f32_16x16x32_bf16 v[140:143], v[224:227], a[28:31], v[140:143]
 ds_read_b64_tr_b16 v[224:225], v241 offset:8192
 ds_read_b64_tr_b16 v[226:227], v241 offset:10240
 v_mfma_f32_16x16x32_bf16 v[144:147], v[228:231], a[16:19], v[144:147]
 s_add_u32 m0, s59, 65536
 s_nop 0
 buffer_load_dwordx4 v253, s[32:35], s51 offen offset:0 lds
 v_mfma_f32_16x16x32_bf16 v[148:151], v[228:231], a[20:23], v[148:151]
 s_add_u32 m0, s59, 73600
 v_mfma_f32_16x16x32_bf16 v[152:155], v[228:231], a[24:27], v[152:155]
 buffer_load_dwordx4 v253, s[32:35], s51 offen offset:128 lds
 v_mfma_f32_16x16x32_bf16 v[156:159], v[228:231], a[28:31], v[156:159]
 ds_read_b64_tr_b16 v[228:229], v242 offset:8192
 ds_read_b64_tr_b16 v[230:231], v242 offset:10240
 v_mfma_f32_16x16x32_bf16 v[160:163], v[232:235], a[16:19], v[160:163]
 s_add_u32 s51, s56, 1081344
 v_mfma_f32_16x16x32_bf16 v[164:167], v[232:235], a[20:23], v[164:167]
 s_add_u32 m0, s59, 67584
 v_mfma_f32_16x16x32_bf16 v[168:171], v[232:235], a[24:27], v[168:171]
 s_waitcnt lgkmcnt(2)
 buffer_load_dwordx4 v253, s[32:35], s51 offen offset:0 lds
 v_mfma_f32_16x16x32_bf16 v[172:175], v[232:235], a[28:31], v[172:175]
 ds_read_b64_tr_b16 v[232:233], v241 offset:8704
 ds_read_b64_tr_b16 v[234:235], v241 offset:10752
 v_mfma_f32_16x16x32_bf16 v[176:179], v[236:239], a[16:19], v[176:179]
 s_add_u32 m0, s59, 75648
 s_nop 0
 buffer_load_dwordx4 v253, s[32:35], s51 offen offset:128 lds
 v_mfma_f32_16x16x32_bf16 v[180:183], v[236:239], a[20:23], v[180:183]
 s_add_u32 s51, s56, 1310720
 v_mfma_f32_16x16x32_bf16 v[184:187], v[236:239], a[24:27], v[184:187]
 s_add_u32 m0, s59, 69632
 v_mfma_f32_16x16x32_bf16 v[188:191], v[236:239], a[28:31], v[188:191]
 ds_read_b64_tr_b16 v[236:237], v242 offset:8704
 ds_read_b64_tr_b16 v[238:239], v242 offset:10752
 v_mfma_f32_16x16x32_bf16 v[64:67], v[224:227], a[0:3], 0
 buffer_load_dwordx4 v253, s[32:35], s51 offen offset:0 lds
 v_mfma_f32_16x16x32_bf16 v[68:71], v[224:227], a[4:7], 0
 s_add_u32 m0, s59, 77696
 v_mfma_f32_16x16x32_bf16 v[72:75], v[224:227], a[8:11], 0
 s_waitcnt lgkmcnt(2)
 buffer_load_dwordx4 v253, s[32:35], s51 offen offset:128 lds
 v_mfma_f32_16x16x32_bf16 v[76:79], v[224:227], a[12:15], 0
 ds_read_b64_tr_b16 v[224:225], v241 offset:12288
 ds_read_b64_tr_b16 v[226:227], v241 offset:14336
 v_mfma_f32_16x16x32_bf16 v[80:83], v[228:231], a[0:3], 0
 s_add_u32 s51, s56, 1343488
 s_add_u32 m0, s59, 71680
 v_mfma_f32_16x16x32_bf16 v[84:87], v[228:231], a[4:7], 0
 buffer_load_dwordx4 v253, s[32:35], s51 offen offset:0 lds
 v_mfma_f32_16x16x32_bf16 v[88:91], v[228:231], a[8:11], 0
 s_add_u32 m0, s59, 79744
 v_mfma_f32_16x16x32_bf16 v[92:95], v[228:231], a[12:15], 0
 ds_read_b64_tr_b16 v[228:229], v242 offset:12288
 ds_read_b64_tr_b16 v[230:231], v242 offset:14336
 v_mfma_f32_16x16x32_bf16 v[96:99], v[232:235], a[0:3], 0
 buffer_load_dwordx4 v253, s[32:35], s51 offen offset:128 lds
 v_mfma_f32_16x16x32_bf16 v[100:103], v[232:235], a[4:7], 0
 v_mfma_f32_16x16x32_bf16 v[104:107], v[232:235], a[8:11], 0
 s_waitcnt lgkmcnt(2)
 v_mfma_f32_16x16x32_bf16 v[108:111], v[232:235], a[12:15], 0
 ds_read_b64_tr_b16 v[232:233], v241 offset:12800
 ds_read_b64_tr_b16 v[234:235], v241 offset:14848
 v_mfma_f32_16x16x32_bf16 v[112:115], v[236:239], a[0:3], 0
 v_mfma_f32_16x16x32_bf16 v[116:119], v[236:239], a[4:7], 0
 v_mfma_f32_16x16x32_bf16 v[120:123], v[236:239], a[8:11], 0
 v_mfma_f32_16x16x32_bf16 v[124:127], v[236:239], a[12:15], 0
 ds_read_b64_tr_b16 v[236:237], v242 offset:12800
 ds_read_b64_tr_b16 v[238:239], v242 offset:14848
 v_mfma_f32_16x16x32_bf16 v[64:67], v[224:227], a[16:19], v[64:67]
 v_add_u32 v241, 32768, v241
 v_mfma_f32_16x16x32_bf16 v[68:71], v[224:227], a[20:23], v[68:71]
 v_mfma_f32_16x16x32_bf16 v[72:75], v[224:227], a[24:27], v[72:75]
 s_waitcnt lgkmcnt(2)
 v_mfma_f32_16x16x32_bf16 v[76:79], v[224:227], a[28:31], v[76:79]
 v_add_u32 v242, 32768, v242
 v_mfma_f32_16x16x32_bf16 v[80:83], v[228:231], a[16:19], v[80:83]
 v_mfma_f32_16x16x32_bf16 v[84:87], v[228:231], a[20:23], v[84:87]
 v_mfma_f32_16x16x32_bf16 v[88:91], v[228:231], a[24:27], v[88:91]
 s_waitcnt lgkmcnt(0)
 s_waitcnt vmcnt(16)
 s_barrier
 v_mfma_f32_16x16x32_bf16 v[92:95], v[228:231], a[28:31], v[92:95]
 ds_read_b64_tr_b16 v[224:225], v241 offset:0
 ds_read_b64_tr_b16 v[226:227], v241 offset:2048
 ds_read_b64_tr_b16 v[228:229], v242 offset:0
 ds_read_b64_tr_b16 v[230:231], v242 offset:2048
 v_mfma_f32_16x16x32_bf16 v[96:99], v[232:235], a[16:19], v[96:99]
 ds_read_b128 a[32:35], v254 offset:49152
 ds_read_b128 a[36:39], v254 offset:51200
 v_mfma_f32_16x16x32_bf16 v[100:103], v[232:235], a[20:23], v[100:103]
 ds_read_b128 a[40:43], v255 offset:49152
 v_mfma_f32_16x16x32_bf16 v[104:107], v[232:235], a[24:27], v[104:107]
 ds_read_b128 a[44:47], v255 offset:51200
 v_mfma_f32_16x16x32_bf16 v[108:111], v[232:235], a[28:31], v[108:111]
 ds_read_b64_tr_b16 v[232:233], v241 offset:512
 ds_read_b64_tr_b16 v[234:235], v241 offset:2560
 v_mfma_f32_16x16x32_bf16 v[112:115], v[236:239], a[16:19], v[112:115]
 ds_read_b128 a[48:51], v254 offset:49664
 ds_read_b128 a[52:55], v254 offset:51712
 v_mfma_f32_16x16x32_bf16 v[116:119], v[236:239], a[20:23], v[116:119]
 ds_read_b128 a[56:59], v255 offset:49664
 v_mfma_f32_16x16x32_bf16 v[120:123], v[236:239], a[24:27], v[120:123]
 ds_read_b128 a[60:63], v255 offset:51712
 v_mfma_f32_16x16x32_bf16 v[124:127], v[236:239], a[28:31], v[124:127]
 ds_read_b64_tr_b16 v[236:237], v242 offset:512
 ds_read_b64_tr_b16 v[238:239], v242 offset:2560
 s_waitcnt lgkmcnt(14)
 s_waitcnt lgkmcnt(8)
 v_mfma_f32_16x16x32_bf16 v[128:131], v[224:227], a[32:35], v[128:131]
 v_mfma_f32_16x16x32_bf16 v[132:135], v[224:227], a[36:39], v[132:135]
 s_add_u32 s51, s56, 1572864
 v_mfma_f32_16x16x32_bf16 v[136:139], v[224:227], a[40:43], v[136:139]
 s_add_u32 m0, s59, 0
 v_mfma_f32_16x16x32_bf16 v[140:143], v[224:227], a[44:47], v[140:143]
 ds_read_b64_tr_b16 v[224:225], v241 offset:4096
 ds_read_b64_tr_b16 v[226:227], v241 offset:6144
 v_mfma_f32_16x16x32_bf16 v[144:147], v[228:231], a[32:35], v[144:147]
 buffer_load_dwordx4 v253, s[32:35], s51 offen offset:0 lds
 v_mfma_f32_16x16x32_bf16 v[148:151], v[228:231], a[36:39], v[148:151]
 s_add_u32 m0, s59, 8064
 v_mfma_f32_16x16x32_bf16 v[152:155], v[228:231], a[40:43], v[152:155]
 s_waitcnt lgkmcnt(8)
 v_mfma_f32_16x16x32_bf16 v[156:159], v[228:231], a[44:47], v[156:159]
 ds_read_b64_tr_b16 v[228:229], v242 offset:4096
 ds_read_b64_tr_b16 v[230:231], v242 offset:6144
 v_mfma_f32_16x16x32_bf16 v[160:163], v[232:235], a[32:35], v[160:163]
 buffer_load_dwordx4 v253, s[32:35], s51 offen offset:128 lds
 s_add_u32 s51, s56, 1605632
 v_mfma_f32_16x16x32_bf16 v[164:167], v[232:235], a[36:39], v[164:167]
 v_mfma_f32_16x16x32_bf16 v[168:171], v[232:235], a[40:43], v[168:171]
 s_waitcnt lgkmcnt(2)
 s_add_u32 m0, s59, 2048
 v_mfma_f32_16x16x32_bf16 v[172:175], v[232:235], a[44:47], v[172:175]
 ds_read_b64_tr_b16 v[232:233], v241 offset:4608
 ds_read_b64_tr_b16 v[234:235], v241 offset:6656
 v_mfma_f32_16x16x32_bf16 v[176:179], v[236:239], a[32:35], v[176:179]
 buffer_load_dwordx4 v253, s[32:35], s51 offen offset:0 lds
 v_mfma_f32_16x16x32_bf16 v[180:183], v[236:239], a[36:39], v[180:183]
 s_add_u32 m0, s59, 10112
 v_mfma_f32_16x16x32_bf16 v[184:187], v[236:239], a[40:43], v[184:187]
 buffer_load_dwordx4 v253, s[32:35], s51 offen offset:128 lds
 v_mfma_f32_16x16x32_bf16 v[188:191], v[236:239], a[44:47], v[188:191]
 ds_read_b64_tr_b16 v[236:237], v242 offset:4608
 ds_read_b64_tr_b16 v[238:239], v242 offset:6656
 v_mfma_f32_16x16x32_bf16 v[128:131], v[224:227], a[48:51], v[128:131]
 s_add_u32 s51, s56, 1835008
 v_mfma_f32_16x16x32_bf16 v[132:135], v[224:227], a[52:55], v[132:135]
 s_add_u32 m0, s59, 4096
 v_mfma_f32_16x16x32_bf16 v[136:139], v[224:227], a[56:59], v[136:139]
 s_waitcnt lgkmcnt(2)
 v_mfma_f32_16x16x32_bf16 v[140:143], v[224:227], a[60:63], v[140:143]
 ds_read_b64_tr_b16 v[224:225], v241 offset:8192
 ds_read_b64_tr_b16 v[226:227], v241 offset:10240
 v_mfma_f32_16x16x32_bf16 v[144:147], v[228:231], a[48:51], v[144:147]
 buffer_load_dwordx4 v253, s[32:35], s51 offen offset:0 lds
 s_add_u32 m0, s59, 12160
 v_mfma_f32_16x16x32_bf16 v[148:151], v[228:231], a[52:55], v[148:151]
 v_mfma_f32_16x16x32_bf16 v[152:155], v[228:231], a[56:59], v[152:155]
 buffer_load_dwordx4 v253, s[32:35], s51 offen offset:128 lds
 v_mfma_f32_16x16x32_bf16 v[156:159], v[228:231], a[60:63], v[156:159]
 ds_read_b64_tr_b16 v[228:229], v242 offset:8192
 ds_read_b64_tr_b16 v[230:231], v242 offset:10240
 v_mfma_f32_16x16x32_bf16 v[160:163], v[232:235], a[48:51], v[160:163]
 s_add_u32 s51, s56, 1867776
 v_mfma_f32_16x16x32_bf16 v[164:167], v[232:235], a[52:55], v[164:167]
 s_add_u32 m0, s59, 6144
 v_mfma_f32_16x16x32_bf16 v[168:171], v[232:235], a[56:59], v[168:171]
 s_waitcnt lgkmcnt(2)
 buffer_load_dwordx4 v253, s[32:35], s51 offen offset:0 lds
 v_mfma_f32_16x16x32_bf16 v[172:175], v[232:235], a[60:63], v[172:175]
 ds_read_b64_tr_b16 v[232:233], v241 offset:8704
 ds_read_b64_tr_b16 v[234:235], v241 offset:10752
 v_mfma_f32_16x16x32_bf16 v[176:179], v[236:239], a[48:51], v[176:179]
 s_add_u32 m0, s59, 14208
 v_mfma_f32_16x16x32_bf16 v[180:183], v[236:239], a[52:55], v[180:183]
 buffer_load_dwordx4 v253, s[32:35], s51 offen offset:128 lds
 v_mfma_f32_16x16x32_bf16 v[184:187], v[236:239], a[56:59], v[184:187]
 v_mfma_f32_16x16x32_bf16 v[188:191], v[236:239], a[60:63], v[188:191]
 ds_read_b64_tr_b16 v[236:237], v242 offset:8704
 ds_read_b64_tr_b16 v[238:239], v242 offset:10752
 v_mfma_f32_16x16x32_bf16 v[64:67], v[224:227], a[32:35], v[64:67]
 s_add_u32 m0, s72, 130560
 v_mfma_f32_16x16x32_bf16 v[68:71], v[224:227], a[36:39], v[68:71]
 v_mfma_f32_16x16x32_bf16 v[72:75], v[224:227], a[40:43], v[72:75]
 s_waitcnt lgkmcnt(2)
 buffer_load_dwordx4 v244, s[20:23], 0 offen offset:512 lds
 v_mfma_f32_16x16x32_bf16 v[76:79], v[224:227], a[44:47], v[76:79]
 ds_read_b64_tr_b16 v[224:225], v241 offset:12288
 ds_read_b64_tr_b16 v[226:227], v241 offset:14336
 v_mfma_f32_16x16x32_bf16 v[80:83], v[228:231], a[32:35], v[80:83]
 v_mfma_f32_16x16x32_bf16 v[84:87], v[228:231], a[36:39], v[84:87]
 s_add_u32 m0, s72, 132608
 v_mfma_f32_16x16x32_bf16 v[88:91], v[228:231], a[40:43], v[88:91]
 v_mfma_f32_16x16x32_bf16 v[92:95], v[228:231], a[44:47], v[92:95]
 ds_read_b64_tr_b16 v[228:229], v242 offset:12288
 ds_read_b64_tr_b16 v[230:231], v242 offset:14336
 v_mfma_f32_16x16x32_bf16 v[96:99], v[232:235], a[32:35], v[96:99]
 buffer_load_dwordx4 v245, s[20:23], 0 offen offset:512 lds
 v_mfma_f32_16x16x32_bf16 v[100:103], v[232:235], a[36:39], v[100:103]
 v_mfma_f32_16x16x32_bf16 v[104:107], v[232:235], a[40:43], v[104:107]
 s_waitcnt lgkmcnt(2)
 s_add_u32 m0, s72, 134656
 v_mfma_f32_16x16x32_bf16 v[108:111], v[232:235], a[44:47], v[108:111]
 ds_read_b64_tr_b16 v[232:233], v241 offset:12800
 ds_read_b64_tr_b16 v[234:235], v241 offset:14848
 v_mfma_f32_16x16x32_bf16 v[112:115], v[236:239], a[32:35], v[112:115]
 v_mfma_f32_16x16x32_bf16 v[116:119], v[236:239], a[36:39], v[116:119]
 buffer_load_dwordx4 v246, s[20:23], 0 offen offset:512 lds
 v_mfma_f32_16x16x32_bf16 v[120:123], v[236:239], a[40:43], v[120:123]
 v_mfma_f32_16x16x32_bf16 v[124:127], v[236:239], a[44:47], v[124:127]
 ds_read_b64_tr_b16 v[236:237], v242 offset:12800
 ds_read_b64_tr_b16 v[238:239], v242 offset:14848
 v_mfma_f32_16x16x32_bf16 v[64:67], v[224:227], a[48:51], v[64:67]
 s_add_u32 m0, s72, 136704
 v_add_u32 v241, 32768, v241
 v_mfma_f32_16x16x32_bf16 v[68:71], v[224:227], a[52:55], v[68:71]
 v_mfma_f32_16x16x32_bf16 v[72:75], v[224:227], a[56:59], v[72:75]
 s_waitcnt lgkmcnt(2)
 buffer_load_dwordx4 v247, s[20:23], 0 offen offset:512 lds
 v_mfma_f32_16x16x32_bf16 v[76:79], v[224:227], a[60:63], v[76:79]
 v_add_u32 v242, 32768, v242
 v_mfma_f32_16x16x32_bf16 v[80:83], v[228:231], a[48:51], v[80:83]
 v_mfma_f32_16x16x32_bf16 v[84:87], v[228:231], a[52:55], v[84:87]
 v_mfma_f32_16x16x32_bf16 v[88:91], v[228:231], a[56:59], v[88:91]
 s_waitcnt lgkmcnt(0)
 s_waitcnt vmcnt(12)
 s_barrier
 v_mfma_f32_16x16x32_bf16 v[92:95], v[228:231], a[60:63], v[92:95]
 ds_read_b64_tr_b16 v[224:225], v241 offset:0
 ds_read_b64_tr_b16 v[226:227], v241 offset:2048
 ds_read_b64_tr_b16 v[228:229], v242 offset:0
 ds_read_b64_tr_b16 v[230:231], v242 offset:2048
 v_mfma_f32_16x16x32_bf16 v[96:99], v[232:235], a[48:51], v[96:99]
 ds_read_b128 a[64:67], v254 offset:0
 ds_read_b128 a[68:71], v254 offset:2048
 v_mfma_f32_16x16x32_bf16 v[100:103], v[232:235], a[52:55], v[100:103]
 ds_read_b128 a[72:75], v255 offset:0
 v_mfma_f32_16x16x32_bf16 v[104:107], v[232:235], a[56:59], v[104:107]
 ds_read_b128 a[76:79], v255 offset:2048
 v_mfma_f32_16x16x32_bf16 v[108:111], v[232:235], a[60:63], v[108:111]
 ds_read_b64_tr_b16 v[232:233], v241 offset:512
 ds_read_b64_tr_b16 v[234:235], v241 offset:2560
 v_mfma_f32_16x16x32_bf16 v[112:115], v[236:239], a[48:51], v[112:115]
 ds_read_b128 a[80:83], v254 offset:512
 ds_read_b128 a[84:87], v254 offset:2560
 v_mfma_f32_16x16x32_bf16 v[116:119], v[236:239], a[52:55], v[116:119]
 ds_read_b128 a[88:91], v255 offset:512
 v_mfma_f32_16x16x32_bf16 v[120:123], v[236:239], a[56:59], v[120:123]
 ds_read_b128 a[92:95], v255 offset:2560
 v_mfma_f32_16x16x32_bf16 v[124:127], v[236:239], a[60:63], v[124:127]
 ds_read_b64_tr_b16 v[236:237], v242 offset:512
 ds_read_b64_tr_b16 v[238:239], v242 offset:2560
 s_waitcnt lgkmcnt(14)
 s_waitcnt lgkmcnt(8)
 v_mfma_f32_16x16x32_bf16 v[128:131], v[224:227], a[64:67], v[128:131]
 v_mfma_f32_16x16x32_bf16 v[132:135], v[224:227], a[68:71], v[132:135]
 s_add_u32 s51, s56, 2097152
 v_mfma_f32_16x16x32_bf16 v[136:139], v[224:227], a[72:75], v[136:139]
 ds_read_b128 a[96:99], v254 offset:16384
 v_mfma_f32_16x16x32_bf16 v[140:143], v[224:227], a[76:79], v[140:143]
 ds_read_b64_tr_b16 v[224:225], v241 offset:4096
 ds_read_b64_tr_b16 v[226:227], v241 offset:6144
 v_mfma_f32_16x16x32_bf16 v[144:147], v[228:231], a[64:67], v[144:147]
 s_add_u32 m0, s59, 32768
 s_nop 0
 buffer_load_dwordx4 v253, s[32:35], s51 offen offset:0 lds
 v_mfma_f32_16x16x32_bf16 v[148:151], v[228:231], a[68:71], v[148:151]
 s_add_u32 m0, s59, 40832
 v_mfma_f32_16x16x32_bf16 v[152:155], v[228:231], a[72:75], v[152:155]
 s_waitcnt lgkmcnt(9)
 v_mfma_f32_16x16x32_bf16 v[156:159], v[228:231], a[76:79], v[156:159]
 ds_read_b64_tr_b16 v[228:229], v242 offset:4096
 ds_read_b64_tr_b16 v[230:231], v242 offset:6144
 v_mfma_f32_16x16x32_bf16 v[160:163], v[232:235], a[64:67], v[160:163]
 buffer_load_dwordx4 v253, s[32:35], s51 offen offset:128 lds
 ds_read_b128 a[100:103], v254 offset:18432
 v_mfma_f32_16x16x32_bf16 v[164:167], v[232:235], a[68:71], v[164:167]
 s_add_u32 s51, s56, 2129920
 v_mfma_f32_16x16x32_bf16 v[168:171], v[232:235], a[72:75], v[168:171]
 s_waitcnt lgkmcnt(3)
 s_add_u32 m0, s59, 34816
 v_mfma_f32_16x16x32_bf16 v[172:175], v[232:235], a[76:79], v[172:175]
 ds_read_b64_tr_b16 v[232:233], v241 offset:4608
 ds_read_b64_tr_b16 v[234:235], v241 offset:6656
 v_mfma_f32_16x16x32_bf16 v[176:179], v[236:239], a[64:67], v[176:179]
 buffer_load_dwordx4 v253, s[32:35], s51 offen offset:0 lds
 ds_read_b128 a[104:107], v255 offset:16384
 v_mfma_f32_16x16x32_bf16 v[180:183], v[236:239], a[68:71], v[180:183]
 s_add_u32 m0, s59, 42880
 v_mfma_f32_16x16x32_bf16 v[184:187], v[236:239], a[72:75], v[184:187]
 buffer_load_dwordx4 v253, s[32:35], s51 offen offset:128 lds
 v_mfma_f32_16x16x32_bf16 v[188:191], v[236:239], a[76:79], v[188:191]
 ds_read_b64_tr_b16 v[236:237], v242 offset:4608
 ds_read_b64_tr_b16 v[238:239], v242 offset:6656
 v_mfma_f32_16x16x32_bf16 v[128:131], v[224:227], a[80:83], v[128:131]
 s_add_u32 s51, s56, 2359296
 v_mfma_f32_16x16x32_bf16 v[132:135], v[224:227], a[84:87], v[132:135]
 s_add_u32 m0, s59, 36864
 v_mfma_f32_16x16x32_bf16 v[136:139], v[224:227], a[88:91], v[136:139]
 s_waitcnt lgkmcnt(3)
 ds_read_b128 a[108:111], v255 offset:18432
 v_mfma_f32_16x16x32_bf16 v[140:143], v[224:227], a[92:95], v[140:143]
 ds_read_b64_tr_b16 v[224:225], v241 offset:8192
 ds_read_b64_tr_b16 v[226:227], v241 offset:10240
 v_mfma_f32_16x16x32_bf16 v[144:147], v[228:231], a[80:83], v[144:147]
 buffer_load_dwordx4 v253, s[32:35], s51 offen offset:0 lds
 s_add_u32 m0, s59, 44928
 v_mfma_f32_16x16x32_bf16 v[148:151], v[228:231], a[84:87], v[148:151]
 v_mfma_f32_16x16x32_bf16 v[152:155], v[228:231], a[88:91], v[152:155]
 buffer_load_dwordx4 v253, s[32:35], s51 offen offset:128 lds
 v_mfma_f32_16x16x32_bf16 v[156:159], v[228:231], a[92:95], v[156:159]
 ds_read_b64_tr_b16 v[228:229], v242 offset:8192
 ds_read_b64_tr_b16 v[230:231], v242 offset:10240
 v_mfma_f32_16x16x32_bf16 v[160:163], v[232:235], a[80:83], v[160:163]
 ds_read_b128 a[112:115], v254 offset:16896
 s_add_u32 s51, s56, 2392064
 v_mfma_f32_16x16x32_bf16 v[164:167], v[232:235], a[84:87], v[164:167]
 s_add_u32 m0, s59, 38912
 v_mfma_f32_16x16x32_bf16 v[168:171], v[232:235], a[88:91], v[168:171]
 s_waitcnt lgkmcnt(3)
 buffer_load_dwordx4 v253, s[32:35], s51 offen offset:0 lds
 v_mfma_f32_16x16x32_bf16 v[172:175], v[232:235], a[92:95], v[172:175]
 ds_read_b64_tr_b16 v[232:233], v241 offset:8704
 ds_read_b64_tr_b16 v[234:235], v241 offset:10752
 v_mfma_f32_16x16x32_bf16 v[176:179], v[236:239], a[80:83], v[176:179]
 s_add_u32 m0, s59, 46976
 ds_read_b128 a[116:119], v254 offset:18944
 v_mfma_f32_16x16x32_bf16 v[180:183], v[236:239], a[84:87], v[180:183]
 buffer_load_dwordx4 v253, s[32:35], s51 offen offset:128 lds
 v_mfma_f32_16x16x32_bf16 v[184:187], v[236:239], a[88:91], v[184:187]
 v_mfma_f32_16x16x32_bf16 v[188:191], v[236:239], a[92:95], v[188:191]
 ds_read_b64_tr_b16 v[236:237], v242 offset:8704
 ds_read_b64_tr_b16 v[238:239], v242 offset:10752
 v_mfma_f32_16x16x32_bf16 v[64:67], v[224:227], a[64:67], v[64:67]
 s_add_u32 m0, s72, 146816
 v_mfma_f32_16x16x32_bf16 v[68:71], v[224:227], a[68:71], v[68:71]
 v_mfma_f32_16x16x32_bf16 v[72:75], v[224:227], a[72:75], v[72:75]
 s_waitcnt lgkmcnt(3)
 ds_read_b128 a[120:123], v255 offset:16896
 v_mfma_f32_16x16x32_bf16 v[76:79], v[224:227], a[76:79], v[76:79]
 ds_read_b64_tr_b16 v[224:225], v241 offset:12288
 ds_read_b64_tr_b16 v[226:227], v241 offset:14336
 v_mfma_f32_16x16x32_bf16 v[80:83], v[228:231], a[64:67], v[80:83]
 buffer_load_dwordx4 v244, s[20:23], 0 offen offset:640 lds
 v_mfma_f32_16x16x32_bf16 v[84:87], v[228:231], a[68:71], v[84:87]
 s_add_u32 m0, s72, 148864
 v_mfma_f32_16x16x32_bf16 v[88:91], v[228:231], a[72:75], v[88:91]
 v_mfma_f32_16x16x32_bf16 v[92:95], v[228:231], a[76:79], v[92:95]
 ds_read_b64_tr_b16 v[228:229], v242 offset:12288
 ds_read_b64_tr_b16 v[230:231], v242 offset:14336
 v_mfma_f32_16x16x32_bf16 v[96:99], v[232:235], a[64:67], v[96:99]
 ds_read_b128 a[124:127], v255 offset:18944
 buffer_load_dwordx4 v245, s[20:23], 0 offen offset:640 lds
 v_mfma_f32_16x16x32_bf16 v[100:103], v[232:235], a[68:71], v[100:103]
 v_mfma_f32_16x16x32_bf16 v[104:107], v[232:235], a[72:75], v[104:107]
 s_waitcnt lgkmcnt(3)
 s_add_u32 m0, s72, 150912
 v_mfma_f32_16x16x32_bf16 v[108:111], v[232:235], a[76:79], v[108:111]
 ds_read_b64_tr_b16 v[232:233], v241 offset:12800
 ds_read_b64_tr_b16 v[234:235], v241 offset:14848
 v_mfma_f32_16x16x32_bf16 v[112:115], v[236:239], a[64:67], v[112:115]
 v_mfma_f32_16x16x32_bf16 v[116:119], v[236:239], a[68:71], v[116:119]
 buffer_load_dwordx4 v246, s[20:23], 0 offen offset:640 lds
 v_mfma_f32_16x16x32_bf16 v[120:123], v[236:239], a[72:75], v[120:123]
 v_mfma_f32_16x16x32_bf16 v[124:127], v[236:239], a[76:79], v[124:127]
 ds_read_b64_tr_b16 v[236:237], v242 offset:12800
 ds_read_b64_tr_b16 v[238:239], v242 offset:14848
 v_mfma_f32_16x16x32_bf16 v[64:67], v[224:227], a[80:83], v[64:67]
 s_add_u32 m0, s72, 152960
 v_subrev_u32 v241, 65536, v241
 v_mfma_f32_16x16x32_bf16 v[68:71], v[224:227], a[84:87], v[68:71]
 v_mfma_f32_16x16x32_bf16 v[72:75], v[224:227], a[88:91], v[72:75]
 s_waitcnt lgkmcnt(2)
 buffer_load_dwordx4 v247, s[20:23], 0 offen offset:640 lds
 v_mfma_f32_16x16x32_bf16 v[76:79], v[224:227], a[92:95], v[76:79]
 v_subrev_u32 v242, 65536, v242
 v_mfma_f32_16x16x32_bf16 v[80:83], v[228:231], a[80:83], v[80:83]
 v_mfma_f32_16x16x32_bf16 v[84:87], v[228:231], a[84:87], v[84:87]
 v_mfma_f32_16x16x32_bf16 v[88:91], v[228:231], a[88:91], v[88:91]
 s_waitcnt lgkmcnt(0)
 s_waitcnt vmcnt(12)
 s_barrier
 v_mfma_f32_16x16x32_bf16 v[92:95], v[228:231], a[92:95], v[92:95]
 ds_read_b64_tr_b16 v[224:225], v241 offset:0
 ds_read_b64_tr_b16 v[226:227], v241 offset:2048
 ds_read_b64_tr_b16 v[228:229], v242 offset:0
 ds_read_b64_tr_b16 v[230:231], v242 offset:2048
 v_mfma_f32_16x16x32_bf16 v[96:99], v[232:235], a[80:83], v[96:99]
 v_mfma_f32_16x16x32_bf16 v[100:103], v[232:235], a[84:87], v[100:103]
 v_mfma_f32_16x16x32_bf16 v[104:107], v[232:235], a[88:91], v[104:107]
 v_mfma_f32_16x16x32_bf16 v[108:111], v[232:235], a[92:95], v[108:111]
 ds_read_b64_tr_b16 v[232:233], v241 offset:512
 ds_read_b64_tr_b16 v[234:235], v241 offset:2560
 v_mfma_f32_16x16x32_bf16 v[112:115], v[236:239], a[80:83], v[112:115]
 v_mfma_f32_16x16x32_bf16 v[116:119], v[236:239], a[84:87], v[116:119]
 v_mfma_f32_16x16x32_bf16 v[120:123], v[236:239], a[88:91], v[120:123]
 v_mfma_f32_16x16x32_bf16 v[124:127], v[236:239], a[92:95], v[124:127]
 ds_read_b64_tr_b16 v[236:237], v242 offset:512
 ds_read_b64_tr_b16 v[238:239], v242 offset:2560
 s_waitcnt lgkmcnt(6)
 v_mfma_f32_16x16x32_bf16 v[128:131], v[224:227], a[96:99], v[128:131]
 v_mfma_f32_16x16x32_bf16 v[132:135], v[224:227], a[100:103], v[132:135]
 s_add_u32 s51, s56, 2621440
 v_mfma_f32_16x16x32_bf16 v[136:139], v[224:227], a[104:107], v[136:139]
 s_waitcnt lgkmcnt(4)
 ds_read_b128 a[128:131], v254 offset:32768
 v_mfma_f32_16x16x32_bf16 v[140:143], v[224:227], a[108:111], v[140:143]
 ds_read_b64_tr_b16 v[224:225], v241 offset:4096
 ds_read_b64_tr_b16 v[226:227], v241 offset:6144
 v_mfma_f32_16x16x32_bf16 v[144:147], v[228:231], a[96:99], v[144:147]
 s_add_u32 m0, s59, 65536
 s_nop 0
 buffer_load_dwordx4 v253, s[32:35], s51 offen offset:0 lds
 v_mfma_f32_16x16x32_bf16 v[148:151], v[228:231], a[100:103], v[148:151]
 s_add_u32 m0, s59, 73600
 v_mfma_f32_16x16x32_bf16 v[152:155], v[228:231], a[104:107], v[152:155]
 s_waitcnt lgkmcnt(5)
 buffer_load_dwordx4 v253, s[32:35], s51 offen offset:128 lds
 v_mfma_f32_16x16x32_bf16 v[156:159], v[228:231], a[108:111], v[156:159]
 ds_read_b64_tr_b16 v[228:229], v242 offset:4096
 ds_read_b64_tr_b16 v[230:231], v242 offset:6144
 v_mfma_f32_16x16x32_bf16 v[160:163], v[232:235], a[96:99], v[160:163]
 s_add_u32 s51, s56, 2654208
 ds_read_b128 a[132:135], v254 offset:34816
 v_mfma_f32_16x16x32_bf16 v[164:167], v[232:235], a[100:103], v[164:167]
 s_add_u32 m0, s59, 67584
 s_nop 0
 buffer_load_dwordx4 v253, s[32:35], s51 offen offset:0 lds
 v_mfma_f32_16x16x32_bf16 v[168:171], v[232:235], a[104:107], v[168:171]
 s_waitcnt lgkmcnt(3)
 v_mfma_f32_16x16x32_bf16 v[172:175], v[232:235], a[108:111], v[172:175]
 ds_read_b64_tr_b16 v[232:233], v241 offset:4608
 ds_read_b64_tr_b16 v[234:235], v241 offset:6656
 v_mfma_f32_16x16x32_bf16 v[176:179], v[236:239], a[96:99], v[176:179]
 s_add_u32 m0, s59, 75648
 s_nop 0
 buffer_load_dwordx4 v253, s[32:35], s51 offen offset:128 lds
 v_mfma_f32_16x16x32_bf16 v[180:183], v[236:239], a[100:103], v[180:183]
 ds_read_b128 a[136:139], v255 offset:32768
 s_add_u32 s51, s56, 2883584
 v_mfma_f32_16x16x32_bf16 v[184:187], v[236:239], a[104:107], v[184:187]
 s_add_u32 m0, s59, 69632
 v_mfma_f32_16x16x32_bf16 v[188:191], v[236:239], a[108:111], v[188:191]
 ds_read_b64_tr_b16 v[236:237], v242 offset:4608
 ds_read_b64_tr_b16 v[238:239], v242 offset:6656
 v_mfma_f32_16x16x32_bf16 v[128:131], v[224:227], a[112:115], v[128:131]
 buffer_load_dwordx4 v253, s[32:35], s51 offen offset:0 lds
 v_mfma_f32_16x16x32_bf16 v[132:135], v[224:227], a[116:119], v[132:135]
 s_add_u32 m0, s59, 77696
 v_mfma_f32_16x16x32_bf16 v[136:139], v[224:227], a[120:123], v[136:139]
 s_waitcnt lgkmcnt(3)
 ds_read_b128 a[140:143], v255 offset:34816
 v_mfma_f32_16x16x32_bf16 v[140:143], v[224:227], a[124:127], v[140:143]
 ds_read_b64_tr_b16 v[224:225], v241 offset:8192
 ds_read_b64_tr_b16 v[226:227], v241 offset:10240
 v_mfma_f32_16x16x32_bf16 v[144:147], v[228:231], a[112:115], v[144:147]
 buffer_load_dwordx4 v253, s[32:35], s51 offen offset:128 lds
 s_add_u32 s51, s56, 2916352
 v_mfma_f32_16x16x32_bf16 v[148:151], v[228:231], a[116:119], v[148:151]
 s_add_u32 m0, s59, 71680
 v_mfma_f32_16x16x32_bf16 v[152:155], v[228:231], a[120:123], v[152:155]
 buffer_load_dwordx4 v253, s[32:35], s51 offen offset:0 lds
 v_mfma_f32_16x16x32_bf16 v[156:159], v[228:231], a[124:127], v[156:159]
 ds_read_b64_tr_b16 v[228:229], v242 offset:8192
 ds_read_b64_tr_b16 v[230:231], v242 offset:10240
 v_mfma_f32_16x16x32_bf16 v[160:163], v[232:235], a[112:115], v[160:163]
 ds_read_b128 a[144:147], v254 offset:33280
 s_add_u32 m0, s59, 79744
 v_mfma_f32_16x16x32_bf16 v[164:167], v[232:235], a[116:119], v[164:167]
 buffer_load_dwordx4 v253, s[32:35], s51 offen offset:128 lds
 v_mfma_f32_16x16x32_bf16 v[168:171], v[232:235], a[120:123], v[168:171]
 s_waitcnt lgkmcnt(3)
 s_add_u32 s51, s56, 3145728
 v_mfma_f32_16x16x32_bf16 v[172:175], v[232:235], a[124:127], v[172:175]
 ds_read_b64_tr_b16 v[232:233], v241 offset:8704
 ds_read_b64_tr_b16 v[234:235], v241 offset:10752
 v_mfma_f32_16x16x32_bf16 v[176:179], v[236:239], a[112:115], v[176:179]
 s_add_u32 m0, s59, 98304
 s_nop 0
 buffer_load_dwordx4 v253, s[32:35], s51 offen offset:0 lds
 v_mfma_f32_16x16x32_bf16 v[180:183], v[236:239], a[116:119], v[180:183]
 ds_read_b128 a[148:151], v254 offset:35328
 s_add_u32 m0, s59, 106368
 v_mfma_f32_16x16x32_bf16 v[184:187], v[236:239], a[120:123], v[184:187]
 v_mfma_f32_16x16x32_bf16 v[188:191], v[236:239], a[124:127], v[188:191]
 ds_read_b64_tr_b16 v[236:237], v242 offset:8704
 ds_read_b64_tr_b16 v[238:239], v242 offset:10752
 v_mfma_f32_16x16x32_bf16 v[64:67], v[224:227], a[96:99], v[64:67]
 buffer_load_dwordx4 v253, s[32:35], s51 offen offset:128 lds
 s_add_u32 s51, s56, 3178496
 v_mfma_f32_16x16x32_bf16 v[68:71], v[224:227], a[100:103], v[68:71]
 s_add_u32 m0, s59, 100352
 v_mfma_f32_16x16x32_bf16 v[72:75], v[224:227], a[104:107], v[72:75]
 s_waitcnt lgkmcnt(3)
 ds_read_b128 a[152:155], v255 offset:33280
 v_mfma_f32_16x16x32_bf16 v[76:79], v[224:227], a[108:111], v[76:79]
 ds_read_b64_tr_b16 v[224:225], v241 offset:12288
 ds_read_b64_tr_b16 v[226:227], v241 offset:14336
 v_mfma_f32_16x16x32_bf16 v[80:83], v[228:231], a[96:99], v[80:83]
 buffer_load_dwordx4 v253, s[32:35], s51 offen offset:0 lds
 s_add_u32 m0, s59, 108416
 v_mfma_f32_16x16x32_bf16 v[84:87], v[228:231], a[100:103], v[84:87]
 buffer_load_dwordx4 v253, s[32:35], s51 offen offset:128 lds
 v_mfma_f32_16x16x32_bf16 v[88:91], v[228:231], a[104:107], v[88:91]
 s_add_u32 s51, s56, 3407872
 v_mfma_f32_16x16x32_bf16 v[92:95], v[228:231], a[108:111], v[92:95]
 ds_read_b64_tr_b16 v[228:229], v242 offset:12288
 ds_read_b64_tr_b16 v[230:231], v242 offset:14336
 v_mfma_f32_16x16x32_bf16 v[96:99], v[232:235], a[96:99], v[96:99]
 ds_read_b128 a[156:159], v255 offset:35328
 s_add_u32 m0, s59, 102400
 v_mfma_f32_16x16x32_bf16 v[100:103], v[232:235], a[100:103], v[100:103]
 buffer_load_dwordx4 v253, s[32:35], s51 offen offset:0 lds
 v_mfma_f32_16x16x32_bf16 v[104:107], v[232:235], a[104:107], v[104:107]
 s_waitcnt lgkmcnt(3)
 s_add_u32 m0, s59, 110464
 v_mfma_f32_16x16x32_bf16 v[108:111], v[232:235], a[108:111], v[108:111]
 ds_read_b64_tr_b16 v[232:233], v241 offset:12800
 ds_read_b64_tr_b16 v[234:235], v241 offset:14848
 v_mfma_f32_16x16x32_bf16 v[112:115], v[236:239], a[96:99], v[112:115]
 buffer_load_dwordx4 v253, s[32:35], s51 offen offset:128 lds
 s_add_u32 s51, s56, 3440640
 v_mfma_f32_16x16x32_bf16 v[116:119], v[236:239], a[100:103], v[116:119]
 v_mfma_f32_16x16x32_bf16 v[120:123], v[236:239], a[104:107], v[120:123]
 s_add_u32 m0, s59, 104448
 v_mfma_f32_16x16x32_bf16 v[124:127], v[236:239], a[108:111], v[124:127]
 ds_read_b64_tr_b16 v[236:237], v242 offset:12800
 ds_read_b64_tr_b16 v[238:239], v242 offset:14848
 v_mfma_f32_16x16x32_bf16 v[64:67], v[224:227], a[112:115], v[64:67]
 buffer_load_dwordx4 v253, s[32:35], s51 offen offset:0 lds
 v_add_u32 v241, 32768, v241
 v_mfma_f32_16x16x32_bf16 v[68:71], v[224:227], a[116:119], v[68:71]
 s_add_u32 m0, s59, 112512
 s_nop 0
 buffer_load_dwordx4 v253, s[32:35], s51 offen offset:128 lds
 v_mfma_f32_16x16x32_bf16 v[72:75], v[224:227], a[120:123], v[72:75]
 s_waitcnt lgkmcnt(2)
 v_mfma_f32_16x16x32_bf16 v[76:79], v[224:227], a[124:127], v[76:79]
 v_add_u32 v242, 32768, v242
 v_mfma_f32_16x16x32_bf16 v[80:83], v[228:231], a[112:115], v[80:83]
 v_mfma_f32_16x16x32_bf16 v[84:87], v[228:231], a[116:119], v[84:87]
 v_mfma_f32_16x16x32_bf16 v[88:91], v[228:231], a[120:123], v[88:91]
 s_waitcnt lgkmcnt(0)
 s_waitcnt vmcnt(16)
 s_barrier
 v_mfma_f32_16x16x32_bf16 v[92:95], v[228:231], a[124:127], v[92:95]
 ds_read_b64_tr_b16 v[224:225], v241 offset:0
 ds_read_b64_tr_b16 v[226:227], v241 offset:2048
 ds_read_b64_tr_b16 v[228:229], v242 offset:0
 ds_read_b64_tr_b16 v[230:231], v242 offset:2048
 v_mfma_f32_16x16x32_bf16 v[96:99], v[232:235], a[112:115], v[96:99]
 v_mfma_f32_16x16x32_bf16 v[100:103], v[232:235], a[116:119], v[100:103]
 v_mfma_f32_16x16x32_bf16 v[104:107], v[232:235], a[120:123], v[104:107]
 v_mfma_f32_16x16x32_bf16 v[108:111], v[232:235], a[124:127], v[108:111]
 ds_read_b64_tr_b16 v[232:233], v241 offset:512
 ds_read_b64_tr_b16 v[234:235], v241 offset:2560
 v_mfma_f32_16x16x32_bf16 v[112:115], v[236:239], a[112:115], v[112:115]
 v_mfma_f32_16x16x32_bf16 v[116:119], v[236:239], a[116:119], v[116:119]
 v_mfma_f32_16x16x32_bf16 v[120:123], v[236:239], a[120:123], v[120:123]
 v_mfma_f32_16x16x32_bf16 v[124:127], v[236:239], a[124:127], v[124:127]
 ds_read_b64_tr_b16 v[236:237], v242 offset:512
 ds_read_b64_tr_b16 v[238:239], v242 offset:2560
 s_waitcnt lgkmcnt(6)
 v_mfma_f32_16x16x32_bf16 v[128:131], v[224:227], a[128:131], v[128:131]
 v_mfma_f32_16x16x32_bf16 v[132:135], v[224:227], a[132:135], v[132:135]
 v_mfma_f32_16x16x32_bf16 v[136:139], v[224:227], a[136:139], v[136:139]
 s_waitcnt lgkmcnt(4)
 ds_read_b128 a[160:163], v254 offset:49152
 v_mfma_f32_16x16x32_bf16 v[140:143], v[224:227], a[140:143], v[140:143]
 ds_read_b64_tr_b16 v[224:225], v241 offset:4096
 ds_read_b64_tr_b16 v[226:227], v241 offset:6144
 v_mfma_f32_16x16x32_bf16 v[144:147], v[228:231], a[128:131], v[144:147]
 s_add_u32 m0, s72, 130304
 s_nop 0
 buffer_load_dwordx4 v244, s[20:23], 0 offen offset:768 lds
 v_mfma_f32_16x16x32_bf16 v[148:151], v[228:231], a[132:135], v[148:151]
 v_mbcnt_lo_u32_b32 v249, -1, 0
 s_add_u32 m0, s72, 132352
 v_mfma_f32_16x16x32_bf16 v[152:155], v[228:231], a[136:139], v[152:155]
 s_waitcnt lgkmcnt(5)
 buffer_load_dwordx4 v245, s[20:23], 0 offen offset:768 lds
 v_mfma_f32_16x16x32_bf16 v[156:159], v[228:231], a[140:143], v[156:159]
 ds_read_b64_tr_b16 v[228:229], v242 offset:4096
 ds_read_b64_tr_b16 v[230:231], v242 offset:6144
 v_mfma_f32_16x16x32_bf16 v[160:163], v[232:235], a[128:131], v[160:163]
 ds_read_b128 a[164:167], v254 offset:51200
 s_add_u32 m0, s72, 134400
 v_mfma_f32_16x16x32_bf16 v[164:167], v[232:235], a[132:135], v[164:167]
 v_mfma_f32_16x16x32_bf16 v[168:171], v[232:235], a[136:139], v[168:171]
 s_waitcnt lgkmcnt(3)
 buffer_load_dwordx4 v246, s[20:23], 0 offen offset:768 lds
 v_mfma_f32_16x16x32_bf16 v[172:175], v[232:235], a[140:143], v[172:175]
 ds_read_b64_tr_b16 v[232:233], v241 offset:4608
 ds_read_b64_tr_b16 v[234:235], v241 offset:6656
 v_mfma_f32_16x16x32_bf16 v[176:179], v[236:239], a[128:131], v[176:179]
 v_mbcnt_hi_u32_b32 v249, -1, v249
 s_add_u32 m0, s72, 136448
 v_mfma_f32_16x16x32_bf16 v[180:183], v[236:239], a[132:135], v[180:183]
 ds_read_b128 a[168:171], v255 offset:49152
 buffer_load_dwordx4 v247, s[20:23], 0 offen offset:768 lds
 v_mfma_f32_16x16x32_bf16 v[184:187], v[236:239], a[136:139], v[184:187]
 v_mfma_f32_16x16x32_bf16 v[188:191], v[236:239], a[140:143], v[188:191]
 ds_read_b64_tr_b16 v[236:237], v242 offset:4608
 ds_read_b64_tr_b16 v[238:239], v242 offset:6656
 v_mfma_f32_16x16x32_bf16 v[128:131], v[224:227], a[144:147], v[128:131]
 s_add_u32 s51, s56, 256
 v_bfe_u32 v250, v249, 2, 3
 v_mfma_f32_16x16x32_bf16 v[132:135], v[224:227], a[148:151], v[132:135]
 s_add_u32 m0, s59, 0
 v_mfma_f32_16x16x32_bf16 v[136:139], v[224:227], a[152:155], v[136:139]
 s_waitcnt lgkmcnt(3)
 ds_read_b128 a[172:175], v255 offset:51200
 v_mfma_f32_16x16x32_bf16 v[140:143], v[224:227], a[156:159], v[140:143]
 ds_read_b64_tr_b16 v[224:225], v241 offset:8192
 ds_read_b64_tr_b16 v[226:227], v241 offset:10240
 v_mfma_f32_16x16x32_bf16 v[144:147], v[228:231], a[144:147], v[144:147]
 buffer_load_dwordx4 v253, s[32:35], s51 offen offset:0 lds
 s_add_u32 s51, s56, 524288
 v_mfma_f32_16x16x32_bf16 v[148:151], v[228:231], a[148:151], v[148:151]
 s_add_u32 m0, s59, 7936
 v_mfma_f32_16x16x32_bf16 v[152:155], v[228:231], a[152:155], v[152:155]
 v_mfma_f32_16x16x32_bf16 v[156:159], v[228:231], a[156:159], v[156:159]
 ds_read_b64_tr_b16 v[228:229], v242 offset:8192
 ds_read_b64_tr_b16 v[230:231], v242 offset:10240
 v_mfma_f32_16x16x32_bf16 v[160:163], v[232:235], a[144:147], v[160:163]
 v_lshlrev_b32 v243, 9, v250
 buffer_load_dwordx4 v253, s[32:35], s51 offen offset:256 lds
 v_mfma_f32_16x16x32_bf16 v[164:167], v[232:235], a[148:151], v[164:167]
 ds_read_b128 a[176:179], v254 offset:49664
 s_add_u32 s51, s56, 32768
 v_mfma_f32_16x16x32_bf16 v[168:171], v[232:235], a[152:155], v[168:171]
 s_waitcnt lgkmcnt(3)
 s_add_u32 m0, s59, 1792
 v_mfma_f32_16x16x32_bf16 v[172:175], v[232:235], a[156:159], v[172:175]
 ds_read_b64_tr_b16 v[232:233], v241 offset:8704
 ds_read_b64_tr_b16 v[234:235], v241 offset:10752
 v_mfma_f32_16x16x32_bf16 v[176:179], v[236:239], a[144:147], v[176:179]
 buffer_load_dwordx4 v253, s[32:35], s51 offen offset:256 lds
 ds_read_b128 a[180:183], v254 offset:51712
 v_mfma_f32_16x16x32_bf16 v[180:183], v[236:239], a[148:151], v[180:183]
 s_add_u32 s51, s56, 557056
 v_lshrrev_b32 v250, 5, v249
 v_mfma_f32_16x16x32_bf16 v[184:187], v[236:239], a[152:155], v[184:187]
 s_add_u32 m0, s59, 9984
 v_mfma_f32_16x16x32_bf16 v[188:191], v[236:239], a[156:159], v[188:191]
 ds_read_b64_tr_b16 v[236:237], v242 offset:8704
 ds_read_b64_tr_b16 v[238:239], v242 offset:10752
 v_mfma_f32_16x16x32_bf16 v[64:67], v[224:227], a[128:131], v[64:67]
 buffer_load_dwordx4 v253, s[32:35], s51 offen offset:256 lds
 v_mfma_f32_16x16x32_bf16 v[68:71], v[224:227], a[132:135], v[68:71]
 s_add_u32 s51, s56, 262144
 v_mfma_f32_16x16x32_bf16 v[72:75], v[224:227], a[136:139], v[72:75]
 s_waitcnt lgkmcnt(3)
 ds_read_b128 a[184:187], v255 offset:49664
 v_mfma_f32_16x16x32_bf16 v[76:79], v[224:227], a[140:143], v[76:79]
 ds_read_b64_tr_b16 v[224:225], v241 offset:12288
 ds_read_b64_tr_b16 v[226:227], v241 offset:14336
 v_mfma_f32_16x16x32_bf16 v[80:83], v[228:231], a[128:131], v[80:83]
 s_add_u32 m0, s59, 3840
 v_lshl_add_u32 v243, v250, 6, v243
 v_mfma_f32_16x16x32_bf16 v[84:87], v[228:231], a[132:135], v[84:87]
 buffer_load_dwordx4 v253, s[32:35], s51 offen offset:256 lds
 s_add_u32 s51, s56, 786432
 v_mfma_f32_16x16x32_bf16 v[88:91], v[228:231], a[136:139], v[88:91]
 v_mfma_f32_16x16x32_bf16 v[92:95], v[228:231], a[140:143], v[92:95]
 ds_read_b64_tr_b16 v[228:229], v242 offset:12288
 ds_read_b64_tr_b16 v[230:231], v242 offset:14336
 v_mfma_f32_16x16x32_bf16 v[96:99], v[232:235], a[128:131], v[96:99]
 s_add_u32 m0, s59, 12032
 ds_read_b128 a[188:191], v255 offset:51712
 v_mfma_f32_16x16x32_bf16 v[100:103], v[232:235], a[132:135], v[100:103]
 buffer_load_dwordx4 v253, s[32:35], s51 offen offset:256 lds
 v_mfma_f32_16x16x32_bf16 v[104:107], v[232:235], a[136:139], v[104:107]
 s_waitcnt lgkmcnt(3)
 v_xor_b32 v250, s80, v249
 v_mfma_f32_16x16x32_bf16 v[108:111], v[232:235], a[140:143], v[108:111]
 ds_read_b64_tr_b16 v[232:233], v241 offset:12800
 ds_read_b64_tr_b16 v[234:235], v241 offset:14848
 v_mfma_f32_16x16x32_bf16 v[112:115], v[236:239], a[128:131], v[112:115]
 s_add_u32 s51, s56, 294912
 s_add_u32 m0, s59, 5888
 v_mfma_f32_16x16x32_bf16 v[116:119], v[236:239], a[132:135], v[116:119]
 buffer_load_dwordx4 v253, s[32:35], s51 offen offset:256 lds
 v_mfma_f32_16x16x32_bf16 v[120:123], v[236:239], a[136:139], v[120:123]
 s_add_u32 s51, s56, 819200
 v_mfma_f32_16x16x32_bf16 v[124:127], v[236:239], a[140:143], v[124:127]
 ds_read_b64_tr_b16 v[236:237], v242 offset:12800
 ds_read_b64_tr_b16 v[238:239], v242 offset:14848
 v_mfma_f32_16x16x32_bf16 v[64:67], v[224:227], a[144:147], v[64:67]
 v_add_u32 v241, 32768, v241
 s_add_u32 m0, s59, 14080
 v_mfma_f32_16x16x32_bf16 v[68:71], v[224:227], a[148:151], v[68:71]
 v_and_b32 v250, 3, v250
 buffer_load_dwordx4 v253, s[32:35], s51 offen offset:256 lds
 v_mfma_f32_16x16x32_bf16 v[72:75], v[224:227], a[152:155], v[72:75]
 s_waitcnt lgkmcnt(2)
 v_mfma_f32_16x16x32_bf16 v[76:79], v[224:227], a[156:159], v[76:79]
 v_add_u32 v242, 32768, v242
 v_mfma_f32_16x16x32_bf16 v[80:83], v[228:231], a[144:147], v[80:83]
 v_mfma_f32_16x16x32_bf16 v[84:87], v[228:231], a[148:151], v[84:87]
 v_mfma_f32_16x16x32_bf16 v[88:91], v[228:231], a[152:155], v[88:91]
 s_waitcnt lgkmcnt(0)
 s_waitcnt vmcnt(20)
 s_barrier
 v_mfma_f32_16x16x32_bf16 v[92:95], v[228:231], a[156:159], v[92:95]
 ds_read_b64_tr_b16 v[224:225], v241 offset:0
 ds_read_b64_tr_b16 v[226:227], v241 offset:2048
 ds_read_b64_tr_b16 v[228:229], v242 offset:0
 ds_read_b64_tr_b16 v[230:231], v242 offset:2048
 v_mfma_f32_16x16x32_bf16 v[96:99], v[232:235], a[144:147], v[96:99]
 v_lshl_add_u32 v243, v250, 4, v243
 v_mfma_f32_16x16x32_bf16 v[100:103], v[232:235], a[148:151], v[100:103]
 v_mfma_f32_16x16x32_bf16 v[104:107], v[232:235], a[152:155], v[104:107]
 v_mfma_f32_16x16x32_bf16 v[108:111], v[232:235], a[156:159], v[108:111]
 ds_read_b64_tr_b16 v[232:233], v241 offset:512
 ds_read_b64_tr_b16 v[234:235], v241 offset:2560
 v_mfma_f32_16x16x32_bf16 v[112:115], v[236:239], a[144:147], v[112:115]
 v_mfma_f32_16x16x32_bf16 v[116:119], v[236:239], a[148:151], v[116:119]
 v_mfma_f32_16x16x32_bf16 v[120:123], v[236:239], a[152:155], v[120:123]
 v_mfma_f32_16x16x32_bf16 v[124:127], v[236:239], a[156:159], v[124:127]
 ds_read_b64_tr_b16 v[236:237], v242 offset:512
 ds_read_b64_tr_b16 v[238:239], v242 offset:2560
 s_waitcnt lgkmcnt(6)
 v_mfma_f32_16x16x32_bf16 v[128:131], v[224:227], a[160:163], v[128:131]
 v_mfma_f32_16x16x32_bf16 v[132:135], v[224:227], a[164:167], v[132:135]
 s_add_u32 s51, s56, 1048576
 v_mfma_f32_16x16x32_bf16 v[136:139], v[224:227], a[168:171], v[136:139]
 s_waitcnt lgkmcnt(4)
 v_mfma_f32_16x16x32_bf16 v[140:143], v[224:227], a[172:175], v[140:143]
 ds_read_b64_tr_b16 v[224:225], v241 offset:4096
 ds_read_b64_tr_b16 v[226:227], v241 offset:6144
 v_mfma_f32_16x16x32_bf16 v[144:147], v[228:231], a[160:163], v[144:147]
 s_add_u32 m0, s59, 32512
 v_mbcnt_lo_u32_b32 v249, -1, 0
 v_mfma_f32_16x16x32_bf16 v[148:151], v[228:231], a[164:167], v[148:151]
 buffer_load_dwordx4 v253, s[32:35], s51 offen offset:256 lds
 v_mfma_f32_16x16x32_bf16 v[152:155], v[228:231], a[168:171], v[152:155]
 s_waitcnt lgkmcnt(4)
 v_mbcnt_hi_u32_b32 v249, -1, v249
 v_mfma_f32_16x16x32_bf16 v[156:159], v[228:231], a[172:175], v[156:159]
 ds_read_b64_tr_b16 v[228:229], v242 offset:4096
 ds_read_b64_tr_b16 v[230:231], v242 offset:6144
 v_mfma_f32_16x16x32_bf16 v[160:163], v[232:235], a[160:163], v[160:163]
 s_add_u32 s51, s56, 1572864
 v_bfe_u32 v250, v249, 2, 3
 v_mfma_f32_16x16x32_bf16 v[164:167], v[232:235], a[164:167], v[164:167]
 s_add_u32 m0, s59, 40704
 v_mfma_f32_16x16x32_bf16 v[168:171], v[232:235], a[168:171], v[168:171]
 s_waitcnt lgkmcnt(2)
 v_lshlrev_b32 v248, 9, v250
 v_mfma_f32_16x16x32_bf16 v[172:175], v[232:235], a[172:175], v[172:175]
 ds_read_b64_tr_b16 v[232:233], v241 offset:4608
 ds_read_b64_tr_b16 v[234:235], v241 offset:6656
 v_mfma_f32_16x16x32_bf16 v[176:179], v[236:239], a[160:163], v[176:179]
 buffer_load_dwordx4 v253, s[32:35], s51 offen offset:256 lds
 v_lshrrev_b32 v250, 5, v249
 v_mfma_f32_16x16x32_bf16 v[180:183], v[236:239], a[164:167], v[180:183]
 s_add_u32 s51, s56, 1081344
 v_mfma_f32_16x16x32_bf16 v[184:187], v[236:239], a[168:171], v[184:187]
 v_lshl_add_u32 v248, v250, 6, v248
 v_mfma_f32_16x16x32_bf16 v[188:191], v[236:239], a[172:175], v[188:191]
 ds_read_b64_tr_b16 v[236:237], v242 offset:4608
 ds_read_b64_tr_b16 v[238:239], v242 offset:6656
 v_mfma_f32_16x16x32_bf16 v[128:131], v[224:227], a[176:179], v[128:131]
 s_add_u32 m0, s59, 34560
 v_bfe_u32 v250, v249, 4, 1
 v_mfma_f32_16x16x32_bf16 v[132:135], v[224:227], a[180:183], v[132:135]
 buffer_load_dwordx4 v253, s[32:35], s51 offen offset:256 lds
 v_mfma_f32_16x16x32_bf16 v[136:139], v[224:227], a[184:187], v[136:139]
 s_waitcnt lgkmcnt(2)
 v_lshlrev_b32 v250, 1, v250
 v_mfma_f32_16x16x32_bf16 v[140:143], v[224:227], a[188:191], v[140:143]
 ds_read_b64_tr_b16 v[224:225], v241 offset:8192
 ds_read_b64_tr_b16 v[226:227], v241 offset:10240
 v_mfma_f32_16x16x32_bf16 v[144:147], v[228:231], a[176:179], v[144:147]
 s_add_u32 s51, s56, 1605632
 v_xor_b32 v250, v250, v249
 v_mfma_f32_16x16x32_bf16 v[148:151], v[228:231], a[180:183], v[148:151]
 s_add_u32 m0, s59, 42752
 v_mfma_f32_16x16x32_bf16 v[152:155], v[228:231], a[184:187], v[152:155]
 v_and_b32 v250, 3, v250
 v_mfma_f32_16x16x32_bf16 v[156:159], v[228:231], a[188:191], v[156:159]
 ds_read_b64_tr_b16 v[228:229], v242 offset:8192
 ds_read_b64_tr_b16 v[230:231], v242 offset:10240
 v_mfma_f32_16x16x32_bf16 v[160:163], v[232:235], a[176:179], v[160:163]
 buffer_load_dwordx4 v253, s[32:35], s51 offen offset:256 lds
 v_lshl_add_u32 v248, v250, 4, v248
 v_mfma_f32_16x16x32_bf16 v[164:167], v[232:235], a[180:183], v[164:167]
 v_mfma_f32_16x16x32_bf16 v[168:171], v[232:235], a[184:187], v[168:171]
 s_waitcnt lgkmcnt(2)
 s_add_u32 s51, s56, 1310720
 v_mfma_f32_16x16x32_bf16 v[172:175], v[232:235], a[188:191], v[172:175]
 ds_read_b64_tr_b16 v[232:233], v241 offset:8704
 ds_read_b64_tr_b16 v[234:235], v241 offset:10752
 v_mfma_f32_16x16x32_bf16 v[176:179], v[236:239], a[176:179], v[176:179]
 v_mbcnt_lo_u32_b32 v249, -1, 0
 s_add_u32 m0, s59, 36608
 v_mfma_f32_16x16x32_bf16 v[180:183], v[236:239], a[180:183], v[180:183]
 v_mbcnt_hi_u32_b32 v249, -1, v249
 v_mfma_f32_16x16x32_bf16 v[184:187], v[236:239], a[184:187], v[184:187]
 buffer_load_dwordx4 v253, s[32:35], s51 offen offset:256 lds
 v_bfe_u32 v250, v249, 3, 1
 v_mfma_f32_16x16x32_bf16 v[188:191], v[236:239], a[188:191], v[188:191]
 ds_read_b64_tr_b16 v[236:237], v242 offset:8704
 ds_read_b64_tr_b16 v[238:239], v242 offset:10752
 v_mfma_f32_16x16x32_bf16 v[64:67], v[224:227], a[160:163], v[64:67]
 s_add_u32 s51, s56, 1835008
 v_lshlrev_b32 v240, 12, v250
 v_mfma_f32_16x16x32_bf16 v[68:71], v[224:227], a[164:167], v[68:71]
 v_mfma_f32_16x16x32_bf16 v[72:75], v[224:227], a[168:171], v[72:75]
 s_waitcnt lgkmcnt(2)
 s_add_u32 m0, s59, 44800
 v_mfma_f32_16x16x32_bf16 v[76:79], v[224:227], a[172:175], v[76:79]
 ds_read_b64_tr_b16 v[224:225], v241 offset:12288
 ds_read_b64_tr_b16 v[226:227], v241 offset:14336
 v_mfma_f32_16x16x32_bf16 v[80:83], v[228:231], a[160:163], v[80:83]
 v_and_b32 v251, 7, v249
 buffer_load_dwordx4 v253, s[32:35], s51 offen offset:256 lds
 v_mfma_f32_16x16x32_bf16 v[84:87], v[228:231], a[164:167], v[84:87]
 v_lshl_add_u32 v240, v251, 6, v240
 v_mfma_f32_16x16x32_bf16 v[88:91], v[228:231], a[168:171], v[88:91]
 s_add_u32 s51, s56, 1343488
 v_bfe_u32 v251, v249, 5, 1
 v_mfma_f32_16x16x32_bf16 v[92:95], v[228:231], a[172:175], v[92:95]
 ds_read_b64_tr_b16 v[228:229], v242 offset:12288
 ds_read_b64_tr_b16 v[230:231], v242 offset:14336
 v_mfma_f32_16x16x32_bf16 v[96:99], v[232:235], a[160:163], v[96:99]
 s_add_u32 m0, s59, 38656
 v_xor_b32 v250, v250, v251
 v_mfma_f32_16x16x32_bf16 v[100:103], v[232:235], a[164:167], v[100:103]
 v_mfma_f32_16x16x32_bf16 v[104:107], v[232:235], a[168:171], v[104:107]
 s_waitcnt lgkmcnt(2)
 buffer_load_dwordx4 v253, s[32:35], s51 offen offset:256 lds
 v_mfma_f32_16x16x32_bf16 v[108:111], v[232:235], a[172:175], v[108:111]
 ds_read_b64_tr_b16 v[232:233], v241 offset:12800
 ds_read_b64_tr_b16 v[234:235], v241 offset:14848
 v_mfma_f32_16x16x32_bf16 v[112:115], v[236:239], a[160:163], v[112:115]
 v_bfe_u32 v251, v249, 4, 1
 s_add_u32 s51, s56, 1867776
 v_mfma_f32_16x16x32_bf16 v[116:119], v[236:239], a[164:167], v[116:119]
 v_lshl_add_u32 v250, v251, 1, v250
 v_mfma_f32_16x16x32_bf16 v[120:123], v[236:239], a[168:171], v[120:123]
 s_add_u32 m0, s59, 46848
 v_lshl_add_u32 v240, v250, 4, v240
 v_mfma_f32_16x16x32_bf16 v[124:127], v[236:239], a[172:175], v[124:127]
 ds_read_b64_tr_b16 v[236:237], v242 offset:12800
 ds_read_b64_tr_b16 v[238:239], v242 offset:14848
 v_mfma_f32_16x16x32_bf16 v[64:67], v[224:227], a[176:179], v[64:67]
 v_add_u32 v241, 32768, v241
 v_add_u32 v240, 98304, v240
 v_mfma_f32_16x16x32_bf16 v[68:71], v[224:227], a[180:183], v[68:71]
 buffer_load_dwordx4 v253, s[32:35], s51 offen offset:256 lds
 v_mfma_f32_16x16x32_bf16 v[72:75], v[224:227], a[184:187], v[72:75]
 s_waitcnt lgkmcnt(2)
 v_add_u32 v240, s71, v240
 v_mfma_f32_16x16x32_bf16 v[76:79], v[224:227], a[188:191], v[76:79]
 v_add_u32 v242, 32768, v242
 v_mfma_f32_16x16x32_bf16 v[80:83], v[228:231], a[176:179], v[80:83]
 v_mfma_f32_16x16x32_bf16 v[84:87], v[228:231], a[180:183], v[84:87]
 v_mfma_f32_16x16x32_bf16 v[88:91], v[228:231], a[184:187], v[88:91]
 s_waitcnt lgkmcnt(0)
 s_waitcnt vmcnt(16)
 s_barrier
 v_mfma_f32_16x16x32_bf16 v[92:95], v[228:231], a[188:191], v[92:95]
 ds_read_b64_tr_b16 v[224:225], v241 offset:0
 ds_read_b64_tr_b16 v[226:227], v241 offset:2048
 ds_read_b64_tr_b16 v[228:229], v242 offset:0
 ds_read_b64_tr_b16 v[230:231], v242 offset:2048
 v_mfma_f32_16x16x32_bf16 v[96:99], v[232:235], a[176:179], v[96:99]
 ds_read_b128 a[192:195], v254 offset:32768
 ds_read_b128 a[196:199], v254 offset:34816
 v_mfma_f32_16x16x32_bf16 v[100:103], v[232:235], a[180:183], v[100:103]
 ds_read_b128 a[200:203], v255 offset:32768
 v_mfma_f32_16x16x32_bf16 v[104:107], v[232:235], a[184:187], v[104:107]
 ds_read_b128 a[204:207], v255 offset:34816
 v_mfma_f32_16x16x32_bf16 v[108:111], v[232:235], a[188:191], v[108:111]
 ds_read_b64_tr_b16 v[232:233], v241 offset:512
 ds_read_b64_tr_b16 v[234:235], v241 offset:2560
 v_mfma_f32_16x16x32_bf16 v[112:115], v[236:239], a[176:179], v[112:115]
 ds_read_b128 a[208:211], v254 offset:33280
 ds_read_b128 a[212:215], v254 offset:35328
 v_mfma_f32_16x16x32_bf16 v[116:119], v[236:239], a[180:183], v[116:119]
 ds_read_b128 a[216:219], v255 offset:33280
 v_mfma_f32_16x16x32_bf16 v[120:123], v[236:239], a[184:187], v[120:123]
 ds_read_b128 a[220:223], v255 offset:35328
 v_mfma_f32_16x16x32_bf16 v[124:127], v[236:239], a[188:191], v[124:127]
 ds_read_b64_tr_b16 v[236:237], v242 offset:512
 ds_read_b64_tr_b16 v[238:239], v242 offset:2560
 s_waitcnt lgkmcnt(14)
 s_waitcnt lgkmcnt(8)
 v_mfma_f32_16x16x32_bf16 v[128:131], v[224:227], a[192:195], v[128:131]
 v_mfma_f32_16x16x32_bf16 v[132:135], v[224:227], a[196:199], v[132:135]
 s_add_u32 s51, s56, 2097152
 v_mfma_f32_16x16x32_bf16 v[136:139], v[224:227], a[200:203], v[136:139]
 v_mfma_f32_16x16x32_bf16 v[140:143], v[224:227], a[204:207], v[140:143]
 ds_read_b64_tr_b16 v[224:225], v241 offset:4096
 ds_read_b64_tr_b16 v[226:227], v241 offset:6144
 v_mfma_f32_16x16x32_bf16 v[144:147], v[228:231], a[192:195], v[144:147]
 s_add_u32 m0, s59, 65280
 v_mfma_f32_16x16x32_bf16 v[148:151], v[228:231], a[196:199], v[148:151]
 buffer_load_dwordx4 v253, s[32:35], s51 offen offset:256 lds
 v_mfma_f32_16x16x32_bf16 v[152:155], v[228:231], a[200:203], v[152:155]
 s_waitcnt lgkmcnt(8)
 v_mfma_f32_16x16x32_bf16 v[156:159], v[228:231], a[204:207], v[156:159]
 ds_read_b64_tr_b16 v[228:229], v242 offset:4096
 ds_read_b64_tr_b16 v[230:231], v242 offset:6144
 v_mfma_f32_16x16x32_bf16 v[160:163], v[232:235], a[192:195], v[160:163]
 s_add_u32 s51, s56, 2621440
 v_mfma_f32_16x16x32_bf16 v[164:167], v[232:235], a[196:199], v[164:167]
 s_add_u32 m0, s59, 73472
 v_mfma_f32_16x16x32_bf16 v[168:171], v[232:235], a[200:203], v[168:171]
 s_waitcnt lgkmcnt(2)
 v_mfma_f32_16x16x32_bf16 v[172:175], v[232:235], a[204:207], v[172:175]
 ds_read_b64_tr_b16 v[232:233], v241 offset:4608
 ds_read_b64_tr_b16 v[234:235], v241 offset:6656
 v_mfma_f32_16x16x32_bf16 v[176:179], v[236:239], a[192:195], v[176:179]
 buffer_load_dwordx4 v253, s[32:35], s51 offen offset:256 lds
 v_mfma_f32_16x16x32_bf16 v[180:183], v[236:239], a[196:199], v[180:183]
 s_add_u32 s51, s56, 2129920
 v_mfma_f32_16x16x32_bf16 v[184:187], v[236:239], a[200:203], v[184:187]
 v_mfma_f32_16x16x32_bf16 v[188:191], v[236:239], a[204:207], v[188:191]
 ds_read_b64_tr_b16 v[236:237], v242 offset:4608
 ds_read_b64_tr_b16 v[238:239], v242 offset:6656
 v_mfma_f32_16x16x32_bf16 v[128:131], v[224:227], a[208:211], v[128:131]
 s_add_u32 m0, s59, 67328
 v_mfma_f32_16x16x32_bf16 v[132:135], v[224:227], a[212:215], v[132:135]
 buffer_load_dwordx4 v253, s[32:35], s51 offen offset:256 lds
 v_mfma_f32_16x16x32_bf16 v[136:139], v[224:227], a[216:219], v[136:139]
 s_waitcnt lgkmcnt(2)
 v_mfma_f32_16x16x32_bf16 v[140:143], v[224:227], a[220:223], v[140:143]
 ds_read_b64_tr_b16 v[224:225], v241 offset:8192
 ds_read_b64_tr_b16 v[226:227], v241 offset:10240
 v_mfma_f32_16x16x32_bf16 v[144:147], v[228:231], a[208:211], v[144:147]
 s_add_u32 s51, s56, 2654208
 v_mbcnt_lo_u32_b32 v254, -1, 0
 v_mfma_f32_16x16x32_bf16 v[148:151], v[228:231], a[212:215], v[148:151]
 s_add_u32 m0, s59, 75520
 v_mfma_f32_16x16x32_bf16 v[152:155], v[228:231], a[216:219], v[152:155]
 v_mbcnt_hi_u32_b32 v254, -1, v254
 v_mfma_f32_16x16x32_bf16 v[156:159], v[228:231], a[220:223], v[156:159]
 ds_read_b64_tr_b16 v[228:229], v242 offset:8192
 ds_read_b64_tr_b16 v[230:231], v242 offset:10240
 v_mfma_f32_16x16x32_bf16 v[160:163], v[232:235], a[208:211], v[160:163]
 buffer_load_dwordx4 v253, s[32:35], s51 offen offset:256 lds
 v_lshlrev_b32 v254, 4, v254
 v_mfma_f32_16x16x32_bf16 v[164:167], v[232:235], a[212:215], v[164:167]
 v_mfma_f32_16x16x32_bf16 v[168:171], v[232:235], a[216:219], v[168:171]
 s_waitcnt lgkmcnt(2)
 s_add_u32 s51, s56, 2359296
 v_mfma_f32_16x16x32_bf16 v[172:175], v[232:235], a[220:223], v[172:175]
 ds_read_b64_tr_b16 v[232:233], v241 offset:8704
 ds_read_b64_tr_b16 v[234:235], v241 offset:10752
 v_mfma_f32_16x16x32_bf16 v[176:179], v[236:239], a[208:211], v[176:179]
 s_bfe_u32 s90, s2, 0x40003
 s_add_u32 m0, s59, 69376
 v_mfma_f32_16x16x32_bf16 v[180:183], v[236:239], a[212:215], v[180:183]
 s_lshl_b32 s90, s90, 2
 v_mfma_f32_16x16x32_bf16 v[184:187], v[236:239], a[216:219], v[184:187]
 buffer_load_dwordx4 v253, s[32:35], s51 offen offset:256 lds
 s_add_u32 s90, s90, s48
 v_mfma_f32_16x16x32_bf16 v[188:191], v[236:239], a[220:223], v[188:191]
 ds_read_b64_tr_b16 v[236:237], v242 offset:8704
 ds_read_b64_tr_b16 v[238:239], v242 offset:10752
 v_mfma_f32_16x16x32_bf16 v[64:67], v[224:227], a[192:195], v[64:67]
 s_add_u32 s51, s56, 2883584
 s_mul_i32 s90, s90, 7168
 v_mfma_f32_16x16x32_bf16 v[68:71], v[224:227], a[196:199], v[68:71]
 v_mfma_f32_16x16x32_bf16 v[72:75], v[224:227], a[200:203], v[72:75]
 s_waitcnt lgkmcnt(2)
 v_mul_f32 v128, s62, v128
 v_mfma_f32_16x16x32_bf16 v[76:79], v[224:227], a[204:207], v[76:79]
 ds_read_b64_tr_b16 v[224:225], v241 offset:12288
 ds_read_b64_tr_b16 v[226:227], v241 offset:14336
 v_mfma_f32_16x16x32_bf16 v[80:83], v[228:231], a[192:195], v[80:83]
 s_add_u32 m0, s59, 77568
 v_mul_f32 v129, s62, v129
 v_mfma_f32_16x16x32_bf16 v[84:87], v[228:231], a[196:199], v[84:87]
 s_lshr_b32 s67, s49, 1
 v_mul_f32 v130, s62, v130
 v_mfma_f32_16x16x32_bf16 v[88:91], v[228:231], a[200:203], v[88:91]
 v_mul_f32 v131, s62, v131
 v_mul_f32 v144, s62, v144
 buffer_load_dwordx4 v253, s[32:35], s51 offen offset:256 lds
 v_mfma_f32_16x16x32_bf16 v[92:95], v[228:231], a[204:207], v[92:95]
 ds_read_b64_tr_b16 v[228:229], v242 offset:12288
 ds_read_b64_tr_b16 v[230:231], v242 offset:14336
 v_mul_f32 v145, s62, v145
 v_mfma_f32_16x16x32_bf16 v[96:99], v[232:235], a[192:195], v[96:99]
 s_mul_i32 s67, s67, 458752
 s_add_u32 s90, s90, s67
 v_mul_f32 v146, s62, v146
 v_mfma_f32_16x16x32_bf16 v[100:103], v[232:235], a[196:199], v[100:103]
 v_mul_f32 v147, s62, v147
 v_cvt_pk_bf16_f32 v3, v146, v147
 s_add_u32 s51, s56, 2392064
 v_mfma_f32_16x16x32_bf16 v[104:107], v[232:235], a[200:203], v[104:107]
 s_waitcnt lgkmcnt(2)
 v_cvt_pk_bf16_f32 v2, v144, v145
 v_cvt_pk_bf16_f32 v0, v128, v129
 v_mfma_f32_16x16x32_bf16 v[108:111], v[232:235], a[204:207], v[108:111]
 ds_read_b64_tr_b16 v[232:233], v241 offset:12800
 ds_read_b64_tr_b16 v[234:235], v241 offset:14848
 v_cvt_pk_bf16_f32 v1, v130, v131
 v_mfma_f32_16x16x32_bf16 v[112:115], v[236:239], a[192:195], v[112:115]
 v_mul_f32 v132, s62, v132
 s_add_u32 m0, s59, 71424
 v_mul_f32 v133, s62, v133
 v_mfma_f32_16x16x32_bf16 v[116:119], v[236:239], a[196:199], v[116:119]
 v_permlane16_swap_b32 v0, v2
 v_permlane16_swap_b32 v1, v3
 v_mul_f32 v134, s62, v134
 v_mfma_f32_16x16x32_bf16 v[120:123], v[236:239], a[200:203], v[120:123]
 buffer_load_dwordx4 v253, s[32:35], s51 offen offset:256 lds
 v_mul_f32 v135, s62, v135
 v_mul_f32 v148, s62, v148
 v_mfma_f32_16x16x32_bf16 v[124:127], v[236:239], a[204:207], v[124:127]
 ds_read_b64_tr_b16 v[236:237], v242 offset:12800
 ds_read_b64_tr_b16 v[238:239], v242 offset:14848
 v_mul_f32 v149, s62, v149
 v_mfma_f32_16x16x32_bf16 v[64:67], v[224:227], a[208:211], v[64:67]
 v_mul_f32 v150, s62, v150
 s_add_u32 s51, s56, 2916352
 v_mul_f32 v151, s62, v151
 v_mfma_f32_16x16x32_bf16 v[68:71], v[224:227], a[212:215], v[68:71]
 v_cvt_pk_bf16_f32 v7, v150, v151
 v_cvt_pk_bf16_f32 v6, v148, v149
 s_add_u32 m0, s59, 79616
 v_mfma_f32_16x16x32_bf16 v[72:75], v[224:227], a[216:219], v[72:75]
 buffer_load_dwordx4 v253, s[32:35], s51 offen offset:256 lds
 s_waitcnt lgkmcnt(2)
 v_cvt_pk_bf16_f32 v4, v132, v133
 v_mfma_f32_16x16x32_bf16 v[76:79], v[224:227], a[220:223], v[76:79]
 v_cvt_pk_bf16_f32 v5, v134, v135
 v_mul_f32 v136, s62, v136
 v_subrev_u32 v241, 98304, v241
 v_mfma_f32_16x16x32_bf16 v[80:83], v[228:231], a[208:211], v[80:83]
 v_mul_f32 v137, s62, v137
 v_permlane16_swap_b32 v4, v6
 v_permlane16_swap_b32 v5, v7
 v_mfma_f32_16x16x32_bf16 v[84:87], v[228:231], a[212:215], v[84:87]
 buffer_load_dwordx4 a[224:227], v254, s[36:39], s90 offen
 s_add_u32 s90, s90, 1024
 v_mul_f32 v138, s62, v138
 v_mfma_f32_16x16x32_bf16 v[88:91], v[228:231], a[216:219], v[88:91]
 v_subrev_u32 v242, 98304, v242
 s_waitcnt lgkmcnt(0)
 s_waitcnt vmcnt(17)
 s_barrier
 v_mfma_f32_16x16x32_bf16 v[92:95], v[228:231], a[220:223], v[92:95]
 ds_read_b64_tr_b16 v[224:225], v241 offset:0
 ds_read_b64_tr_b16 v[226:227], v241 offset:2048
 ds_read_b64_tr_b16 v[228:229], v242 offset:0
 ds_read_b64_tr_b16 v[230:231], v242 offset:2048
 v_mfma_f32_16x16x32_bf16 v[96:99], v[232:235], a[208:211], v[96:99]
 v_mul_f32 v139, s62, v139
 v_mul_f32 v152, s62, v152
 v_mul_f32 v153, s62, v153
 v_mfma_f32_16x16x32_bf16 v[100:103], v[232:235], a[212:215], v[100:103]
 v_mul_f32 v154, s62, v154
 v_mul_f32 v155, s62, v155
 v_cvt_pk_bf16_f32 v11, v154, v155
 v_mfma_f32_16x16x32_bf16 v[104:107], v[232:235], a[216:219], v[104:107]
 v_cvt_pk_bf16_f32 v10, v152, v153
 v_cvt_pk_bf16_f32 v8, v136, v137
 v_cvt_pk_bf16_f32 v9, v138, v139
 v_mfma_f32_16x16x32_bf16 v[108:111], v[232:235], a[220:223], v[108:111]
 ds_read_b64_tr_b16 v[232:233], v241 offset:512
 ds_read_b64_tr_b16 v[234:235], v241 offset:2560
 v_mul_f32 v140, s62, v140
 v_mfma_f32_16x16x32_bf16 v[112:115], v[236:239], a[208:211], v[112:115]
 v_mul_f32 v141, s62, v141
 v_permlane16_swap_b32 v8, v10
 v_permlane16_swap_b32 v9, v11
 v_mfma_f32_16x16x32_bf16 v[116:119], v[236:239], a[212:215], v[116:119]
 v_mul_f32 v142, s62, v142
 v_mul_f32 v143, s62, v143
 v_mul_f32 v156, s62, v156
 v_mfma_f32_16x16x32_bf16 v[120:123], v[236:239], a[216:219], v[120:123]
 v_mul_f32 v157, s62, v157
 v_mul_f32 v158, s62, v158
 v_mul_f32 v159, s62, v159
 v_mfma_f32_16x16x32_bf16 v[124:127], v[236:239], a[220:223], v[124:127]
 v_cvt_pk_bf16_f32 v15, v158, v159
 v_cvt_pk_bf16_f32 v14, v156, v157
 v_cvt_pk_bf16_f32 v12, v140, v141
 v_cvt_pk_bf16_f32 v13, v142, v143
 s_nop 0
 v_permlane16_swap_b32 v12, v14
 v_permlane16_swap_b32 v13, v15
 ds_read_b64_tr_b16 v[236:237], v242 offset:512
 ds_read_b64_tr_b16 v[238:239], v242 offset:2560
 s_waitcnt lgkmcnt(6)
 v_mfma_f32_16x16x32_bf16 v[192:195], v[224:227], a[0:3], 0
 v_mfma_f32_16x16x32_bf16 v[196:199], v[224:227], a[4:7], 0
 s_add_u32 s51, s56, 3145728
 v_mfma_f32_16x16x32_bf16 v[200:203], v[224:227], a[8:11], 0
 s_waitcnt lgkmcnt(4)
 v_mul_f32 v160, s62, v160
 v_mfma_f32_16x16x32_bf16 v[204:207], v[224:227], a[12:15], 0
 ds_read_b64_tr_b16 v[224:225], v241 offset:4096
 ds_read_b64_tr_b16 v[226:227], v241 offset:6144
 v_mfma_f32_16x16x32_bf16 v[208:211], v[228:231], a[0:3], 0
 s_add_u32 m0, s59, 98048
 v_mul_f32 v161, s62, v161
 v_mfma_f32_16x16x32_bf16 v[212:215], v[228:231], a[4:7], 0
 v_mul_f32 v162, s62, v162
 buffer_load_dwordx4 v253, s[32:35], s51 offen offset:256 lds
 v_mfma_f32_16x16x32_bf16 v[216:219], v[228:231], a[8:11], 0
 s_waitcnt lgkmcnt(4)
 v_mul_f32 v163, s62, v163
 v_mfma_f32_16x16x32_bf16 v[220:223], v[228:231], a[12:15], 0
 ds_read_b64_tr_b16 v[228:229], v242 offset:4096
 ds_read_b64_tr_b16 v[230:231], v242 offset:6144
 v_mfma_f32_16x16x32_bf16 v[128:131], v[232:235], a[0:3], 0
 v_mul_f32 v176, s62, v176
 s_add_u32 s51, s56, 0
 v_mfma_f32_16x16x32_bf16 v[132:135], v[232:235], a[4:7], 0
 v_mul_f32 v177, s62, v177
 s_add_u32 m0, s59, 106112
 v_mfma_f32_16x16x32_bf16 v[136:139], v[232:235], a[8:11], 0
 s_waitcnt lgkmcnt(2)
 v_mul_f32 v178, s62, v178
 v_mfma_f32_16x16x32_bf16 v[140:143], v[232:235], a[12:15], 0
 ds_read_b64_tr_b16 v[232:233], v241 offset:4608
 ds_read_b64_tr_b16 v[234:235], v241 offset:6656
 v_mfma_f32_16x16x32_bf16 v[144:147], v[236:239], a[0:3], 0
 v_mul_f32 v179, s62, v179
 buffer_load_dwordx4 v253, s[32:35], s51 offen offset:384 lds
 v_mfma_f32_16x16x32_bf16 v[148:151], v[236:239], a[4:7], 0
 v_cvt_pk_bf16_f32 v19, v178, v179
 s_add_u32 s51, s56, 3178496
 v_mfma_f32_16x16x32_bf16 v[152:155], v[236:239], a[8:11], 0
 v_cvt_pk_bf16_f32 v18, v176, v177
 v_cvt_pk_bf16_f32 v16, v160, v161
 v_mfma_f32_16x16x32_bf16 v[156:159], v[236:239], a[12:15], 0
 ds_read_b64_tr_b16 v[236:237], v242 offset:4608
 ds_read_b64_tr_b16 v[238:239], v242 offset:6656
 v_mfma_f32_16x16x32_bf16 v[192:195], v[224:227], a[16:19], v[192:195]
 s_add_u32 m0, s59, 100096
 v_cvt_pk_bf16_f32 v17, v162, v163
 v_mfma_f32_16x16x32_bf16 v[196:199], v[224:227], a[20:23], v[196:199]
 v_mul_f32 v164, s62, v164
 buffer_load_dwordx4 v253, s[32:35], s51 offen offset:256 lds
 v_mfma_f32_16x16x32_bf16 v[200:203], v[224:227], a[24:27], v[200:203]
 s_waitcnt lgkmcnt(2)
 v_mul_f32 v165, s62, v165
 v_mfma_f32_16x16x32_bf16 v[204:207], v[224:227], a[28:31], v[204:207]
 ds_read_b64_tr_b16 v[224:225], v241 offset:8192
 ds_read_b64_tr_b16 v[226:227], v241 offset:10240
 v_mfma_f32_16x16x32_bf16 v[208:211], v[228:231], a[16:19], v[208:211]
 s_add_u32 s51, s56, 32768
 v_permlane16_swap_b32 v16, v18
 v_mfma_f32_16x16x32_bf16 v[212:215], v[228:231], a[20:23], v[212:215]
 v_permlane16_swap_b32 v17, v19
 s_add_u32 m0, s59, 108160
 v_mfma_f32_16x16x32_bf16 v[216:219], v[228:231], a[24:27], v[216:219]
 v_mul_f32 v166, s62, v166
 v_mfma_f32_16x16x32_bf16 v[220:223], v[228:231], a[28:31], v[220:223]
 ds_read_b64_tr_b16 v[228:229], v242 offset:8192
 ds_read_b64_tr_b16 v[230:231], v242 offset:10240
 v_mfma_f32_16x16x32_bf16 v[128:131], v[232:235], a[16:19], v[128:131]
 buffer_load_dwordx4 v253, s[32:35], s51 offen offset:384 lds
 v_mul_f32 v167, s62, v167
 v_mfma_f32_16x16x32_bf16 v[132:135], v[232:235], a[20:23], v[132:135]
 v_mul_f32 v180, s62, v180
 v_mfma_f32_16x16x32_bf16 v[136:139], v[232:235], a[24:27], v[136:139]
 s_waitcnt lgkmcnt(2)
 s_add_u32 s51, s56, 3407872
 v_mfma_f32_16x16x32_bf16 v[140:143], v[232:235], a[28:31], v[140:143]
 ds_read_b64_tr_b16 v[232:233], v241 offset:8704
 ds_read_b64_tr_b16 v[234:235], v241 offset:10752
 v_mfma_f32_16x16x32_bf16 v[144:147], v[236:239], a[16:19], v[144:147]
 v_mul_f32 v181, s62, v181
 v_mul_f32 v182, s62, v182
 v_mfma_f32_16x16x32_bf16 v[148:151], v[236:239], a[20:23], v[148:151]
 s_add_u32 m0, s59, 102144
 v_mul_f32 v183, s62, v183
 v_mfma_f32_16x16x32_bf16 v[152:155], v[236:239], a[24:27], v[152:155]
 buffer_load_dwordx4 v253, s[32:35], s51 offen offset:256 lds
 v_cvt_pk_bf16_f32 v23, v182, v183
 v_mfma_f32_16x16x32_bf16 v[156:159], v[236:239], a[28:31], v[156:159]
 ds_read_b64_tr_b16 v[236:237], v242 offset:8704
 ds_read_b64_tr_b16 v[238:239], v242 offset:10752
 v_mfma_f32_16x16x32_bf16 v[192:195], v[224:227], a[32:35], v[192:195]
 v_cvt_pk_bf16_f32 v22, v180, v181
 s_add_u32 s51, s56, 262144
 v_mfma_f32_16x16x32_bf16 v[196:199], v[224:227], a[36:39], v[196:199]
 v_cvt_pk_bf16_f32 v20, v164, v165
 v_mfma_f32_16x16x32_bf16 v[200:203], v[224:227], a[40:43], v[200:203]
 s_waitcnt lgkmcnt(2)
 v_cvt_pk_bf16_f32 v21, v166, v167
 v_mfma_f32_16x16x32_bf16 v[204:207], v[224:227], a[44:47], v[204:207]
 ds_read_b64_tr_b16 v[224:225], v241 offset:12288
 ds_read_b64_tr_b16 v[226:227], v241 offset:14336
 v_mfma_f32_16x16x32_bf16 v[208:211], v[228:231], a[32:35], v[208:211]
 s_add_u32 m0, s59, 110208
 v_mul_f32 v168, s62, v168
 v_mfma_f32_16x16x32_bf16 v[212:215], v[228:231], a[36:39], v[212:215]
 buffer_load_dwordx4 v253, s[32:35], s51 offen offset:384 lds
 v_mul_f32 v169, s62, v169
 v_mfma_f32_16x16x32_bf16 v[216:219], v[228:231], a[40:43], v[216:219]
 v_permlane16_swap_b32 v20, v22
 s_add_u32 s51, s56, 3440640
 v_mfma_f32_16x16x32_bf16 v[220:223], v[228:231], a[44:47], v[220:223]
 ds_read_b64_tr_b16 v[228:229], v242 offset:12288
 ds_read_b64_tr_b16 v[230:231], v242 offset:14336
 v_mfma_f32_16x16x32_bf16 v[128:131], v[232:235], a[32:35], v[128:131]
 v_permlane16_swap_b32 v21, v23
 s_add_u32 m0, s59, 104192
 v_mfma_f32_16x16x32_bf16 v[132:135], v[232:235], a[36:39], v[132:135]
 v_mul_f32 v170, s62, v170
 v_mfma_f32_16x16x32_bf16 v[136:139], v[232:235], a[40:43], v[136:139]
 s_waitcnt lgkmcnt(2)
 v_mul_f32 v171, s62, v171
 v_mfma_f32_16x16x32_bf16 v[140:143], v[232:235], a[44:47], v[140:143]
 ds_read_b64_tr_b16 v[232:233], v241 offset:12800
 ds_read_b64_tr_b16 v[234:235], v241 offset:14848
 v_mfma_f32_16x16x32_bf16 v[144:147], v[236:239], a[32:35], v[144:147]
 buffer_load_dwordx4 v253, s[32:35], s51 offen offset:256 lds
 v_mul_f32 v184, s62, v184
 v_mfma_f32_16x16x32_bf16 v[148:151], v[236:239], a[36:39], v[148:151]
 v_mul_f32 v185, s62, v185
 s_add_u32 s51, s56, 294912
 v_mfma_f32_16x16x32_bf16 v[152:155], v[236:239], a[40:43], v[152:155]
 v_mul_f32 v186, s62, v186
 s_add_u32 m0, s59, 112256
 v_mfma_f32_16x16x32_bf16 v[156:159], v[236:239], a[44:47], v[156:159]
 ds_read_b64_tr_b16 v[236:237], v242 offset:12800
 ds_read_b64_tr_b16 v[238:239], v242 offset:14848
 v_mfma_f32_16x16x32_bf16 v[192:195], v[224:227], a[48:51], v[192:195]
 v_mul_f32 v187, s62, v187
 v_add_u32 v241, 32768, v241
 v_mfma_f32_16x16x32_bf16 v[196:199], v[224:227], a[52:55], v[196:199]
 v_cvt_pk_bf16_f32 v27, v186, v187
 buffer_load_dwordx4 v253, s[32:35], s51 offen offset:384 lds
 v_mfma_f32_16x16x32_bf16 v[200:203], v[224:227], a[56:59], v[200:203]
 s_waitcnt lgkmcnt(2)
 v_cvt_pk_bf16_f32 v26, v184, v185
 v_mfma_f32_16x16x32_bf16 v[204:207], v[224:227], a[60:63], v[204:207]
 buffer_load_dwordx4 a[224:227], v254, s[36:39], s90 offen
 v_cvt_pk_bf16_f32 v24, v168, v169
 v_mfma_f32_16x16x32_bf16 v[208:211], v[228:231], a[48:51], v[208:211]
 v_add_u32 v242, 32768, v242
 v_cvt_pk_bf16_f32 v25, v170, v171
 v_mfma_f32_16x16x32_bf16 v[212:215], v[228:231], a[52:55], v[212:215]
 s_add_u32 s90, s90, 1024
 v_mul_f32 v172, s62, v172
 v_mfma_f32_16x16x32_bf16 v[216:219], v[228:231], a[56:59], v[216:219]
 s_waitcnt lgkmcnt(0)
 s_waitcnt vmcnt(18)
 s_barrier
 v_mfma_f32_16x16x32_bf16 v[220:223], v[228:231], a[60:63], v[220:223]
 ds_read_b64_tr_b16 v[224:225], v241 offset:0
 ds_read_b64_tr_b16 v[226:227], v241 offset:2048
 ds_read_b64_tr_b16 v[228:229], v242 offset:0
 ds_read_b64_tr_b16 v[230:231], v242 offset:2048
 v_mfma_f32_16x16x32_bf16 v[128:131], v[232:235], a[48:51], v[128:131]
 v_mul_f32 v173, s62, v173
 v_permlane16_swap_b32 v24, v26
 v_mfma_f32_16x16x32_bf16 v[132:135], v[232:235], a[52:55], v[132:135]
 v_permlane16_swap_b32 v25, v27
 v_mfma_f32_16x16x32_bf16 v[136:139], v[232:235], a[56:59], v[136:139]
 v_mul_f32 v174, s62, v174
 v_mfma_f32_16x16x32_bf16 v[140:143], v[232:235], a[60:63], v[140:143]
 ds_read_b64_tr_b16 v[232:233], v241 offset:512
 ds_read_b64_tr_b16 v[234:235], v241 offset:2560
 v_mfma_f32_16x16x32_bf16 v[144:147], v[236:239], a[48:51], v[144:147]
 v_mul_f32 v175, s62, v175
 v_mfma_f32_16x16x32_bf16 v[148:151], v[236:239], a[52:55], v[148:151]
 v_mul_f32 v188, s62, v188
 v_mfma_f32_16x16x32_bf16 v[152:155], v[236:239], a[56:59], v[152:155]
 v_mul_f32 v189, s62, v189
 v_mfma_f32_16x16x32_bf16 v[156:159], v[236:239], a[60:63], v[156:159]
 ds_read_b64_tr_b16 v[236:237], v242 offset:512
 ds_read_b64_tr_b16 v[238:239], v242 offset:2560
 s_waitcnt lgkmcnt(6)
 v_mfma_f32_16x16x32_bf16 v[192:195], v[224:227], a[64:67], v[192:195]
 v_mul_f32 v190, s62, v190
 v_mfma_f32_16x16x32_bf16 v[196:199], v[224:227], a[68:71], v[196:199]
 s_add_u32 s51, s56, 524672
 v_mul_f32 v191, s62, v191
 v_mfma_f32_16x16x32_bf16 v[200:203], v[224:227], a[72:75], v[200:203]
 s_waitcnt lgkmcnt(4)
 v_cvt_pk_bf16_f32 v31, v190, v191
 v_mfma_f32_16x16x32_bf16 v[204:207], v[224:227], a[76:79], v[204:207]
 ds_read_b64_tr_b16 v[224:225], v241 offset:4096
 ds_read_b64_tr_b16 v[226:227], v241 offset:6144
 v_mfma_f32_16x16x32_bf16 v[208:211], v[228:231], a[64:67], v[208:211]
 s_add_u32 m0, s59, 0
 v_cvt_pk_bf16_f32 v30, v188, v189
 v_mfma_f32_16x16x32_bf16 v[212:215], v[228:231], a[68:71], v[212:215]
 buffer_load_dwordx4 v253, s[32:35], s51 offen offset:0 lds
 v_cvt_pk_bf16_f32 v28, v172, v173
 v_mfma_f32_16x16x32_bf16 v[216:219], v[228:231], a[72:75], v[216:219]
 s_waitcnt lgkmcnt(4)
 v_cvt_pk_bf16_f32 v29, v174, v175
 v_mfma_f32_16x16x32_bf16 v[220:223], v[228:231], a[76:79], v[220:223]
 ds_read_b64_tr_b16 v[228:229], v242 offset:4096
 ds_read_b64_tr_b16 v[230:231], v242 offset:6144
 v_mfma_f32_16x16x32_bf16 v[128:131], v[232:235], a[64:67], v[128:131]
 s_add_u32 s51, s56, 1048576
 v_permlane16_swap_b32 v28, v30
 v_mfma_f32_16x16x32_bf16 v[132:135], v[232:235], a[68:71], v[132:135]
 v_permlane16_swap_b32 v29, v31
 s_add_u32 m0, s59, 7808
 v_mfma_f32_16x16x32_bf16 v[136:139], v[232:235], a[72:75], v[136:139]
 s_waitcnt lgkmcnt(2)
 v_mul_f32 v64, s62, v64
 v_mfma_f32_16x16x32_bf16 v[140:143], v[232:235], a[76:79], v[140:143]
 ds_read_b64_tr_b16 v[232:233], v241 offset:4608
 ds_read_b64_tr_b16 v[234:235], v241 offset:6656
 v_mfma_f32_16x16x32_bf16 v[144:147], v[236:239], a[64:67], v[144:147]
 buffer_load_dwordx4 v253, s[32:35], s51 offen offset:384 lds
 v_mul_f32 v65, s62, v65
 v_mfma_f32_16x16x32_bf16 v[148:151], v[236:239], a[68:71], v[148:151]
 v_mul_f32 v66, s62, v66
 s_add_u32 s51, s56, 557056
 v_mfma_f32_16x16x32_bf16 v[152:155], v[236:239], a[72:75], v[152:155]
 v_mul_f32 v67, s62, v67
 v_mfma_f32_16x16x32_bf16 v[156:159], v[236:239], a[76:79], v[156:159]
 ds_read_b64_tr_b16 v[236:237], v242 offset:4608
 ds_read_b64_tr_b16 v[238:239], v242 offset:6656
 v_mfma_f32_16x16x32_bf16 v[192:195], v[224:227], a[80:83], v[192:195]
 s_add_u32 m0, s59, 1664
 v_mul_f32 v80, s62, v80
 v_mfma_f32_16x16x32_bf16 v[196:199], v[224:227], a[84:87], v[196:199]
 v_mul_f32 v81, s62, v81
 buffer_load_dwordx4 v253, s[32:35], s51 offen offset:384 lds
 v_mfma_f32_16x16x32_bf16 v[200:203], v[224:227], a[88:91], v[200:203]
 s_waitcnt lgkmcnt(2)
 v_mul_f32 v82, s62, v82
 v_mfma_f32_16x16x32_bf16 v[204:207], v[224:227], a[92:95], v[204:207]
 ds_read_b64_tr_b16 v[224:225], v241 offset:8192
 ds_read_b64_tr_b16 v[226:227], v241 offset:10240
 v_mfma_f32_16x16x32_bf16 v[208:211], v[228:231], a[80:83], v[208:211]
 v_mul_f32 v83, s62, v83
 s_add_u32 s51, s56, 1081344
 v_mfma_f32_16x16x32_bf16 v[212:215], v[228:231], a[84:87], v[212:215]
 v_cvt_pk_bf16_f32 v35, v82, v83
 s_add_u32 m0, s59, 9856
 v_mfma_f32_16x16x32_bf16 v[216:219], v[228:231], a[88:91], v[216:219]
 v_cvt_pk_bf16_f32 v34, v80, v81
 v_mfma_f32_16x16x32_bf16 v[220:223], v[228:231], a[92:95], v[220:223]
 ds_read_b64_tr_b16 v[228:229], v242 offset:8192
 ds_read_b64_tr_b16 v[230:231], v242 offset:10240
 v_mfma_f32_16x16x32_bf16 v[128:131], v[232:235], a[80:83], v[128:131]
 v_cvt_pk_bf16_f32 v32, v64, v65
 buffer_load_dwordx4 v253, s[32:35], s51 offen offset:384 lds
 v_mfma_f32_16x16x32_bf16 v[132:135], v[232:235], a[84:87], v[132:135]
 v_cvt_pk_bf16_f32 v33, v66, v67
 v_mfma_f32_16x16x32_bf16 v[136:139], v[232:235], a[88:91], v[136:139]
 s_waitcnt lgkmcnt(2)
 s_add_u32 s51, s56, 786432
 v_mfma_f32_16x16x32_bf16 v[140:143], v[232:235], a[92:95], v[140:143]
 ds_read_b64_tr_b16 v[232:233], v241 offset:8704
 ds_read_b64_tr_b16 v[234:235], v241 offset:10752
 v_mfma_f32_16x16x32_bf16 v[144:147], v[236:239], a[80:83], v[144:147]
 v_mul_f32 v68, s62, v68
 v_mul_f32 v69, s62, v69
 v_mfma_f32_16x16x32_bf16 v[148:151], v[236:239], a[84:87], v[148:151]
 s_add_u32 m0, s59, 3712
 v_permlane16_swap_b32 v32, v34
 v_mfma_f32_16x16x32_bf16 v[152:155], v[236:239], a[88:91], v[152:155]
 v_permlane16_swap_b32 v33, v35
 buffer_load_dwordx4 v253, s[32:35], s51 offen offset:384 lds
 v_mfma_f32_16x16x32_bf16 v[156:159], v[236:239], a[92:95], v[156:159]
 ds_read_b64_tr_b16 v[236:237], v242 offset:8704
 ds_read_b64_tr_b16 v[238:239], v242 offset:10752
 v_mfma_f32_16x16x32_bf16 v[192:195], v[224:227], a[96:99], v[192:195]
 v_mul_f32 v70, s62, v70
 s_add_u32 s51, s56, 1310720
 v_mfma_f32_16x16x32_bf16 v[196:199], v[224:227], a[100:103], v[196:199]
 v_mul_f32 v71, s62, v71
 v_mul_f32 v84, s62, v84
 v_mfma_f32_16x16x32_bf16 v[200:203], v[224:227], a[104:107], v[200:203]
 s_waitcnt lgkmcnt(2)
 s_add_u32 m0, s59, 11904
 v_mfma_f32_16x16x32_bf16 v[204:207], v[224:227], a[108:111], v[204:207]
 ds_read_b64_tr_b16 v[224:225], v241 offset:12288
 ds_read_b64_tr_b16 v[226:227], v241 offset:14336
 v_mfma_f32_16x16x32_bf16 v[208:211], v[228:231], a[96:99], v[208:211]
 v_mul_f32 v85, s62, v85
 buffer_load_dwordx4 v253, s[32:35], s51 offen offset:384 lds
 v_mfma_f32_16x16x32_bf16 v[212:215], v[228:231], a[100:103], v[212:215]
 v_mul_f32 v86, s62, v86
 v_mul_f32 v87, s62, v87
 v_mfma_f32_16x16x32_bf16 v[216:219], v[228:231], a[104:107], v[216:219]
 s_add_u32 s51, s56, 819200
 v_mfma_f32_16x16x32_bf16 v[220:223], v[228:231], a[108:111], v[220:223]
 ds_read_b64_tr_b16 v[228:229], v242 offset:12288
 ds_read_b64_tr_b16 v[230:231], v242 offset:14336
 v_mfma_f32_16x16x32_bf16 v[128:131], v[232:235], a[96:99], v[128:131]
 v_cvt_pk_bf16_f32 v39, v86, v87
 v_cvt_pk_bf16_f32 v38, v84, v85
 v_mfma_f32_16x16x32_bf16 v[132:135], v[232:235], a[100:103], v[132:135]
 s_add_u32 m0, s59, 5760
 v_cvt_pk_bf16_f32 v36, v68, v69
 v_mfma_f32_16x16x32_bf16 v[136:139], v[232:235], a[104:107], v[136:139]
 s_waitcnt lgkmcnt(2)
 buffer_load_dwordx4 v253, s[32:35], s51 offen offset:384 lds
 v_mfma_f32_16x16x32_bf16 v[140:143], v[232:235], a[108:111], v[140:143]
 ds_read_b64_tr_b16 v[232:233], v241 offset:12800
 ds_read_b64_tr_b16 v[234:235], v241 offset:14848
 v_mfma_f32_16x16x32_bf16 v[144:147], v[236:239], a[96:99], v[144:147]
 v_cvt_pk_bf16_f32 v37, v70, v71
 v_mul_f32 v72, s62, v72
 v_mfma_f32_16x16x32_bf16 v[148:151], v[236:239], a[100:103], v[148:151]
 s_add_u32 s51, s56, 1343488
 v_mul_f32 v73, s62, v73
 v_mfma_f32_16x16x32_bf16 v[152:155], v[236:239], a[104:107], v[152:155]
 s_add_u32 m0, s59, 13952
 v_mfma_f32_16x16x32_bf16 v[156:159], v[236:239], a[108:111], v[156:159]
 ds_read_b64_tr_b16 v[236:237], v242 offset:12800
 ds_read_b64_tr_b16 v[238:239], v242 offset:14848
 v_mfma_f32_16x16x32_bf16 v[192:195], v[224:227], a[112:115], v[192:195]
 v_permlane16_swap_b32 v36, v38
 v_add_u32 v241, 32768, v241
 v_mfma_f32_16x16x32_bf16 v[196:199], v[224:227], a[116:119], v[196:199]
 v_permlane16_swap_b32 v37, v39
 buffer_load_dwordx4 v253, s[32:35], s51 offen offset:384 lds
 v_mfma_f32_16x16x32_bf16 v[200:203], v[224:227], a[120:123], v[200:203]
 s_waitcnt lgkmcnt(2)
 v_mul_f32 v74, s62, v74
 v_mfma_f32_16x16x32_bf16 v[204:207], v[224:227], a[124:127], v[204:207]
 v_mul_f32 v75, s62, v75
 buffer_load_dwordx4 a[224:227], v254, s[36:39], s90 offen
 v_mfma_f32_16x16x32_bf16 v[208:211], v[228:231], a[112:115], v[208:211]
 v_add_u32 v242, 32768, v242
 v_mul_f32 v88, s62, v88
 v_mfma_f32_16x16x32_bf16 v[212:215], v[228:231], a[116:119], v[212:215]
 s_add_u32 s90, s90, 1024
 v_mul_f32 v89, s62, v89
 v_mfma_f32_16x16x32_bf16 v[216:219], v[228:231], a[120:123], v[216:219]
 s_waitcnt lgkmcnt(0)
 s_waitcnt vmcnt(19)
 s_barrier
 v_mfma_f32_16x16x32_bf16 v[220:223], v[228:231], a[124:127], v[220:223]
 ds_read_b64_tr_b16 v[224:225], v241 offset:0
 ds_read_b64_tr_b16 v[226:227], v241 offset:2048
 ds_read_b64_tr_b16 v[228:229], v242 offset:0
 ds_read_b64_tr_b16 v[230:231], v242 offset:2048
 v_mfma_f32_16x16x32_bf16 v[128:131], v[232:235], a[112:115], v[128:131]
 v_mul_f32 v90, s62, v90
 v_mul_f32 v91, s62, v91
 v_mfma_f32_16x16x32_bf16 v[132:135], v[232:235], a[116:119], v[132:135]
 v_cvt_pk_bf16_f32 v43, v90, v91
 v_mfma_f32_16x16x32_bf16 v[136:139], v[232:235], a[120:123], v[136:139]
 v_cvt_pk_bf16_f32 v42, v88, v89
 v_mfma_f32_16x16x32_bf16 v[140:143], v[232:235], a[124:127], v[140:143]
 ds_read_b64_tr_b16 v[232:233], v241 offset:512
 ds_read_b64_tr_b16 v[234:235], v241 offset:2560
 v_mfma_f32_16x16x32_bf16 v[144:147], v[236:239], a[112:115], v[144:147]
 v_cvt_pk_bf16_f32 v40, v72, v73
 v_mfma_f32_16x16x32_bf16 v[148:151], v[236:239], a[116:119], v[148:151]
 v_cvt_pk_bf16_f32 v41, v74, v75
 v_mfma_f32_16x16x32_bf16 v[152:155], v[236:239], a[120:123], v[152:155]
 v_mul_f32 v76, s62, v76
 v_mfma_f32_16x16x32_bf16 v[156:159], v[236:239], a[124:127], v[156:159]
 ds_read_b64_tr_b16 v[236:237], v242 offset:512
 ds_read_b64_tr_b16 v[238:239], v242 offset:2560
 s_waitcnt lgkmcnt(6)
 v_mfma_f32_16x16x32_bf16 v[192:195], v[224:227], a[128:131], v[192:195]
 v_mul_f32 v77, s62, v77
 v_mfma_f32_16x16x32_bf16 v[196:199], v[224:227], a[132:135], v[196:199]
 s_add_u32 s51, s56, 1572864
 v_permlane16_swap_b32 v40, v42
 v_mfma_f32_16x16x32_bf16 v[200:203], v[224:227], a[136:139], v[200:203]
 s_waitcnt lgkmcnt(4)
 v_permlane16_swap_b32 v41, v43
 v_mfma_f32_16x16x32_bf16 v[204:207], v[224:227], a[140:143], v[204:207]
 ds_read_b64_tr_b16 v[224:225], v241 offset:4096
 ds_read_b64_tr_b16 v[226:227], v241 offset:6144
 v_mfma_f32_16x16x32_bf16 v[208:211], v[228:231], a[128:131], v[208:211]
 s_add_u32 m0, s59, 32384
 v_mul_f32 v78, s62, v78
 v_mfma_f32_16x16x32_bf16 v[212:215], v[228:231], a[132:135], v[212:215]
 buffer_load_dwordx4 v253, s[32:35], s51 offen offset:384 lds
 v_mul_f32 v79, s62, v79
 v_mfma_f32_16x16x32_bf16 v[216:219], v[228:231], a[136:139], v[216:219]
 s_waitcnt lgkmcnt(4)
 v_mul_f32 v92, s62, v92
 v_mfma_f32_16x16x32_bf16 v[220:223], v[228:231], a[140:143], v[220:223]
 ds_read_b64_tr_b16 v[228:229], v242 offset:4096
 ds_read_b64_tr_b16 v[230:231], v242 offset:6144
 v_mfma_f32_16x16x32_bf16 v[128:131], v[232:235], a[128:131], v[128:131]
 s_add_u32 s51, s56, 2097152
 v_mul_f32 v93, s62, v93
 v_mfma_f32_16x16x32_bf16 v[132:135], v[232:235], a[132:135], v[132:135]
 v_mul_f32 v94, s62, v94
 s_add_u32 m0, s59, 40576
 v_mfma_f32_16x16x32_bf16 v[136:139], v[232:235], a[136:139], v[136:139]
 s_waitcnt lgkmcnt(2)
 v_mul_f32 v95, s62, v95
 v_mfma_f32_16x16x32_bf16 v[140:143], v[232:235], a[140:143], v[140:143]
 ds_read_b64_tr_b16 v[232:233], v241 offset:4608
 ds_read_b64_tr_b16 v[234:235], v241 offset:6656
 v_mfma_f32_16x16x32_bf16 v[144:147], v[236:239], a[128:131], v[144:147]
 buffer_load_dwordx4 v253, s[32:35], s51 offen offset:384 lds
 v_cvt_pk_bf16_f32 v47, v94, v95
 v_mfma_f32_16x16x32_bf16 v[148:151], v[236:239], a[132:135], v[148:151]
 v_cvt_pk_bf16_f32 v46, v92, v93
 s_add_u32 s51, s56, 1605632
 v_mfma_f32_16x16x32_bf16 v[152:155], v[236:239], a[136:139], v[152:155]
 v_cvt_pk_bf16_f32 v44, v76, v77
 v_mfma_f32_16x16x32_bf16 v[156:159], v[236:239], a[140:143], v[156:159]
 ds_read_b64_tr_b16 v[236:237], v242 offset:4608
 ds_read_b64_tr_b16 v[238:239], v242 offset:6656
 v_mfma_f32_16x16x32_bf16 v[192:195], v[224:227], a[144:147], v[192:195]
 s_add_u32 m0, s59, 34432
 v_cvt_pk_bf16_f32 v45, v78, v79
 v_mfma_f32_16x16x32_bf16 v[196:199], v[224:227], a[148:151], v[196:199]
 v_mul_f32 v96, s62, v96
 buffer_load_dwordx4 v253, s[32:35], s51 offen offset:384 lds
 v_mfma_f32_16x16x32_bf16 v[200:203], v[224:227], a[152:155], v[200:203]
 s_waitcnt lgkmcnt(2)
 v_mul_f32 v97, s62, v97
 v_mfma_f32_16x16x32_bf16 v[204:207], v[224:227], a[156:159], v[204:207]
 ds_read_b64_tr_b16 v[224:225], v241 offset:8192
 ds_read_b64_tr_b16 v[226:227], v241 offset:10240
 v_mfma_f32_16x16x32_bf16 v[208:211], v[228:231], a[144:147], v[208:211]
 v_permlane16_swap_b32 v44, v46
 s_add_u32 s51, s56, 2129920
 v_mfma_f32_16x16x32_bf16 v[212:215], v[228:231], a[148:151], v[212:215]
 v_permlane16_swap_b32 v45, v47
 s_add_u32 m0, s59, 42624
 v_mfma_f32_16x16x32_bf16 v[216:219], v[228:231], a[152:155], v[216:219]
 v_mul_f32 v98, s62, v98
 v_mfma_f32_16x16x32_bf16 v[220:223], v[228:231], a[156:159], v[220:223]
 ds_read_b64_tr_b16 v[228:229], v242 offset:8192
 ds_read_b64_tr_b16 v[230:231], v242 offset:10240
 v_mfma_f32_16x16x32_bf16 v[128:131], v[232:235], a[144:147], v[128:131]
 v_mul_f32 v99, s62, v99
 buffer_load_dwordx4 v253, s[32:35], s51 offen offset:384 lds
 v_mfma_f32_16x16x32_bf16 v[132:135], v[232:235], a[148:151], v[132:135]
 v_mul_f32 v112, s62, v112
 v_mfma_f32_16x16x32_bf16 v[136:139], v[232:235], a[152:155], v[136:139]
 s_waitcnt lgkmcnt(2)
 s_add_u32 s51, s56, 1835008
 v_mfma_f32_16x16x32_bf16 v[140:143], v[232:235], a[156:159], v[140:143]
 ds_read_b64_tr_b16 v[232:233], v241 offset:8704
 ds_read_b64_tr_b16 v[234:235], v241 offset:10752
 v_mfma_f32_16x16x32_bf16 v[144:147], v[236:239], a[144:147], v[144:147]
 v_mul_f32 v113, s62, v113
 v_mul_f32 v114, s62, v114
 v_mfma_f32_16x16x32_bf16 v[148:151], v[236:239], a[148:151], v[148:151]
 s_add_u32 m0, s59, 36480
 v_mul_f32 v115, s62, v115
 v_mfma_f32_16x16x32_bf16 v[152:155], v[236:239], a[152:155], v[152:155]
 v_cvt_pk_bf16_f32 v51, v114, v115
 buffer_load_dwordx4 v253, s[32:35], s51 offen offset:384 lds
 v_mfma_f32_16x16x32_bf16 v[156:159], v[236:239], a[156:159], v[156:159]
 ds_read_b64_tr_b16 v[236:237], v242 offset:8704
 ds_read_b64_tr_b16 v[238:239], v242 offset:10752
 v_mfma_f32_16x16x32_bf16 v[192:195], v[224:227], a[160:163], v[192:195]
 v_cvt_pk_bf16_f32 v50, v112, v113
 s_add_u32 s51, s56, 2359296
 v_mfma_f32_16x16x32_bf16 v[196:199], v[224:227], a[164:167], v[196:199]
 v_cvt_pk_bf16_f32 v48, v96, v97
 v_cvt_pk_bf16_f32 v49, v98, v99
 v_mfma_f32_16x16x32_bf16 v[200:203], v[224:227], a[168:171], v[200:203]
 s_waitcnt lgkmcnt(2)
 s_add_u32 m0, s59, 44672
 v_mfma_f32_16x16x32_bf16 v[204:207], v[224:227], a[172:175], v[204:207]
 ds_read_b64_tr_b16 v[224:225], v241 offset:12288
 ds_read_b64_tr_b16 v[226:227], v241 offset:14336
 v_mfma_f32_16x16x32_bf16 v[208:211], v[228:231], a[160:163], v[208:211]
 v_mul_f32 v100, s62, v100
 buffer_load_dwordx4 v253, s[32:35], s51 offen offset:384 lds
 v_mfma_f32_16x16x32_bf16 v[212:215], v[228:231], a[164:167], v[212:215]
 v_mul_f32 v101, s62, v101
 v_permlane16_swap_b32 v48, v50
 v_mfma_f32_16x16x32_bf16 v[216:219], v[228:231], a[168:171], v[216:219]
 s_add_u32 s51, s56, 1867776
 v_mfma_f32_16x16x32_bf16 v[220:223], v[228:231], a[172:175], v[220:223]
 ds_read_b64_tr_b16 v[228:229], v242 offset:12288
 ds_read_b64_tr_b16 v[230:231], v242 offset:14336
 v_mfma_f32_16x16x32_bf16 v[128:131], v[232:235], a[160:163], v[128:131]
 v_permlane16_swap_b32 v49, v51
 v_mul_f32 v102, s62, v102
 v_mfma_f32_16x16x32_bf16 v[132:135], v[232:235], a[164:167], v[132:135]
 s_add_u32 m0, s59, 38528
 v_mul_f32 v103, s62, v103
 v_mfma_f32_16x16x32_bf16 v[136:139], v[232:235], a[168:171], v[136:139]
 s_waitcnt lgkmcnt(2)
 buffer_load_dwordx4 v253, s[32:35], s51 offen offset:384 lds
 v_mfma_f32_16x16x32_bf16 v[140:143], v[232:235], a[172:175], v[140:143]
 ds_read_b64_tr_b16 v[232:233], v241 offset:12800
 ds_read_b64_tr_b16 v[234:235], v241 offset:14848
 v_mfma_f32_16x16x32_bf16 v[144:147], v[236:239], a[160:163], v[144:147]
 v_mul_f32 v116, s62, v116
 v_mul_f32 v117, s62, v117
 v_mfma_f32_16x16x32_bf16 v[148:151], v[236:239], a[164:167], v[148:151]
 s_add_u32 s51, s56, 2392064
 v_mul_f32 v118, s62, v118
 v_mfma_f32_16x16x32_bf16 v[152:155], v[236:239], a[168:171], v[152:155]
 s_add_u32 m0, s59, 46720
 v_mfma_f32_16x16x32_bf16 v[156:159], v[236:239], a[172:175], v[156:159]
 ds_read_b64_tr_b16 v[236:237], v242 offset:12800
 ds_read_b64_tr_b16 v[238:239], v242 offset:14848
 v_mfma_f32_16x16x32_bf16 v[192:195], v[224:227], a[176:179], v[192:195]
 v_mul_f32 v119, s62, v119
 v_add_u32 v241, 32768, v241
 v_mfma_f32_16x16x32_bf16 v[196:199], v[224:227], a[180:183], v[196:199]
 v_cvt_pk_bf16_f32 v55, v118, v119
 buffer_load_dwordx4 v253, s[32:35], s51 offen offset:384 lds
 v_mfma_f32_16x16x32_bf16 v[200:203], v[224:227], a[184:187], v[200:203]
 s_waitcnt lgkmcnt(2)
 v_cvt_pk_bf16_f32 v54, v116, v117
 v_mfma_f32_16x16x32_bf16 v[204:207], v[224:227], a[188:191], v[204:207]
 v_cvt_pk_bf16_f32 v52, v100, v101
 buffer_load_dwordx4 a[224:227], v254, s[36:39], s90 offen
 v_mfma_f32_16x16x32_bf16 v[208:211], v[228:231], a[176:179], v[208:211]
 v_add_u32 v242, 32768, v242
 v_cvt_pk_bf16_f32 v53, v102, v103
 v_mfma_f32_16x16x32_bf16 v[212:215], v[228:231], a[180:183], v[212:215]
 s_add_u32 s90, s90, 1024
 v_mul_f32 v104, s62, v104
 v_mfma_f32_16x16x32_bf16 v[216:219], v[228:231], a[184:187], v[216:219]
 s_waitcnt lgkmcnt(0)
 s_waitcnt vmcnt(19)
 s_barrier
 v_mfma_f32_16x16x32_bf16 v[220:223], v[228:231], a[188:191], v[220:223]
 ds_read_b64_tr_b16 v[224:225], v241 offset:0
 ds_read_b64_tr_b16 v[226:227], v241 offset:2048
 ds_read_b64_tr_b16 v[228:229], v242 offset:0
 ds_read_b64_tr_b16 v[230:231], v242 offset:2048
 v_mfma_f32_16x16x32_bf16 v[128:131], v[232:235], a[176:179], v[128:131]
 v_mul_f32 v105, s62, v105
 v_permlane16_swap_b32 v52, v54
 v_mfma_f32_16x16x32_bf16 v[132:135], v[232:235], a[180:183], v[132:135]
 v_permlane16_swap_b32 v53, v55
 v_mfma_f32_16x16x32_bf16 v[136:139], v[232:235], a[184:187], v[136:139]
 v_mul_f32 v106, s62, v106
 v_mfma_f32_16x16x32_bf16 v[140:143], v[232:235], a[188:191], v[140:143]
 ds_read_b64_tr_b16 v[232:233], v241 offset:512
 ds_read_b64_tr_b16 v[234:235], v241 offset:2560
 v_mfma_f32_16x16x32_bf16 v[144:147], v[236:239], a[176:179], v[144:147]
 v_mul_f32 v107, s62, v107
 v_mfma_f32_16x16x32_bf16 v[148:151], v[236:239], a[180:183], v[148:151]
 v_mul_f32 v120, s62, v120
 v_mfma_f32_16x16x32_bf16 v[152:155], v[236:239], a[184:187], v[152:155]
 v_mul_f32 v121, s62, v121
 v_mfma_f32_16x16x32_bf16 v[156:159], v[236:239], a[188:191], v[156:159]
 ds_read_b64_tr_b16 v[236:237], v242 offset:512
 ds_read_b64_tr_b16 v[238:239], v242 offset:2560
 s_waitcnt lgkmcnt(6)
 v_mfma_f32_16x16x32_bf16 v[192:195], v[224:227], a[192:195], v[192:195]
 v_mul_f32 v122, s62, v122
 v_mfma_f32_16x16x32_bf16 v[196:199], v[224:227], a[196:199], v[196:199]
 s_add_u32 s51, s56, 2621440
 v_mul_f32 v123, s62, v123
 v_mfma_f32_16x16x32_bf16 v[200:203], v[224:227], a[200:203], v[200:203]
 s_waitcnt lgkmcnt(4)
 v_cvt_pk_bf16_f32 v59, v122, v123
 v_mfma_f32_16x16x32_bf16 v[204:207], v[224:227], a[204:207], v[204:207]
 ds_read_b64_tr_b16 v[224:225], v241 offset:4096
 ds_read_b64_tr_b16 v[226:227], v241 offset:6144
 v_mfma_f32_16x16x32_bf16 v[208:211], v[228:231], a[192:195], v[208:211]
 s_add_u32 m0, s59, 65152
 v_cvt_pk_bf16_f32 v58, v120, v121
 v_mfma_f32_16x16x32_bf16 v[212:215], v[228:231], a[196:199], v[212:215]
 buffer_load_dwordx4 v253, s[32:35], s51 offen offset:384 lds
 v_cvt_pk_bf16_f32 v56, v104, v105
 v_mfma_f32_16x16x32_bf16 v[216:219], v[228:231], a[200:203], v[216:219]
 s_waitcnt lgkmcnt(4)
 v_cvt_pk_bf16_f32 v57, v106, v107
 v_mfma_f32_16x16x32_bf16 v[220:223], v[228:231], a[204:207], v[220:223]
 ds_read_b64_tr_b16 v[228:229], v242 offset:4096
 ds_read_b64_tr_b16 v[230:231], v242 offset:6144
 v_mfma_f32_16x16x32_bf16 v[128:131], v[232:235], a[192:195], v[128:131]
 s_add_u32 s51, s56, 3145728
 v_mul_f32 v108, s62, v108
 v_mfma_f32_16x16x32_bf16 v[132:135], v[232:235], a[196:199], v[132:135]
 v_mul_f32 v109, s62, v109
 s_add_u32 m0, s59, 73344
 v_mfma_f32_16x16x32_bf16 v[136:139], v[232:235], a[200:203], v[136:139]
 s_waitcnt lgkmcnt(2)
 v_permlane16_swap_b32 v56, v58
 v_mfma_f32_16x16x32_bf16 v[140:143], v[232:235], a[204:207], v[140:143]
 ds_read_b64_tr_b16 v[232:233], v241 offset:4608
 ds_read_b64_tr_b16 v[234:235], v241 offset:6656
 v_mfma_f32_16x16x32_bf16 v[144:147], v[236:239], a[192:195], v[144:147]
 buffer_load_dwordx4 v253, s[32:35], s51 offen offset:384 lds
 v_permlane16_swap_b32 v57, v59
 v_mfma_f32_16x16x32_bf16 v[148:151], v[236:239], a[196:199], v[148:151]
 v_mul_f32 v110, s62, v110
 s_add_u32 s51, s56, 2654208
 v_mfma_f32_16x16x32_bf16 v[152:155], v[236:239], a[200:203], v[152:155]
 v_mul_f32 v111, s62, v111
 v_mfma_f32_16x16x32_bf16 v[156:159], v[236:239], a[204:207], v[156:159]
 ds_read_b64_tr_b16 v[236:237], v242 offset:4608
 ds_read_b64_tr_b16 v[238:239], v242 offset:6656
 v_mfma_f32_16x16x32_bf16 v[192:195], v[224:227], a[208:211], v[192:195]
 s_add_u32 m0, s59, 67200
 v_mul_f32 v124, s62, v124
 v_mfma_f32_16x16x32_bf16 v[196:199], v[224:227], a[212:215], v[196:199]
 v_mul_f32 v125, s62, v125
 buffer_load_dwordx4 v253, s[32:35], s51 offen offset:384 lds
 v_mfma_f32_16x16x32_bf16 v[200:203], v[224:227], a[216:219], v[200:203]
 s_waitcnt lgkmcnt(2)
 v_mul_f32 v126, s62, v126
 v_mfma_f32_16x16x32_bf16 v[204:207], v[224:227], a[220:223], v[204:207]
 ds_read_b64_tr_b16 v[224:225], v241 offset:8192
 ds_read_b64_tr_b16 v[226:227], v241 offset:10240
 v_mfma_f32_16x16x32_bf16 v[208:211], v[228:231], a[208:211], v[208:211]
 s_add_u32 s51, s56, 3178496
 v_mul_f32 v127, s62, v127
 v_mfma_f32_16x16x32_bf16 v[212:215], v[228:231], a[212:215], v[212:215]
 v_cvt_pk_bf16_f32 v63, v126, v127
 s_add_u32 m0, s59, 75392
 v_mfma_f32_16x16x32_bf16 v[216:219], v[228:231], a[216:219], v[216:219]
 v_cvt_pk_bf16_f32 v62, v124, v125
 v_mfma_f32_16x16x32_bf16 v[220:223], v[228:231], a[220:223], v[220:223]
 ds_read_b64_tr_b16 v[228:229], v242 offset:8192
 ds_read_b64_tr_b16 v[230:231], v242 offset:10240
 v_mfma_f32_16x16x32_bf16 v[128:131], v[232:235], a[208:211], v[128:131]
 v_cvt_pk_bf16_f32 v60, v108, v109
 buffer_load_dwordx4 v253, s[32:35], s51 offen offset:384 lds
 v_mfma_f32_16x16x32_bf16 v[132:135], v[232:235], a[212:215], v[132:135]
 v_cvt_pk_bf16_f32 v61, v110, v111
 v_mfma_f32_16x16x32_bf16 v[136:139], v[232:235], a[216:219], v[136:139]
 s_waitcnt lgkmcnt(2)
 s_add_u32 s51, s56, 2883584
 v_mfma_f32_16x16x32_bf16 v[140:143], v[232:235], a[220:223], v[140:143]
 ds_read_b64_tr_b16 v[232:233], v241 offset:8704
 ds_read_b64_tr_b16 v[234:235], v241 offset:10752
 v_mfma_f32_16x16x32_bf16 v[144:147], v[236:239], a[208:211], v[144:147]
 v_permlane16_swap_b32 v60, v62
 v_permlane16_swap_b32 v61, v63
 v_mfma_f32_16x16x32_bf16 v[148:151], v[236:239], a[212:215], v[148:151]
 s_add_u32 m0, s59, 69248
 v_mfma_f32_16x16x32_bf16 v[152:155], v[236:239], a[216:219], v[152:155]
 buffer_load_dwordx4 v253, s[32:35], s51 offen offset:384 lds
 v_mfma_f32_16x16x32_bf16 v[156:159], v[236:239], a[220:223], v[156:159]
 ds_read_b64_tr_b16 v[236:237], v242 offset:8704
 ds_read_b64_tr_b16 v[238:239], v242 offset:10752
 v_mfma_f32_16x16x32_bf16 v[160:163], v[224:227], a[0:3], 0
 s_add_u32 s51, s56, 3407872
 v_mfma_f32_16x16x32_bf16 v[164:167], v[224:227], a[4:7], 0
 v_mfma_f32_16x16x32_bf16 v[168:171], v[224:227], a[8:11], 0
 s_waitcnt lgkmcnt(2)
 s_add_u32 m0, s59, 77440
 v_mfma_f32_16x16x32_bf16 v[172:175], v[224:227], a[12:15], 0
 ds_read_b64_tr_b16 v[224:225], v241 offset:12288
 ds_read_b64_tr_b16 v[226:227], v241 offset:14336
 v_mfma_f32_16x16x32_bf16 v[176:179], v[228:231], a[0:3], 0
 v_mul_f32 v192, s62, v192
 buffer_load_dwordx4 v253, s[32:35], s51 offen offset:384 lds
 v_mfma_f32_16x16x32_bf16 v[180:183], v[228:231], a[4:7], 0
 v_mfma_f32_16x16x32_bf16 v[184:187], v[228:231], a[8:11], 0
 v_mul_f32 v193, s62, v193
 s_add_u32 s51, s56, 2916352
 v_mfma_f32_16x16x32_bf16 v[188:191], v[228:231], a[12:15], 0
 ds_read_b64_tr_b16 v[228:229], v242 offset:12288
 ds_read_b64_tr_b16 v[230:231], v242 offset:14336
 v_mfma_f32_16x16x32_bf16 v[96:99], v[232:235], a[0:3], 0
 v_mul_f32 v194, s62, v194
 s_add_u32 m0, s59, 71296
 v_mfma_f32_16x16x32_bf16 v[100:103], v[232:235], a[4:7], 0
 v_mfma_f32_16x16x32_bf16 v[104:107], v[232:235], a[8:11], 0
 s_waitcnt lgkmcnt(2)
 v_mul_f32 v195, s62, v195
 v_mfma_f32_16x16x32_bf16 v[108:111], v[232:235], a[12:15], 0
 ds_read_b64_tr_b16 v[232:233], v241 offset:12800
 ds_read_b64_tr_b16 v[234:235], v241 offset:14848
 v_mfma_f32_16x16x32_bf16 v[112:115], v[236:239], a[0:3], 0
 buffer_load_dwordx4 v253, s[32:35], s51 offen offset:384 lds
 v_mul_f32 v208, s62, v208
 v_mfma_f32_16x16x32_bf16 v[116:119], v[236:239], a[4:7], 0
 s_add_u32 s51, s56, 3440640
 v_mfma_f32_16x16x32_bf16 v[120:123], v[236:239], a[8:11], 0
 v_mul_f32 v209, s62, v209
 s_add_u32 m0, s59, 79488
 v_mfma_f32_16x16x32_bf16 v[124:127], v[236:239], a[12:15], 0
 ds_read_b64_tr_b16 v[236:237], v242 offset:12800
 ds_read_b64_tr_b16 v[238:239], v242 offset:14848
 v_mfma_f32_16x16x32_bf16 v[160:163], v[224:227], a[16:19], v[160:163]
 v_mul_f32 v210, s62, v210
 v_subrev_u32 v241, 98304, v241
 v_mfma_f32_16x16x32_bf16 v[164:167], v[224:227], a[20:23], v[164:167]
 buffer_load_dwordx4 v253, s[32:35], s51 offen offset:384 lds
 v_mfma_f32_16x16x32_bf16 v[168:171], v[224:227], a[24:27], v[168:171]
 s_waitcnt lgkmcnt(2)
 v_mul_f32 v211, s62, v211
 v_mfma_f32_16x16x32_bf16 v[172:175], v[224:227], a[28:31], v[172:175]
 buffer_load_dwordx4 a[224:227], v254, s[36:39], s90 offen
 v_subrev_u32 v242, 98304, v242
 v_mfma_f32_16x16x32_bf16 v[176:179], v[228:231], a[16:19], v[176:179]
 v_cvt_pk_bf16_f32 v67, v210, v211
 s_add_u32 s90, s90, 1024
 v_mfma_f32_16x16x32_bf16 v[180:183], v[228:231], a[20:23], v[180:183]
 v_mfma_f32_16x16x32_bf16 v[184:187], v[228:231], a[24:27], v[184:187]
 s_waitcnt lgkmcnt(0)
 s_waitcnt vmcnt(19)
 s_barrier
 v_mfma_f32_16x16x32_bf16 v[188:191], v[228:231], a[28:31], v[188:191]
 ds_read_b64_tr_b16 v[224:225], v241 offset:0
 ds_read_b64_tr_b16 v[226:227], v241 offset:2048
 ds_read_b64_tr_b16 v[228:229], v242 offset:0
 ds_read_b64_tr_b16 v[230:231], v242 offset:2048
 v_mfma_f32_16x16x32_bf16 v[96:99], v[232:235], a[16:19], v[96:99]
 v_cvt_pk_bf16_f32 v66, v208, v209
 v_cvt_pk_bf16_f32 v64, v192, v193
 v_mfma_f32_16x16x32_bf16 v[100:103], v[232:235], a[20:23], v[100:103]
 v_mfma_f32_16x16x32_bf16 v[104:107], v[232:235], a[24:27], v[104:107]
 v_cvt_pk_bf16_f32 v65, v194, v195
 v_mfma_f32_16x16x32_bf16 v[108:111], v[232:235], a[28:31], v[108:111]
 ds_read_b64_tr_b16 v[232:233], v241 offset:512
 ds_read_b64_tr_b16 v[234:235], v241 offset:2560
 v_mfma_f32_16x16x32_bf16 v[112:115], v[236:239], a[16:19], v[112:115]
 v_mul_f32 v196, s62, v196
 v_mfma_f32_16x16x32_bf16 v[116:119], v[236:239], a[20:23], v[116:119]
 v_mfma_f32_16x16x32_bf16 v[120:123], v[236:239], a[24:27], v[120:123]
 v_mul_f32 v197, s62, v197
 v_mfma_f32_16x16x32_bf16 v[124:127], v[236:239], a[28:31], v[124:127]
 ds_read_b64_tr_b16 v[236:237], v242 offset:512
 ds_read_b64_tr_b16 v[238:239], v242 offset:2560
 s_waitcnt lgkmcnt(6)
 v_mfma_f32_16x16x32_bf16 v[160:163], v[224:227], a[32:35], v[160:163]
 v_permlane16_swap_b32 v64, v66
 v_mfma_f32_16x16x32_bf16 v[164:167], v[224:227], a[36:39], v[164:167]
 s_add_u32 m0, s69, 98304
 v_permlane16_swap_b32 v65, v67
 v_mfma_f32_16x16x32_bf16 v[168:171], v[224:227], a[40:43], v[168:171]
 s_waitcnt lgkmcnt(4)
 v_mfma_f32_16x16x32_bf16 v[172:175], v[224:227], a[44:47], v[172:175]
 ds_read_b64_tr_b16 v[224:225], v241 offset:4096
 ds_read_b64_tr_b16 v[226:227], v241 offset:6144
 v_mfma_f32_16x16x32_bf16 v[176:179], v[228:231], a[32:35], v[176:179]
 buffer_load_dwordx4 v243, s[24:27], s54 offen offset:0 nt lds
 v_mul_f32 v198, s62, v198
 v_mfma_f32_16x16x32_bf16 v[180:183], v[228:231], a[36:39], v[180:183]
 v_mbcnt_lo_u32_b32 v249, -1, 0
 v_mul_f32 v199, s62, v199
 v_mfma_f32_16x16x32_bf16 v[184:187], v[228:231], a[40:43], v[184:187]
 s_waitcnt lgkmcnt(4)
 s_add_u32 m0, s69, 106496
 v_mfma_f32_16x16x32_bf16 v[188:191], v[228:231], a[44:47], v[188:191]
 ds_read_b64_tr_b16 v[228:229], v242 offset:4096
 ds_read_b64_tr_b16 v[230:231], v242 offset:6144
 v_mfma_f32_16x16x32_bf16 v[96:99], v[232:235], a[32:35], v[96:99]
 v_mbcnt_hi_u32_b32 v249, -1, v249
 v_mul_f32 v212, s62, v212
 v_mfma_f32_16x16x32_bf16 v[100:103], v[232:235], a[36:39], v[100:103]
 buffer_load_dwordx4 v243, s[24:27], s53 offen offset:0 nt lds
 v_mul_f32 v213, s62, v213
 v_mfma_f32_16x16x32_bf16 v[104:107], v[232:235], a[40:43], v[104:107]
 s_waitcnt lgkmcnt(2)
 v_lshrrev_b32 v250, 2, v249
 v_mfma_f32_16x16x32_bf16 v[108:111], v[232:235], a[44:47], v[108:111]
 ds_read_b64_tr_b16 v[232:233], v241 offset:4608
 ds_read_b64_tr_b16 v[234:235], v241 offset:6656
 v_mfma_f32_16x16x32_bf16 v[112:115], v[236:239], a[32:35], v[112:115]
 v_mul_f32 v214, s62, v214
 s_add_u32 m0, s69, 99200
 v_mfma_f32_16x16x32_bf16 v[116:119], v[236:239], a[36:39], v[116:119]
 v_mul_u32_u24 v253, 896, v250
 v_mul_f32 v215, s62, v215
 v_mfma_f32_16x16x32_bf16 v[120:123], v[236:239], a[40:43], v[120:123]
 buffer_load_dwordx4 v243, s[24:27], s54 offen offset:128 nt lds
 v_mfma_f32_16x16x32_bf16 v[124:127], v[236:239], a[44:47], v[124:127]
 ds_read_b64_tr_b16 v[236:237], v242 offset:4608
 ds_read_b64_tr_b16 v[238:239], v242 offset:6656
 v_mfma_f32_16x16x32_bf16 v[160:163], v[224:227], a[48:51], v[160:163]
 v_cvt_pk_bf16_f32 v71, v214, v215
 v_bfe_u32 v250, v249, 4, 1
 v_mfma_f32_16x16x32_bf16 v[164:167], v[224:227], a[52:55], v[164:167]
 v_cvt_pk_bf16_f32 v70, v212, v213
 s_add_u32 m0, s69, 107392
 v_mfma_f32_16x16x32_bf16 v[168:171], v[224:227], a[56:59], v[168:171]
 s_waitcnt lgkmcnt(2)
 v_mfma_f32_16x16x32_bf16 v[172:175], v[224:227], a[60:63], v[172:175]
 ds_read_b64_tr_b16 v[224:225], v241 offset:8192
 ds_read_b64_tr_b16 v[226:227], v241 offset:10240
 v_mfma_f32_16x16x32_bf16 v[176:179], v[228:231], a[48:51], v[176:179]
 v_lshlrev_b32 v250, 1, v250
 v_cvt_pk_bf16_f32 v68, v196, v197
 v_mfma_f32_16x16x32_bf16 v[180:183], v[228:231], a[52:55], v[180:183]
 buffer_load_dwordx4 v243, s[24:27], s53 offen offset:128 nt lds
 v_cvt_pk_bf16_f32 v69, v198, v199
 v_mfma_f32_16x16x32_bf16 v[184:187], v[228:231], a[56:59], v[184:187]
 v_xor_b32 v250, v250, v249
 v_mfma_f32_16x16x32_bf16 v[188:191], v[228:231], a[60:63], v[188:191]
 ds_read_b64_tr_b16 v[228:229], v242 offset:8192
 ds_read_b64_tr_b16 v[230:231], v242 offset:10240
 v_mfma_f32_16x16x32_bf16 v[96:99], v[232:235], a[48:51], v[96:99]
 s_add_u32 m0, s69, 100096
 v_mul_f32 v200, s62, v200
 v_mfma_f32_16x16x32_bf16 v[100:103], v[232:235], a[52:55], v[100:103]
 v_and_b32 v250, 3, v250
 v_mul_f32 v201, s62, v201
 v_mfma_f32_16x16x32_bf16 v[104:107], v[232:235], a[56:59], v[104:107]
 s_waitcnt lgkmcnt(2)
 buffer_load_dwordx4 v243, s[24:27], s54 offen offset:256 nt lds
 v_mfma_f32_16x16x32_bf16 v[108:111], v[232:235], a[60:63], v[108:111]
 ds_read_b64_tr_b16 v[232:233], v241 offset:8704
 ds_read_b64_tr_b16 v[234:235], v241 offset:10752
 v_mfma_f32_16x16x32_bf16 v[112:115], v[236:239], a[48:51], v[112:115]
 v_permlane16_swap_b32 v68, v70
 v_lshl_add_u32 v253, v250, 4, v253
 v_mfma_f32_16x16x32_bf16 v[116:119], v[236:239], a[52:55], v[116:119]
 s_add_u32 m0, s69, 108288
 v_permlane16_swap_b32 v69, v71
 v_mfma_f32_16x16x32_bf16 v[120:123], v[236:239], a[56:59], v[120:123]
 v_mfma_f32_16x16x32_bf16 v[124:127], v[236:239], a[60:63], v[124:127]
 ds_read_b64_tr_b16 v[236:237], v242 offset:8704
 ds_read_b64_tr_b16 v[238:239], v242 offset:10752
 v_mfma_f32_16x16x32_bf16 v[160:163], v[224:227], a[64:67], v[160:163]
 v_mul_f32 v202, s62, v202
 buffer_load_dwordx4 v243, s[24:27], s53 offen offset:256 nt lds
 v_mfma_f32_16x16x32_bf16 v[164:167], v[224:227], a[68:71], v[164:167]
 v_mul_f32 v203, s62, v203
 v_mfma_f32_16x16x32_bf16 v[168:171], v[224:227], a[72:75], v[168:171]
 s_waitcnt lgkmcnt(2)
 s_add_u32 m0, s69, 100992
 v_mfma_f32_16x16x32_bf16 v[172:175], v[224:227], a[76:79], v[172:175]
 ds_read_b64_tr_b16 v[224:225], v241 offset:12288
 ds_read_b64_tr_b16 v[226:227], v241 offset:14336
 v_mfma_f32_16x16x32_bf16 v[176:179], v[228:231], a[64:67], v[176:179]
 v_mul_f32 v216, s62, v216
 v_mul_f32 v217, s62, v217
 v_mfma_f32_16x16x32_bf16 v[180:183], v[228:231], a[68:71], v[180:183]
 buffer_load_dwordx4 v243, s[24:27], s54 offen offset:384 nt lds
 v_mfma_f32_16x16x32_bf16 v[184:187], v[228:231], a[72:75], v[184:187]
 v_mul_f32 v218, s62, v218
 v_mfma_f32_16x16x32_bf16 v[188:191], v[228:231], a[76:79], v[188:191]
 ds_read_b64_tr_b16 v[228:229], v242 offset:12288
 ds_read_b64_tr_b16 v[230:231], v242 offset:14336
 v_mfma_f32_16x16x32_bf16 v[96:99], v[232:235], a[64:67], v[96:99]
 s_add_u32 m0, s69, 109184
 v_mul_f32 v219, s62, v219
 v_mfma_f32_16x16x32_bf16 v[100:103], v[232:235], a[68:71], v[100:103]
 v_mfma_f32_16x16x32_bf16 v[104:107], v[232:235], a[72:75], v[104:107]
 s_waitcnt lgkmcnt(2)
 v_cvt_pk_bf16_f32 v75, v218, v219
 v_mfma_f32_16x16x32_bf16 v[108:111], v[232:235], a[76:79], v[108:111]
 ds_read_b64_tr_b16 v[232:233], v241 offset:12800
 ds_read_b64_tr_b16 v[234:235], v241 offset:14848
 v_mfma_f32_16x16x32_bf16 v[112:115], v[236:239], a[64:67], v[112:115]
 buffer_load_dwordx4 v243, s[24:27], s53 offen offset:384 nt lds
 v_cvt_pk_bf16_f32 v74, v216, v217
 v_mfma_f32_16x16x32_bf16 v[116:119], v[236:239], a[68:71], v[116:119]
 s_add_u32 s54, s54, 16384
 v_mfma_f32_16x16x32_bf16 v[120:123], v[236:239], a[72:75], v[120:123]
 v_cvt_pk_bf16_f32 v72, v200, v201
 v_mfma_f32_16x16x32_bf16 v[124:127], v[236:239], a[76:79], v[124:127]
 ds_read_b64_tr_b16 v[236:237], v242 offset:12800
 ds_read_b64_tr_b16 v[238:239], v242 offset:14848
 v_mfma_f32_16x16x32_bf16 v[160:163], v[224:227], a[80:83], v[160:163]
 v_add_u32 v241, 32768, v241
 s_add_u32 s53, s53, 16384
 v_mfma_f32_16x16x32_bf16 v[164:167], v[224:227], a[84:87], v[164:167]
 v_cvt_pk_bf16_f32 v73, v202, v203
 v_mfma_f32_16x16x32_bf16 v[168:171], v[224:227], a[88:91], v[168:171]
 s_waitcnt lgkmcnt(2)
 v_mul_f32 v204, s62, v204
 v_mfma_f32_16x16x32_bf16 v[172:175], v[224:227], a[92:95], v[172:175]
 buffer_load_dwordx4 a[224:227], v254, s[36:39], s90 offen
 v_add_u32 v242, 32768, v242
 v_mfma_f32_16x16x32_bf16 v[176:179], v[228:231], a[80:83], v[176:179]
 v_mul_f32 v205, s62, v205
 s_add_u32 s90, s90, 1024
 v_mfma_f32_16x16x32_bf16 v[180:183], v[228:231], a[84:87], v[180:183]
 v_mfma_f32_16x16x32_bf16 v[184:187], v[228:231], a[88:91], v[184:187]
 s_waitcnt lgkmcnt(0)
 s_waitcnt vmcnt(19)
 s_barrier
 v_mfma_f32_16x16x32_bf16 v[188:191], v[228:231], a[92:95], v[188:191]
 ds_read_b64_tr_b16 v[224:225], v241 offset:0
 ds_read_b64_tr_b16 v[226:227], v241 offset:2048
 ds_read_b64_tr_b16 v[228:229], v242 offset:0
 ds_read_b64_tr_b16 v[230:231], v242 offset:2048
 v_mfma_f32_16x16x32_bf16 v[96:99], v[232:235], a[80:83], v[96:99]
 v_permlane16_swap_b32 v72, v74
 v_permlane16_swap_b32 v73, v75
 v_mfma_f32_16x16x32_bf16 v[100:103], v[232:235], a[84:87], v[100:103]
 v_mfma_f32_16x16x32_bf16 v[104:107], v[232:235], a[88:91], v[104:107]
 v_mul_f32 v206, s62, v206
 v_mfma_f32_16x16x32_bf16 v[108:111], v[232:235], a[92:95], v[108:111]
 ds_read_b64_tr_b16 v[232:233], v241 offset:512
 ds_read_b64_tr_b16 v[234:235], v241 offset:2560
 v_mfma_f32_16x16x32_bf16 v[112:115], v[236:239], a[80:83], v[112:115]
 v_mul_f32 v207, s62, v207
 v_mfma_f32_16x16x32_bf16 v[116:119], v[236:239], a[84:87], v[116:119]
 v_mfma_f32_16x16x32_bf16 v[120:123], v[236:239], a[88:91], v[120:123]
 v_mul_f32 v220, s62, v220
 v_mfma_f32_16x16x32_bf16 v[124:127], v[236:239], a[92:95], v[124:127]
 ds_read_b64_tr_b16 v[236:237], v242 offset:512
 ds_read_b64_tr_b16 v[238:239], v242 offset:2560
 s_waitcnt lgkmcnt(6)
 v_mfma_f32_16x16x32_bf16 v[160:163], v[224:227], a[96:99], v[160:163]
 v_mul_f32 v221, s62, v221
 v_mfma_f32_16x16x32_bf16 v[164:167], v[224:227], a[100:103], v[164:167]
 s_add_u32 m0, s69, 0
 v_mfma_f32_16x16x32_bf16 v[168:171], v[224:227], a[104:107], v[168:171]
 s_waitcnt lgkmcnt(4)
 v_mul_f32 v222, s62, v222
 v_mfma_f32_16x16x32_bf16 v[172:175], v[224:227], a[108:111], v[172:175]
 ds_read_b64_tr_b16 v[224:225], v241 offset:4096
 ds_read_b64_tr_b16 v[226:227], v241 offset:6144
 v_mfma_f32_16x16x32_bf16 v[176:179], v[228:231], a[96:99], v[176:179]
 buffer_load_dwordx4 v243, s[24:27], s54 offen offset:0 nt lds
 v_mul_f32 v223, s62, v223
 v_mfma_f32_16x16x32_bf16 v[180:183], v[228:231], a[100:103], v[180:183]
 v_mfma_f32_16x16x32_bf16 v[184:187], v[228:231], a[104:107], v[184:187]
 s_waitcnt lgkmcnt(4)
 v_cvt_pk_bf16_f32 v79, v222, v223
 v_mfma_f32_16x16x32_bf16 v[188:191], v[228:231], a[108:111], v[188:191]
 ds_read_b64_tr_b16 v[228:229], v242 offset:4096
 ds_read_b64_tr_b16 v[230:231], v242 offset:6144
 v_mfma_f32_16x16x32_bf16 v[96:99], v[232:235], a[96:99], v[96:99]
 s_add_u32 m0, s69, 8192
 v_cvt_pk_bf16_f32 v78, v220, v221
 v_mfma_f32_16x16x32_bf16 v[100:103], v[232:235], a[100:103], v[100:103]
 buffer_load_dwordx4 v243, s[24:27], s53 offen offset:0 nt lds
 v_mfma_f32_16x16x32_bf16 v[104:107], v[232:235], a[104:107], v[104:107]
 s_waitcnt lgkmcnt(2)
 v_cvt_pk_bf16_f32 v76, v204, v205
 v_mfma_f32_16x16x32_bf16 v[108:111], v[232:235], a[108:111], v[108:111]
 ds_read_b64_tr_b16 v[232:233], v241 offset:4608
 ds_read_b64_tr_b16 v[234:235], v241 offset:6656
 v_mfma_f32_16x16x32_bf16 v[112:115], v[236:239], a[96:99], v[112:115]
 v_cvt_pk_bf16_f32 v77, v206, v207
 s_add_u32 m0, s69, 896
 v_mfma_f32_16x16x32_bf16 v[116:119], v[236:239], a[100:103], v[116:119]
 v_mfma_f32_16x16x32_bf16 v[120:123], v[236:239], a[104:107], v[120:123]
 v_mul_f32 v128, s62, v128
 buffer_load_dwordx4 v243, s[24:27], s54 offen offset:128 nt lds
 v_mfma_f32_16x16x32_bf16 v[124:127], v[236:239], a[108:111], v[124:127]
 ds_read_b64_tr_b16 v[236:237], v242 offset:4608
 ds_read_b64_tr_b16 v[238:239], v242 offset:6656
 v_mfma_f32_16x16x32_bf16 v[160:163], v[224:227], a[112:115], v[160:163]
 v_mul_f32 v129, s62, v129
 v_mfma_f32_16x16x32_bf16 v[164:167], v[224:227], a[116:119], v[164:167]
 s_add_u32 m0, s69, 9088
 v_mfma_f32_16x16x32_bf16 v[168:171], v[224:227], a[120:123], v[168:171]
 s_waitcnt lgkmcnt(2)
 v_permlane16_swap_b32 v76, v78
 v_mfma_f32_16x16x32_bf16 v[172:175], v[224:227], a[124:127], v[172:175]
 ds_read_b64_tr_b16 v[224:225], v241 offset:8192
 ds_read_b64_tr_b16 v[226:227], v241 offset:10240
 v_mfma_f32_16x16x32_bf16 v[176:179], v[228:231], a[112:115], v[176:179]
 v_permlane16_swap_b32 v77, v79
 buffer_load_dwordx4 v243, s[24:27], s53 offen offset:128 nt lds
 v_mfma_f32_16x16x32_bf16 v[180:183], v[228:231], a[116:119], v[180:183]
 v_mfma_f32_16x16x32_bf16 v[184:187], v[228:231], a[120:123], v[184:187]
 v_mul_f32 v130, s62, v130
 v_mfma_f32_16x16x32_bf16 v[188:191], v[228:231], a[124:127], v[188:191]
 ds_read_b64_tr_b16 v[228:229], v242 offset:8192
 ds_read_b64_tr_b16 v[230:231], v242 offset:10240
 v_mfma_f32_16x16x32_bf16 v[96:99], v[232:235], a[112:115], v[96:99]
 s_add_u32 m0, s69, 1792
 v_mul_f32 v131, s62, v131
 v_mfma_f32_16x16x32_bf16 v[100:103], v[232:235], a[116:119], v[100:103]
 v_mfma_f32_16x16x32_bf16 v[104:107], v[232:235], a[120:123], v[104:107]
 s_waitcnt lgkmcnt(2)
 v_mul_f32 v144, s62, v144
 v_mfma_f32_16x16x32_bf16 v[108:111], v[232:235], a[124:127], v[108:111]
 ds_read_b64_tr_b16 v[232:233], v241 offset:8704
 ds_read_b64_tr_b16 v[234:235], v241 offset:10752
 v_mfma_f32_16x16x32_bf16 v[112:115], v[236:239], a[112:115], v[112:115]
 buffer_load_dwordx4 v243, s[24:27], s54 offen offset:256 nt lds
 v_mul_f32 v145, s62, v145
 v_mfma_f32_16x16x32_bf16 v[116:119], v[236:239], a[116:119], v[116:119]
 s_add_u32 m0, s69, 9984
 v_mfma_f32_16x16x32_bf16 v[120:123], v[236:239], a[120:123], v[120:123]
 v_mul_f32 v146, s62, v146
 v_mfma_f32_16x16x32_bf16 v[124:127], v[236:239], a[124:127], v[124:127]
 ds_read_b64_tr_b16 v[236:237], v242 offset:8704
 ds_read_b64_tr_b16 v[238:239], v242 offset:10752
 v_mfma_f32_16x16x32_bf16 v[160:163], v[224:227], a[128:131], v[160:163]
 buffer_load_dwordx4 v243, s[24:27], s53 offen offset:256 nt lds
 v_mul_f32 v147, s62, v147
 v_mfma_f32_16x16x32_bf16 v[164:167], v[224:227], a[132:135], v[164:167]
 v_mfma_f32_16x16x32_bf16 v[168:171], v[224:227], a[136:139], v[168:171]
 s_waitcnt lgkmcnt(2)
 v_cvt_pk_bf16_f32 v83, v146, v147
 v_mfma_f32_16x16x32_bf16 v[172:175], v[224:227], a[140:143], v[172:175]
 ds_read_b64_tr_b16 v[224:225], v241 offset:12288
 ds_read_b64_tr_b16 v[226:227], v241 offset:14336
 v_mfma_f32_16x16x32_bf16 v[176:179], v[228:231], a[128:131], v[176:179]
 s_add_u32 m0, s69, 2688
 v_cvt_pk_bf16_f32 v82, v144, v145
 v_mfma_f32_16x16x32_bf16 v[180:183], v[228:231], a[132:135], v[180:183]
 buffer_load_dwordx4 v243, s[24:27], s54 offen offset:384 nt lds
 v_mfma_f32_16x16x32_bf16 v[184:187], v[228:231], a[136:139], v[184:187]
 v_cvt_pk_bf16_f32 v80, v128, v129
 v_mfma_f32_16x16x32_bf16 v[188:191], v[228:231], a[140:143], v[188:191]
 ds_read_b64_tr_b16 v[228:229], v242 offset:12288
 ds_read_b64_tr_b16 v[230:231], v242 offset:14336
 v_mfma_f32_16x16x32_bf16 v[96:99], v[232:235], a[128:131], v[96:99]
 s_add_u32 m0, s69, 10880
 v_cvt_pk_bf16_f32 v81, v130, v131
 v_mfma_f32_16x16x32_bf16 v[100:103], v[232:235], a[132:135], v[100:103]
 v_mfma_f32_16x16x32_bf16 v[104:107], v[232:235], a[136:139], v[104:107]
 s_waitcnt lgkmcnt(2)
 v_mul_f32 v132, s62, v132
 v_mfma_f32_16x16x32_bf16 v[108:111], v[232:235], a[140:143], v[108:111]
 ds_read_b64_tr_b16 v[232:233], v241 offset:12800
 ds_read_b64_tr_b16 v[234:235], v241 offset:14848
 v_mfma_f32_16x16x32_bf16 v[112:115], v[236:239], a[128:131], v[112:115]
 buffer_load_dwordx4 v243, s[24:27], s53 offen offset:384 nt lds
 v_mul_f32 v133, s62, v133
 v_mfma_f32_16x16x32_bf16 v[116:119], v[236:239], a[132:135], v[116:119]
 s_add_u32 s54, s54, 16384
 v_mfma_f32_16x16x32_bf16 v[120:123], v[236:239], a[136:139], v[120:123]
 v_permlane16_swap_b32 v80, v82
 v_mfma_f32_16x16x32_bf16 v[124:127], v[236:239], a[140:143], v[124:127]
 ds_read_b64_tr_b16 v[236:237], v242 offset:12800
 ds_read_b64_tr_b16 v[238:239], v242 offset:14848
 v_mfma_f32_16x16x32_bf16 v[160:163], v[224:227], a[144:147], v[160:163]
 v_permlane16_swap_b32 v81, v83
 v_add_u32 v241, 32768, v241
 v_mfma_f32_16x16x32_bf16 v[164:167], v[224:227], a[148:151], v[164:167]
 s_add_u32 s53, s53, 16384
 v_mfma_f32_16x16x32_bf16 v[168:171], v[224:227], a[152:155], v[168:171]
 s_waitcnt lgkmcnt(2)
 v_mul_f32 v134, s62, v134
 v_mfma_f32_16x16x32_bf16 v[172:175], v[224:227], a[156:159], v[172:175]
 buffer_load_dwordx4 a[224:227], v254, s[36:39], s90 offen
 v_add_u32 v242, 32768, v242
 v_mfma_f32_16x16x32_bf16 v[176:179], v[228:231], a[144:147], v[176:179]
 v_mul_f32 v135, s62, v135
 s_add_u32 s90, s90, 1024
 v_mfma_f32_16x16x32_bf16 v[180:183], v[228:231], a[148:151], v[180:183]
 v_mfma_f32_16x16x32_bf16 v[184:187], v[228:231], a[152:155], v[184:187]
 s_waitcnt lgkmcnt(0)
 s_waitcnt vmcnt(19)
 s_barrier
 v_mfma_f32_16x16x32_bf16 v[188:191], v[228:231], a[156:159], v[188:191]
 ds_read_b64_tr_b16 v[224:225], v241 offset:0
 ds_read_b64_tr_b16 v[226:227], v241 offset:2048
 ds_read_b64_tr_b16 v[228:229], v242 offset:0
 ds_read_b64_tr_b16 v[230:231], v242 offset:2048
 v_mfma_f32_16x16x32_bf16 v[96:99], v[232:235], a[144:147], v[96:99]
 v_mul_f32 v148, s62, v148
 v_mul_f32 v149, s62, v149
 v_mfma_f32_16x16x32_bf16 v[100:103], v[232:235], a[148:151], v[100:103]
 v_mfma_f32_16x16x32_bf16 v[104:107], v[232:235], a[152:155], v[104:107]
 v_mul_f32 v150, s62, v150
 v_mfma_f32_16x16x32_bf16 v[108:111], v[232:235], a[156:159], v[108:111]
 ds_read_b64_tr_b16 v[232:233], v241 offset:512
 ds_read_b64_tr_b16 v[234:235], v241 offset:2560
 v_mfma_f32_16x16x32_bf16 v[112:115], v[236:239], a[144:147], v[112:115]
 v_mul_f32 v151, s62, v151
 v_mfma_f32_16x16x32_bf16 v[116:119], v[236:239], a[148:151], v[116:119]
 v_mfma_f32_16x16x32_bf16 v[120:123], v[236:239], a[152:155], v[120:123]
 v_cvt_pk_bf16_f32 v87, v150, v151
 v_mfma_f32_16x16x32_bf16 v[124:127], v[236:239], a[156:159], v[124:127]
 ds_read_b64_tr_b16 v[236:237], v242 offset:512
 ds_read_b64_tr_b16 v[238:239], v242 offset:2560
 s_waitcnt lgkmcnt(6)
 v_mfma_f32_16x16x32_bf16 v[160:163], v[224:227], a[160:163], v[160:163]
 v_cvt_pk_bf16_f32 v86, v148, v149
 v_mfma_f32_16x16x32_bf16 v[164:167], v[224:227], a[164:167], v[164:167]
 s_add_u32 m0, s69, 32768
 v_cvt_pk_bf16_f32 v84, v132, v133
 v_mfma_f32_16x16x32_bf16 v[168:171], v[224:227], a[168:171], v[168:171]
 s_waitcnt lgkmcnt(4)
 v_mfma_f32_16x16x32_bf16 v[172:175], v[224:227], a[172:175], v[172:175]
 ds_read_b64_tr_b16 v[224:225], v241 offset:4096
 ds_read_b64_tr_b16 v[226:227], v241 offset:6144
 v_mfma_f32_16x16x32_bf16 v[176:179], v[228:231], a[160:163], v[176:179]
 buffer_load_dwordx4 v248, s[28:31], s55 offen offset:0 nt lds
 v_cvt_pk_bf16_f32 v85, v134, v135
 v_mfma_f32_16x16x32_bf16 v[180:183], v[228:231], a[164:167], v[180:183]
 v_mul_f32 v136, s62, v136
 v_mfma_f32_16x16x32_bf16 v[184:187], v[228:231], a[168:171], v[184:187]
 s_waitcnt lgkmcnt(4)
 s_add_u32 m0, s69, 40960
 v_mfma_f32_16x16x32_bf16 v[188:191], v[228:231], a[172:175], v[188:191]
 ds_read_b64_tr_b16 v[228:229], v242 offset:4096
 ds_read_b64_tr_b16 v[230:231], v242 offset:6144
 v_mfma_f32_16x16x32_bf16 v[96:99], v[232:235], a[160:163], v[96:99]
 v_mul_f32 v137, s62, v137
 v_mfma_f32_16x16x32_bf16 v[100:103], v[232:235], a[164:167], v[100:103]
 buffer_load_dwordx4 v248, s[28:31], s58 offen offset:0 nt lds
 v_permlane16_swap_b32 v84, v86
 v_mfma_f32_16x16x32_bf16 v[104:107], v[232:235], a[168:171], v[104:107]
 s_waitcnt lgkmcnt(2)
 v_mfma_f32_16x16x32_bf16 v[108:111], v[232:235], a[172:175], v[108:111]
 ds_read_b64_tr_b16 v[232:233], v241 offset:4608
 ds_read_b64_tr_b16 v[234:235], v241 offset:6656
 v_mfma_f32_16x16x32_bf16 v[112:115], v[236:239], a[160:163], v[112:115]
 v_permlane16_swap_b32 v85, v87
 s_add_u32 m0, s69, 33664
 v_mfma_f32_16x16x32_bf16 v[116:119], v[236:239], a[164:167], v[116:119]
 v_mul_f32 v138, s62, v138
 v_mfma_f32_16x16x32_bf16 v[120:123], v[236:239], a[168:171], v[120:123]
 buffer_load_dwordx4 v248, s[28:31], s55 offen offset:128 nt lds
 v_mfma_f32_16x16x32_bf16 v[124:127], v[236:239], a[172:175], v[124:127]
 ds_read_b64_tr_b16 v[236:237], v242 offset:4608
 ds_read_b64_tr_b16 v[238:239], v242 offset:6656
 v_mfma_f32_16x16x32_bf16 v[160:163], v[224:227], a[176:179], v[160:163]
 v_mul_f32 v139, s62, v139
 v_mfma_f32_16x16x32_bf16 v[164:167], v[224:227], a[180:183], v[164:167]
 v_mul_f32 v152, s62, v152
 s_add_u32 m0, s69, 41856
 v_mfma_f32_16x16x32_bf16 v[168:171], v[224:227], a[184:187], v[168:171]
 s_waitcnt lgkmcnt(2)
 v_mfma_f32_16x16x32_bf16 v[172:175], v[224:227], a[188:191], v[172:175]
 ds_read_b64_tr_b16 v[224:225], v241 offset:8192
 ds_read_b64_tr_b16 v[226:227], v241 offset:10240
 v_mfma_f32_16x16x32_bf16 v[176:179], v[228:231], a[176:179], v[176:179]
 v_mul_f32 v153, s62, v153
 buffer_load_dwordx4 v248, s[28:31], s58 offen offset:128 nt lds
 v_mfma_f32_16x16x32_bf16 v[180:183], v[228:231], a[180:183], v[180:183]
 v_mul_f32 v154, s62, v154
 v_mfma_f32_16x16x32_bf16 v[184:187], v[228:231], a[184:187], v[184:187]
 v_mfma_f32_16x16x32_bf16 v[188:191], v[228:231], a[188:191], v[188:191]
 ds_read_b64_tr_b16 v[228:229], v242 offset:8192
 ds_read_b64_tr_b16 v[230:231], v242 offset:10240
 v_mfma_f32_16x16x32_bf16 v[96:99], v[232:235], a[176:179], v[96:99]
 s_add_u32 m0, s69, 34560
 v_mul_f32 v155, s62, v155
 v_mfma_f32_16x16x32_bf16 v[100:103], v[232:235], a[180:183], v[100:103]
 v_cvt_pk_bf16_f32 v91, v154, v155
 v_mfma_f32_16x16x32_bf16 v[104:107], v[232:235], a[184:187], v[104:107]
 s_waitcnt lgkmcnt(2)
 buffer_load_dwordx4 v248, s[28:31], s55 offen offset:256 nt lds
 v_mfma_f32_16x16x32_bf16 v[108:111], v[232:235], a[188:191], v[108:111]
 ds_read_b64_tr_b16 v[232:233], v241 offset:8704
 ds_read_b64_tr_b16 v[234:235], v241 offset:10752
 v_mfma_f32_16x16x32_bf16 v[112:115], v[236:239], a[176:179], v[112:115]
 v_cvt_pk_bf16_f32 v90, v152, v153
 s_add_u32 m0, s69, 42752
 v_mfma_f32_16x16x32_bf16 v[116:119], v[236:239], a[180:183], v[116:119]
 v_cvt_pk_bf16_f32 v88, v136, v137
 v_mfma_f32_16x16x32_bf16 v[120:123], v[236:239], a[184:187], v[120:123]
 v_mfma_f32_16x16x32_bf16 v[124:127], v[236:239], a[188:191], v[124:127]
 ds_read_b64_tr_b16 v[236:237], v242 offset:8704
 ds_read_b64_tr_b16 v[238:239], v242 offset:10752
 v_mfma_f32_16x16x32_bf16 v[160:163], v[224:227], a[192:195], v[160:163]
 v_cvt_pk_bf16_f32 v89, v138, v139
 buffer_load_dwordx4 v248, s[28:31], s58 offen offset:256 nt lds
 v_mfma_f32_16x16x32_bf16 v[164:167], v[224:227], a[196:199], v[164:167]
 v_mul_f32 v140, s62, v140
 v_mfma_f32_16x16x32_bf16 v[168:171], v[224:227], a[200:203], v[168:171]
 s_waitcnt lgkmcnt(2)
 s_add_u32 m0, s69, 35456
 v_mfma_f32_16x16x32_bf16 v[172:175], v[224:227], a[204:207], v[172:175]
 ds_read_b64_tr_b16 v[224:225], v241 offset:12288
 ds_read_b64_tr_b16 v[226:227], v241 offset:14336
 v_mfma_f32_16x16x32_bf16 v[176:179], v[228:231], a[192:195], v[176:179]
 v_mul_f32 v141, s62, v141
 v_permlane16_swap_b32 v88, v90
 v_mfma_f32_16x16x32_bf16 v[180:183], v[228:231], a[196:199], v[180:183]
 buffer_load_dwordx4 v248, s[28:31], s55 offen offset:384 nt lds
 v_mfma_f32_16x16x32_bf16 v[184:187], v[228:231], a[200:203], v[184:187]
 v_permlane16_swap_b32 v89, v91
 v_mfma_f32_16x16x32_bf16 v[188:191], v[228:231], a[204:207], v[188:191]
 ds_read_b64_tr_b16 v[228:229], v242 offset:12288
 ds_read_b64_tr_b16 v[230:231], v242 offset:14336
 v_mfma_f32_16x16x32_bf16 v[96:99], v[232:235], a[192:195], v[96:99]
 s_add_u32 m0, s69, 43648
 v_mul_f32 v142, s62, v142
 v_mfma_f32_16x16x32_bf16 v[100:103], v[232:235], a[196:199], v[100:103]
 v_mfma_f32_16x16x32_bf16 v[104:107], v[232:235], a[200:203], v[104:107]
 s_waitcnt lgkmcnt(2)
 v_mul_f32 v143, s62, v143
 v_mfma_f32_16x16x32_bf16 v[108:111], v[232:235], a[204:207], v[108:111]
 ds_read_b64_tr_b16 v[232:233], v241 offset:12800
 ds_read_b64_tr_b16 v[234:235], v241 offset:14848
 v_mfma_f32_16x16x32_bf16 v[112:115], v[236:239], a[192:195], v[112:115]
 buffer_load_dwordx4 v248, s[28:31], s58 offen offset:384 nt lds
 v_mul_f32 v156, s62, v156
 v_mfma_f32_16x16x32_bf16 v[116:119], v[236:239], a[196:199], v[116:119]
 s_add_u32 s55, s55, 16384
 v_mfma_f32_16x16x32_bf16 v[120:123], v[236:239], a[200:203], v[120:123]
 v_mul_f32 v157, s62, v157
 v_mfma_f32_16x16x32_bf16 v[124:127], v[236:239], a[204:207], v[124:127]
 ds_read_b64_tr_b16 v[236:237], v242 offset:12800
 ds_read_b64_tr_b16 v[238:239], v242 offset:14848
 v_mfma_f32_16x16x32_bf16 v[160:163], v[224:227], a[208:211], v[160:163]
 v_mbcnt_lo_u32_b32 v249, -1, 0
 s_add_u32 s58, s58, 16384
 v_mfma_f32_16x16x32_bf16 v[164:167], v[224:227], a[212:215], v[164:167]
 v_mul_f32 v158, s62, v158
 v_mbcnt_hi_u32_b32 v249, -1, v249
 v_mfma_f32_16x16x32_bf16 v[168:171], v[224:227], a[216:219], v[168:171]
 s_waitcnt lgkmcnt(2)
 v_lshrrev_b32 v250, 5, v249
 v_mfma_f32_16x16x32_bf16 v[172:175], v[224:227], a[220:223], v[172:175]
 v_mul_f32 v159, s62, v159
 v_lshlrev_b32 v241, 12, v250
 v_mfma_f32_16x16x32_bf16 v[176:179], v[228:231], a[208:211], v[176:179]
 v_bfe_u32 v250, v249, 2, 3
 v_cvt_pk_bf16_f32 v95, v158, v159
 v_mfma_f32_16x16x32_bf16 v[180:183], v[228:231], a[212:215], v[180:183]
 v_lshl_add_u32 v241, v250, 6, v241
 v_bfe_u32 v250, v249, 4, 1
 v_mfma_f32_16x16x32_bf16 v[184:187], v[228:231], a[216:219], v[184:187]
 s_waitcnt lgkmcnt(0)
 s_waitcnt vmcnt(18)
 s_barrier
 v_mfma_f32_16x16x32_bf16 v[188:191], v[228:231], a[220:223], v[188:191]
 ds_read_b128 v[224:227], v240 offset:0
 ds_read_b128 v[228:231], v240 offset:8192
 v_mfma_f32_16x16x32_bf16 v[96:99], v[232:235], a[208:211], v[96:99]
 v_cvt_pk_bf16_f32 v94, v156, v157
 v_lshlrev_b32 v250, 1, v250
 v_mfma_f32_16x16x32_bf16 v[100:103], v[232:235], a[212:215], v[100:103]
 v_bfe_u32 v251, v249, 1, 1
 v_cvt_pk_bf16_f32 v92, v140, v141
 v_mfma_f32_16x16x32_bf16 v[104:107], v[232:235], a[216:219], v[104:107]
 v_xor_b32 v250, v250, v251
 v_lshl_add_u32 v241, v250, 4, v241
 v_mfma_f32_16x16x32_bf16 v[108:111], v[232:235], a[220:223], v[108:111]
 ds_read_b128 v[232:235], v240 offset:512
 v_cvt_pk_bf16_f32 v93, v142, v143
 v_mfma_f32_16x16x32_bf16 v[112:115], v[236:239], a[208:211], v[112:115]
 v_and_b32 v250, 1, v249
 v_lshl_add_u32 v241, v250, 3, v241
 v_mfma_f32_16x16x32_bf16 v[116:119], v[236:239], a[212:215], v[116:119]
 v_permlane16_swap_b32 v92, v94
 v_add_u32 v241, 32768, v241
 v_mfma_f32_16x16x32_bf16 v[120:123], v[236:239], a[216:219], v[120:123]
 v_add_u32 v241, s71, v241
 v_xor_b32 v242, 32, v241
 v_mfma_f32_16x16x32_bf16 v[124:127], v[236:239], a[220:223], v[124:127]
 v_permlane16_swap_b32 v93, v95
 ds_read_b128 v[236:239], v240 offset:8704
 s_waitcnt lgkmcnt(3)
 v_mfma_f32_16x16x32_bf16 v[128:131], v[224:227], v[0:3], 0
 v_mfma_f32_16x16x32_bf16 v[132:135], v[224:227], v[4:7], 0
 v_mul_f32 v96, s62, v96
 s_add_u32 m0, s69, 65536
 v_mfma_f32_16x16x32_bf16 v[136:139], v[224:227], v[8:11], 0
 s_waitcnt lgkmcnt(2)
 v_mul_f32 v97, s62, v97
 v_mfma_f32_16x16x32_bf16 v[140:143], v[224:227], v[12:15], 0
 ds_read_b128 v[224:227], v240 offset:1024
 v_mul_f32 v98, s62, v98
 v_mfma_f32_16x16x32_bf16 v[144:147], v[228:231], v[0:3], 0
 v_mul_f32 v99, s62, v99
 v_mul_f32 v112, s62, v112
 v_mfma_f32_16x16x32_bf16 v[148:151], v[228:231], v[4:7], 0
 v_mul_f32 v113, s62, v113
 v_mul_f32 v114, s62, v114
 v_mfma_f32_16x16x32_bf16 v[152:155], v[228:231], v[8:11], 0
 s_waitcnt lgkmcnt(2)
 v_mul_f32 v115, s62, v115
 buffer_load_dwordx4 v243, s[24:27], s54 offen offset:0 nt lds
 v_mfma_f32_16x16x32_bf16 v[156:159], v[228:231], v[12:15], 0
 ds_read_b128 v[228:231], v240 offset:9216
 v_cvt_pk_bf16_f32 v115, v114, v115
 v_cvt_pk_bf16_f32 v114, v112, v113
 v_mfma_f32_16x16x32_bf16 v[128:131], v[232:235], v[16:19], v[128:131]
 v_cvt_pk_bf16_f32 v112, v96, v97
 v_cvt_pk_bf16_f32 v113, v98, v99
 v_mul_f32 v100, s62, v100
 v_mfma_f32_16x16x32_bf16 v[132:135], v[232:235], v[20:23], v[132:135]
 v_mul_f32 v101, s62, v101
 v_permlane16_swap_b32 v112, v114
 s_add_u32 m0, s69, 73728
 v_mfma_f32_16x16x32_bf16 v[136:139], v[232:235], v[24:27], v[136:139]
 s_waitcnt lgkmcnt(1)
 v_permlane16_swap_b32 v113, v115
 v_mul_f32 v102, s62, v102
 v_mfma_f32_16x16x32_bf16 v[140:143], v[232:235], v[28:31], v[140:143]
 ds_read_b128 v[232:235], v240 offset:1536
 v_mul_f32 v103, s62, v103
 v_mul_f32 v116, s62, v116
 v_mfma_f32_16x16x32_bf16 v[144:147], v[236:239], v[16:19], v[144:147]
 v_mul_f32 v117, s62, v117
 v_mul_f32 v118, s62, v118
 v_mul_f32 v119, s62, v119
 v_mfma_f32_16x16x32_bf16 v[148:151], v[236:239], v[20:23], v[148:151]
 buffer_load_dwordx4 v243, s[24:27], s53 offen offset:0 nt lds
 v_cvt_pk_bf16_f32 v119, v118, v119
 v_cvt_pk_bf16_f32 v118, v116, v117
 v_mfma_f32_16x16x32_bf16 v[152:155], v[236:239], v[24:27], v[152:155]
 v_cvt_pk_bf16_f32 v116, v100, v101
 v_cvt_pk_bf16_f32 v117, v102, v103
 v_mul_f32 v104, s62, v104
 v_mfma_f32_16x16x32_bf16 v[156:159], v[236:239], v[28:31], v[156:159]
 ds_read_b128 v[236:239], v240 offset:9728
 v_mul_f32 v105, s62, v105
 v_permlane16_swap_b32 v116, v118
 v_mfma_f32_16x16x32_bf16 v[128:131], v[224:227], v[32:35], v[128:131]
 s_add_u32 m0, s69, 66432
 v_permlane16_swap_b32 v117, v119
 v_mul_f32 v106, s62, v106
 v_mfma_f32_16x16x32_bf16 v[132:135], v[224:227], v[36:39], v[132:135]
 v_mul_f32 v107, s62, v107
 v_mul_f32 v120, s62, v120
 v_mul_f32 v121, s62, v121
 v_mfma_f32_16x16x32_bf16 v[136:139], v[224:227], v[40:43], v[136:139]
 s_waitcnt lgkmcnt(1)
 v_mul_f32 v122, s62, v122
 v_mul_f32 v123, s62, v123
 v_mfma_f32_16x16x32_bf16 v[140:143], v[224:227], v[44:47], v[140:143]
 ds_read_b128 v[224:227], v240 offset:2048
 buffer_load_dwordx4 v243, s[24:27], s54 offen offset:128 nt lds
 v_cvt_pk_bf16_f32 v123, v122, v123
 v_mfma_f32_16x16x32_bf16 v[144:147], v[228:231], v[32:35], v[144:147]
 v_cvt_pk_bf16_f32 v122, v120, v121
 v_cvt_pk_bf16_f32 v120, v104, v105
 v_cvt_pk_bf16_f32 v121, v106, v107
 v_mfma_f32_16x16x32_bf16 v[148:151], v[228:231], v[36:39], v[148:151]
 v_mul_f32 v108, s62, v108
 v_mul_f32 v109, s62, v109
 v_permlane16_swap_b32 v120, v122
 v_mfma_f32_16x16x32_bf16 v[152:155], v[228:231], v[40:43], v[152:155]
 s_add_u32 m0, s69, 74624
 v_permlane16_swap_b32 v121, v123
 v_mul_f32 v110, s62, v110
 v_mfma_f32_16x16x32_bf16 v[156:159], v[228:231], v[44:47], v[156:159]
 ds_read_b128 v[228:231], v240 offset:10240
 v_mul_f32 v111, s62, v111
 v_mul_f32 v124, s62, v124
 v_mfma_f32_16x16x32_bf16 v[128:131], v[232:235], v[48:51], v[128:131]
 v_mul_f32 v125, s62, v125
 v_mul_f32 v126, s62, v126
 v_mul_f32 v127, s62, v127
 v_mfma_f32_16x16x32_bf16 v[132:135], v[232:235], v[52:55], v[132:135]
 buffer_load_dwordx4 v243, s[24:27], s53 offen offset:128 nt lds
 v_cvt_pk_bf16_f32 v127, v126, v127
 v_cvt_pk_bf16_f32 v126, v124, v125
 v_mfma_f32_16x16x32_bf16 v[136:139], v[232:235], v[56:59], v[136:139]
 s_waitcnt lgkmcnt(1)
 v_cvt_pk_bf16_f32 v124, v108, v109
 v_cvt_pk_bf16_f32 v125, v110, v111
 v_mfma_f32_16x16x32_bf16 v[140:143], v[232:235], v[60:63], v[140:143]
 ds_read_b128 v[232:235], v240 offset:2560
 v_mul_f32 v160, s62, v160
 v_mul_f32 v161, s62, v161
 v_mfma_f32_16x16x32_bf16 v[144:147], v[236:239], v[48:51], v[144:147]
 v_permlane16_swap_b32 v124, v126
 s_add_u32 m0, s69, 67328
 v_permlane16_swap_b32 v125, v127
 v_mfma_f32_16x16x32_bf16 v[148:151], v[236:239], v[52:55], v[148:151]
 v_mul_f32 v162, s62, v162
 v_mul_f32 v163, s62, v163
 v_mul_f32 v176, s62, v176
 v_mfma_f32_16x16x32_bf16 v[152:155], v[236:239], v[56:59], v[152:155]
 v_mul_f32 v177, s62, v177
 v_mul_f32 v178, s62, v178
 v_mul_f32 v179, s62, v179
 v_mfma_f32_16x16x32_bf16 v[156:159], v[236:239], v[60:63], v[156:159]
 ds_read_b128 v[236:239], v240 offset:10752
 buffer_load_dwordx4 v243, s[24:27], s54 offen offset:256 nt lds
 v_cvt_pk_bf16_f32 v99, v178, v179
 v_mfma_f32_16x16x32_bf16 v[128:131], v[224:227], v[64:67], v[128:131]
 v_cvt_pk_bf16_f32 v98, v176, v177
 v_cvt_pk_bf16_f32 v96, v160, v161
 v_cvt_pk_bf16_f32 v97, v162, v163
 v_mfma_f32_16x16x32_bf16 v[132:135], v[224:227], v[68:71], v[132:135]
 v_mul_f32 v164, s62, v164
 v_mul_f32 v165, s62, v165
 v_permlane16_swap_b32 v96, v98
 v_mfma_f32_16x16x32_bf16 v[136:139], v[224:227], v[72:75], v[136:139]
 s_waitcnt lgkmcnt(1)
 s_add_u32 m0, s69, 75520
 v_permlane16_swap_b32 v97, v99
 v_mfma_f32_16x16x32_bf16 v[140:143], v[224:227], v[76:79], v[140:143]
 ds_read_b128 v[224:227], v240 offset:3072
 v_mul_f32 v166, s62, v166
 v_mul_f32 v167, s62, v167
 v_mfma_f32_16x16x32_bf16 v[144:147], v[228:231], v[64:67], v[144:147]
 v_mul_f32 v180, s62, v180
 v_mul_f32 v181, s62, v181
 v_mul_f32 v182, s62, v182
 v_mfma_f32_16x16x32_bf16 v[148:151], v[228:231], v[68:71], v[148:151]
 v_mul_f32 v183, s62, v183
 buffer_load_dwordx4 v243, s[24:27], s53 offen offset:256 nt lds
 v_cvt_pk_bf16_f32 v103, v182, v183
 v_mfma_f32_16x16x32_bf16 v[152:155], v[228:231], v[72:75], v[152:155]
 v_cvt_pk_bf16_f32 v102, v180, v181
 v_cvt_pk_bf16_f32 v100, v164, v165
 v_cvt_pk_bf16_f32 v101, v166, v167
 v_mfma_f32_16x16x32_bf16 v[156:159], v[228:231], v[76:79], v[156:159]
 ds_read_b128 v[228:231], v240 offset:11264
 v_mul_f32 v168, s62, v168
 v_mul_f32 v169, s62, v169
 v_mfma_f32_16x16x32_bf16 v[128:131], v[232:235], v[80:83], v[128:131]
 v_permlane16_swap_b32 v100, v102
 s_add_u32 m0, s69, 68224
 v_permlane16_swap_b32 v101, v103
 v_mfma_f32_16x16x32_bf16 v[132:135], v[232:235], v[84:87], v[132:135]
 v_mul_f32 v170, s62, v170
 v_mul_f32 v171, s62, v171
 v_mul_f32 v184, s62, v184
 v_mfma_f32_16x16x32_bf16 v[136:139], v[232:235], v[88:91], v[136:139]
 s_waitcnt lgkmcnt(1)
 v_mul_f32 v185, s62, v185
 v_mul_f32 v186, s62, v186
 v_mfma_f32_16x16x32_bf16 v[140:143], v[232:235], v[92:95], v[140:143]
 ds_read_b128 v[232:235], v240 offset:3584
 v_mul_f32 v187, s62, v187
 buffer_load_dwordx4 v243, s[24:27], s54 offen offset:384 nt lds
 v_mfma_f32_16x16x32_bf16 v[144:147], v[236:239], v[80:83], v[144:147]
 v_cvt_pk_bf16_f32 v107, v186, v187
 v_cvt_pk_bf16_f32 v106, v184, v185
 v_cvt_pk_bf16_f32 v104, v168, v169
 v_cvt_pk_bf16_f32 v105, v170, v171
 v_mul_f32 v172, s62, v172
 v_mul_f32 v173, s62, v173
 v_permlane16_swap_b32 v104, v106
 v_permlane16_swap_b32 v105, v107
 v_mul_f32 v174, s62, v174
 v_mul_f32 v175, s62, v175
 v_mul_f32 v188, s62, v188
 v_mul_f32 v189, s62, v189
 v_mul_f32 v190, s62, v190
 v_mul_f32 v191, s62, v191
 v_cvt_pk_bf16_f32 v111, v190, v191
 v_cvt_pk_bf16_f32 v110, v188, v189
 v_cvt_pk_bf16_f32 v108, v172, v173
 v_cvt_pk_bf16_f32 v109, v174, v175
 s_nop 0
 v_permlane16_swap_b32 v108, v110
 v_permlane16_swap_b32 v109, v111
 v_mfma_f32_16x16x32_bf16 v[148:151], v[236:239], v[84:87], v[148:151]
 s_add_u32 m0, s69, 76416
 s_nop 0
 buffer_load_dwordx4 v243, s[24:27], s53 offen offset:384 nt lds
 v_mfma_f32_16x16x32_bf16 v[152:155], v[236:239], v[88:91], v[152:155]
 s_add_u32 s54, s54, 16384
 v_mfma_f32_16x16x32_bf16 v[156:159], v[236:239], v[92:95], v[156:159]
 ds_read_b128 v[236:239], v240 offset:11776
 v_mfma_f32_16x16x32_bf16 v[128:131], v[224:227], v[96:99], v[128:131]
 v_subrev_u32 v240, 98304, v240
 s_add_u32 s53, s53, 16384
 v_mfma_f32_16x16x32_bf16 v[132:135], v[224:227], v[100:103], v[132:135]
 v_mfma_f32_16x16x32_bf16 v[136:139], v[224:227], v[104:107], v[136:139]
 s_waitcnt lgkmcnt(1)
 v_mfma_f32_16x16x32_bf16 v[140:143], v[224:227], v[108:111], v[140:143]
 v_mfma_f32_16x16x32_bf16 v[144:147], v[228:231], v[96:99], v[144:147]
 v_mfma_f32_16x16x32_bf16 v[148:151], v[228:231], v[100:103], v[148:151]
 v_mfma_f32_16x16x32_bf16 v[152:155], v[228:231], v[104:107], v[152:155]
 s_waitcnt lgkmcnt(0)
 s_waitcnt vmcnt(17)
 s_barrier
 v_mfma_f32_16x16x32_bf16 v[156:159], v[228:231], v[108:111], v[156:159]
 ds_read_b128 v[224:227], v240 offset:0
 ds_read_b128 v[228:231], v240 offset:8192
 v_mfma_f32_16x16x32_bf16 v[128:131], v[232:235], v[112:115], v[128:131]
 v_mfma_f32_16x16x32_bf16 v[132:135], v[232:235], v[116:119], v[132:135]
 v_mfma_f32_16x16x32_bf16 v[136:139], v[232:235], v[120:123], v[136:139]
 v_mfma_f32_16x16x32_bf16 v[140:143], v[232:235], v[124:127], v[140:143]
 ds_read_b128 v[232:235], v240 offset:512
 v_mfma_f32_16x16x32_bf16 v[144:147], v[236:239], v[112:115], v[144:147]
 v_mfma_f32_16x16x32_bf16 v[148:151], v[236:239], v[116:119], v[148:151]
 v_mfma_f32_16x16x32_bf16 v[152:155], v[236:239], v[120:123], v[152:155]
 v_mfma_f32_16x16x32_bf16 v[156:159], v[236:239], v[124:127], v[156:159]
 ds_read_b128 v[236:239], v240 offset:8704
 s_waitcnt vmcnt(16)
 v_max3_f32 v192, v128, v129, v130
 v_max3_f32 v196, v132, v133, v134
 v_max3_f32 v200, v136, v137, v138
 v_max3_f32 v204, v140, v141, v142
 v_max3_f32 v192, v192, v131, v144
 v_max3_f32 v196, v196, v135, v148
 v_max3_f32 v200, v200, v139, v152
 v_max3_f32 v204, v204, v143, v156
 v_max3_f32 v192, v192, v145, v146
 v_max3_f32 v196, v196, v149, v150
 v_max3_f32 v200, v200, v153, v154
 v_max3_f32 v204, v204, v157, v158
 v_max_f32 v192, v192, v147
 v_max_f32 v196, v196, v151
 v_max_f32 v200, v200, v155
 v_max_f32 v204, v204, v159
 v_mov_b32 v193, v192
 v_mov_b32 v197, v196
 v_mov_b32 v201, v200
 v_mov_b32 v205, v204
 v_permlane16_swap_b32 v192, v193
 v_permlane16_swap_b32 v196, v197
 v_permlane16_swap_b32 v200, v201
 v_permlane16_swap_b32 v204, v205
 v_max_f32 v192, v192, v193
 v_max_f32 v196, v196, v197
 v_max_f32 v200, v200, v201
 v_max_f32 v204, v204, v205
 v_mov_b32 v193, v192
 v_mov_b32 v197, v196
 v_mov_b32 v201, v200
 v_mov_b32 v205, v204
 v_permlane32_swap_b32 v192, v193
 v_permlane32_swap_b32 v196, v197
 v_permlane32_swap_b32 v200, v201
 v_permlane32_swap_b32 v204, v205
 v_max_f32 v192, v192, v193
 v_max_f32 v196, v196, v197
 v_max_f32 v200, v200, v201
 v_max_f32 v204, v204, v205
 v_ceil_f32 v192, v192
 v_ceil_f32 v196, v196
 v_ceil_f32 v200, v200
 v_ceil_f32 v204, v204
 v_sub_f32 v208, 0, v192
 v_max_f32 v196, s64, v196
 v_sub_f32 v216, 0, v200
 v_max_f32 v204, s73, v204
 v_sub_f32 v209, 0, v192
 v_sub_f32 v212, 0, v196
 v_sub_f32 v217, 0, v200
 v_sub_f32 v220, 0, v204
 v_sub_f32 v210, 0, v192
 v_sub_f32 v213, 0, v196
 v_sub_f32 v218, 0, v200
 v_sub_f32 v221, 0, v204
 v_sub_f32 v211, 0, v192
 v_sub_f32 v214, 0, v196
 v_sub_f32 v219, 0, v200
 v_sub_f32 v222, 0, v204
 v_mov_b32 v244, 0
 v_sub_f32 v215, 0, v196
 v_mov_b32 v246, 0
 v_sub_f32 v223, 0, v204
 v_mov_b32 v245, 0
 v_mov_b32 v247, 0
 s_waitcnt lgkmcnt(3)
 v_mfma_f32_16x16x32_bf16 v[160:163], v[224:227], v[0:3], v[208:211]
 v_add_f32 v128, v128, v208
 v_add_f32 v129, v129, v208
 v_mfma_f32_16x16x32_bf16 v[164:167], v[224:227], v[4:7], v[212:215]
 v_add_f32 v130, v130, v208
 s_add_u32 m0, s69, 98304
 v_mfma_f32_16x16x32_bf16 v[168:171], v[224:227], v[8:11], v[216:219]
 s_waitcnt lgkmcnt(2)
 v_add_f32 v131, v131, v208
 v_mfma_f32_16x16x32_bf16 v[172:175], v[224:227], v[12:15], v[220:223]
 ds_read_b128 v[224:227], v240 offset:1024
 v_mfma_f32_16x16x32_bf16 v[176:179], v[228:231], v[0:3], v[208:211]
 v_exp_f32 v128, v128
 v_mfma_f32_16x16x32_bf16 v[180:183], v[228:231], v[4:7], v[212:215]
 v_add_f32 v144, v144, v208
 v_exp_f32 v129, v129
 v_mfma_f32_16x16x32_bf16 v[184:187], v[228:231], v[8:11], v[216:219]
 s_waitcnt lgkmcnt(2)
 buffer_load_dwordx4 v248, s[28:31], s55 offen offset:0 nt lds
 v_add_f32 v145, v145, v208
 v_mfma_f32_16x16x32_bf16 v[188:191], v[228:231], v[12:15], v[220:223]
 ds_read_b128 v[228:231], v240 offset:9216
 v_exp_f32 v130, v130
 v_mfma_f32_16x16x32_bf16 v[160:163], v[232:235], v[16:19], v[160:163]
 v_add_f32 v146, v146, v208
 v_exp_f32 v131, v131
 v_mfma_f32_16x16x32_bf16 v[164:167], v[232:235], v[20:23], v[164:167]
 s_add_u32 m0, s69, 106496
 v_add_f32 v147, v147, v208
 v_exp_f32 v144, v144
 v_mfma_f32_16x16x32_bf16 v[168:171], v[232:235], v[24:27], v[168:171]
 s_waitcnt lgkmcnt(1)
 v_add_f32 v244, v244, v128
 v_cvt_pk_bf16_f32 v192, v128, v129
 v_mfma_f32_16x16x32_bf16 v[172:175], v[232:235], v[28:31], v[172:175]
 ds_read_b128 v[232:235], v240 offset:1536
 v_add_f32 v132, v132, v212
 v_exp_f32 v145, v145
 v_mfma_f32_16x16x32_bf16 v[176:179], v[236:239], v[16:19], v[176:179]
 buffer_load_dwordx4 v248, s[28:31], s58 offen offset:0 nt lds
 v_add_f32 v244, v244, v129
 v_mfma_f32_16x16x32_bf16 v[180:183], v[236:239], v[20:23], v[180:183]
 v_cvt_pk_bf16_f32 v193, v130, v131
 v_add_f32 v133, v133, v212
 v_exp_f32 v146, v146
 v_mfma_f32_16x16x32_bf16 v[184:187], v[236:239], v[24:27], v[184:187]
 s_add_u32 m0, s69, 99200
 v_add_f32 v244, v244, v130
 v_mfma_f32_16x16x32_bf16 v[188:191], v[236:239], v[28:31], v[188:191]
 ds_read_b128 v[236:239], v240 offset:9728
 v_add_f32 v244, v244, v131
 v_add_f32 v134, v134, v212
 v_mfma_f32_16x16x32_bf16 v[160:163], v[224:227], v[32:35], v[160:163]
 v_exp_f32 v147, v147
 v_add_f32 v135, v135, v212
 v_mfma_f32_16x16x32_bf16 v[164:167], v[224:227], v[36:39], v[164:167]
 v_exp_f32 v132, v132
 buffer_load_dwordx4 v248, s[28:31], s55 offen offset:128 nt lds
 v_mfma_f32_16x16x32_bf16 v[168:171], v[224:227], v[40:43], v[168:171]
 s_waitcnt lgkmcnt(1)
 v_add_f32 v244, v244, v144
 v_cvt_pk_bf16_f32 v194, v144, v145
 v_mfma_f32_16x16x32_bf16 v[172:175], v[224:227], v[44:47], v[172:175]
 ds_read_b128 v[224:227], v240 offset:2048
 v_add_f32 v148, v148, v212
 v_exp_f32 v133, v133
 v_mfma_f32_16x16x32_bf16 v[176:179], v[228:231], v[32:35], v[176:179]
 s_add_u32 m0, s69, 107392
 v_add_f32 v244, v244, v145
 v_cvt_pk_bf16_f32 v195, v146, v147
 v_mfma_f32_16x16x32_bf16 v[180:183], v[228:231], v[36:39], v[180:183]
 v_add_f32 v149, v149, v212
 v_exp_f32 v134, v134
 v_mfma_f32_16x16x32_bf16 v[184:187], v[228:231], v[40:43], v[184:187]
 v_add_f32 v244, v244, v146
 buffer_load_dwordx4 v248, s[28:31], s58 offen offset:128 nt lds
 v_mfma_f32_16x16x32_bf16 v[188:191], v[228:231], v[44:47], v[188:191]
 ds_read_b128 v[228:231], v240 offset:10240
 v_add_f32 v244, v244, v147
 v_add_f32 v150, v150, v212
 v_mfma_f32_16x16x32_bf16 v[160:163], v[232:235], v[48:51], v[160:163]
 v_exp_f32 v135, v135
 v_add_f32 v151, v151, v212
 v_mfma_f32_16x16x32_bf16 v[164:167], v[232:235], v[52:55], v[164:167]
 v_exp_f32 v148, v148
 s_add_u32 m0, s69, 100096
 v_mfma_f32_16x16x32_bf16 v[168:171], v[232:235], v[56:59], v[168:171]
 s_waitcnt lgkmcnt(1)
 v_add_f32 v245, v245, v132
 v_cvt_pk_bf16_f32 v196, v132, v133
 v_mfma_f32_16x16x32_bf16 v[172:175], v[232:235], v[60:63], v[172:175]
 ds_read_b128 v[232:235], v240 offset:2560
 v_add_f32 v136, v136, v216
 v_exp_f32 v149, v149
 v_mfma_f32_16x16x32_bf16 v[176:179], v[236:239], v[48:51], v[176:179]
 v_add_f32 v245, v245, v133
 buffer_load_dwordx4 v248, s[28:31], s55 offen offset:256 nt lds
 v_cvt_pk_bf16_f32 v197, v134, v135
 v_mfma_f32_16x16x32_bf16 v[180:183], v[236:239], v[52:55], v[180:183]
 v_add_f32 v137, v137, v216
 v_exp_f32 v150, v150
 v_mfma_f32_16x16x32_bf16 v[184:187], v[236:239], v[56:59], v[184:187]
 v_add_f32 v245, v245, v134
 v_add_f32 v245, v245, v135
 v_mfma_f32_16x16x32_bf16 v[188:191], v[236:239], v[60:63], v[188:191]
 ds_read_b128 v[236:239], v240 offset:10752
 s_add_u32 m0, s69, 108288
 v_add_f32 v138, v138, v216
 v_mfma_f32_16x16x32_bf16 v[160:163], v[224:227], v[64:67], v[160:163]
 v_exp_f32 v151, v151
 v_add_f32 v139, v139, v216
 v_mfma_f32_16x16x32_bf16 v[164:167], v[224:227], v[68:71], v[164:167]
 v_exp_f32 v136, v136
 v_mfma_f32_16x16x32_bf16 v[168:171], v[224:227], v[72:75], v[168:171]
 s_waitcnt lgkmcnt(1)
 v_add_f32 v245, v245, v148
 buffer_load_dwordx4 v248, s[28:31], s58 offen offset:256 nt lds
 v_mfma_f32_16x16x32_bf16 v[172:175], v[224:227], v[76:79], v[172:175]
 ds_read_b128 v[224:227], v240 offset:3072
 v_cvt_pk_bf16_f32 v198, v148, v149
 v_add_f32 v152, v152, v216
 v_mfma_f32_16x16x32_bf16 v[176:179], v[228:231], v[64:67], v[176:179]
 v_exp_f32 v137, v137
 v_add_f32 v245, v245, v149
 v_mfma_f32_16x16x32_bf16 v[180:183], v[228:231], v[68:71], v[180:183]
 v_cvt_pk_bf16_f32 v199, v150, v151
 s_add_u32 m0, s69, 100992
 v_add_f32 v153, v153, v216
 v_mfma_f32_16x16x32_bf16 v[184:187], v[228:231], v[72:75], v[184:187]
 v_exp_f32 v138, v138
 v_add_f32 v245, v245, v150
 v_mfma_f32_16x16x32_bf16 v[188:191], v[228:231], v[76:79], v[188:191]
 ds_read_b128 v[228:231], v240 offset:11264
 v_add_f32 v245, v245, v151
 v_add_f32 v154, v154, v216
 v_mfma_f32_16x16x32_bf16 v[160:163], v[232:235], v[80:83], v[160:163]
 buffer_load_dwordx4 v248, s[28:31], s55 offen offset:384 nt lds
 v_exp_f32 v139, v139
 v_mfma_f32_16x16x32_bf16 v[164:167], v[232:235], v[84:87], v[164:167]
 v_add_f32 v155, v155, v216
 v_exp_f32 v152, v152
 v_mfma_f32_16x16x32_bf16 v[168:171], v[232:235], v[88:91], v[168:171]
 s_waitcnt lgkmcnt(1)
 v_add_f32 v246, v246, v136
 v_cvt_pk_bf16_f32 v200, v136, v137
 v_mfma_f32_16x16x32_bf16 v[172:175], v[232:235], v[92:95], v[172:175]
 ds_read_b128 v[232:235], v240 offset:3584
 s_add_u32 m0, s69, 109184
 v_add_f32 v140, v140, v220
 v_mfma_f32_16x16x32_bf16 v[176:179], v[236:239], v[80:83], v[176:179]
 v_exp_f32 v153, v153
 v_add_f32 v246, v246, v137
 v_mfma_f32_16x16x32_bf16 v[180:183], v[236:239], v[84:87], v[180:183]
 v_cvt_pk_bf16_f32 v201, v138, v139
 v_add_f32 v141, v141, v220
 buffer_load_dwordx4 v248, s[28:31], s58 offen offset:384 nt lds
 v_mfma_f32_16x16x32_bf16 v[184:187], v[236:239], v[88:91], v[184:187]
 v_exp_f32 v154, v154
 v_add_f32 v246, v246, v138
 v_mfma_f32_16x16x32_bf16 v[188:191], v[236:239], v[92:95], v[188:191]
 ds_read_b128 v[236:239], v240 offset:11776
 v_add_f32 v246, v246, v139
 v_add_f32 v142, v142, v220
 v_mfma_f32_16x16x32_bf16 v[160:163], v[224:227], v[96:99], v[160:163]
 v_exp_f32 v155, v155
 s_add_u32 s55, s55, 16384
 v_mfma_f32_16x16x32_bf16 v[164:167], v[224:227], v[100:103], v[164:167]
 v_add_f32 v143, v143, v220
 v_exp_f32 v140, v140
 v_mfma_f32_16x16x32_bf16 v[168:171], v[224:227], v[104:107], v[168:171]
 s_add_u32 s58, s58, 16384
 s_waitcnt lgkmcnt(1)
 v_add_f32 v246, v246, v152
 v_mfma_f32_16x16x32_bf16 v[172:175], v[224:227], v[108:111], v[172:175]
 v_cvt_pk_bf16_f32 v202, v152, v153
 v_add_u32 v240, 65536, v240
 v_add_f32 v156, v156, v220
 v_mfma_f32_16x16x32_bf16 v[176:179], v[228:231], v[96:99], v[176:179]
 v_exp_f32 v141, v141
 v_add_f32 v246, v246, v153
 v_mfma_f32_16x16x32_bf16 v[180:183], v[228:231], v[100:103], v[180:183]
 v_cvt_pk_bf16_f32 v203, v154, v155
 v_add_f32 v157, v157, v220
 v_exp_f32 v142, v142
 v_mfma_f32_16x16x32_bf16 v[184:187], v[228:231], v[104:107], v[184:187]
 s_waitcnt lgkmcnt(0)
 s_waitcnt vmcnt(16)
 s_barrier
 v_mfma_f32_16x16x32_bf16 v[188:191], v[228:231], v[108:111], v[188:191]
 ds_read_b64_tr_b16 v[224:225], v241 offset:0
 ds_read_b64_tr_b16 v[226:227], v241 offset:8192
 ds_read_b64_tr_b16 v[228:229], v242 offset:0
 ds_read_b64_tr_b16 v[230:231], v242 offset:8192
 v_mfma_f32_16x16x32_bf16 v[160:163], v[232:235], v[112:115], v[160:163]
 v_add_f32 v246, v246, v154
 v_add_f32 v246, v246, v155
 v_add_f32 v158, v158, v220
 v_mfma_f32_16x16x32_bf16 v[164:167], v[232:235], v[116:119], v[164:167]
 v_exp_f32 v143, v143
 v_add_f32 v159, v159, v220
 v_mfma_f32_16x16x32_bf16 v[168:171], v[232:235], v[120:123], v[168:171]
 v_exp_f32 v156, v156
 v_add_f32 v247, v247, v140
 v_mfma_f32_16x16x32_bf16 v[172:175], v[232:235], v[124:127], v[172:175]
 ds_read_b64_tr_b16 v[232:233], v241 offset:512
 ds_read_b64_tr_b16 v[234:235], v241 offset:8704
 v_cvt_pk_bf16_f32 v204, v140, v141
 v_mfma_f32_16x16x32_bf16 v[176:179], v[236:239], v[112:115], v[176:179]
 v_exp_f32 v157, v157
 v_add_f32 v247, v247, v141
 v_mfma_f32_16x16x32_bf16 v[180:183], v[236:239], v[116:119], v[180:183]
 v_cvt_pk_bf16_f32 v205, v142, v143
 v_exp_f32 v158, v158
 v_mfma_f32_16x16x32_bf16 v[184:187], v[236:239], v[120:123], v[184:187]
 v_add_f32 v247, v247, v142
 v_add_f32 v247, v247, v143
 v_exp_f32 v159, v159
 v_add_f32 v247, v247, v156
 v_cvt_pk_bf16_f32 v206, v156, v157
 v_add_f32 v247, v247, v157
 v_cvt_pk_bf16_f32 v207, v158, v159
 v_add_f32 v247, v247, v158
 v_add_f32 v247, v247, v159
 v_mfma_f32_16x16x32_bf16 v[188:191], v[236:239], v[124:127], v[188:191]
 ds_read_b64_tr_b16 v[236:237], v242 offset:512
 ds_read_b64_tr_b16 v[238:239], v242 offset:8704
 s_waitcnt lgkmcnt(6)
 v_mfma_f32_16x16x32_bf16 a[0:3], v[224:227], v[192:195], 0
 v_mfma_f32_16x16x32_bf16 a[4:7], v[224:227], v[196:199], 0
 s_add_u32 m0, s69, 0
 v_mfma_f32_16x16x32_bf16 a[8:11], v[224:227], v[200:203], 0
 s_waitcnt lgkmcnt(4)
 v_max3_f32 v249, v160, v161, v162
 v_mfma_f32_16x16x32_bf16 a[12:15], v[224:227], v[204:207], 0
 ds_read_b64_tr_b16 v[224:225], v241 offset:1024
 ds_read_b64_tr_b16 v[226:227], v241 offset:9216
 v_mfma_f32_16x16x32_bf16 a[16:19], v[228:231], v[192:195], 0
 v_max3_f32 v250, v163, v164, v165
 buffer_load_dwordx4 v243, s[24:27], s54 offen offset:0 nt lds
 v_mfma_f32_16x16x32_bf16 a[20:23], v[228:231], v[196:199], 0
 v_max3_f32 v249, v249, v166, v167
 v_max3_f32 v250, v250, v168, v169
 v_mfma_f32_16x16x32_bf16 a[24:27], v[228:231], v[200:203], 0
 s_waitcnt lgkmcnt(4)
 v_max3_f32 v249, v249, v170, v171
 v_mfma_f32_16x16x32_bf16 a[28:31], v[228:231], v[204:207], 0
 ds_read_b64_tr_b16 v[228:229], v242 offset:1024
 ds_read_b64_tr_b16 v[230:231], v242 offset:9216
 v_mfma_f32_16x16x32_bf16 a[32:35], v[232:235], v[192:195], 0
 s_add_u32 m0, s69, 8192
 v_max3_f32 v250, v250, v172, v173
 v_mfma_f32_16x16x32_bf16 a[36:39], v[232:235], v[196:199], 0
 v_max3_f32 v249, v249, v174, v175
 v_max3_f32 v250, v250, v176, v177
 v_mfma_f32_16x16x32_bf16 a[40:43], v[232:235], v[200:203], 0
 s_waitcnt lgkmcnt(2)
 buffer_load_dwordx4 v243, s[24:27], s53 offen offset:0 nt lds
 v_mfma_f32_16x16x32_bf16 a[44:47], v[232:235], v[204:207], 0
 ds_read_b64_tr_b16 v[232:233], v241 offset:1536
 ds_read_b64_tr_b16 v[234:235], v241 offset:9728
 v_mfma_f32_16x16x32_bf16 a[48:51], v[236:239], v[192:195], 0
 v_max3_f32 v249, v249, v178, v179
 v_max3_f32 v250, v250, v180, v181
 v_mfma_f32_16x16x32_bf16 a[52:55], v[236:239], v[196:199], 0
 v_max3_f32 v249, v249, v182, v183
 s_add_u32 m0, s69, 896
 v_mfma_f32_16x16x32_bf16 a[56:59], v[236:239], v[200:203], 0
 v_max3_f32 v250, v250, v184, v185
 v_max3_f32 v249, v249, v186, v187
 v_mfma_f32_16x16x32_bf16 a[60:63], v[236:239], v[204:207], 0
 ds_read_b64_tr_b16 v[236:237], v242 offset:1536
 ds_read_b64_tr_b16 v[238:239], v242 offset:9728
 v_mfma_f32_16x16x32_bf16 a[64:67], v[224:227], v[192:195], 0
 buffer_load_dwordx4 v243, s[24:27], s54 offen offset:128 nt lds
 v_max3_f32 v250, v250, v188, v189
 v_mfma_f32_16x16x32_bf16 a[68:71], v[224:227], v[196:199], 0
 v_max3_f32 v249, v249, v190, v191
 v_max_f32 v249, v249, v250
 v_mfma_f32_16x16x32_bf16 a[72:75], v[224:227], v[200:203], 0
 s_waitcnt lgkmcnt(2)
 s_add_u32 m0, s69, 9088
 v_mfma_f32_16x16x32_bf16 a[76:79], v[224:227], v[204:207], 0
 ds_read_b64_tr_b16 v[224:225], v241 offset:2048
 ds_read_b64_tr_b16 v[226:227], v241 offset:10240
 v_mfma_f32_16x16x32_bf16 a[80:83], v[228:231], v[192:195], 0
 v_cmp_lt_f32 vcc, s63, v249
 s_cbranch_vccnz L_tr_1
L_back_1:
 v_mfma_f32_16x16x32_bf16 a[84:87], v[228:231], v[196:199], 0
 v_exp_f32 v160, v160
 v_mfma_f32_16x16x32_bf16 a[88:91], v[228:231], v[200:203], 0
 buffer_load_dwordx4 v243, s[24:27], s53 offen offset:128 nt lds
 v_mfma_f32_16x16x32_bf16 a[92:95], v[228:231], v[204:207], 0
 ds_read_b64_tr_b16 v[228:229], v242 offset:2048
 ds_read_b64_tr_b16 v[230:231], v242 offset:10240
 v_mfma_f32_16x16x32_bf16 a[96:99], v[232:235], v[192:195], 0
 v_exp_f32 v161, v161
 v_mfma_f32_16x16x32_bf16 a[100:103], v[232:235], v[196:199], 0
 s_add_u32 m0, s69, 1792
 v_mfma_f32_16x16x32_bf16 a[104:107], v[232:235], v[200:203], 0
 s_waitcnt lgkmcnt(2)
 v_exp_f32 v162, v162
 v_mfma_f32_16x16x32_bf16 a[108:111], v[232:235], v[204:207], 0
 ds_read_b64_tr_b16 v[232:233], v241 offset:2560
 ds_read_b64_tr_b16 v[234:235], v241 offset:10752
 v_mfma_f32_16x16x32_bf16 a[112:115], v[236:239], v[192:195], 0
 v_exp_f32 v163, v163
 buffer_load_dwordx4 v243, s[24:27], s54 offen offset:256 nt lds
 v_mfma_f32_16x16x32_bf16 a[116:119], v[236:239], v[196:199], 0
 v_exp_f32 v176, v176
 v_mfma_f32_16x16x32_bf16 a[120:123], v[236:239], v[200:203], 0
 s_add_u32 m0, s69, 9984
 v_mfma_f32_16x16x32_bf16 a[124:127], v[236:239], v[204:207], 0
 ds_read_b64_tr_b16 v[236:237], v242 offset:2560
 ds_read_b64_tr_b16 v[238:239], v242 offset:10752
 v_mfma_f32_16x16x32_bf16 a[128:131], v[224:227], v[192:195], 0
 v_exp_f32 v177, v177
 v_mfma_f32_16x16x32_bf16 a[132:135], v[224:227], v[196:199], 0
 buffer_load_dwordx4 v243, s[24:27], s53 offen offset:256 nt lds
 v_mfma_f32_16x16x32_bf16 a[136:139], v[224:227], v[200:203], 0
 s_waitcnt lgkmcnt(2)
 v_exp_f32 v178, v178
 v_mfma_f32_16x16x32_bf16 a[140:143], v[224:227], v[204:207], 0
 ds_read_b64_tr_b16 v[224:225], v241 offset:3072
 ds_read_b64_tr_b16 v[226:227], v241 offset:11264
 v_mfma_f32_16x16x32_bf16 a[144:147], v[228:231], v[192:195], 0
 v_exp_f32 v179, v179
 s_add_u32 m0, s69, 2688
 v_mfma_f32_16x16x32_bf16 a[148:151], v[228:231], v[196:199], 0
 v_exp_f32 v164, v164
 v_mfma_f32_16x16x32_bf16 a[152:155], v[228:231], v[200:203], 0
 buffer_load_dwordx4 v243, s[24:27], s54 offen offset:384 nt lds
 v_mfma_f32_16x16x32_bf16 a[156:159], v[228:231], v[204:207], 0
 ds_read_b64_tr_b16 v[228:229], v242 offset:3072
 ds_read_b64_tr_b16 v[230:231], v242 offset:11264
 v_mfma_f32_16x16x32_bf16 a[160:163], v[232:235], v[192:195], 0
 v_exp_f32 v165, v165
 v_mfma_f32_16x16x32_bf16 a[164:167], v[232:235], v[196:199], 0
 s_add_u32 m0, s69, 10880
 v_mfma_f32_16x16x32_bf16 a[168:171], v[232:235], v[200:203], 0
 s_waitcnt lgkmcnt(2)
 v_exp_f32 v166, v166
 v_mfma_f32_16x16x32_bf16 a[172:175], v[232:235], v[204:207], 0
 ds_read_b64_tr_b16 v[232:233], v241 offset:3584
 ds_read_b64_tr_b16 v[234:235], v241 offset:11776
 v_mfma_f32_16x16x32_bf16 a[176:179], v[236:239], v[192:195], 0
 v_exp_f32 v167, v167
 v_mfma_f32_16x16x32_bf16 a[180:183], v[236:239], v[196:199], 0
 buffer_load_dwordx4 v243, s[24:27], s53 offen offset:384 nt lds
 v_mfma_f32_16x16x32_bf16 a[184:187], v[236:239], v[200:203], 0
 v_exp_f32 v180, v180
 v_mfma_f32_16x16x32_bf16 a[188:191], v[236:239], v[204:207], 0
 ds_read_b64_tr_b16 v[236:237], v242 offset:3584
 ds_read_b64_tr_b16 v[238:239], v242 offset:11776
 s_add_u32 s54, s54, 16384
 v_mfma_f32_16x16x32_bf16 a[192:195], v[224:227], v[192:195], 0
 v_exp_f32 v181, v181
 v_mfma_f32_16x16x32_bf16 a[196:199], v[224:227], v[196:199], 0
 v_exp_f32 v182, v182
 v_mfma_f32_16x16x32_bf16 a[200:203], v[224:227], v[200:203], 0
 s_add_u32 s53, s53, 16384
 s_waitcnt lgkmcnt(2)
 v_add_u32 v241, 65536, v241
 v_mfma_f32_16x16x32_bf16 a[204:207], v[224:227], v[204:207], 0
 v_exp_f32 v183, v183
 v_mfma_f32_16x16x32_bf16 a[208:211], v[228:231], v[192:195], 0
 v_exp_f32 v168, v168
 v_mfma_f32_16x16x32_bf16 a[212:215], v[228:231], v[196:199], 0
 v_mfma_f32_16x16x32_bf16 a[216:219], v[228:231], v[200:203], 0
 s_waitcnt lgkmcnt(0)
 s_waitcnt vmcnt(16)
 s_barrier
 v_mfma_f32_16x16x32_bf16 a[220:223], v[228:231], v[204:207], 0
 ds_read_b128 v[224:227], v240 offset:0
 ds_read_b128 v[228:231], v240 offset:8192
 v_mfma_f32_16x16x32_bf16 a[224:227], v[232:235], v[192:195], 0
 v_exp_f32 v169, v169
 v_mfma_f32_16x16x32_bf16 a[228:231], v[232:235], v[196:199], 0
 v_add_u32 v242, 65536, v242
 v_mfma_f32_16x16x32_bf16 a[232:235], v[232:235], v[200:203], 0
 v_exp_f32 v170, v170
 v_mfma_f32_16x16x32_bf16 a[236:239], v[232:235], v[204:207], 0
 ds_read_b128 v[232:235], v240 offset:512
 v_mfma_f32_16x16x32_bf16 a[240:243], v[236:239], v[192:195], 0
 v_exp_f32 v171, v171
 v_mfma_f32_16x16x32_bf16 a[244:247], v[236:239], v[196:199], 0
 v_exp_f32 v184, v184
 v_mfma_f32_16x16x32_bf16 a[248:251], v[236:239], v[200:203], 0
 v_exp_f32 v185, v185
 v_mfma_f32_16x16x32_bf16 a[252:255], v[236:239], v[204:207], 0
 ds_read_b128 v[236:239], v240 offset:8704
 s_mov_b32 s61, 6
L_loop:
 s_waitcnt lgkmcnt(3)
 v_mfma_f32_16x16x32_bf16 v[128:131], v[224:227], v[0:3], v[208:211]
 v_add_f32 v244, v244, v160
 v_cvt_pk_bf16_f32 v192, v160, v161
 v_mfma_f32_16x16x32_bf16 v[132:135], v[224:227], v[4:7], v[212:215]
 s_add_u32 m0, s69, 32768
 v_mfma_f32_16x16x32_bf16 v[136:139], v[224:227], v[8:11], v[216:219]
 s_waitcnt lgkmcnt(2)
 v_mfma_f32_16x16x32_bf16 v[140:143], v[224:227], v[12:15], v[220:223]
 ds_read_b128 v[224:227], v240 offset:1024
 v_mfma_f32_16x16x32_bf16 v[144:147], v[228:231], v[0:3], v[208:211]
 v_exp_f32 v186, v186
 v_mfma_f32_16x16x32_bf16 v[148:151], v[228:231], v[4:7], v[212:215]
 v_add_f32 v244, v244, v161
 buffer_load_dwordx4 v248, s[28:31], s55 offen offset:0 nt lds
 v_mfma_f32_16x16x32_bf16 v[152:155], v[228:231], v[8:11], v[216:219]
 s_waitcnt lgkmcnt(2)
 v_cvt_pk_bf16_f32 v193, v162, v163
 v_mfma_f32_16x16x32_bf16 v[156:159], v[228:231], v[12:15], v[220:223]
 ds_read_b128 v[228:231], v240 offset:9216
 v_mfma_f32_16x16x32_bf16 v[128:131], v[232:235], v[16:19], v[128:131]
 v_exp_f32 v187, v187
 v_mfma_f32_16x16x32_bf16 v[132:135], v[232:235], v[20:23], v[132:135]
 s_add_u32 m0, s69, 40960
 v_add_f32 v244, v244, v162
 v_mfma_f32_16x16x32_bf16 v[136:139], v[232:235], v[24:27], v[136:139]
 s_waitcnt lgkmcnt(1)
 v_add_f32 v244, v244, v163
 v_mfma_f32_16x16x32_bf16 v[140:143], v[232:235], v[28:31], v[140:143]
 ds_read_b128 v[232:235], v240 offset:1536
 v_exp_f32 v172, v172
 v_mfma_f32_16x16x32_bf16 v[144:147], v[236:239], v[16:19], v[144:147]
 buffer_load_dwordx4 v248, s[28:31], s58 offen offset:0 nt lds
 v_add_f32 v244, v244, v176
 v_mfma_f32_16x16x32_bf16 v[148:151], v[236:239], v[20:23], v[148:151]
 v_cvt_pk_bf16_f32 v194, v176, v177
 s_add_u32 m0, s69, 33664
 v_mfma_f32_16x16x32_bf16 v[152:155], v[236:239], v[24:27], v[152:155]
 v_exp_f32 v173, v173
 v_mfma_f32_16x16x32_bf16 v[156:159], v[236:239], v[28:31], v[156:159]
 ds_read_b128 v[236:239], v240 offset:9728
 v_add_f32 v244, v244, v177
 v_mfma_f32_16x16x32_bf16 v[128:131], v[224:227], v[32:35], v[128:131]
 buffer_load_dwordx4 v248, s[28:31], s55 offen offset:128 nt lds
 v_cvt_pk_bf16_f32 v195, v178, v179
 v_mfma_f32_16x16x32_bf16 v[132:135], v[224:227], v[36:39], v[132:135]
 v_exp_f32 v174, v174
 v_mfma_f32_16x16x32_bf16 v[136:139], v[224:227], v[40:43], v[136:139]
 s_waitcnt lgkmcnt(1)
 s_add_u32 m0, s69, 41856
 v_mfma_f32_16x16x32_bf16 v[140:143], v[224:227], v[44:47], v[140:143]
 ds_read_b128 v[224:227], v240 offset:2048
 v_add_f32 v244, v244, v178
 v_mfma_f32_16x16x32_bf16 v[144:147], v[228:231], v[32:35], v[144:147]
 v_add_f32 v244, v244, v179
 v_mfma_f32_16x16x32_bf16 v[148:151], v[228:231], v[36:39], v[148:151]
 v_exp_f32 v175, v175
 v_mfma_f32_16x16x32_bf16 v[152:155], v[228:231], v[40:43], v[152:155]
 buffer_load_dwordx4 v248, s[28:31], s58 offen offset:128 nt lds
 v_add_f32 v245, v245, v164
 v_mfma_f32_16x16x32_bf16 v[156:159], v[228:231], v[44:47], v[156:159]
 ds_read_b128 v[228:231], v240 offset:10240
 v_cvt_pk_bf16_f32 v196, v164, v165
 v_mfma_f32_16x16x32_bf16 v[128:131], v[232:235], v[48:51], v[128:131]
 s_add_u32 m0, s69, 34560
 v_mfma_f32_16x16x32_bf16 v[132:135], v[232:235], v[52:55], v[132:135]
 v_exp_f32 v188, v188
 v_mfma_f32_16x16x32_bf16 v[136:139], v[232:235], v[56:59], v[136:139]
 s_waitcnt lgkmcnt(1)
 v_add_f32 v245, v245, v165
 v_mfma_f32_16x16x32_bf16 v[140:143], v[232:235], v[60:63], v[140:143]
 ds_read_b128 v[232:235], v240 offset:2560
 buffer_load_dwordx4 v248, s[28:31], s55 offen offset:256 nt lds
 v_mfma_f32_16x16x32_bf16 v[144:147], v[236:239], v[48:51], v[144:147]
 v_cvt_pk_bf16_f32 v197, v166, v167
 v_mfma_f32_16x16x32_bf16 v[148:151], v[236:239], v[52:55], v[148:151]
 v_exp_f32 v189, v189
 v_mfma_f32_16x16x32_bf16 v[152:155], v[236:239], v[56:59], v[152:155]
 s_add_u32 m0, s69, 42752
 v_add_f32 v245, v245, v166
 v_mfma_f32_16x16x32_bf16 v[156:159], v[236:239], v[60:63], v[156:159]
 ds_read_b128 v[236:239], v240 offset:10752
 v_add_f32 v245, v245, v167
 v_mfma_f32_16x16x32_bf16 v[128:131], v[224:227], v[64:67], v[128:131]
 v_exp_f32 v190, v190
 v_mfma_f32_16x16x32_bf16 v[132:135], v[224:227], v[68:71], v[132:135]
 buffer_load_dwordx4 v248, s[28:31], s58 offen offset:256 nt lds
 v_add_f32 v245, v245, v180
 v_mfma_f32_16x16x32_bf16 v[136:139], v[224:227], v[72:75], v[136:139]
 s_waitcnt lgkmcnt(1)
 v_cvt_pk_bf16_f32 v198, v180, v181
 v_mfma_f32_16x16x32_bf16 v[140:143], v[224:227], v[76:79], v[140:143]
 ds_read_b128 v[224:227], v240 offset:3072
 s_add_u32 m0, s69, 35456
 v_mfma_f32_16x16x32_bf16 v[144:147], v[228:231], v[64:67], v[144:147]
 v_exp_f32 v191, v191
 v_mfma_f32_16x16x32_bf16 v[148:151], v[228:231], v[68:71], v[148:151]
 v_add_f32 v245, v245, v181
 buffer_load_dwordx4 v248, s[28:31], s55 offen offset:384 nt lds
 v_mfma_f32_16x16x32_bf16 v[152:155], v[228:231], v[72:75], v[152:155]
 v_cvt_pk_bf16_f32 v199, v182, v183
 v_add_f32 v245, v245, v182
 v_mfma_f32_16x16x32_bf16 v[156:159], v[228:231], v[76:79], v[156:159]
 ds_read_b128 v[228:231], v240 offset:11264
 v_add_f32 v245, v245, v183
 v_mfma_f32_16x16x32_bf16 v[128:131], v[232:235], v[80:83], v[128:131]
 s_add_u32 m0, s69, 43648
 v_add_f32 v246, v246, v168
 v_mfma_f32_16x16x32_bf16 v[132:135], v[232:235], v[84:87], v[132:135]
 v_cvt_pk_bf16_f32 v200, v168, v169
 v_mfma_f32_16x16x32_bf16 v[136:139], v[232:235], v[88:91], v[136:139]
 s_waitcnt lgkmcnt(1)
 v_add_f32 v246, v246, v169
 v_mfma_f32_16x16x32_bf16 v[140:143], v[232:235], v[92:95], v[140:143]
 ds_read_b128 v[232:235], v240 offset:3584
 buffer_load_dwordx4 v248, s[28:31], s58 offen offset:384 nt lds
 v_mfma_f32_16x16x32_bf16 v[144:147], v[236:239], v[80:83], v[144:147]
 v_cvt_pk_bf16_f32 v201, v170, v171
 v_add_f32 v246, v246, v170
 v_mfma_f32_16x16x32_bf16 v[148:151], v[236:239], v[84:87], v[148:151]
 v_add_f32 v246, v246, v171
 s_add_u32 s55, s55, 16384
 v_mfma_f32_16x16x32_bf16 v[152:155], v[236:239], v[88:91], v[152:155]
 v_add_f32 v246, v246, v184
 v_mfma_f32_16x16x32_bf16 v[156:159], v[236:239], v[92:95], v[156:159]
 ds_read_b128 v[236:239], v240 offset:11776
 v_cvt_pk_bf16_f32 v202, v184, v185
 v_mfma_f32_16x16x32_bf16 v[128:131], v[224:227], v[96:99], v[128:131]
 v_subrev_u32 v240, 65536, v240
 v_add_f32 v246, v246, v185
 v_mfma_f32_16x16x32_bf16 v[132:135], v[224:227], v[100:103], v[132:135]
 s_add_u32 s58, s58, 16384
 v_cvt_pk_bf16_f32 v203, v186, v187
 v_mfma_f32_16x16x32_bf16 v[136:139], v[224:227], v[104:107], v[136:139]
 s_waitcnt lgkmcnt(1)
 v_add_f32 v246, v246, v186
 v_mfma_f32_16x16x32_bf16 v[140:143], v[224:227], v[108:111], v[140:143]
 v_add_f32 v246, v246, v187
 v_add_f32 v247, v247, v172
 v_mfma_f32_16x16x32_bf16 v[144:147], v[228:231], v[96:99], v[144:147]
 v_cvt_pk_bf16_f32 v204, v172, v173
 v_mfma_f32_16x16x32_bf16 v[148:151], v[228:231], v[100:103], v[148:151]
 v_add_f32 v247, v247, v173
 v_mfma_f32_16x16x32_bf16 v[152:155], v[228:231], v[104:107], v[152:155]
 s_waitcnt lgkmcnt(0)
 s_waitcnt vmcnt(16)
 s_barrier
 v_mfma_f32_16x16x32_bf16 v[156:159], v[228:231], v[108:111], v[156:159]
 ds_read_b64_tr_b16 v[224:225], v241 offset:0
 ds_read_b64_tr_b16 v[226:227], v241 offset:8192
 ds_read_b64_tr_b16 v[228:229], v242 offset:0
 ds_read_b64_tr_b16 v[230:231], v242 offset:8192
 v_mfma_f32_16x16x32_bf16 v[128:131], v[232:235], v[112:115], v[128:131]
 v_cvt_pk_bf16_f32 v205, v174, v175
 v_add_f32 v247, v247, v174
 v_mfma_f32_16x16x32_bf16 v[132:135], v[232:235], v[116:119], v[132:135]
 v_add_f32 v247, v247, v175
 v_add_f32 v247, v247, v188
 v_mfma_f32_16x16x32_bf16 v[136:139], v[232:235], v[120:123], v[136:139]
 v_cvt_pk_bf16_f32 v206, v188, v189
 v_mfma_f32_16x16x32_bf16 v[140:143], v[232:235], v[124:127], v[140:143]
 ds_read_b64_tr_b16 v[232:233], v241 offset:512
 ds_read_b64_tr_b16 v[234:235], v241 offset:8704
 v_mfma_f32_16x16x32_bf16 v[144:147], v[236:239], v[112:115], v[144:147]
 v_add_f32 v247, v247, v189
 v_cvt_pk_bf16_f32 v207, v190, v191
 v_mfma_f32_16x16x32_bf16 v[148:151], v[236:239], v[116:119], v[148:151]
 v_add_f32 v247, v247, v190
 v_mfma_f32_16x16x32_bf16 v[152:155], v[236:239], v[120:123], v[152:155]
 v_add_f32 v247, v247, v191
 v_mfma_f32_16x16x32_bf16 v[156:159], v[236:239], v[124:127], v[156:159]
 ds_read_b64_tr_b16 v[236:237], v242 offset:512
 ds_read_b64_tr_b16 v[238:239], v242 offset:8704
 s_waitcnt lgkmcnt(6)
 v_mfma_f32_16x16x32_bf16 a[0:3], v[224:227], v[192:195], a[0:3]
 v_mfma_f32_16x16x32_bf16 a[4:7], v[224:227], v[196:199], a[4:7]
 s_add_u32 m0, s69, 65536
 v_mfma_f32_16x16x32_bf16 a[8:11], v[224:227], v[200:203], a[8:11]
 s_waitcnt lgkmcnt(4)
 v_max3_f32 v249, v128, v129, v130
 v_mfma_f32_16x16x32_bf16 a[12:15], v[224:227], v[204:207], a[12:15]
 ds_read_b64_tr_b16 v[224:225], v241 offset:1024
 ds_read_b64_tr_b16 v[226:227], v241 offset:9216
 v_mfma_f32_16x16x32_bf16 a[16:19], v[228:231], v[192:195], a[16:19]
 v_max3_f32 v250, v131, v132, v133
 buffer_load_dwordx4 v243, s[24:27], s54 offen offset:0 nt lds
 v_mfma_f32_16x16x32_bf16 a[20:23], v[228:231], v[196:199], a[20:23]
 v_max3_f32 v249, v249, v134, v135
 v_max3_f32 v250, v250, v136, v137
 v_mfma_f32_16x16x32_bf16 a[24:27], v[228:231], v[200:203], a[24:27]
 s_waitcnt lgkmcnt(4)
 v_max3_f32 v249, v249, v138, v139
 v_mfma_f32_16x16x32_bf16 a[28:31], v[228:231], v[204:207], a[28:31]
 ds_read_b64_tr_b16 v[228:229], v242 offset:1024
 ds_read_b64_tr_b16 v[230:231], v242 offset:9216
 v_mfma_f32_16x16x32_bf16 a[32:35], v[232:235], v[192:195], a[32:35]
 s_add_u32 m0, s69, 73728
 v_max3_f32 v250, v250, v140, v141
 v_mfma_f32_16x16x32_bf16 a[36:39], v[232:235], v[196:199], a[36:39]
 v_max3_f32 v249, v249, v142, v143
 v_max3_f32 v250, v250, v144, v145
 v_mfma_f32_16x16x32_bf16 a[40:43], v[232:235], v[200:203], a[40:43]
 s_waitcnt lgkmcnt(2)
 buffer_load_dwordx4 v243, s[24:27], s53 offen offset:0 nt lds
 v_mfma_f32_16x16x32_bf16 a[44:47], v[232:235], v[204:207], a[44:47]
 ds_read_b64_tr_b16 v[232:233], v241 offset:1536
 ds_read_b64_tr_b16 v[234:235], v241 offset:9728
 v_mfma_f32_16x16x32_bf16 a[48:51], v[236:239], v[192:195], a[48:51]
 v_max3_f32 v249, v249, v146, v147
 v_max3_f32 v250, v250, v148, v149
 v_mfma_f32_16x16x32_bf16 a[52:55], v[236:239], v[196:199], a[52:55]
 v_max3_f32 v249, v249, v150, v151
 s_add_u32 m0, s69, 66432
 v_mfma_f32_16x16x32_bf16 a[56:59], v[236:239], v[200:203], a[56:59]
 v_max3_f32 v250, v250, v152, v153
 v_max3_f32 v249, v249, v154, v155
 v_mfma_f32_16x16x32_bf16 a[60:63], v[236:239], v[204:207], a[60:63]
 ds_read_b64_tr_b16 v[236:237], v242 offset:1536
 ds_read_b64_tr_b16 v[238:239], v242 offset:9728
 v_mfma_f32_16x16x32_bf16 a[64:67], v[224:227], v[192:195], a[64:67]
 buffer_load_dwordx4 v243, s[24:27], s54 offen offset:128 nt lds
 v_max3_f32 v250, v250, v156, v157
 v_mfma_f32_16x16x32_bf16 a[68:71], v[224:227], v[196:199], a[68:71]
 v_max3_f32 v249, v249, v158, v159
 v_max_f32 v249, v249, v250
 v_mfma_f32_16x16x32_bf16 a[72:75], v[224:227], v[200:203], a[72:75]
 s_waitcnt lgkmcnt(2)
 s_add_u32 m0, s69, 74624
 v_mfma_f32_16x16x32_bf16 a[76:79], v[224:227], v[204:207], a[76:79]
 ds_read_b64_tr_b16 v[224:225], v241 offset:2048
 ds_read_b64_tr_b16 v[226:227], v241 offset:10240
 v_mfma_f32_16x16x32_bf16 a[80:83], v[228:231], v[192:195], a[80:83]
 v_cmp_lt_f32 vcc, s63, v249
 s_cbranch_vccnz L_tr_2
L_back_2:
 v_mfma_f32_16x16x32_bf16 a[84:87], v[228:231], v[196:199], a[84:87]
 v_exp_f32 v128, v128
 v_mfma_f32_16x16x32_bf16 a[88:91], v[228:231], v[200:203], a[88:91]
 buffer_load_dwordx4 v243, s[24:27], s53 offen offset:128 nt lds
 v_mfma_f32_16x16x32_bf16 a[92:95], v[228:231], v[204:207], a[92:95]
 ds_read_b64_tr_b16 v[228:229], v242 offset:2048
 ds_read_b64_tr_b16 v[230:231], v242 offset:10240
 v_mfma_f32_16x16x32_bf16 a[96:99], v[232:235], v[192:195], a[96:99]
 v_exp_f32 v129, v129
 v_mfma_f32_16x16x32_bf16 a[100:103], v[232:235], v[196:199], a[100:103]
 s_add_u32 m0, s69, 67328
 v_mfma_f32_16x16x32_bf16 a[104:107], v[232:235], v[200:203], a[104:107]
 s_waitcnt lgkmcnt(2)
 v_exp_f32 v130, v130
 v_mfma_f32_16x16x32_bf16 a[108:111], v[232:235], v[204:207], a[108:111]
 ds_read_b64_tr_b16 v[232:233], v241 offset:2560
 ds_read_b64_tr_b16 v[234:235], v241 offset:10752
 v_mfma_f32_16x16x32_bf16 a[112:115], v[236:239], v[192:195], a[112:115]
 v_exp_f32 v131, v131
 buffer_load_dwordx4 v243, s[24:27], s54 offen offset:256 nt lds
 v_mfma_f32_16x16x32_bf16 a[116:119], v[236:239], v[196:199], a[116:119]
 v_exp_f32 v144, v144
 v_mfma_f32_16x16x32_bf16 a[120:123], v[236:239], v[200:203], a[120:123]
 s_add_u32 m0, s69, 75520
 v_mfma_f32_16x16x32_bf16 a[124:127], v[236:239], v[204:207], a[124:127]
 ds_read_b64_tr_b16 v[236:237], v242 offset:2560
 ds_read_b64_tr_b16 v[238:239], v242 offset:10752
 v_mfma_f32_16x16x32_bf16 a[128:131], v[224:227], v[192:195], a[128:131]
 v_exp_f32 v145, v145
 v_mfma_f32_16x16x32_bf16 a[132:135], v[224:227], v[196:199], a[132:135]
 buffer_load_dwordx4 v243, s[24:27], s53 offen offset:256 nt lds
 v_mfma_f32_16x16x32_bf16 a[136:139], v[224:227], v[200:203], a[136:139]
 s_waitcnt lgkmcnt(2)
 v_exp_f32 v146, v146
 v_mfma_f32_16x16x32_bf16 a[140:143], v[224:227], v[204:207], a[140:143]
 ds_read_b64_tr_b16 v[224:225], v241 offset:3072
 ds_read_b64_tr_b16 v[226:227], v241 offset:11264
 v_mfma_f32_16x16x32_bf16 a[144:147], v[228:231], v[192:195], a[144:147]
 v_exp_f32 v147, v147
 s_add_u32 m0, s69, 68224
 v_mfma_f32_16x16x32_bf16 a[148:151], v[228:231], v[196:199], a[148:151]
 v_exp_f32 v132, v132
 v_mfma_f32_16x16x32_bf16 a[152:155], v[228:231], v[200:203], a[152:155]
 buffer_load_dwordx4 v243, s[24:27], s54 offen offset:384 nt lds
 v_mfma_f32_16x16x32_bf16 a[156:159], v[228:231], v[204:207], a[156:159]
 ds_read_b64_tr_b16 v[228:229], v242 offset:3072
 ds_read_b64_tr_b16 v[230:231], v242 offset:11264
 v_mfma_f32_16x16x32_bf16 a[160:163], v[232:235], v[192:195], a[160:163]
 v_exp_f32 v133, v133
 v_mfma_f32_16x16x32_bf16 a[164:167], v[232:235], v[196:199], a[164:167]
 s_add_u32 m0, s69, 76416
 v_mfma_f32_16x16x32_bf16 a[168:171], v[232:235], v[200:203], a[168:171]
 s_waitcnt lgkmcnt(2)
 v_exp_f32 v134, v134
 v_mfma_f32_16x16x32_bf16 a[172:175], v[232:235], v[204:207], a[172:175]
 ds_read_b64_tr_b16 v[232:233], v241 offset:3584
 ds_read_b64_tr_b16 v[234:235], v241 offset:11776
 v_mfma_f32_16x16x32_bf16 a[176:179], v[236:239], v[192:195], a[176:179]
 v_exp_f32 v135, v135
 v_mfma_f32_16x16x32_bf16 a[180:183], v[236:239], v[196:199], a[180:183]
 buffer_load_dwordx4 v243, s[24:27], s53 offen offset:384 nt lds
 v_mfma_f32_16x16x32_bf16 a[184:187], v[236:239], v[200:203], a[184:187]
 v_exp_f32 v148, v148
 v_mfma_f32_16x16x32_bf16 a[188:191], v[236:239], v[204:207], a[188:191]
 ds_read_b64_tr_b16 v[236:237], v242 offset:3584
 ds_read_b64_tr_b16 v[238:239], v242 offset:11776
 s_add_u32 s54, s54, 16384
 v_mfma_f32_16x16x32_bf16 a[192:195], v[224:227], v[192:195], a[192:195]
 v_exp_f32 v149, v149
 v_mfma_f32_16x16x32_bf16 a[196:199], v[224:227], v[196:199], a[196:199]
 v_exp_f32 v150, v150
 v_mfma_f32_16x16x32_bf16 a[200:203], v[224:227], v[200:203], a[200:203]
 s_add_u32 s53, s53, 16384
 s_waitcnt lgkmcnt(2)
 v_subrev_u32 v241, 65536, v241
 v_mfma_f32_16x16x32_bf16 a[204:207], v[224:227], v[204:207], a[204:207]
 v_exp_f32 v151, v151
 v_mfma_f32_16x16x32_bf16 a[208:211], v[228:231], v[192:195], a[208:211]
 v_exp_f32 v136, v136
 v_mfma_f32_16x16x32_bf16 a[212:215], v[228:231], v[196:199], a[212:215]
 v_mfma_f32_16x16x32_bf16 a[216:219], v[228:231], v[200:203], a[216:219]
 s_waitcnt lgkmcnt(0)
 s_waitcnt vmcnt(16)
 s_barrier
 v_mfma_f32_16x16x32_bf16 a[220:223], v[228:231], v[204:207], a[220:223]
 ds_read_b128 v[224:227], v240 offset:0
 ds_read_b128 v[228:231], v240 offset:8192
 v_mfma_f32_16x16x32_bf16 a[224:227], v[232:235], v[192:195], a[224:227]
 v_exp_f32 v137, v137
 v_mfma_f32_16x16x32_bf16 a[228:231], v[232:235], v[196:199], a[228:231]
 v_subrev_u32 v242, 65536, v242
 v_mfma_f32_16x16x32_bf16 a[232:235], v[232:235], v[200:203], a[232:235]
 v_exp_f32 v138, v138
 v_mfma_f32_16x16x32_bf16 a[236:239], v[232:235], v[204:207], a[236:239]
 ds_read_b128 v[232:235], v240 offset:512
 v_mfma_f32_16x16x32_bf16 a[240:243], v[236:239], v[192:195], a[240:243]
 v_exp_f32 v139, v139
 v_mfma_f32_16x16x32_bf16 a[244:247], v[236:239], v[196:199], a[244:247]
 v_exp_f32 v152, v152
 v_mfma_f32_16x16x32_bf16 a[248:251], v[236:239], v[200:203], a[248:251]
 v_exp_f32 v153, v153
 v_mfma_f32_16x16x32_bf16 a[252:255], v[236:239], v[204:207], a[252:255]
 ds_read_b128 v[236:239], v240 offset:8704
 s_waitcnt lgkmcnt(3)
 v_mfma_f32_16x16x32_bf16 v[160:163], v[224:227], v[0:3], v[208:211]
 v_add_f32 v244, v244, v128
 v_cvt_pk_bf16_f32 v192, v128, v129
 v_mfma_f32_16x16x32_bf16 v[164:167], v[224:227], v[4:7], v[212:215]
 s_add_u32 m0, s69, 98304
 v_mfma_f32_16x16x32_bf16 v[168:171], v[224:227], v[8:11], v[216:219]
 s_waitcnt lgkmcnt(2)
 v_mfma_f32_16x16x32_bf16 v[172:175], v[224:227], v[12:15], v[220:223]
 ds_read_b128 v[224:227], v240 offset:1024
 v_mfma_f32_16x16x32_bf16 v[176:179], v[228:231], v[0:3], v[208:211]
 v_exp_f32 v154, v154
 v_mfma_f32_16x16x32_bf16 v[180:183], v[228:231], v[4:7], v[212:215]
 v_add_f32 v244, v244, v129
 buffer_load_dwordx4 v248, s[28:31], s55 offen offset:0 nt lds
 v_mfma_f32_16x16x32_bf16 v[184:187], v[228:231], v[8:11], v[216:219]
 s_waitcnt lgkmcnt(2)
 v_cvt_pk_bf16_f32 v193, v130, v131
 v_mfma_f32_16x16x32_bf16 v[188:191], v[228:231], v[12:15], v[220:223]
 ds_read_b128 v[228:231], v240 offset:9216
 v_mfma_f32_16x16x32_bf16 v[160:163], v[232:235], v[16:19], v[160:163]
 v_exp_f32 v155, v155
 v_mfma_f32_16x16x32_bf16 v[164:167], v[232:235], v[20:23], v[164:167]
 s_add_u32 m0, s69, 106496
 v_add_f32 v244, v244, v130
 v_mfma_f32_16x16x32_bf16 v[168:171], v[232:235], v[24:27], v[168:171]
 s_waitcnt lgkmcnt(1)
 v_add_f32 v244, v244, v131
 v_mfma_f32_16x16x32_bf16 v[172:175], v[232:235], v[28:31], v[172:175]
 ds_read_b128 v[232:235], v240 offset:1536
 v_exp_f32 v140, v140
 v_mfma_f32_16x16x32_bf16 v[176:179], v[236:239], v[16:19], v[176:179]
 buffer_load_dwordx4 v248, s[28:31], s58 offen offset:0 nt lds
 v_add_f32 v244, v244, v144
 v_mfma_f32_16x16x32_bf16 v[180:183], v[236:239], v[20:23], v[180:183]
 v_cvt_pk_bf16_f32 v194, v144, v145
 s_add_u32 m0, s69, 99200
 v_mfma_f32_16x16x32_bf16 v[184:187], v[236:239], v[24:27], v[184:187]
 v_exp_f32 v141, v141
 v_mfma_f32_16x16x32_bf16 v[188:191], v[236:239], v[28:31], v[188:191]
 ds_read_b128 v[236:239], v240 offset:9728
 v_add_f32 v244, v244, v145
 v_mfma_f32_16x16x32_bf16 v[160:163], v[224:227], v[32:35], v[160:163]
 buffer_load_dwordx4 v248, s[28:31], s55 offen offset:128 nt lds
 v_cvt_pk_bf16_f32 v195, v146, v147
 v_mfma_f32_16x16x32_bf16 v[164:167], v[224:227], v[36:39], v[164:167]
 v_exp_f32 v142, v142
 v_mfma_f32_16x16x32_bf16 v[168:171], v[224:227], v[40:43], v[168:171]
 s_waitcnt lgkmcnt(1)
 s_add_u32 m0, s69, 107392
 v_mfma_f32_16x16x32_bf16 v[172:175], v[224:227], v[44:47], v[172:175]
 ds_read_b128 v[224:227], v240 offset:2048
 v_add_f32 v244, v244, v146
 v_mfma_f32_16x16x32_bf16 v[176:179], v[228:231], v[32:35], v[176:179]
 v_add_f32 v244, v244, v147
 v_mfma_f32_16x16x32_bf16 v[180:183], v[228:231], v[36:39], v[180:183]
 v_exp_f32 v143, v143
 v_mfma_f32_16x16x32_bf16 v[184:187], v[228:231], v[40:43], v[184:187]
 buffer_load_dwordx4 v248, s[28:31], s58 offen offset:128 nt lds
 v_add_f32 v245, v245, v132
 v_mfma_f32_16x16x32_bf16 v[188:191], v[228:231], v[44:47], v[188:191]
 ds_read_b128 v[228:231], v240 offset:10240
 v_cvt_pk_bf16_f32 v196, v132, v133
 v_mfma_f32_16x16x32_bf16 v[160:163], v[232:235], v[48:51], v[160:163]
 s_add_u32 m0, s69, 100096
 v_mfma_f32_16x16x32_bf16 v[164:167], v[232:235], v[52:55], v[164:167]
 v_exp_f32 v156, v156
 v_mfma_f32_16x16x32_bf16 v[168:171], v[232:235], v[56:59], v[168:171]
 s_waitcnt lgkmcnt(1)
 v_add_f32 v245, v245, v133
 v_mfma_f32_16x16x32_bf16 v[172:175], v[232:235], v[60:63], v[172:175]
 ds_read_b128 v[232:235], v240 offset:2560
 buffer_load_dwordx4 v248, s[28:31], s55 offen offset:256 nt lds
 v_mfma_f32_16x16x32_bf16 v[176:179], v[236:239], v[48:51], v[176:179]
 v_cvt_pk_bf16_f32 v197, v134, v135
 v_mfma_f32_16x16x32_bf16 v[180:183], v[236:239], v[52:55], v[180:183]
 v_exp_f32 v157, v157
 v_mfma_f32_16x16x32_bf16 v[184:187], v[236:239], v[56:59], v[184:187]
 s_add_u32 m0, s69, 108288
 v_add_f32 v245, v245, v134
 v_mfma_f32_16x16x32_bf16 v[188:191], v[236:239], v[60:63], v[188:191]
 ds_read_b128 v[236:239], v240 offset:10752
 v_add_f32 v245, v245, v135
 v_mfma_f32_16x16x32_bf16 v[160:163], v[224:227], v[64:67], v[160:163]
 v_exp_f32 v158, v158
 v_mfma_f32_16x16x32_bf16 v[164:167], v[224:227], v[68:71], v[164:167]
 buffer_load_dwordx4 v248, s[28:31], s58 offen offset:256 nt lds
 v_add_f32 v245, v245, v148
 v_mfma_f32_16x16x32_bf16 v[168:171], v[224:227], v[72:75], v[168:171]
 s_waitcnt lgkmcnt(1)
 v_cvt_pk_bf16_f32 v198, v148, v149
 v_mfma_f32_16x16x32_bf16 v[172:175], v[224:227], v[76:79], v[172:175]
 ds_read_b128 v[224:227], v240 offset:3072
 s_add_u32 m0, s69, 100992
 v_mfma_f32_16x16x32_bf16 v[176:179], v[228:231], v[64:67], v[176:179]
 v_exp_f32 v159, v159
 v_mfma_f32_16x16x32_bf16 v[180:183], v[228:231], v[68:71], v[180:183]
 v_add_f32 v245, v245, v149
 buffer_load_dwordx4 v248, s[28:31], s55 offen offset:384 nt lds
 v_mfma_f32_16x16x32_bf16 v[184:187], v[228:231], v[72:75], v[184:187]
 v_cvt_pk_bf16_f32 v199, v150, v151
 v_add_f32 v245, v245, v150
 v_mfma_f32_16x16x32_bf16 v[188:191], v[228:231], v[76:79], v[188:191]
 ds_read_b128 v[228:231], v240 offset:11264
 v_add_f32 v245, v245, v151
 v_mfma_f32_16x16x32_bf16 v[160:163], v[232:235], v[80:83], v[160:163]
 s_add_u32 m0, s69, 109184
 v_add_f32 v246, v246, v136
 v_mfma_f32_16x16x32_bf16 v[164:167], v[232:235], v[84:87], v[164:167]
 v_cvt_pk_bf16_f32 v200, v136, v137
 v_mfma_f32_16x16x32_bf16 v[168:171], v[232:235], v[88:91], v[168:171]
 s_waitcnt lgkmcnt(1)
 v_add_f32 v246, v246, v137
 v_mfma_f32_16x16x32_bf16 v[172:175], v[232:235], v[92:95], v[172:175]
 ds_read_b128 v[232:235], v240 offset:3584
 buffer_load_dwordx4 v248, s[28:31], s58 offen offset:384 nt lds
 v_mfma_f32_16x16x32_bf16 v[176:179], v[236:239], v[80:83], v[176:179]
 v_cvt_pk_bf16_f32 v201, v138, v139
 v_add_f32 v246, v246, v138
 v_mfma_f32_16x16x32_bf16 v[180:183], v[236:239], v[84:87], v[180:183]
 v_add_f32 v246, v246, v139
 s_add_u32 s55, s55, 16384
 v_mfma_f32_16x16x32_bf16 v[184:187], v[236:239], v[88:91], v[184:187]
 v_add_f32 v246, v246, v152
 v_mfma_f32_16x16x32_bf16 v[188:191], v[236:239], v[92:95], v[188:191]
 ds_read_b128 v[236:239], v240 offset:11776
 v_cvt_pk_bf16_f32 v202, v152, v153
 v_mfma_f32_16x16x32_bf16 v[160:163], v[224:227], v[96:99], v[160:163]
 v_add_u32 v240, 65536, v240
 v_add_f32 v246, v246, v153
 v_mfma_f32_16x16x32_bf16 v[164:167], v[224:227], v[100:103], v[164:167]
 s_add_u32 s58, s58, 16384
 v_cvt_pk_bf16_f32 v203, v154, v155
 v_mfma_f32_16x16x32_bf16 v[168:171], v[224:227], v[104:107], v[168:171]
 s_waitcnt lgkmcnt(1)
 v_add_f32 v246, v246, v154
 v_mfma_f32_16x16x32_bf16 v[172:175], v[224:227], v[108:111], v[172:175]
 v_add_f32 v246, v246, v155
 v_add_f32 v247, v247, v140
 v_mfma_f32_16x16x32_bf16 v[176:179], v[228:231], v[96:99], v[176:179]
 v_cvt_pk_bf16_f32 v204, v140, v141
 v_mfma_f32_16x16x32_bf16 v[180:183], v[228:231], v[100:103], v[180:183]
 v_add_f32 v247, v247, v141
 v_mfma_f32_16x16x32_bf16 v[184:187], v[228:231], v[104:107], v[184:187]
 s_waitcnt lgkmcnt(0)
 s_waitcnt vmcnt(16)
 s_barrier
 v_mfma_f32_16x16x32_bf16 v[188:191], v[228:231], v[108:111], v[188:191]
 ds_read_b64_tr_b16 v[224:225], v241 offset:0
 ds_read_b64_tr_b16 v[226:227], v241 offset:8192
 ds_read_b64_tr_b16 v[228:229], v242 offset:0
 ds_read_b64_tr_b16 v[230:231], v242 offset:8192
 v_mfma_f32_16x16x32_bf16 v[160:163], v[232:235], v[112:115], v[160:163]
 v_cvt_pk_bf16_f32 v205, v142, v143
 v_add_f32 v247, v247, v142
 v_mfma_f32_16x16x32_bf16 v[164:167], v[232:235], v[116:119], v[164:167]
 v_add_f32 v247, v247, v143
 v_add_f32 v247, v247, v156
 v_mfma_f32_16x16x32_bf16 v[168:171], v[232:235], v[120:123], v[168:171]
 v_cvt_pk_bf16_f32 v206, v156, v157
 v_mfma_f32_16x16x32_bf16 v[172:175], v[232:235], v[124:127], v[172:175]
 ds_read_b64_tr_b16 v[232:233], v241 offset:512
 ds_read_b64_tr_b16 v[234:235], v241 offset:8704
 v_mfma_f32_16x16x32_bf16 v[176:179], v[236:239], v[112:115], v[176:179]
 v_add_f32 v247, v247, v157
 v_cvt_pk_bf16_f32 v207, v158, v159
 v_mfma_f32_16x16x32_bf16 v[180:183], v[236:239], v[116:119], v[180:183]
 v_add_f32 v247, v247, v158
 v_mfma_f32_16x16x32_bf16 v[184:187], v[236:239], v[120:123], v[184:187]
 v_add_f32 v247, v247, v159
 v_mfma_f32_16x16x32_bf16 v[188:191], v[236:239], v[124:127], v[188:191]
 ds_read_b64_tr_b16 v[236:237], v242 offset:512
 ds_read_b64_tr_b16 v[238:239], v242 offset:8704
 s_waitcnt lgkmcnt(6)
 v_mfma_f32_16x16x32_bf16 a[0:3], v[224:227], v[192:195], a[0:3]
 v_mfma_f32_16x16x32_bf16 a[4:7], v[224:227], v[196:199], a[4:7]
 s_add_u32 m0, s69, 0
 v_mfma_f32_16x16x32_bf16 a[8:11], v[224:227], v[200:203], a[8:11]
 s_waitcnt lgkmcnt(4)
 v_max3_f32 v249, v160, v161, v162
 v_mfma_f32_16x16x32_bf16 a[12:15], v[224:227], v[204:207], a[12:15]
 ds_read_b64_tr_b16 v[224:225], v241 offset:1024
 ds_read_b64_tr_b16 v[226:227], v241 offset:9216
 v_mfma_f32_16x16x32_bf16 a[16:19], v[228:231], v[192:195], a[16:19]
 v_max3_f32 v250, v163, v164, v165
 buffer_load_dwordx4 v243, s[24:27], s54 offen offset:0 nt lds
 v_mfma_f32_16x16x32_bf16 a[20:23], v[228:231], v[196:199], a[20:23]
 v_max3_f32 v249, v249, v166, v167
 v_max3_f32 v250, v250, v168, v169
 v_mfma_f32_16x16x32_bf16 a[24:27], v[228:231], v[200:203], a[24:27]
 s_waitcnt lgkmcnt(4)
 v_max3_f32 v249, v249, v170, v171
 v_mfma_f32_16x16x32_bf16 a[28:31], v[228:231], v[204:207], a[28:31]
 ds_read_b64_tr_b16 v[228:229], v242 offset:1024
 ds_read_b64_tr_b16 v[230:231], v242 offset:9216
 v_mfma_f32_16x16x32_bf16 a[32:35], v[232:235], v[192:195], a[32:35]
 s_add_u32 m0, s69, 8192
 v_max3_f32 v250, v250, v172, v173
 v_mfma_f32_16x16x32_bf16 a[36:39], v[232:235], v[196:199], a[36:39]
 v_max3_f32 v249, v249, v174, v175
 v_max3_f32 v250, v250, v176, v177
 v_mfma_f32_16x16x32_bf16 a[40:43], v[232:235], v[200:203], a[40:43]
 s_waitcnt lgkmcnt(2)
 buffer_load_dwordx4 v243, s[24:27], s53 offen offset:0 nt lds
 v_mfma_f32_16x16x32_bf16 a[44:47], v[232:235], v[204:207], a[44:47]
 ds_read_b64_tr_b16 v[232:233], v241 offset:1536
 ds_read_b64_tr_b16 v[234:235], v241 offset:9728
 v_mfma_f32_16x16x32_bf16 a[48:51], v[236:239], v[192:195], a[48:51]
 v_max3_f32 v249, v249, v178, v179
 v_max3_f32 v250, v250, v180, v181
 v_mfma_f32_16x16x32_bf16 a[52:55], v[236:239], v[196:199], a[52:55]
 v_max3_f32 v249, v249, v182, v183
 s_add_u32 m0, s69, 896
 v_mfma_f32_16x16x32_bf16 a[56:59], v[236:239], v[200:203], a[56:59]
 v_max3_f32 v250, v250, v184, v185
 v_max3_f32 v249, v249, v186, v187
 v_mfma_f32_16x16x32_bf16 a[60:63], v[236:239], v[204:207], a[60:63]
 ds_read_b64_tr_b16 v[236:237], v242 offset:1536
 ds_read_b64_tr_b16 v[238:239], v242 offset:9728
 v_mfma_f32_16x16x32_bf16 a[64:67], v[224:227], v[192:195], a[64:67]
 buffer_load_dwordx4 v243, s[24:27], s54 offen offset:128 nt lds
 v_max3_f32 v250, v250, v188, v189
 v_mfma_f32_16x16x32_bf16 a[68:71], v[224:227], v[196:199], a[68:71]
 v_max3_f32 v249, v249, v190, v191
 v_max_f32 v249, v249, v250
 v_mfma_f32_16x16x32_bf16 a[72:75], v[224:227], v[200:203], a[72:75]
 s_waitcnt lgkmcnt(2)
 s_add_u32 m0, s69, 9088
 v_mfma_f32_16x16x32_bf16 a[76:79], v[224:227], v[204:207], a[76:79]
 ds_read_b64_tr_b16 v[224:225], v241 offset:2048
 ds_read_b64_tr_b16 v[226:227], v241 offset:10240
 v_mfma_f32_16x16x32_bf16 a[80:83], v[228:231], v[192:195], a[80:83]
 v_cmp_lt_f32 vcc, s63, v249
 s_cbranch_vccnz L_tr_3
L_back_3:
 v_mfma_f32_16x16x32_bf16 a[84:87], v[228:231], v[196:199], a[84:87]
 v_exp_f32 v160, v160
 v_mfma_f32_16x16x32_bf16 a[88:91], v[228:231], v[200:203], a[88:91]
 buffer_load_dwordx4 v243, s[24:27], s53 offen offset:128 nt lds
 v_mfma_f32_16x16x32_bf16 a[92:95], v[228:231], v[204:207], a[92:95]
 ds_read_b64_tr_b16 v[228:229], v242 offset:2048
 ds_read_b64_tr_b16 v[230:231], v242 offset:10240
 v_mfma_f32_16x16x32_bf16 a[96:99], v[232:235], v[192:195], a[96:99]
 v_exp_f32 v161, v161
 v_mfma_f32_16x16x32_bf16 a[100:103], v[232:235], v[196:199], a[100:103]
 s_add_u32 m0, s69, 1792
 v_mfma_f32_16x16x32_bf16 a[104:107], v[232:235], v[200:203], a[104:107]
 s_waitcnt lgkmcnt(2)
 v_exp_f32 v162, v162
 v_mfma_f32_16x16x32_bf16 a[108:111], v[232:235], v[204:207], a[108:111]
 ds_read_b64_tr_b16 v[232:233], v241 offset:2560
 ds_read_b64_tr_b16 v[234:235], v241 offset:10752
 v_mfma_f32_16x16x32_bf16 a[112:115], v[236:239], v[192:195], a[112:115]
 v_exp_f32 v163, v163
 buffer_load_dwordx4 v243, s[24:27], s54 offen offset:256 nt lds
 v_mfma_f32_16x16x32_bf16 a[116:119], v[236:239], v[196:199], a[116:119]
 v_exp_f32 v176, v176
 v_mfma_f32_16x16x32_bf16 a[120:123], v[236:239], v[200:203], a[120:123]
 s_add_u32 m0, s69, 9984
 v_mfma_f32_16x16x32_bf16 a[124:127], v[236:239], v[204:207], a[124:127]
 ds_read_b64_tr_b16 v[236:237], v242 offset:2560
 ds_read_b64_tr_b16 v[238:239], v242 offset:10752
 v_mfma_f32_16x16x32_bf16 a[128:131], v[224:227], v[192:195], a[128:131]
 v_exp_f32 v177, v177
 v_mfma_f32_16x16x32_bf16 a[132:135], v[224:227], v[196:199], a[132:135]
 buffer_load_dwordx4 v243, s[24:27], s53 offen offset:256 nt lds
 v_mfma_f32_16x16x32_bf16 a[136:139], v[224:227], v[200:203], a[136:139]
 s_waitcnt lgkmcnt(2)
 v_exp_f32 v178, v178
 v_mfma_f32_16x16x32_bf16 a[140:143], v[224:227], v[204:207], a[140:143]
 ds_read_b64_tr_b16 v[224:225], v241 offset:3072
 ds_read_b64_tr_b16 v[226:227], v241 offset:11264
 v_mfma_f32_16x16x32_bf16 a[144:147], v[228:231], v[192:195], a[144:147]
 v_exp_f32 v179, v179
 s_add_u32 m0, s69, 2688
 v_mfma_f32_16x16x32_bf16 a[148:151], v[228:231], v[196:199], a[148:151]
 v_exp_f32 v164, v164
 v_mfma_f32_16x16x32_bf16 a[152:155], v[228:231], v[200:203], a[152:155]
 buffer_load_dwordx4 v243, s[24:27], s54 offen offset:384 nt lds
 v_mfma_f32_16x16x32_bf16 a[156:159], v[228:231], v[204:207], a[156:159]
 ds_read_b64_tr_b16 v[228:229], v242 offset:3072
 ds_read_b64_tr_b16 v[230:231], v242 offset:11264
 v_mfma_f32_16x16x32_bf16 a[160:163], v[232:235], v[192:195], a[160:163]
 v_exp_f32 v165, v165
 v_mfma_f32_16x16x32_bf16 a[164:167], v[232:235], v[196:199], a[164:167]
 s_add_u32 m0, s69, 10880
 v_mfma_f32_16x16x32_bf16 a[168:171], v[232:235], v[200:203], a[168:171]
 s_waitcnt lgkmcnt(2)
 v_exp_f32 v166, v166
 v_mfma_f32_16x16x32_bf16 a[172:175], v[232:235], v[204:207], a[172:175]
 ds_read_b64_tr_b16 v[232:233], v241 offset:3584
 ds_read_b64_tr_b16 v[234:235], v241 offset:11776
 v_mfma_f32_16x16x32_bf16 a[176:179], v[236:239], v[192:195], a[176:179]
 v_exp_f32 v167, v167
 v_mfma_f32_16x16x32_bf16 a[180:183], v[236:239], v[196:199], a[180:183]
 buffer_load_dwordx4 v243, s[24:27], s53 offen offset:384 nt lds
 v_mfma_f32_16x16x32_bf16 a[184:187], v[236:239], v[200:203], a[184:187]
 v_exp_f32 v180, v180
 v_mfma_f32_16x16x32_bf16 a[188:191], v[236:239], v[204:207], a[188:191]
 ds_read_b64_tr_b16 v[236:237], v242 offset:3584
 ds_read_b64_tr_b16 v[238:239], v242 offset:11776
 s_add_u32 s54, s54, 16384
 v_mfma_f32_16x16x32_bf16 a[192:195], v[224:227], v[192:195], a[192:195]
 v_exp_f32 v181, v181
 v_mfma_f32_16x16x32_bf16 a[196:199], v[224:227], v[196:199], a[196:199]
 v_exp_f32 v182, v182
 v_mfma_f32_16x16x32_bf16 a[200:203], v[224:227], v[200:203], a[200:203]
 s_add_u32 s53, s53, 16384
 s_waitcnt lgkmcnt(2)
 v_add_u32 v241, 65536, v241
 v_mfma_f32_16x16x32_bf16 a[204:207], v[224:227], v[204:207], a[204:207]
 v_exp_f32 v183, v183
 v_mfma_f32_16x16x32_bf16 a[208:211], v[228:231], v[192:195], a[208:211]
 v_exp_f32 v168, v168
 v_mfma_f32_16x16x32_bf16 a[212:215], v[228:231], v[196:199], a[212:215]
 v_mfma_f32_16x16x32_bf16 a[216:219], v[228:231], v[200:203], a[216:219]
 s_waitcnt lgkmcnt(0)
 s_waitcnt vmcnt(16)
 s_barrier
 v_mfma_f32_16x16x32_bf16 a[220:223], v[228:231], v[204:207], a[220:223]
 ds_read_b128 v[224:227], v240 offset:0
 ds_read_b128 v[228:231], v240 offset:8192
 v_mfma_f32_16x16x32_bf16 a[224:227], v[232:235], v[192:195], a[224:227]
 v_exp_f32 v169, v169
 v_mfma_f32_16x16x32_bf16 a[228:231], v[232:235], v[196:199], a[228:231]
 v_add_u32 v242, 65536, v242
 v_mfma_f32_16x16x32_bf16 a[232:235], v[232:235], v[200:203], a[232:235]
 v_exp_f32 v170, v170
 v_mfma_f32_16x16x32_bf16 a[236:239], v[232:235], v[204:207], a[236:239]
 ds_read_b128 v[232:235], v240 offset:512
 v_mfma_f32_16x16x32_bf16 a[240:243], v[236:239], v[192:195], a[240:243]
 v_exp_f32 v171, v171
 v_mfma_f32_16x16x32_bf16 a[244:247], v[236:239], v[196:199], a[244:247]
 v_exp_f32 v184, v184
 v_mfma_f32_16x16x32_bf16 a[248:251], v[236:239], v[200:203], a[248:251]
 v_exp_f32 v185, v185
 v_mfma_f32_16x16x32_bf16 a[252:255], v[236:239], v[204:207], a[252:255]
 ds_read_b128 v[236:239], v240 offset:8704
 s_sub_u32 s61, s61, 1
 s_cmp_lg_u32 s61, 0
 s_cbranch_scc1 L_loop
 s_waitcnt lgkmcnt(3)
 v_mfma_f32_16x16x32_bf16 v[128:131], v[224:227], v[0:3], v[208:211]
 v_add_f32 v244, v244, v160
 v_cvt_pk_bf16_f32 v192, v160, v161
 v_mfma_f32_16x16x32_bf16 v[132:135], v[224:227], v[4:7], v[212:215]
 s_add_u32 m0, s69, 32768
 v_mfma_f32_16x16x32_bf16 v[136:139], v[224:227], v[8:11], v[216:219]
 s_waitcnt lgkmcnt(2)
 v_mfma_f32_16x16x32_bf16 v[140:143], v[224:227], v[12:15], v[220:223]
 ds_read_b128 v[224:227], v240 offset:1024
 v_mfma_f32_16x16x32_bf16 v[144:147], v[228:231], v[0:3], v[208:211]
 v_exp_f32 v186, v186
 v_mfma_f32_16x16x32_bf16 v[148:151], v[228:231], v[4:7], v[212:215]
 v_add_f32 v244, v244, v161
 buffer_load_dwordx4 v248, s[28:31], s55 offen offset:0 nt lds
 v_mfma_f32_16x16x32_bf16 v[152:155], v[228:231], v[8:11], v[216:219]
 s_waitcnt lgkmcnt(2)
 v_cvt_pk_bf16_f32 v193, v162, v163
 v_mfma_f32_16x16x32_bf16 v[156:159], v[228:231], v[12:15], v[220:223]
 ds_read_b128 v[228:231], v240 offset:9216
 v_mfma_f32_16x16x32_bf16 v[128:131], v[232:235], v[16:19], v[128:131]
 v_exp_f32 v187, v187
 v_mfma_f32_16x16x32_bf16 v[132:135], v[232:235], v[20:23], v[132:135]
 s_add_u32 m0, s69, 40960
 v_add_f32 v244, v244, v162
 v_mfma_f32_16x16x32_bf16 v[136:139], v[232:235], v[24:27], v[136:139]
 s_waitcnt lgkmcnt(1)
 v_add_f32 v244, v244, v163
 v_mfma_f32_16x16x32_bf16 v[140:143], v[232:235], v[28:31], v[140:143]
 ds_read_b128 v[232:235], v240 offset:1536
 v_exp_f32 v172, v172
 v_mfma_f32_16x16x32_bf16 v[144:147], v[236:239], v[16:19], v[144:147]
 buffer_load_dwordx4 v248, s[28:31], s58 offen offset:0 nt lds
 v_add_f32 v244, v244, v176
 v_mfma_f32_16x16x32_bf16 v[148:151], v[236:239], v[20:23], v[148:151]
 v_cvt_pk_bf16_f32 v194, v176, v177
 s_add_u32 m0, s69, 33664
 v_mfma_f32_16x16x32_bf16 v[152:155], v[236:239], v[24:27], v[152:155]
 v_exp_f32 v173, v173
 v_mfma_f32_16x16x32_bf16 v[156:159], v[236:239], v[28:31], v[156:159]
 ds_read_b128 v[236:239], v240 offset:9728
 v_add_f32 v244, v244, v177
 v_mfma_f32_16x16x32_bf16 v[128:131], v[224:227], v[32:35], v[128:131]
 buffer_load_dwordx4 v248, s[28:31], s55 offen offset:128 nt lds
 v_cvt_pk_bf16_f32 v195, v178, v179
 v_mfma_f32_16x16x32_bf16 v[132:135], v[224:227], v[36:39], v[132:135]
 v_exp_f32 v174, v174
 v_mfma_f32_16x16x32_bf16 v[136:139], v[224:227], v[40:43], v[136:139]
 s_waitcnt lgkmcnt(1)
 s_add_u32 m0, s69, 41856
 v_mfma_f32_16x16x32_bf16 v[140:143], v[224:227], v[44:47], v[140:143]
 ds_read_b128 v[224:227], v240 offset:2048
 v_add_f32 v244, v244, v178
 v_mfma_f32_16x16x32_bf16 v[144:147], v[228:231], v[32:35], v[144:147]
 v_add_f32 v244, v244, v179
 v_mfma_f32_16x16x32_bf16 v[148:151], v[228:231], v[36:39], v[148:151]
 v_exp_f32 v175, v175
 v_mfma_f32_16x16x32_bf16 v[152:155], v[228:231], v[40:43], v[152:155]
 buffer_load_dwordx4 v248, s[28:31], s58 offen offset:128 nt lds
 v_add_f32 v245, v245, v164
 v_mfma_f32_16x16x32_bf16 v[156:159], v[228:231], v[44:47], v[156:159]
 ds_read_b128 v[228:231], v240 offset:10240
 v_cvt_pk_bf16_f32 v196, v164, v165
 v_mfma_f32_16x16x32_bf16 v[128:131], v[232:235], v[48:51], v[128:131]
 s_add_u32 m0, s69, 34560
 v_mfma_f32_16x16x32_bf16 v[132:135], v[232:235], v[52:55], v[132:135]
 v_exp_f32 v188, v188
 v_mfma_f32_16x16x32_bf16 v[136:139], v[232:235], v[56:59], v[136:139]
 s_waitcnt lgkmcnt(1)
 v_add_f32 v245, v245, v165
 v_mfma_f32_16x16x32_bf16 v[140:143], v[232:235], v[60:63], v[140:143]
 ds_read_b128 v[232:235], v240 offset:2560
 buffer_load_dwordx4 v248, s[28:31], s55 offen offset:256 nt lds
 v_mfma_f32_16x16x32_bf16 v[144:147], v[236:239], v[48:51], v[144:147]
 v_cvt_pk_bf16_f32 v197, v166, v167
 v_mfma_f32_16x16x32_bf16 v[148:151], v[236:239], v[52:55], v[148:151]
 v_exp_f32 v189, v189
 v_mfma_f32_16x16x32_bf16 v[152:155], v[236:239], v[56:59], v[152:155]
 s_add_u32 m0, s69, 42752
 v_add_f32 v245, v245, v166
 v_mfma_f32_16x16x32_bf16 v[156:159], v[236:239], v[60:63], v[156:159]
 ds_read_b128 v[236:239], v240 offset:10752
 v_add_f32 v245, v245, v167
 v_mfma_f32_16x16x32_bf16 v[128:131], v[224:227], v[64:67], v[128:131]
 v_exp_f32 v190, v190
 v_mfma_f32_16x16x32_bf16 v[132:135], v[224:227], v[68:71], v[132:135]
 buffer_load_dwordx4 v248, s[28:31], s58 offen offset:256 nt lds
 v_add_f32 v245, v245, v180
 v_mfma_f32_16x16x32_bf16 v[136:139], v[224:227], v[72:75], v[136:139]
 s_waitcnt lgkmcnt(1)
 v_cvt_pk_bf16_f32 v198, v180, v181
 v_mfma_f32_16x16x32_bf16 v[140:143], v[224:227], v[76:79], v[140:143]
 ds_read_b128 v[224:227], v240 offset:3072
 s_add_u32 m0, s69, 35456
 v_mfma_f32_16x16x32_bf16 v[144:147], v[228:231], v[64:67], v[144:147]
 v_exp_f32 v191, v191
 v_mfma_f32_16x16x32_bf16 v[148:151], v[228:231], v[68:71], v[148:151]
 v_add_f32 v245, v245, v181
 buffer_load_dwordx4 v248, s[28:31], s55 offen offset:384 nt lds
 v_mfma_f32_16x16x32_bf16 v[152:155], v[228:231], v[72:75], v[152:155]
 v_cvt_pk_bf16_f32 v199, v182, v183
 v_add_f32 v245, v245, v182
 v_mfma_f32_16x16x32_bf16 v[156:159], v[228:231], v[76:79], v[156:159]
 ds_read_b128 v[228:231], v240 offset:11264
 v_add_f32 v245, v245, v183
 v_mfma_f32_16x16x32_bf16 v[128:131], v[232:235], v[80:83], v[128:131]
 s_add_u32 m0, s69, 43648
 v_add_f32 v246, v246, v168
 v_mfma_f32_16x16x32_bf16 v[132:135], v[232:235], v[84:87], v[132:135]
 v_cvt_pk_bf16_f32 v200, v168, v169
 v_mfma_f32_16x16x32_bf16 v[136:139], v[232:235], v[88:91], v[136:139]
 s_waitcnt lgkmcnt(1)
 v_add_f32 v246, v246, v169
 v_mfma_f32_16x16x32_bf16 v[140:143], v[232:235], v[92:95], v[140:143]
 ds_read_b128 v[232:235], v240 offset:3584
 buffer_load_dwordx4 v248, s[28:31], s58 offen offset:384 nt lds
 v_mfma_f32_16x16x32_bf16 v[144:147], v[236:239], v[80:83], v[144:147]
 v_cvt_pk_bf16_f32 v201, v170, v171
 v_add_f32 v246, v246, v170
 v_mfma_f32_16x16x32_bf16 v[148:151], v[236:239], v[84:87], v[148:151]
 v_add_f32 v246, v246, v171
 s_add_u32 s55, s55, 16384
 v_mfma_f32_16x16x32_bf16 v[152:155], v[236:239], v[88:91], v[152:155]
 v_add_f32 v246, v246, v184
 v_mfma_f32_16x16x32_bf16 v[156:159], v[236:239], v[92:95], v[156:159]
 ds_read_b128 v[236:239], v240 offset:11776
 v_cvt_pk_bf16_f32 v202, v184, v185
 v_mfma_f32_16x16x32_bf16 v[128:131], v[224:227], v[96:99], v[128:131]
 v_subrev_u32 v240, 65536, v240
 v_add_f32 v246, v246, v185
 v_mfma_f32_16x16x32_bf16 v[132:135], v[224:227], v[100:103], v[132:135]
 s_add_u32 s58, s58, 16384
 v_cvt_pk_bf16_f32 v203, v186, v187
 v_mfma_f32_16x16x32_bf16 v[136:139], v[224:227], v[104:107], v[136:139]
 s_waitcnt lgkmcnt(1)
 v_add_f32 v246, v246, v186
 v_mfma_f32_16x16x32_bf16 v[140:143], v[224:227], v[108:111], v[140:143]
 v_add_f32 v246, v246, v187
 v_add_f32 v247, v247, v172
 v_mfma_f32_16x16x32_bf16 v[144:147], v[228:231], v[96:99], v[144:147]
 v_cvt_pk_bf16_f32 v204, v172, v173
 v_mfma_f32_16x16x32_bf16 v[148:151], v[228:231], v[100:103], v[148:151]
 v_add_f32 v247, v247, v173
 v_mfma_f32_16x16x32_bf16 v[152:155], v[228:231], v[104:107], v[152:155]
 s_waitcnt lgkmcnt(0)
 s_waitcnt vmcnt(16)
 s_barrier
 v_mfma_f32_16x16x32_bf16 v[156:159], v[228:231], v[108:111], v[156:159]
 ds_read_b64_tr_b16 v[224:225], v241 offset:0
 ds_read_b64_tr_b16 v[226:227], v241 offset:8192
 ds_read_b64_tr_b16 v[228:229], v242 offset:0
 ds_read_b64_tr_b16 v[230:231], v242 offset:8192
 v_mfma_f32_16x16x32_bf16 v[128:131], v[232:235], v[112:115], v[128:131]
 v_cvt_pk_bf16_f32 v205, v174, v175
 v_add_f32 v247, v247, v174
 v_mfma_f32_16x16x32_bf16 v[132:135], v[232:235], v[116:119], v[132:135]
 v_add_f32 v247, v247, v175
 v_add_f32 v247, v247, v188
 v_mfma_f32_16x16x32_bf16 v[136:139], v[232:235], v[120:123], v[136:139]
 v_cvt_pk_bf16_f32 v206, v188, v189
 v_mfma_f32_16x16x32_bf16 v[140:143], v[232:235], v[124:127], v[140:143]
 ds_read_b64_tr_b16 v[232:233], v241 offset:512
 ds_read_b64_tr_b16 v[234:235], v241 offset:8704
 v_mfma_f32_16x16x32_bf16 v[144:147], v[236:239], v[112:115], v[144:147]
 v_add_f32 v247, v247, v189
 v_cvt_pk_bf16_f32 v207, v190, v191
 v_mfma_f32_16x16x32_bf16 v[148:151], v[236:239], v[116:119], v[148:151]
 v_add_f32 v247, v247, v190
 v_mfma_f32_16x16x32_bf16 v[152:155], v[236:239], v[120:123], v[152:155]
 v_add_f32 v247, v247, v191
 v_mfma_f32_16x16x32_bf16 v[156:159], v[236:239], v[124:127], v[156:159]
 ds_read_b64_tr_b16 v[236:237], v242 offset:512
 ds_read_b64_tr_b16 v[238:239], v242 offset:8704
 s_waitcnt lgkmcnt(6)
 v_mfma_f32_16x16x32_bf16 a[0:3], v[224:227], v[192:195], a[0:3]
 v_mfma_f32_16x16x32_bf16 a[4:7], v[224:227], v[196:199], a[4:7]
 s_add_u32 m0, s69, 65536
 v_mfma_f32_16x16x32_bf16 a[8:11], v[224:227], v[200:203], a[8:11]
 s_waitcnt lgkmcnt(4)
 v_max3_f32 v249, v128, v129, v130
 v_mfma_f32_16x16x32_bf16 a[12:15], v[224:227], v[204:207], a[12:15]
 ds_read_b64_tr_b16 v[224:225], v241 offset:1024
 ds_read_b64_tr_b16 v[226:227], v241 offset:9216
 v_mfma_f32_16x16x32_bf16 a[16:19], v[228:231], v[192:195], a[16:19]
 v_max3_f32 v250, v131, v132, v133
 buffer_load_dwordx4 v248, s[28:31], s55 offen offset:0 nt lds
 v_mfma_f32_16x16x32_bf16 a[20:23], v[228:231], v[196:199], a[20:23]
 v_max3_f32 v249, v249, v134, v135
 v_max3_f32 v250, v250, v136, v137
 v_mfma_f32_16x16x32_bf16 a[24:27], v[228:231], v[200:203], a[24:27]
 s_waitcnt lgkmcnt(4)
 v_max3_f32 v249, v249, v138, v139
 v_mfma_f32_16x16x32_bf16 a[28:31], v[228:231], v[204:207], a[28:31]
 ds_read_b64_tr_b16 v[228:229], v242 offset:1024
 ds_read_b64_tr_b16 v[230:231], v242 offset:9216
 v_mfma_f32_16x16x32_bf16 a[32:35], v[232:235], v[192:195], a[32:35]
 s_add_u32 m0, s69, 73728
 v_max3_f32 v250, v250, v140, v141
 v_mfma_f32_16x16x32_bf16 a[36:39], v[232:235], v[196:199], a[36:39]
 v_max3_f32 v249, v249, v142, v143
 v_max3_f32 v250, v250, v144, v145
 v_mfma_f32_16x16x32_bf16 a[40:43], v[232:235], v[200:203], a[40:43]
 s_waitcnt lgkmcnt(2)
 buffer_load_dwordx4 v248, s[28:31], s58 offen offset:0 nt lds
 v_mfma_f32_16x16x32_bf16 a[44:47], v[232:235], v[204:207], a[44:47]
 ds_read_b64_tr_b16 v[232:233], v241 offset:1536
 ds_read_b64_tr_b16 v[234:235], v241 offset:9728
 v_mfma_f32_16x16x32_bf16 a[48:51], v[236:239], v[192:195], a[48:51]
 v_max3_f32 v249, v249, v146, v147
 v_max3_f32 v250, v250, v148, v149
 v_mfma_f32_16x16x32_bf16 a[52:55], v[236:239], v[196:199], a[52:55]
 v_max3_f32 v249, v249, v150, v151
 s_add_u32 m0, s69, 66432
 v_mfma_f32_16x16x32_bf16 a[56:59], v[236:239], v[200:203], a[56:59]
 v_max3_f32 v250, v250, v152, v153
 v_max3_f32 v249, v249, v154, v155
 v_mfma_f32_16x16x32_bf16 a[60:63], v[236:239], v[204:207], a[60:63]
 ds_read_b64_tr_b16 v[236:237], v242 offset:1536
 ds_read_b64_tr_b16 v[238:239], v242 offset:9728
 v_mfma_f32_16x16x32_bf16 a[64:67], v[224:227], v[192:195], a[64:67]
 buffer_load_dwordx4 v248, s[28:31], s55 offen offset:128 nt lds
 v_max3_f32 v250, v250, v156, v157
 v_mfma_f32_16x16x32_bf16 a[68:71], v[224:227], v[196:199], a[68:71]
 v_max3_f32 v249, v249, v158, v159
 v_max_f32 v249, v249, v250
 v_mfma_f32_16x16x32_bf16 a[72:75], v[224:227], v[200:203], a[72:75]
 s_waitcnt lgkmcnt(2)
 s_add_u32 m0, s69, 74624
 v_mfma_f32_16x16x32_bf16 a[76:79], v[224:227], v[204:207], a[76:79]
 ds_read_b64_tr_b16 v[224:225], v241 offset:2048
 ds_read_b64_tr_b16 v[226:227], v241 offset:10240
 v_mfma_f32_16x16x32_bf16 a[80:83], v[228:231], v[192:195], a[80:83]
 v_cmp_lt_f32 vcc, s63, v249
 s_cbranch_vccnz L_tr_14
L_back_14:
 v_mfma_f32_16x16x32_bf16 a[84:87], v[228:231], v[196:199], a[84:87]
 v_exp_f32 v128, v128
 v_mfma_f32_16x16x32_bf16 a[88:91], v[228:231], v[200:203], a[88:91]
 buffer_load_dwordx4 v248, s[28:31], s58 offen offset:128 nt lds
 v_mfma_f32_16x16x32_bf16 a[92:95], v[228:231], v[204:207], a[92:95]
 ds_read_b64_tr_b16 v[228:229], v242 offset:2048
 ds_read_b64_tr_b16 v[230:231], v242 offset:10240
 v_mfma_f32_16x16x32_bf16 a[96:99], v[232:235], v[192:195], a[96:99]
 v_exp_f32 v129, v129
 v_mfma_f32_16x16x32_bf16 a[100:103], v[232:235], v[196:199], a[100:103]
 s_add_u32 m0, s69, 67328
 v_mfma_f32_16x16x32_bf16 a[104:107], v[232:235], v[200:203], a[104:107]
 s_waitcnt lgkmcnt(2)
 v_exp_f32 v130, v130
 v_mfma_f32_16x16x32_bf16 a[108:111], v[232:235], v[204:207], a[108:111]
 ds_read_b64_tr_b16 v[232:233], v241 offset:2560
 ds_read_b64_tr_b16 v[234:235], v241 offset:10752
 v_mfma_f32_16x16x32_bf16 a[112:115], v[236:239], v[192:195], a[112:115]
 v_exp_f32 v131, v131
 buffer_load_dwordx4 v248, s[28:31], s55 offen offset:256 nt lds
 v_mfma_f32_16x16x32_bf16 a[116:119], v[236:239], v[196:199], a[116:119]
 v_exp_f32 v144, v144
 v_mfma_f32_16x16x32_bf16 a[120:123], v[236:239], v[200:203], a[120:123]
 s_add_u32 m0, s69, 75520
 v_mfma_f32_16x16x32_bf16 a[124:127], v[236:239], v[204:207], a[124:127]
 ds_read_b64_tr_b16 v[236:237], v242 offset:2560
 ds_read_b64_tr_b16 v[238:239], v242 offset:10752
 v_mfma_f32_16x16x32_bf16 a[128:131], v[224:227], v[192:195], a[128:131]
 v_exp_f32 v145, v145
 v_mfma_f32_16x16x32_bf16 a[132:135], v[224:227], v[196:199], a[132:135]
 buffer_load_dwordx4 v248, s[28:31], s58 offen offset:256 nt lds
 v_mfma_f32_16x16x32_bf16 a[136:139], v[224:227], v[200:203], a[136:139]
 s_waitcnt lgkmcnt(2)
 v_exp_f32 v146, v146
 v_mfma_f32_16x16x32_bf16 a[140:143], v[224:227], v[204:207], a[140:143]
 ds_read_b64_tr_b16 v[224:225], v241 offset:3072
 ds_read_b64_tr_b16 v[226:227], v241 offset:11264
 v_mfma_f32_16x16x32_bf16 a[144:147], v[228:231], v[192:195], a[144:147]
 v_exp_f32 v147, v147
 s_add_u32 m0, s69, 68224
 v_mfma_f32_16x16x32_bf16 a[148:151], v[228:231], v[196:199], a[148:151]
 v_exp_f32 v132, v132
 v_mfma_f32_16x16x32_bf16 a[152:155], v[228:231], v[200:203], a[152:155]
 buffer_load_dwordx4 v248, s[28:31], s55 offen offset:384 nt lds
 v_mfma_f32_16x16x32_bf16 a[156:159], v[228:231], v[204:207], a[156:159]
 ds_read_b64_tr_b16 v[228:229], v242 offset:3072
 ds_read_b64_tr_b16 v[230:231], v242 offset:11264
 v_mfma_f32_16x16x32_bf16 a[160:163], v[232:235], v[192:195], a[160:163]
 v_exp_f32 v133, v133
 v_mfma_f32_16x16x32_bf16 a[164:167], v[232:235], v[196:199], a[164:167]
 s_add_u32 m0, s69, 76416
 v_mfma_f32_16x16x32_bf16 a[168:171], v[232:235], v[200:203], a[168:171]
 s_waitcnt lgkmcnt(2)
 v_exp_f32 v134, v134
 v_mfma_f32_16x16x32_bf16 a[172:175], v[232:235], v[204:207], a[172:175]
 ds_read_b64_tr_b16 v[232:233], v241 offset:3584
 ds_read_b64_tr_b16 v[234:235], v241 offset:11776
 v_mfma_f32_16x16x32_bf16 a[176:179], v[236:239], v[192:195], a[176:179]
 v_exp_f32 v135, v135
 v_mfma_f32_16x16x32_bf16 a[180:183], v[236:239], v[196:199], a[180:183]
 buffer_load_dwordx4 v248, s[28:31], s58 offen offset:384 nt lds
 v_mfma_f32_16x16x32_bf16 a[184:187], v[236:239], v[200:203], a[184:187]
 v_exp_f32 v148, v148
 v_mfma_f32_16x16x32_bf16 a[188:191], v[236:239], v[204:207], a[188:191]
 ds_read_b64_tr_b16 v[236:237], v242 offset:3584
 ds_read_b64_tr_b16 v[238:239], v242 offset:11776
 s_add_u32 s55, s55, 16384
 v_mfma_f32_16x16x32_bf16 a[192:195], v[224:227], v[192:195], a[192:195]
 v_exp_f32 v149, v149
 v_mfma_f32_16x16x32_bf16 a[196:199], v[224:227], v[196:199], a[196:199]
 v_exp_f32 v150, v150
 v_mfma_f32_16x16x32_bf16 a[200:203], v[224:227], v[200:203], a[200:203]
 s_add_u32 s58, s58, 16384
 s_waitcnt lgkmcnt(2)
 v_subrev_u32 v241, 65536, v241
 v_mfma_f32_16x16x32_bf16 a[204:207], v[224:227], v[204:207], a[204:207]
 v_exp_f32 v151, v151
 v_mfma_f32_16x16x32_bf16 a[208:211], v[228:231], v[192:195], a[208:211]
 v_exp_f32 v136, v136
 v_mfma_f32_16x16x32_bf16 a[212:215], v[228:231], v[196:199], a[212:215]
 v_mfma_f32_16x16x32_bf16 a[216:219], v[228:231], v[200:203], a[216:219]
 s_waitcnt lgkmcnt(0)
 s_waitcnt vmcnt(16)
 s_barrier
 v_mfma_f32_16x16x32_bf16 a[220:223], v[228:231], v[204:207], a[220:223]
 ds_read_b128 v[224:227], v240 offset:0
 ds_read_b128 v[228:231], v240 offset:8192
 v_mfma_f32_16x16x32_bf16 a[224:227], v[232:235], v[192:195], a[224:227]
 v_exp_f32 v137, v137
 v_mfma_f32_16x16x32_bf16 a[228:231], v[232:235], v[196:199], a[228:231]
 v_subrev_u32 v242, 65536, v242
 v_mfma_f32_16x16x32_bf16 a[232:235], v[232:235], v[200:203], a[232:235]
 v_exp_f32 v138, v138
 v_mfma_f32_16x16x32_bf16 a[236:239], v[232:235], v[204:207], a[236:239]
 ds_read_b128 v[232:235], v240 offset:512
 v_mfma_f32_16x16x32_bf16 a[240:243], v[236:239], v[192:195], a[240:243]
 v_exp_f32 v139, v139
 v_mfma_f32_16x16x32_bf16 a[244:247], v[236:239], v[196:199], a[244:247]
 v_exp_f32 v152, v152
 v_mfma_f32_16x16x32_bf16 a[248:251], v[236:239], v[200:203], a[248:251]
 v_exp_f32 v153, v153
 v_mfma_f32_16x16x32_bf16 a[252:255], v[236:239], v[204:207], a[252:255]
 ds_read_b128 v[236:239], v240 offset:8704
 s_waitcnt lgkmcnt(3)
 v_mfma_f32_16x16x32_bf16 v[160:163], v[224:227], v[0:3], v[208:211]
 v_add_f32 v244, v244, v128
 v_cvt_pk_bf16_f32 v192, v128, v129
 v_mfma_f32_16x16x32_bf16 v[164:167], v[224:227], v[4:7], v[212:215]
 s_add_u32 m0, s70, 98304
 v_mfma_f32_16x16x32_bf16 v[168:171], v[224:227], v[8:11], v[216:219]
 s_waitcnt lgkmcnt(2)
 v_mfma_f32_16x16x32_bf16 v[172:175], v[224:227], v[12:15], v[220:223]
 ds_read_b128 v[224:227], v240 offset:1024
 v_mfma_f32_16x16x32_bf16 v[176:179], v[228:231], v[0:3], v[208:211]
 v_exp_f32 v154, v154
 v_mfma_f32_16x16x32_bf16 v[180:183], v[228:231], v[4:7], v[212:215]
 v_add_f32 v244, v244, v129
 buffer_load_dwordx4 v253, s[36:39], s82 offen offset:0 lds
 v_mfma_f32_16x16x32_bf16 v[184:187], v[228:231], v[8:11], v[216:219]
 s_waitcnt lgkmcnt(2)
 v_cvt_pk_bf16_f32 v193, v130, v131
 v_mfma_f32_16x16x32_bf16 v[188:191], v[228:231], v[12:15], v[220:223]
 ds_read_b128 v[228:231], v240 offset:9216
 v_mfma_f32_16x16x32_bf16 v[160:163], v[232:235], v[16:19], v[160:163]
 v_exp_f32 v155, v155
 v_mfma_f32_16x16x32_bf16 v[164:167], v[232:235], v[20:23], v[164:167]
 s_add_u32 m0, s70, 99328
 v_add_f32 v244, v244, v130
 v_mfma_f32_16x16x32_bf16 v[168:171], v[232:235], v[24:27], v[168:171]
 s_waitcnt lgkmcnt(1)
 v_add_f32 v244, v244, v131
 v_mfma_f32_16x16x32_bf16 v[172:175], v[232:235], v[28:31], v[172:175]
 ds_read_b128 v[232:235], v240 offset:1536
 v_exp_f32 v140, v140
 v_mfma_f32_16x16x32_bf16 v[176:179], v[236:239], v[16:19], v[176:179]
 v_mbcnt_lo_u32_b32 v243, -1, 0
 buffer_load_dwordx4 v253, s[36:39], s83 offen offset:0 lds
 v_mfma_f32_16x16x32_bf16 v[180:183], v[236:239], v[20:23], v[180:183]
 v_add_f32 v244, v244, v144
 v_cvt_pk_bf16_f32 v194, v144, v145
 v_mfma_f32_16x16x32_bf16 v[184:187], v[236:239], v[24:27], v[184:187]
 v_exp_f32 v141, v141
 v_mfma_f32_16x16x32_bf16 v[188:191], v[236:239], v[28:31], v[188:191]
 ds_read_b128 v[236:239], v240 offset:9728
 s_add_u32 m0, s70, 100352
 v_mfma_f32_16x16x32_bf16 v[160:163], v[224:227], v[32:35], v[160:163]
 v_add_f32 v244, v244, v145
 v_cvt_pk_bf16_f32 v195, v146, v147
 v_mfma_f32_16x16x32_bf16 v[164:167], v[224:227], v[36:39], v[164:167]
 buffer_load_dwordx4 v253, s[36:39], s84 offen offset:0 lds
 v_mfma_f32_16x16x32_bf16 v[168:171], v[224:227], v[40:43], v[168:171]
 s_waitcnt lgkmcnt(1)
 v_mfma_f32_16x16x32_bf16 v[172:175], v[224:227], v[44:47], v[172:175]
 ds_read_b128 v[224:227], v240 offset:2048
 v_exp_f32 v142, v142
 v_mfma_f32_16x16x32_bf16 v[176:179], v[228:231], v[32:35], v[176:179]
 v_add_f32 v244, v244, v146
 v_add_f32 v244, v244, v147
 v_mfma_f32_16x16x32_bf16 v[180:183], v[228:231], v[36:39], v[180:183]
 s_add_u32 m0, s70, 101376
 v_mbcnt_hi_u32_b32 v243, -1, v243
 v_mfma_f32_16x16x32_bf16 v[184:187], v[228:231], v[40:43], v[184:187]
 v_exp_f32 v143, v143
 v_mfma_f32_16x16x32_bf16 v[188:191], v[228:231], v[44:47], v[188:191]
 ds_read_b128 v[228:231], v240 offset:10240
 v_add_f32 v245, v245, v132
 v_mfma_f32_16x16x32_bf16 v[160:163], v[232:235], v[48:51], v[160:163]
 buffer_load_dwordx4 v253, s[36:39], s85 offen offset:0 lds
 v_cvt_pk_bf16_f32 v196, v132, v133
 v_mfma_f32_16x16x32_bf16 v[164:167], v[232:235], v[52:55], v[164:167]
 v_exp_f32 v156, v156
 v_mfma_f32_16x16x32_bf16 v[168:171], v[232:235], v[56:59], v[168:171]
 s_waitcnt lgkmcnt(1)
 v_add_f32 v245, v245, v133
 v_mfma_f32_16x16x32_bf16 v[172:175], v[232:235], v[60:63], v[172:175]
 ds_read_b128 v[232:235], v240 offset:2560
 s_add_u32 m0, s70, 102400
 v_mfma_f32_16x16x32_bf16 v[176:179], v[236:239], v[48:51], v[176:179]
 v_cvt_pk_bf16_f32 v197, v134, v135
 v_mfma_f32_16x16x32_bf16 v[180:183], v[236:239], v[52:55], v[180:183]
 v_exp_f32 v157, v157
 v_mfma_f32_16x16x32_bf16 v[184:187], v[236:239], v[56:59], v[184:187]
 buffer_load_dwordx4 v253, s[36:39], s86 offen offset:0 lds
 v_add_f32 v245, v245, v134
 v_mfma_f32_16x16x32_bf16 v[188:191], v[236:239], v[60:63], v[188:191]
 ds_read_b128 v[236:239], v240 offset:10752
 v_lshlrev_b32 v243, 4, v243
 v_mfma_f32_16x16x32_bf16 v[160:163], v[224:227], v[64:67], v[160:163]
 v_add_f32 v245, v245, v135
 v_mfma_f32_16x16x32_bf16 v[164:167], v[224:227], v[68:71], v[164:167]
 v_exp_f32 v158, v158
 v_mfma_f32_16x16x32_bf16 v[168:171], v[224:227], v[72:75], v[168:171]
 s_waitcnt lgkmcnt(1)
 s_add_u32 m0, s70, 103424
 v_mfma_f32_16x16x32_bf16 v[172:175], v[224:227], v[76:79], v[172:175]
 ds_read_b128 v[224:227], v240 offset:3072
 v_add_f32 v245, v245, v148
 v_mfma_f32_16x16x32_bf16 v[176:179], v[228:231], v[64:67], v[176:179]
 v_cvt_pk_bf16_f32 v198, v148, v149
 v_mfma_f32_16x16x32_bf16 v[180:183], v[228:231], v[68:71], v[180:183]
 v_exp_f32 v159, v159
 buffer_load_dwordx4 v253, s[36:39], s87 offen offset:0 lds
 v_mfma_f32_16x16x32_bf16 v[184:187], v[228:231], v[72:75], v[184:187]
 v_add_f32 v245, v245, v149
 v_cvt_pk_bf16_f32 v199, v150, v151
 v_mfma_f32_16x16x32_bf16 v[188:191], v[228:231], v[76:79], v[188:191]
 ds_read_b128 v[228:231], v240 offset:11264
 s_add_u32 m0, s70, 104448
 v_mfma_f32_16x16x32_bf16 v[160:163], v[232:235], v[80:83], v[160:163]
 v_add_f32 v245, v245, v150
 v_add_f32 v245, v245, v151
 v_mfma_f32_16x16x32_bf16 v[164:167], v[232:235], v[84:87], v[164:167]
 v_add_u32 v248, s60, v243
 v_add_f32 v246, v246, v136
 v_mfma_f32_16x16x32_bf16 v[168:171], v[232:235], v[88:91], v[168:171]
 s_waitcnt lgkmcnt(1)
 buffer_load_dwordx4 v253, s[36:39], s88 offen offset:0 lds
 v_mfma_f32_16x16x32_bf16 v[172:175], v[232:235], v[92:95], v[172:175]
 ds_read_b128 v[232:235], v240 offset:3584
 v_cvt_pk_bf16_f32 v200, v136, v137
 v_mfma_f32_16x16x32_bf16 v[176:179], v[236:239], v[80:83], v[176:179]
 v_add_f32 v246, v246, v137
 v_cvt_pk_bf16_f32 v201, v138, v139
 v_mfma_f32_16x16x32_bf16 v[180:183], v[236:239], v[84:87], v[180:183]
 v_add_f32 v246, v246, v138
 s_add_u32 m0, s70, 105472
 v_mfma_f32_16x16x32_bf16 v[184:187], v[236:239], v[88:91], v[184:187]
 v_add_f32 v246, v246, v139
 v_add_f32 v246, v246, v152
 v_mfma_f32_16x16x32_bf16 v[188:191], v[236:239], v[92:95], v[188:191]
 ds_read_b128 v[236:239], v240 offset:11776
 v_cvt_pk_bf16_f32 v202, v152, v153
 v_mfma_f32_16x16x32_bf16 v[160:163], v[224:227], v[96:99], v[160:163]
 buffer_load_dwordx4 v253, s[36:39], s89 offen offset:0 lds
 v_add_f32 v246, v246, v153
 v_mfma_f32_16x16x32_bf16 v[164:167], v[224:227], v[100:103], v[164:167]
 v_cvt_pk_bf16_f32 v203, v154, v155
 v_mfma_f32_16x16x32_bf16 v[168:171], v[224:227], v[104:107], v[168:171]
 s_waitcnt lgkmcnt(1)
 v_add_f32 v246, v246, v154
 v_mfma_f32_16x16x32_bf16 v[172:175], v[224:227], v[108:111], v[172:175]
 v_add_f32 v246, v246, v155
 v_add_f32 v247, v247, v140
 v_mfma_f32_16x16x32_bf16 v[176:179], v[228:231], v[96:99], v[176:179]
 v_cvt_pk_bf16_f32 v204, v140, v141
 v_mfma_f32_16x16x32_bf16 v[180:183], v[228:231], v[100:103], v[180:183]
 v_add_f32 v247, v247, v141
 v_mfma_f32_16x16x32_bf16 v[184:187], v[228:231], v[104:107], v[184:187]
 s_waitcnt lgkmcnt(0)
 s_waitcnt vmcnt(16)
 s_barrier
 v_mfma_f32_16x16x32_bf16 v[188:191], v[228:231], v[108:111], v[188:191]
 ds_read_b64_tr_b16 v[224:225], v241 offset:0
 ds_read_b64_tr_b16 v[226:227], v241 offset:8192
 ds_read_b64_tr_b16 v[228:229], v242 offset:0
 ds_read_b64_tr_b16 v[230:231], v242 offset:8192
 v_mfma_f32_16x16x32_bf16 v[160:163], v[232:235], v[112:115], v[160:163]
 v_cvt_pk_bf16_f32 v205, v142, v143
 v_add_f32 v247, v247, v142
 v_mfma_f32_16x16x32_bf16 v[164:167], v[232:235], v[116:119], v[164:167]
 v_add_f32 v247, v247, v143
 v_add_f32 v247, v247, v156
 v_mfma_f32_16x16x32_bf16 v[168:171], v[232:235], v[120:123], v[168:171]
 v_cvt_pk_bf16_f32 v206, v156, v157
 v_mfma_f32_16x16x32_bf16 v[172:175], v[232:235], v[124:127], v[172:175]
 ds_read_b64_tr_b16 v[232:233], v241 offset:512
 ds_read_b64_tr_b16 v[234:235], v241 offset:8704
 v_mfma_f32_16x16x32_bf16 v[176:179], v[236:239], v[112:115], v[176:179]
 v_add_f32 v247, v247, v157
 v_cvt_pk_bf16_f32 v207, v158, v159
 v_mfma_f32_16x16x32_bf16 v[180:183], v[236:239], v[116:119], v[180:183]
 v_add_f32 v247, v247, v158
 v_mfma_f32_16x16x32_bf16 v[184:187], v[236:239], v[120:123], v[184:187]
 v_add_f32 v247, v247, v159
 v_mfma_f32_16x16x32_bf16 v[188:191], v[236:239], v[124:127], v[188:191]
 ds_read_b64_tr_b16 v[236:237], v242 offset:512
 ds_read_b64_tr_b16 v[238:239], v242 offset:8704
 s_waitcnt lgkmcnt(6)
 v_mfma_f32_16x16x32_bf16 a[0:3], v[224:227], v[192:195], a[0:3]
 v_mfma_f32_16x16x32_bf16 a[4:7], v[224:227], v[196:199], a[4:7]
 s_add_u32 s51, s82, 64
 v_mfma_f32_16x16x32_bf16 a[8:11], v[224:227], v[200:203], a[8:11]
 s_waitcnt lgkmcnt(4)
 v_max3_f32 v249, v160, v161, v162
 v_mfma_f32_16x16x32_bf16 a[12:15], v[224:227], v[204:207], a[12:15]
 ds_read_b64_tr_b16 v[224:225], v241 offset:1024
 ds_read_b64_tr_b16 v[226:227], v241 offset:9216
 v_mfma_f32_16x16x32_bf16 a[16:19], v[228:231], v[192:195], a[16:19]
 v_max3_f32 v250, v163, v164, v165
 s_add_u32 m0, s70, 0
 v_mfma_f32_16x16x32_bf16 a[20:23], v[228:231], v[196:199], a[20:23]
 v_max3_f32 v249, v249, v166, v167
 v_max3_f32 v250, v250, v168, v169
 v_mfma_f32_16x16x32_bf16 a[24:27], v[228:231], v[200:203], a[24:27]
 s_waitcnt lgkmcnt(4)
 v_max3_f32 v249, v249, v170, v171
 v_mfma_f32_16x16x32_bf16 a[28:31], v[228:231], v[204:207], a[28:31]
 ds_read_b64_tr_b16 v[228:229], v242 offset:1024
 ds_read_b64_tr_b16 v[230:231], v242 offset:9216
 v_mfma_f32_16x16x32_bf16 a[32:35], v[232:235], v[192:195], a[32:35]
 buffer_load_dwordx4 v253, s[36:39], s51 offen offset:0 lds
 v_max3_f32 v250, v250, v172, v173
 v_mfma_f32_16x16x32_bf16 a[36:39], v[232:235], v[196:199], a[36:39]
 v_max3_f32 v249, v249, v174, v175
 v_max3_f32 v250, v250, v176, v177
 v_mfma_f32_16x16x32_bf16 a[40:43], v[232:235], v[200:203], a[40:43]
 s_waitcnt lgkmcnt(2)
 s_add_u32 m0, s70, 960
 v_mfma_f32_16x16x32_bf16 a[44:47], v[232:235], v[204:207], a[44:47]
 ds_read_b64_tr_b16 v[232:233], v241 offset:1536
 ds_read_b64_tr_b16 v[234:235], v241 offset:9728
 v_mfma_f32_16x16x32_bf16 a[48:51], v[236:239], v[192:195], a[48:51]
 v_max3_f32 v249, v249, v178, v179
 v_max3_f32 v250, v250, v180, v181
 v_mfma_f32_16x16x32_bf16 a[52:55], v[236:239], v[196:199], a[52:55]
 v_max3_f32 v249, v249, v182, v183
 buffer_load_dwordx4 v253, s[36:39], s83 offen offset:64 lds
 v_mfma_f32_16x16x32_bf16 a[56:59], v[236:239], v[200:203], a[56:59]
 v_max3_f32 v250, v250, v184, v185
 v_max3_f32 v249, v249, v186, v187
 v_mfma_f32_16x16x32_bf16 a[60:63], v[236:239], v[204:207], a[60:63]
 ds_read_b64_tr_b16 v[236:237], v242 offset:1536
 ds_read_b64_tr_b16 v[238:239], v242 offset:9728
 v_mfma_f32_16x16x32_bf16 a[64:67], v[224:227], v[192:195], a[64:67]
 v_max3_f32 v250, v250, v188, v189
 s_add_u32 m0, s70, 1984
 v_mfma_f32_16x16x32_bf16 a[68:71], v[224:227], v[196:199], a[68:71]
 v_max3_f32 v249, v249, v190, v191
 v_max_f32 v249, v249, v250
 v_mfma_f32_16x16x32_bf16 a[72:75], v[224:227], v[200:203], a[72:75]
 s_waitcnt lgkmcnt(2)
 v_mfma_f32_16x16x32_bf16 a[76:79], v[224:227], v[204:207], a[76:79]
 ds_read_b64_tr_b16 v[224:225], v241 offset:2048
 ds_read_b64_tr_b16 v[226:227], v241 offset:10240
 v_mfma_f32_16x16x32_bf16 a[80:83], v[228:231], v[192:195], a[80:83]
 v_cmp_lt_f32 vcc, s63, v249
 s_cbranch_vccnz L_tr_15
L_back_15:
 v_mfma_f32_16x16x32_bf16 a[84:87], v[228:231], v[196:199], a[84:87]
 buffer_load_dwordx4 v253, s[36:39], s84 offen offset:64 lds
 v_mfma_f32_16x16x32_bf16 a[88:91], v[228:231], v[200:203], a[88:91]
 v_exp_f32 v160, v160
 v_mfma_f32_16x16x32_bf16 a[92:95], v[228:231], v[204:207], a[92:95]
 ds_read_b64_tr_b16 v[228:229], v242 offset:2048
 ds_read_b64_tr_b16 v[230:231], v242 offset:10240
 v_mfma_f32_16x16x32_bf16 a[96:99], v[232:235], v[192:195], a[96:99]
 s_add_u32 m0, s70, 3008
 v_exp_f32 v161, v161
 v_mfma_f32_16x16x32_bf16 a[100:103], v[232:235], v[196:199], a[100:103]
 v_exp_f32 v162, v162
 v_mfma_f32_16x16x32_bf16 a[104:107], v[232:235], v[200:203], a[104:107]
 s_waitcnt lgkmcnt(2)
 buffer_load_dwordx4 v253, s[36:39], s85 offen offset:64 lds
 v_mfma_f32_16x16x32_bf16 a[108:111], v[232:235], v[204:207], a[108:111]
 ds_read_b64_tr_b16 v[232:233], v241 offset:2560
 ds_read_b64_tr_b16 v[234:235], v241 offset:10752
 v_mfma_f32_16x16x32_bf16 a[112:115], v[236:239], v[192:195], a[112:115]
 v_exp_f32 v163, v163
 v_mfma_f32_16x16x32_bf16 a[116:119], v[236:239], v[196:199], a[116:119]
 s_add_u32 m0, s70, 4032
 v_mfma_f32_16x16x32_bf16 a[120:123], v[236:239], v[200:203], a[120:123]
 v_exp_f32 v176, v176
 v_mfma_f32_16x16x32_bf16 a[124:127], v[236:239], v[204:207], a[124:127]
 ds_read_b64_tr_b16 v[236:237], v242 offset:2560
 ds_read_b64_tr_b16 v[238:239], v242 offset:10752
 v_mfma_f32_16x16x32_bf16 a[128:131], v[224:227], v[192:195], a[128:131]
 v_exp_f32 v177, v177
 buffer_load_dwordx4 v253, s[36:39], s86 offen offset:64 lds
 v_mfma_f32_16x16x32_bf16 a[132:135], v[224:227], v[196:199], a[132:135]
 v_exp_f32 v178, v178
 v_mfma_f32_16x16x32_bf16 a[136:139], v[224:227], v[200:203], a[136:139]
 s_waitcnt lgkmcnt(2)
 s_add_u32 m0, s70, 5056
 v_mfma_f32_16x16x32_bf16 a[140:143], v[224:227], v[204:207], a[140:143]
 ds_read_b64_tr_b16 v[224:225], v241 offset:3072
 ds_read_b64_tr_b16 v[226:227], v241 offset:11264
 v_mfma_f32_16x16x32_bf16 a[144:147], v[228:231], v[192:195], a[144:147]
 v_exp_f32 v179, v179
 v_mfma_f32_16x16x32_bf16 a[148:151], v[228:231], v[196:199], a[148:151]
 v_exp_f32 v164, v164
 v_mfma_f32_16x16x32_bf16 a[152:155], v[228:231], v[200:203], a[152:155]
 buffer_load_dwordx4 v253, s[36:39], s87 offen offset:64 lds
 v_mfma_f32_16x16x32_bf16 a[156:159], v[228:231], v[204:207], a[156:159]
 ds_read_b64_tr_b16 v[228:229], v242 offset:3072
 ds_read_b64_tr_b16 v[230:231], v242 offset:11264
 v_mfma_f32_16x16x32_bf16 a[160:163], v[232:235], v[192:195], a[160:163]
 v_exp_f32 v165, v165
 v_mfma_f32_16x16x32_bf16 a[164:167], v[232:235], v[196:199], a[164:167]
 s_add_u32 m0, s70, 6080
 v_mfma_f32_16x16x32_bf16 a[168:171], v[232:235], v[200:203], a[168:171]
 s_waitcnt lgkmcnt(2)
 v_exp_f32 v166, v166
 v_mfma_f32_16x16x32_bf16 a[172:175], v[232:235], v[204:207], a[172:175]
 ds_read_b64_tr_b16 v[232:233], v241 offset:3584
 ds_read_b64_tr_b16 v[234:235], v241 offset:11776
 v_mfma_f32_16x16x32_bf16 a[176:179], v[236:239], v[192:195], a[176:179]
 v_exp_f32 v167, v167
 buffer_load_dwordx4 v253, s[36:39], s88 offen offset:64 lds
 v_mfma_f32_16x16x32_bf16 a[180:183], v[236:239], v[196:199], a[180:183]
 v_exp_f32 v180, v180
 v_mfma_f32_16x16x32_bf16 a[184:187], v[236:239], v[200:203], a[184:187]
 s_add_u32 m0, s70, 7104
 v_mfma_f32_16x16x32_bf16 a[188:191], v[236:239], v[204:207], a[188:191]
 ds_read_b64_tr_b16 v[236:237], v242 offset:3584
 ds_read_b64_tr_b16 v[238:239], v242 offset:11776
 v_mfma_f32_16x16x32_bf16 a[192:195], v[224:227], v[192:195], a[192:195]
 v_exp_f32 v181, v181
 v_mfma_f32_16x16x32_bf16 a[196:199], v[224:227], v[196:199], a[196:199]
 v_exp_f32 v182, v182
 v_mfma_f32_16x16x32_bf16 a[200:203], v[224:227], v[200:203], a[200:203]
 buffer_load_dwordx4 v253, s[36:39], s89 offen offset:64 lds
 s_waitcnt lgkmcnt(2)
 v_add_u32 v241, 32768, v241
 v_mfma_f32_16x16x32_bf16 a[204:207], v[224:227], v[204:207], a[204:207]
 v_exp_f32 v183, v183
 v_mfma_f32_16x16x32_bf16 a[208:211], v[228:231], v[192:195], a[208:211]
 v_add_u32 v242, 32768, v242
 v_mfma_f32_16x16x32_bf16 a[212:215], v[228:231], v[196:199], a[212:215]
 v_exp_f32 v168, v168
 v_mfma_f32_16x16x32_bf16 a[216:219], v[228:231], v[200:203], a[216:219]
 s_waitcnt lgkmcnt(0)
 s_waitcnt vmcnt(16)
 s_barrier
 v_mfma_f32_16x16x32_bf16 a[220:223], v[228:231], v[204:207], a[220:223]
 ds_read_b64_tr_b16 v[224:225], v241 offset:0
 ds_read_b64_tr_b16 v[226:227], v241 offset:8192
 ds_read_b64_tr_b16 v[228:229], v242 offset:0
 ds_read_b64_tr_b16 v[230:231], v242 offset:8192
 v_mfma_f32_16x16x32_bf16 a[224:227], v[232:235], v[192:195], a[224:227]
 v_exp_f32 v169, v169
 v_mfma_f32_16x16x32_bf16 a[228:231], v[232:235], v[196:199], a[228:231]
 v_exp_f32 v170, v170
 v_mfma_f32_16x16x32_bf16 a[232:235], v[232:235], v[200:203], a[232:235]
 v_exp_f32 v171, v171
 v_mfma_f32_16x16x32_bf16 a[236:239], v[232:235], v[204:207], a[236:239]
 ds_read_b64_tr_b16 v[232:233], v241 offset:512
 ds_read_b64_tr_b16 v[234:235], v241 offset:8704
 v_mfma_f32_16x16x32_bf16 a[240:243], v[236:239], v[192:195], a[240:243]
 v_exp_f32 v184, v184
 v_mfma_f32_16x16x32_bf16 a[244:247], v[236:239], v[196:199], a[244:247]
 v_mfma_f32_16x16x32_bf16 a[248:251], v[236:239], v[200:203], a[248:251]
 v_exp_f32 v185, v185
 v_mfma_f32_16x16x32_bf16 a[252:255], v[236:239], v[204:207], a[252:255]
 ds_read_b64_tr_b16 v[236:237], v242 offset:512
 ds_read_b64_tr_b16 v[238:239], v242 offset:8704
 v_add_f32 v244, v244, v160
 v_cvt_pk_bf16_f32 v192, v160, v161
 v_exp_f32 v186, v186
 v_add_f32 v244, v244, v161
 v_cvt_pk_bf16_f32 v193, v162, v163
 v_exp_f32 v187, v187
 v_add_f32 v244, v244, v162
 v_add_f32 v244, v244, v163
 v_exp_f32 v172, v172
 v_add_f32 v244, v244, v176
 v_cvt_pk_bf16_f32 v194, v176, v177
 v_exp_f32 v173, v173
 v_add_f32 v244, v244, v177
 v_cvt_pk_bf16_f32 v195, v178, v179
 v_exp_f32 v174, v174
 v_add_f32 v244, v244, v178
 v_add_f32 v244, v244, v179
 v_exp_f32 v175, v175
 v_add_f32 v245, v245, v164
 v_cvt_pk_bf16_f32 v196, v164, v165
 v_exp_f32 v188, v188
 v_add_f32 v245, v245, v165
 v_cvt_pk_bf16_f32 v197, v166, v167
 v_exp_f32 v189, v189
 v_add_f32 v245, v245, v166
 v_add_f32 v245, v245, v167
 v_exp_f32 v190, v190
 v_add_f32 v245, v245, v180
 v_cvt_pk_bf16_f32 v198, v180, v181
 v_exp_f32 v191, v191
 v_add_f32 v245, v245, v181
 v_cvt_pk_bf16_f32 v199, v182, v183
 v_add_f32 v245, v245, v182
 v_add_f32 v245, v245, v183
 v_add_f32 v246, v246, v168
 v_cvt_pk_bf16_f32 v200, v168, v169
 v_add_f32 v246, v246, v169
 v_cvt_pk_bf16_f32 v201, v170, v171
 v_add_f32 v246, v246, v170
 v_add_f32 v246, v246, v171
 v_add_f32 v246, v246, v184
 v_cvt_pk_bf16_f32 v202, v184, v185
 v_add_f32 v246, v246, v185
 v_cvt_pk_bf16_f32 v203, v186, v187
 v_add_f32 v246, v246, v186
 v_add_f32 v246, v246, v187
 v_add_f32 v247, v247, v172
 v_cvt_pk_bf16_f32 v204, v172, v173
 v_add_f32 v247, v247, v173
 v_cvt_pk_bf16_f32 v205, v174, v175
 v_add_f32 v247, v247, v174
 v_add_f32 v247, v247, v175
 v_add_f32 v247, v247, v188
 v_cvt_pk_bf16_f32 v206, v188, v189
 v_add_f32 v247, v247, v189
 v_cvt_pk_bf16_f32 v207, v190, v191
 v_add_f32 v247, v247, v190
 v_add_f32 v247, v247, v191
 s_waitcnt lgkmcnt(6)
 v_mfma_f32_16x16x32_bf16 a[0:3], v[224:227], v[192:195], a[0:3]
 v_mfma_f32_16x16x32_bf16 a[4:7], v[224:227], v[196:199], a[4:7]
 s_add_u32 m0, s70, 32640
 v_mfma_f32_16x16x32_bf16 a[8:11], v[224:227], v[200:203], a[8:11]
 s_waitcnt lgkmcnt(4)
 v_mfma_f32_16x16x32_bf16 a[12:15], v[224:227], v[204:207], a[12:15]
 ds_read_b64_tr_b16 v[224:225], v241 offset:1024
 ds_read_b64_tr_b16 v[226:227], v241 offset:9216
 v_mfma_f32_16x16x32_bf16 a[16:19], v[228:231], v[192:195], a[16:19]
 buffer_load_dwordx4 v253, s[36:39], s82 offen offset:128 lds
 v_mfma_f32_16x16x32_bf16 a[20:23], v[228:231], v[196:199], a[20:23]
 v_mfma_f32_16x16x32_bf16 a[24:27], v[228:231], v[200:203], a[24:27]
 s_waitcnt lgkmcnt(4)
 v_mfma_f32_16x16x32_bf16 a[28:31], v[228:231], v[204:207], a[28:31]
 ds_read_b64_tr_b16 v[228:229], v242 offset:1024
 ds_read_b64_tr_b16 v[230:231], v242 offset:9216
 v_mfma_f32_16x16x32_bf16 a[32:35], v[232:235], v[192:195], a[32:35]
 s_add_u32 m0, s70, 33664
 v_mfma_f32_16x16x32_bf16 a[36:39], v[232:235], v[196:199], a[36:39]
 v_mfma_f32_16x16x32_bf16 a[40:43], v[232:235], v[200:203], a[40:43]
 s_waitcnt lgkmcnt(2)
 v_accvgpr_read_b32 v208, a0
 v_mfma_f32_16x16x32_bf16 a[44:47], v[232:235], v[204:207], a[44:47]
 ds_read_b64_tr_b16 v[232:233], v241 offset:1536
 ds_read_b64_tr_b16 v[234:235], v241 offset:9728
 v_mfma_f32_16x16x32_bf16 a[48:51], v[236:239], v[192:195], a[48:51]
 v_accvgpr_read_b32 v209, a1
 buffer_load_dwordx4 v253, s[36:39], s83 offen offset:128 lds
 v_mfma_f32_16x16x32_bf16 a[52:55], v[236:239], v[196:199], a[52:55]
 v_accvgpr_read_b32 v210, a2
 v_accvgpr_read_b32 v211, a3
 v_mfma_f32_16x16x32_bf16 a[56:59], v[236:239], v[200:203], a[56:59]
 v_accvgpr_read_b32 v212, a16
 v_accvgpr_read_b32 v213, a17
 v_accvgpr_read_b32 v214, a18
 v_mfma_f32_16x16x32_bf16 a[60:63], v[236:239], v[204:207], a[60:63]
 ds_read_b64_tr_b16 v[236:237], v242 offset:1536
 ds_read_b64_tr_b16 v[238:239], v242 offset:9728
 v_accvgpr_read_b32 v215, a19
 v_mfma_f32_16x16x32_bf16 a[64:67], v[224:227], v[192:195], a[64:67]
 v_cvt_pk_bf16_f32 v0, v208, v209
 v_cvt_pk_bf16_f32 v1, v210, v211
 s_add_u32 m0, s70, 34688
 v_mfma_f32_16x16x32_bf16 a[68:71], v[224:227], v[196:199], a[68:71]
 v_cvt_pk_bf16_f32 v2, v212, v213
 v_cvt_pk_bf16_f32 v3, v214, v215
 v_accvgpr_read_b32 v216, a4
 v_mfma_f32_16x16x32_bf16 a[72:75], v[224:227], v[200:203], a[72:75]
 s_waitcnt lgkmcnt(2)
 v_accvgpr_read_b32 v217, a5
 v_accvgpr_read_b32 v218, a6
 v_mfma_f32_16x16x32_bf16 a[76:79], v[224:227], v[204:207], a[76:79]
 ds_read_b64_tr_b16 v[224:225], v241 offset:2048
 ds_read_b64_tr_b16 v[226:227], v241 offset:10240
 v_accvgpr_read_b32 v219, a7
 v_mfma_f32_16x16x32_bf16 a[80:83], v[228:231], v[192:195], a[80:83]
 v_accvgpr_read_b32 v220, a20
 v_accvgpr_read_b32 v221, a21
 buffer_load_dwordx4 v253, s[36:39], s84 offen offset:128 lds
 v_mfma_f32_16x16x32_bf16 a[84:87], v[228:231], v[196:199], a[84:87]
 v_accvgpr_read_b32 v222, a22
 v_accvgpr_read_b32 v223, a23
 v_cvt_pk_bf16_f32 v4, v216, v217
 v_mfma_f32_16x16x32_bf16 a[88:91], v[228:231], v[200:203], a[88:91]
 v_cvt_pk_bf16_f32 v5, v218, v219
 v_cvt_pk_bf16_f32 v6, v220, v221
 v_cvt_pk_bf16_f32 v7, v222, v223
 v_mfma_f32_16x16x32_bf16 a[92:95], v[228:231], v[204:207], a[92:95]
 ds_read_b64_tr_b16 v[228:229], v242 offset:2048
 ds_read_b64_tr_b16 v[230:231], v242 offset:10240
 v_accvgpr_read_b32 v208, a8
 v_mfma_f32_16x16x32_bf16 a[96:99], v[232:235], v[192:195], a[96:99]
 v_accvgpr_read_b32 v209, a9
 v_accvgpr_read_b32 v210, a10
 s_add_u32 m0, s70, 35712
 v_mfma_f32_16x16x32_bf16 a[100:103], v[232:235], v[196:199], a[100:103]
 v_accvgpr_read_b32 v211, a11
 v_accvgpr_read_b32 v212, a24
 v_accvgpr_read_b32 v213, a25
 v_mfma_f32_16x16x32_bf16 a[104:107], v[232:235], v[200:203], a[104:107]
 s_waitcnt lgkmcnt(2)
 v_accvgpr_read_b32 v214, a26
 v_accvgpr_read_b32 v215, a27
 v_mfma_f32_16x16x32_bf16 a[108:111], v[232:235], v[204:207], a[108:111]
 v_cvt_pk_bf16_f32 v8, v208, v209
 v_cvt_pk_bf16_f32 v9, v210, v211
 v_cvt_pk_bf16_f32 v10, v212, v213
 v_cvt_pk_bf16_f32 v11, v214, v215
 v_accvgpr_read_b32 v216, a12
 v_accvgpr_read_b32 v217, a13
 v_accvgpr_read_b32 v218, a14
 v_accvgpr_read_b32 v219, a15
 v_accvgpr_read_b32 v220, a28
 v_accvgpr_read_b32 v221, a29
 v_accvgpr_read_b32 v222, a30
 v_accvgpr_read_b32 v223, a31
 v_cvt_pk_bf16_f32 v12, v216, v217
 v_cvt_pk_bf16_f32 v13, v218, v219
 v_cvt_pk_bf16_f32 v14, v220, v221
 v_cvt_pk_bf16_f32 v15, v222, v223
 ds_read_b64_tr_b16 v[232:233], v241 offset:2560
 ds_read_b64_tr_b16 v[234:235], v241 offset:10752
 v_mfma_f32_16x16x32_bf16 a[112:115], v[236:239], v[192:195], a[112:115]
 buffer_load_dwordx4 v253, s[36:39], s85 offen offset:128 lds
 s_add_u32 m0, s70, 36736
 v_mfma_f32_16x16x32_bf16 a[116:119], v[236:239], v[196:199], a[116:119]
 v_accvgpr_read_b32 v208, a32
 v_accvgpr_read_b32 v209, a33
 v_mfma_f32_16x16x32_bf16 a[120:123], v[236:239], v[200:203], a[120:123]
 v_accvgpr_read_b32 v210, a34
 v_accvgpr_read_b32 v211, a35
 v_mfma_f32_16x16x32_bf16 a[124:127], v[236:239], v[204:207], a[124:127]
 ds_read_b64_tr_b16 v[236:237], v242 offset:2560
 ds_read_b64_tr_b16 v[238:239], v242 offset:10752
 buffer_load_dwordx4 v253, s[36:39], s86 offen offset:128 lds
 v_mfma_f32_16x16x32_bf16 a[128:131], v[224:227], v[192:195], a[128:131]
 v_accvgpr_read_b32 v212, a48
 v_accvgpr_read_b32 v213, a49
 v_accvgpr_read_b32 v214, a50
 v_mfma_f32_16x16x32_bf16 a[132:135], v[224:227], v[196:199], a[132:135]
 v_accvgpr_read_b32 v215, a51
 v_cvt_pk_bf16_f32 v16, v208, v209
 v_cvt_pk_bf16_f32 v17, v210, v211
 v_mfma_f32_16x16x32_bf16 a[136:139], v[224:227], v[200:203], a[136:139]
 s_waitcnt lgkmcnt(2)
 v_cvt_pk_bf16_f32 v18, v212, v213
 v_cvt_pk_bf16_f32 v19, v214, v215
 v_mfma_f32_16x16x32_bf16 a[140:143], v[224:227], v[204:207], a[140:143]
 ds_read_b64_tr_b16 v[224:225], v241 offset:3072
 ds_read_b64_tr_b16 v[226:227], v241 offset:11264
 s_add_u32 m0, s70, 37760
 v_mfma_f32_16x16x32_bf16 a[144:147], v[228:231], v[192:195], a[144:147]
 v_accvgpr_read_b32 v216, a36
 v_accvgpr_read_b32 v217, a37
 v_accvgpr_read_b32 v218, a38
 v_mfma_f32_16x16x32_bf16 a[148:151], v[228:231], v[196:199], a[148:151]
 v_accvgpr_read_b32 v219, a39
 v_accvgpr_read_b32 v220, a52
 v_accvgpr_read_b32 v221, a53
 v_mfma_f32_16x16x32_bf16 a[152:155], v[228:231], v[200:203], a[152:155]
 v_accvgpr_read_b32 v222, a54
 v_accvgpr_read_b32 v223, a55
 buffer_load_dwordx4 v253, s[36:39], s87 offen offset:128 lds
 v_mfma_f32_16x16x32_bf16 a[156:159], v[228:231], v[204:207], a[156:159]
 ds_read_b64_tr_b16 v[228:229], v242 offset:3072
 ds_read_b64_tr_b16 v[230:231], v242 offset:11264
 v_cvt_pk_bf16_f32 v20, v216, v217
 v_mfma_f32_16x16x32_bf16 a[160:163], v[232:235], v[192:195], a[160:163]
 v_cvt_pk_bf16_f32 v21, v218, v219
 v_cvt_pk_bf16_f32 v22, v220, v221
 v_cvt_pk_bf16_f32 v23, v222, v223
 v_mfma_f32_16x16x32_bf16 a[164:167], v[232:235], v[196:199], a[164:167]
 v_accvgpr_read_b32 v208, a40
 v_accvgpr_read_b32 v209, a41
 v_accvgpr_read_b32 v210, a42
 v_mfma_f32_16x16x32_bf16 a[168:171], v[232:235], v[200:203], a[168:171]
 s_waitcnt lgkmcnt(2)
 v_accvgpr_read_b32 v211, a43
 v_accvgpr_read_b32 v212, a56
 v_mfma_f32_16x16x32_bf16 a[172:175], v[232:235], v[204:207], a[172:175]
 ds_read_b64_tr_b16 v[232:233], v241 offset:3584
 ds_read_b64_tr_b16 v[234:235], v241 offset:11776
 s_add_u32 m0, s70, 38784
 v_mfma_f32_16x16x32_bf16 a[176:179], v[236:239], v[192:195], a[176:179]
 v_accvgpr_read_b32 v213, a57
 v_accvgpr_read_b32 v214, a58
 v_accvgpr_read_b32 v215, a59
 v_mfma_f32_16x16x32_bf16 a[180:183], v[236:239], v[196:199], a[180:183]
 v_cvt_pk_bf16_f32 v24, v208, v209
 v_cvt_pk_bf16_f32 v25, v210, v211
 v_cvt_pk_bf16_f32 v26, v212, v213
 v_cvt_pk_bf16_f32 v27, v214, v215
 v_accvgpr_read_b32 v216, a44
 v_accvgpr_read_b32 v217, a45
 v_accvgpr_read_b32 v218, a46
 v_accvgpr_read_b32 v219, a47
 v_accvgpr_read_b32 v220, a60
 v_accvgpr_read_b32 v221, a61
 v_accvgpr_read_b32 v222, a62
 v_accvgpr_read_b32 v223, a63
 v_cvt_pk_bf16_f32 v28, v216, v217
 v_cvt_pk_bf16_f32 v29, v218, v219
 v_cvt_pk_bf16_f32 v30, v220, v221
 v_cvt_pk_bf16_f32 v31, v222, v223
 v_mfma_f32_16x16x32_bf16 a[184:187], v[236:239], v[200:203], a[184:187]
 buffer_load_dwordx4 v253, s[36:39], s88 offen offset:128 lds
 s_add_u32 m0, s70, 39808
 v_mfma_f32_16x16x32_bf16 a[188:191], v[236:239], v[204:207], a[188:191]
 ds_read_b64_tr_b16 v[236:237], v242 offset:3584
 ds_read_b64_tr_b16 v[238:239], v242 offset:11776
 v_mfma_f32_16x16x32_bf16 a[192:195], v[224:227], v[192:195], a[192:195]
 v_accvgpr_read_b32 v208, a64
 v_accvgpr_read_b32 v209, a65
 v_mfma_f32_16x16x32_bf16 a[196:199], v[224:227], v[196:199], a[196:199]
 v_accvgpr_read_b32 v210, a66
 v_accvgpr_read_b32 v211, a67
 v_mfma_f32_16x16x32_bf16 a[200:203], v[224:227], v[200:203], a[200:203]
 buffer_load_dwordx4 v253, s[36:39], s89 offen offset:128 lds
 s_waitcnt lgkmcnt(2)
 v_accvgpr_read_b32 v212, a80
 v_mfma_f32_16x16x32_bf16 a[204:207], v[224:227], v[204:207], a[204:207]
 v_accvgpr_read_b32 v213, a81
 v_mbcnt_lo_u32_b32 v249, -1, 0
 v_accvgpr_read_b32 v214, a82
 v_mfma_f32_16x16x32_bf16 a[208:211], v[228:231], v[192:195], a[208:211]
 v_mbcnt_hi_u32_b32 v249, -1, v249
 v_accvgpr_read_b32 v215, a83
 v_lshrrev_b32 v250, 5, v249
 v_mfma_f32_16x16x32_bf16 a[212:215], v[228:231], v[196:199], a[212:215]
 v_cvt_pk_bf16_f32 v32, v208, v209
 v_lshlrev_b32 v241, 9, v250
 v_cvt_pk_bf16_f32 v33, v210, v211
 v_mfma_f32_16x16x32_bf16 a[216:219], v[228:231], v[200:203], a[216:219]
 v_bfe_u32 v250, v249, 2, 3
 v_lshl_add_u32 v241, v250, 6, v241
 v_bfe_u32 v250, v249, 4, 1
 v_lshlrev_b32 v250, 1, v250
 v_bfe_u32 v251, v249, 1, 1
 v_xor_b32 v250, v250, v251
 v_lshl_add_u32 v241, v250, 4, v241
 v_and_b32 v250, 1, v249
 v_lshl_add_u32 v241, v250, 3, v241
 v_add_u32 v241, 98304, v241
 v_add_u32 v241, s71, v241
 v_xor_b32 v242, 32, v241
 s_waitcnt lgkmcnt(0)
 s_waitcnt vmcnt(16)
 s_barrier
 v_mfma_f32_16x16x32_bf16 a[220:223], v[228:231], v[204:207], a[220:223]
 ds_read_b64_tr_b16 v[224:225], v241 offset:0
 ds_read_b64_tr_b16 v[226:227], v241 offset:1024
 ds_read_b64_tr_b16 v[228:229], v242 offset:0
 ds_read_b64_tr_b16 v[230:231], v242 offset:1024
 v_mfma_f32_16x16x32_bf16 a[224:227], v[232:235], v[192:195], a[224:227]
 v_cvt_pk_bf16_f32 v34, v212, v213
 v_cvt_pk_bf16_f32 v35, v214, v215
 v_accvgpr_read_b32 v216, a68
 v_mfma_f32_16x16x32_bf16 a[228:231], v[232:235], v[196:199], a[228:231]
 v_accvgpr_read_b32 v217, a69
 v_accvgpr_read_b32 v218, a70
 v_accvgpr_read_b32 v219, a71
 v_mfma_f32_16x16x32_bf16 a[232:235], v[232:235], v[200:203], a[232:235]
 v_accvgpr_read_b32 v220, a84
 v_accvgpr_read_b32 v221, a85
 v_accvgpr_read_b32 v222, a86
 v_mfma_f32_16x16x32_bf16 a[236:239], v[232:235], v[204:207], a[236:239]
 ds_read_b64_tr_b16 v[232:233], v241 offset:2048
 ds_read_b64_tr_b16 v[234:235], v241 offset:3072
 v_accvgpr_read_b32 v223, a87
 v_mfma_f32_16x16x32_bf16 a[240:243], v[236:239], v[192:195], a[240:243]
 v_cvt_pk_bf16_f32 v36, v216, v217
 v_cvt_pk_bf16_f32 v37, v218, v219
 v_cvt_pk_bf16_f32 v38, v220, v221
 v_mfma_f32_16x16x32_bf16 a[244:247], v[236:239], v[196:199], a[244:247]
 v_cvt_pk_bf16_f32 v39, v222, v223
 v_accvgpr_read_b32 v208, a72
 v_accvgpr_read_b32 v209, a73
 v_mfma_f32_16x16x32_bf16 a[248:251], v[236:239], v[200:203], a[248:251]
 v_accvgpr_read_b32 v210, a74
 v_accvgpr_read_b32 v211, a75
 v_accvgpr_read_b32 v212, a88
 v_mfma_f32_16x16x32_bf16 a[252:255], v[236:239], v[204:207], a[252:255]
 v_accvgpr_read_b32 v213, a89
 v_accvgpr_read_b32 v214, a90
 v_accvgpr_read_b32 v215, a91
 v_cvt_pk_bf16_f32 v40, v208, v209
 v_cvt_pk_bf16_f32 v41, v210, v211
 v_cvt_pk_bf16_f32 v42, v212, v213
 v_cvt_pk_bf16_f32 v43, v214, v215
 v_accvgpr_read_b32 v216, a76
 v_accvgpr_read_b32 v217, a77
 v_accvgpr_read_b32 v218, a78
 v_accvgpr_read_b32 v219, a79
 v_accvgpr_read_b32 v220, a92
 v_accvgpr_read_b32 v221, a93
 v_accvgpr_read_b32 v222, a94
 v_accvgpr_read_b32 v223, a95
 v_cvt_pk_bf16_f32 v44, v216, v217
 v_cvt_pk_bf16_f32 v45, v218, v219
 v_cvt_pk_bf16_f32 v46, v220, v221
 v_cvt_pk_bf16_f32 v47, v222, v223
 ds_read_b64_tr_b16 v[236:237], v242 offset:2048
 ds_read_b64_tr_b16 v[238:239], v242 offset:3072
 s_waitcnt lgkmcnt(6)
 v_mfma_f32_16x16x32_bf16 v[128:131], v[224:227], v[0:3], 0
 v_accvgpr_read_b32 v208, a96
 v_accvgpr_read_b32 v209, a97
 v_mfma_f32_16x16x32_bf16 v[132:135], v[224:227], v[4:7], 0
 v_accvgpr_read_b32 v210, a98
 s_add_u32 m0, s70, 65344
 v_mfma_f32_16x16x32_bf16 v[136:139], v[224:227], v[8:11], 0
 s_waitcnt lgkmcnt(4)
 v_accvgpr_read_b32 v211, a99
 v_mfma_f32_16x16x32_bf16 v[140:143], v[224:227], v[12:15], 0
 ds_read_b64_tr_b16 v[224:225], v241 offset:4096
 ds_read_b64_tr_b16 v[226:227], v241 offset:5120
 v_mfma_f32_16x16x32_bf16 v[144:147], v[228:231], v[0:3], 0
 v_accvgpr_read_b32 v212, a112
 v_accvgpr_read_b32 v213, a113
 v_mfma_f32_16x16x32_bf16 v[148:151], v[228:231], v[4:7], 0
 v_accvgpr_read_b32 v214, a114
 v_accvgpr_read_b32 v215, a115
 v_mfma_f32_16x16x32_bf16 v[152:155], v[228:231], v[8:11], 0
 s_waitcnt lgkmcnt(4)
 v_cvt_pk_bf16_f32 v48, v208, v209
 buffer_load_dwordx4 v253, s[36:39], s82 offen offset:192 lds
 v_mfma_f32_16x16x32_bf16 v[156:159], v[228:231], v[12:15], 0
 ds_read_b64_tr_b16 v[228:229], v242 offset:4096
 ds_read_b64_tr_b16 v[230:231], v242 offset:5120
 v_cvt_pk_bf16_f32 v49, v210, v211
 v_mfma_f32_16x16x32_bf16 v[128:131], v[232:235], v[16:19], v[128:131]
 v_cvt_pk_bf16_f32 v50, v212, v213
 v_cvt_pk_bf16_f32 v51, v214, v215
 v_accvgpr_read_b32 v216, a100
 v_mfma_f32_16x16x32_bf16 v[132:135], v[232:235], v[20:23], v[132:135]
 v_accvgpr_read_b32 v217, a101
 v_accvgpr_read_b32 v218, a102
 s_add_u32 m0, s70, 66368
 v_mfma_f32_16x16x32_bf16 v[136:139], v[232:235], v[24:27], v[136:139]
 s_waitcnt lgkmcnt(2)
 v_accvgpr_read_b32 v219, a103
 v_accvgpr_read_b32 v220, a116
 v_mfma_f32_16x16x32_bf16 v[140:143], v[232:235], v[28:31], v[140:143]
 ds_read_b64_tr_b16 v[232:233], v241 offset:6144
 ds_read_b64_tr_b16 v[234:235], v241 offset:7168
 v_accvgpr_read_b32 v221, a117
 v_mfma_f32_16x16x32_bf16 v[144:147], v[236:239], v[16:19], v[144:147]
 v_accvgpr_read_b32 v222, a118
 v_accvgpr_read_b32 v223, a119
 v_cvt_pk_bf16_f32 v52, v216, v217
 v_mfma_f32_16x16x32_bf16 v[148:151], v[236:239], v[20:23], v[148:151]
 buffer_load_dwordx4 v253, s[36:39], s83 offen offset:192 lds
 v_cvt_pk_bf16_f32 v53, v218, v219
 v_cvt_pk_bf16_f32 v54, v220, v221
 v_mfma_f32_16x16x32_bf16 v[152:155], v[236:239], v[24:27], v[152:155]
 v_cvt_pk_bf16_f32 v55, v222, v223
 v_accvgpr_read_b32 v208, a104
 v_mfma_f32_16x16x32_bf16 v[156:159], v[236:239], v[28:31], v[156:159]
 ds_read_b64_tr_b16 v[236:237], v242 offset:6144
 ds_read_b64_tr_b16 v[238:239], v242 offset:7168
 v_accvgpr_read_b32 v209, a105
 v_mfma_f32_16x16x32_bf16 v[128:131], v[224:227], v[32:35], v[128:131]
 v_accvgpr_read_b32 v210, a106
 v_accvgpr_read_b32 v211, a107
 s_add_u32 m0, s70, 67392
 v_mfma_f32_16x16x32_bf16 v[132:135], v[224:227], v[36:39], v[132:135]
 v_accvgpr_read_b32 v212, a120
 v_accvgpr_read_b32 v213, a121
 v_accvgpr_read_b32 v214, a122
 v_mfma_f32_16x16x32_bf16 v[136:139], v[224:227], v[40:43], v[136:139]
 s_waitcnt lgkmcnt(2)
 v_accvgpr_read_b32 v215, a123
 v_cvt_pk_bf16_f32 v56, v208, v209
 v_mfma_f32_16x16x32_bf16 v[140:143], v[224:227], v[44:47], v[140:143]
 ds_read_b64_tr_b16 v[224:225], v241 offset:8192
 ds_read_b64_tr_b16 v[226:227], v241 offset:9216
 v_cvt_pk_bf16_f32 v57, v210, v211
 v_mfma_f32_16x16x32_bf16 v[144:147], v[228:231], v[32:35], v[144:147]
 buffer_load_dwordx4 v253, s[36:39], s84 offen offset:192 lds
 v_cvt_pk_bf16_f32 v58, v212, v213
 v_cvt_pk_bf16_f32 v59, v214, v215
 v_mfma_f32_16x16x32_bf16 v[148:151], v[228:231], v[36:39], v[148:151]
 v_accvgpr_read_b32 v216, a108
 v_accvgpr_read_b32 v217, a109
 v_accvgpr_read_b32 v218, a110
 v_mfma_f32_16x16x32_bf16 v[152:155], v[228:231], v[40:43], v[152:155]
 v_accvgpr_read_b32 v219, a111
 s_add_u32 m0, s70, 68416
 v_accvgpr_read_b32 v220, a124
 v_mfma_f32_16x16x32_bf16 v[156:159], v[228:231], v[44:47], v[156:159]
 v_accvgpr_read_b32 v221, a125
 v_accvgpr_read_b32 v222, a126
 v_accvgpr_read_b32 v223, a127
 v_cvt_pk_bf16_f32 v60, v216, v217
 v_cvt_pk_bf16_f32 v61, v218, v219
 v_cvt_pk_bf16_f32 v62, v220, v221
 v_cvt_pk_bf16_f32 v63, v222, v223
 ds_read_b64_tr_b16 v[228:229], v242 offset:8192
 ds_read_b64_tr_b16 v[230:231], v242 offset:9216
 v_mfma_f32_16x16x32_bf16 v[128:131], v[232:235], v[48:51], v[128:131]
 buffer_load_dwordx4 v253, s[36:39], s85 offen offset:192 lds
 v_accvgpr_read_b32 v208, a128
 v_mfma_f32_16x16x32_bf16 v[132:135], v[232:235], v[52:55], v[132:135]
 v_accvgpr_read_b32 v209, a129
 v_accvgpr_read_b32 v210, a130
 v_mfma_f32_16x16x32_bf16 v[136:139], v[232:235], v[56:59], v[136:139]
 s_waitcnt lgkmcnt(2)
 v_accvgpr_read_b32 v211, a131
 v_mfma_f32_16x16x32_bf16 v[140:143], v[232:235], v[60:63], v[140:143]
 ds_read_b64_tr_b16 v[232:233], v241 offset:10240
 ds_read_b64_tr_b16 v[234:235], v241 offset:11264
 v_accvgpr_read_b32 v212, a144
 v_mfma_f32_16x16x32_bf16 v[144:147], v[236:239], v[48:51], v[144:147]
 v_accvgpr_read_b32 v213, a145
 v_accvgpr_read_b32 v214, a146
 v_accvgpr_read_b32 v215, a147
 v_mfma_f32_16x16x32_bf16 v[148:151], v[236:239], v[52:55], v[148:151]
 v_cvt_pk_bf16_f32 v64, v208, v209
 v_cvt_pk_bf16_f32 v65, v210, v211
 v_cvt_pk_bf16_f32 v66, v212, v213
 v_mfma_f32_16x16x32_bf16 v[152:155], v[236:239], v[56:59], v[152:155]
 v_cvt_pk_bf16_f32 v67, v214, v215
 v_accvgpr_read_b32 v216, a132
 s_add_u32 m0, s70, 69440
 v_mfma_f32_16x16x32_bf16 v[156:159], v[236:239], v[60:63], v[156:159]
 v_accvgpr_read_b32 v217, a133
 v_accvgpr_read_b32 v218, a134
 v_accvgpr_read_b32 v219, a135
 v_accvgpr_read_b32 v220, a148
 v_accvgpr_read_b32 v221, a149
 v_accvgpr_read_b32 v222, a150
 v_accvgpr_read_b32 v223, a151
 v_cvt_pk_bf16_f32 v68, v216, v217
 v_cvt_pk_bf16_f32 v69, v218, v219
 v_cvt_pk_bf16_f32 v70, v220, v221
 v_cvt_pk_bf16_f32 v71, v222, v223
 v_accvgpr_read_b32 v208, a136
 v_accvgpr_read_b32 v209, a137
 v_accvgpr_read_b32 v210, a138
 v_accvgpr_read_b32 v211, a139
 v_accvgpr_read_b32 v212, a152
 v_accvgpr_read_b32 v213, a153
 v_accvgpr_read_b32 v214, a154
 v_accvgpr_read_b32 v215, a155
 v_cvt_pk_bf16_f32 v72, v208, v209
 v_cvt_pk_bf16_f32 v73, v210, v211
 v_cvt_pk_bf16_f32 v74, v212, v213
 v_cvt_pk_bf16_f32 v75, v214, v215
 v_accvgpr_read_b32 v216, a140
 v_accvgpr_read_b32 v217, a141
 v_accvgpr_read_b32 v218, a142
 v_accvgpr_read_b32 v219, a143
 v_accvgpr_read_b32 v220, a156
 v_accvgpr_read_b32 v221, a157
 v_accvgpr_read_b32 v222, a158
 v_accvgpr_read_b32 v223, a159
 v_cvt_pk_bf16_f32 v76, v216, v217
 v_cvt_pk_bf16_f32 v77, v218, v219
 v_cvt_pk_bf16_f32 v78, v220, v221
 v_cvt_pk_bf16_f32 v79, v222, v223
 ds_read_b64_tr_b16 v[236:237], v242 offset:10240
 ds_read_b64_tr_b16 v[238:239], v242 offset:11264
 v_mfma_f32_16x16x32_bf16 v[128:131], v[224:227], v[64:67], v[128:131]
 buffer_load_dwordx4 v253, s[36:39], s86 offen offset:192 lds
 v_accvgpr_read_b32 v208, a160
 v_mfma_f32_16x16x32_bf16 v[132:135], v[224:227], v[68:71], v[132:135]
 v_accvgpr_read_b32 v209, a161
 s_add_u32 m0, s70, 70464
 v_mfma_f32_16x16x32_bf16 v[136:139], v[224:227], v[72:75], v[136:139]
 s_waitcnt lgkmcnt(2)
 v_accvgpr_read_b32 v210, a162
 v_mfma_f32_16x16x32_bf16 v[140:143], v[224:227], v[76:79], v[140:143]
 ds_read_b64_tr_b16 v[224:225], v241 offset:12288
 ds_read_b64_tr_b16 v[226:227], v241 offset:13312
 v_accvgpr_read_b32 v211, a163
 v_mfma_f32_16x16x32_bf16 v[144:147], v[228:231], v[64:67], v[144:147]
 v_accvgpr_read_b32 v212, a176
 v_accvgpr_read_b32 v213, a177
 v_accvgpr_read_b32 v214, a178
 v_mfma_f32_16x16x32_bf16 v[148:151], v[228:231], v[68:71], v[148:151]
 v_accvgpr_read_b32 v215, a179
 v_cvt_pk_bf16_f32 v80, v208, v209
 v_cvt_pk_bf16_f32 v81, v210, v211
 v_mfma_f32_16x16x32_bf16 v[152:155], v[228:231], v[72:75], v[152:155]
 v_cvt_pk_bf16_f32 v82, v212, v213
 v_cvt_pk_bf16_f32 v83, v214, v215
 v_accvgpr_read_b32 v216, a164
 v_mfma_f32_16x16x32_bf16 v[156:159], v[228:231], v[76:79], v[156:159]
 v_accvgpr_read_b32 v217, a165
 v_accvgpr_read_b32 v218, a166
 v_accvgpr_read_b32 v219, a167
 v_accvgpr_read_b32 v220, a180
 v_accvgpr_read_b32 v221, a181
 v_accvgpr_read_b32 v222, a182
 v_accvgpr_read_b32 v223, a183
 v_cvt_pk_bf16_f32 v84, v216, v217
 v_cvt_pk_bf16_f32 v85, v218, v219
 v_cvt_pk_bf16_f32 v86, v220, v221
 v_cvt_pk_bf16_f32 v87, v222, v223
 v_accvgpr_read_b32 v208, a168
 v_accvgpr_read_b32 v209, a169
 v_accvgpr_read_b32 v210, a170
 v_accvgpr_read_b32 v211, a171
 v_accvgpr_read_b32 v212, a184
 v_accvgpr_read_b32 v213, a185
 v_accvgpr_read_b32 v214, a186
 v_accvgpr_read_b32 v215, a187
 v_cvt_pk_bf16_f32 v88, v208, v209
 v_cvt_pk_bf16_f32 v89, v210, v211
 v_cvt_pk_bf16_f32 v90, v212, v213
 v_cvt_pk_bf16_f32 v91, v214, v215
 v_accvgpr_read_b32 v216, a172
 v_accvgpr_read_b32 v217, a173
 v_accvgpr_read_b32 v218, a174
 v_accvgpr_read_b32 v219, a175
 v_accvgpr_read_b32 v220, a188
 v_accvgpr_read_b32 v221, a189
 v_accvgpr_read_b32 v222, a190
 v_accvgpr_read_b32 v223, a191
 v_cvt_pk_bf16_f32 v92, v216, v217
 v_cvt_pk_bf16_f32 v93, v218, v219
 v_cvt_pk_bf16_f32 v94, v220, v221
 v_cvt_pk_bf16_f32 v95, v222, v223
 ds_read_b64_tr_b16 v[228:229], v242 offset:12288
 ds_read_b64_tr_b16 v[230:231], v242 offset:13312
 v_mfma_f32_16x16x32_bf16 v[128:131], v[232:235], v[80:83], v[128:131]
 buffer_load_dwordx4 v253, s[36:39], s87 offen offset:192 lds
 s_add_u32 m0, s70, 71488
 v_mfma_f32_16x16x32_bf16 v[132:135], v[232:235], v[84:87], v[132:135]
 v_accvgpr_read_b32 v208, a192
 v_accvgpr_read_b32 v209, a193
 v_mfma_f32_16x16x32_bf16 v[136:139], v[232:235], v[88:91], v[136:139]
 s_waitcnt lgkmcnt(2)
 v_accvgpr_read_b32 v210, a194
 v_mfma_f32_16x16x32_bf16 v[140:143], v[232:235], v[92:95], v[140:143]
 ds_read_b64_tr_b16 v[232:233], v241 offset:14336
 ds_read_b64_tr_b16 v[234:235], v241 offset:15360
 v_accvgpr_read_b32 v211, a195
 v_mfma_f32_16x16x32_bf16 v[144:147], v[236:239], v[80:83], v[144:147]
 v_accvgpr_read_b32 v212, a208
 v_accvgpr_read_b32 v213, a209
 v_accvgpr_read_b32 v214, a210
 v_mfma_f32_16x16x32_bf16 v[148:151], v[236:239], v[84:87], v[148:151]
 v_accvgpr_read_b32 v215, a211
 v_cvt_pk_bf16_f32 v96, v208, v209
 v_cvt_pk_bf16_f32 v97, v210, v211
 v_mfma_f32_16x16x32_bf16 v[152:155], v[236:239], v[88:91], v[152:155]
 buffer_load_dwordx4 v253, s[36:39], s88 offen offset:192 lds
 v_cvt_pk_bf16_f32 v98, v212, v213
 v_cvt_pk_bf16_f32 v99, v214, v215
 v_mfma_f32_16x16x32_bf16 v[156:159], v[236:239], v[92:95], v[156:159]
 v_accvgpr_read_b32 v216, a196
 v_accvgpr_read_b32 v217, a197
 v_accvgpr_read_b32 v218, a198
 v_accvgpr_read_b32 v219, a199
 v_accvgpr_read_b32 v220, a212
 v_accvgpr_read_b32 v221, a213
 v_accvgpr_read_b32 v222, a214
 v_accvgpr_read_b32 v223, a215
 v_cvt_pk_bf16_f32 v100, v216, v217
 v_cvt_pk_bf16_f32 v101, v218, v219
 v_cvt_pk_bf16_f32 v102, v220, v221
 v_cvt_pk_bf16_f32 v103, v222, v223
 v_accvgpr_read_b32 v208, a200
 v_accvgpr_read_b32 v209, a201
 v_accvgpr_read_b32 v210, a202
 v_accvgpr_read_b32 v211, a203
 v_accvgpr_read_b32 v212, a216
 v_accvgpr_read_b32 v213, a217
 v_accvgpr_read_b32 v214, a218
 v_accvgpr_read_b32 v215, a219
 v_cvt_pk_bf16_f32 v104, v208, v209
 v_cvt_pk_bf16_f32 v105, v210, v211
 v_cvt_pk_bf16_f32 v106, v212, v213
 v_cvt_pk_bf16_f32 v107, v214, v215
 v_accvgpr_read_b32 v216, a204
 v_accvgpr_read_b32 v217, a205
 v_accvgpr_read_b32 v218, a206
 v_accvgpr_read_b32 v219, a207
 v_accvgpr_read_b32 v220, a220
 v_accvgpr_read_b32 v221, a221
 v_accvgpr_read_b32 v222, a222
 v_accvgpr_read_b32 v223, a223
 v_cvt_pk_bf16_f32 v108, v216, v217
 v_cvt_pk_bf16_f32 v109, v218, v219
 v_cvt_pk_bf16_f32 v110, v220, v221
 v_cvt_pk_bf16_f32 v111, v222, v223
 ds_read_b64_tr_b16 v[236:237], v242 offset:14336
 ds_read_b64_tr_b16 v[238:239], v242 offset:15360
 v_mfma_f32_16x16x32_bf16 v[128:131], v[224:227], v[96:99], v[128:131]
 s_add_u32 m0, s70, 72512
 s_nop 0
 buffer_load_dwordx4 v253, s[36:39], s89 offen offset:192 lds
 v_mfma_f32_16x16x32_bf16 v[132:135], v[224:227], v[100:103], v[132:135]
 v_accvgpr_read_b32 v208, a224
 v_subrev_u32 v241, 98304, v241
 v_mfma_f32_16x16x32_bf16 v[136:139], v[224:227], v[104:107], v[136:139]
 s_waitcnt lgkmcnt(2)
 v_accvgpr_read_b32 v209, a225
 v_accvgpr_read_b32 v210, a226
 v_mfma_f32_16x16x32_bf16 v[140:143], v[224:227], v[108:111], v[140:143]
 v_accvgpr_read_b32 v211, a227
 v_accvgpr_read_b32 v212, a240
 v_accvgpr_read_b32 v213, a241
 v_mfma_f32_16x16x32_bf16 v[144:147], v[228:231], v[96:99], v[144:147]
 v_accvgpr_read_b32 v214, a242
 v_accvgpr_read_b32 v215, a243
 v_cvt_pk_bf16_f32 v112, v208, v209
 v_mfma_f32_16x16x32_bf16 v[148:151], v[228:231], v[100:103], v[148:151]
 v_cvt_pk_bf16_f32 v113, v210, v211
 v_cvt_pk_bf16_f32 v114, v212, v213
 v_cvt_pk_bf16_f32 v115, v214, v215
 v_mfma_f32_16x16x32_bf16 v[152:155], v[228:231], v[104:107], v[152:155]
 v_subrev_u32 v242, 98304, v242
 s_waitcnt lgkmcnt(0)
 s_waitcnt vmcnt(16)
 s_barrier
 v_mfma_f32_16x16x32_bf16 v[156:159], v[228:231], v[108:111], v[156:159]
 v_accvgpr_read_b32 v216, a228
 v_accvgpr_read_b32 v217, a229
 v_accvgpr_read_b32 v218, a230
 v_accvgpr_read_b32 v219, a231
 v_accvgpr_read_b32 v220, a244
 v_accvgpr_read_b32 v221, a245
 v_accvgpr_read_b32 v222, a246
 v_accvgpr_read_b32 v223, a247
 v_cvt_pk_bf16_f32 v116, v216, v217
 v_cvt_pk_bf16_f32 v117, v218, v219
 v_cvt_pk_bf16_f32 v118, v220, v221
 v_cvt_pk_bf16_f32 v119, v222, v223
 v_accvgpr_read_b32 v208, a232
 v_accvgpr_read_b32 v209, a233
 v_accvgpr_read_b32 v210, a234
 v_accvgpr_read_b32 v211, a235
 v_accvgpr_read_b32 v212, a248
 v_accvgpr_read_b32 v213, a249
 v_accvgpr_read_b32 v214, a250
 v_accvgpr_read_b32 v215, a251
 v_cvt_pk_bf16_f32 v120, v208, v209
 v_cvt_pk_bf16_f32 v121, v210, v211
 v_cvt_pk_bf16_f32 v122, v212, v213
 v_cvt_pk_bf16_f32 v123, v214, v215
 v_accvgpr_read_b32 v216, a236
 v_accvgpr_read_b32 v217, a237
 v_accvgpr_read_b32 v218, a238
 v_accvgpr_read_b32 v219, a239
 v_accvgpr_read_b32 v220, a252
 v_accvgpr_read_b32 v221, a253
 v_accvgpr_read_b32 v222, a254
 v_accvgpr_read_b32 v223, a255
 v_cvt_pk_bf16_f32 v124, v216, v217
 v_cvt_pk_bf16_f32 v125, v218, v219
 v_cvt_pk_bf16_f32 v126, v220, v221
 v_cvt_pk_bf16_f32 v127, v222, v223
 ds_read_b64_tr_b16 v[224:225], v241 offset:0
 ds_read_b64_tr_b16 v[226:227], v241 offset:1024
 ds_read_b64_tr_b16 v[228:229], v242 offset:0
 ds_read_b64_tr_b16 v[230:231], v242 offset:1024
 v_mfma_f32_16x16x32_bf16 v[128:131], v[232:235], v[112:115], v[128:131]
 v_mov_b32 v249, v244
 v_mov_b32 v250, v245
 v_mfma_f32_16x16x32_bf16 v[132:135], v[232:235], v[116:119], v[132:135]
 v_mov_b32 v251, v246
 v_mov_b32 v252, v247
 v_mfma_f32_16x16x32_bf16 v[136:139], v[232:235], v[120:123], v[136:139]
 v_permlane16_swap_b32 v244, v249
 v_permlane16_swap_b32 v245, v250
 v_mfma_f32_16x16x32_bf16 v[140:143], v[232:235], v[124:127], v[140:143]
 ds_read_b64_tr_b16 v[232:233], v241 offset:2048
 ds_read_b64_tr_b16 v[234:235], v241 offset:3072
 v_permlane16_swap_b32 v246, v251
 v_mfma_f32_16x16x32_bf16 v[144:147], v[236:239], v[112:115], v[144:147]
 v_permlane16_swap_b32 v247, v252
 v_add_f32 v244, v244, v249
 v_add_f32 v245, v245, v250
 v_mfma_f32_16x16x32_bf16 v[148:151], v[236:239], v[116:119], v[148:151]
 v_add_f32 v246, v246, v251
 v_add_f32 v247, v247, v252
 v_mov_b32 v249, v244
 v_mfma_f32_16x16x32_bf16 v[152:155], v[236:239], v[120:123], v[152:155]
 v_mov_b32 v250, v245
 v_mov_b32 v251, v246
 v_mov_b32 v252, v247
 v_mfma_f32_16x16x32_bf16 v[156:159], v[236:239], v[124:127], v[156:159]
 v_permlane32_swap_b32 v244, v249
 v_permlane32_swap_b32 v245, v250
 v_permlane32_swap_b32 v246, v251
 v_permlane32_swap_b32 v247, v252
 v_add_f32 v244, v244, v249
 v_add_f32 v245, v245, v250
 v_add_f32 v246, v246, v251
 v_add_f32 v247, v247, v252
 v_rcp_f32 v249, v244
 v_rcp_f32 v250, v245
 v_rcp_f32 v251, v246
 v_rcp_f32 v252, v247
 v_fma_f32 v244, -v244, v249, 2.0
 v_fma_f32 v245, -v245, v250, 2.0
 v_fma_f32 v246, -v246, v251, 2.0
 v_fma_f32 v247, -v247, v252, 2.0
 v_mul_f32 v244, v244, v249
 v_mul_f32 v245, v245, v250
 v_mul_f32 v246, v246, v251
 v_mul_f32 v247, v247, v252
 s_lshl_b32 s52, s48, 12
 s_add_u32 s52, s52, 131072
 v_add_u32 v240, s52, v243
 v_xor_b32 v252, 0x2000, v240
 ds_read_b64_tr_b16 v[236:237], v242 offset:2048
 ds_read_b64_tr_b16 v[238:239], v242 offset:3072
 s_waitcnt lgkmcnt(6)
 v_mfma_f32_16x16x32_bf16 v[160:163], v[224:227], v[0:3], 0
 v_mfma_f32_16x16x32_bf16 v[164:167], v[224:227], v[4:7], 0
 s_add_u32 m0, s70, 98048
 v_mfma_f32_16x16x32_bf16 v[168:171], v[224:227], v[8:11], 0
 s_waitcnt lgkmcnt(4)
 s_lshr_b32 s54, s49, 1
 v_mfma_f32_16x16x32_bf16 v[172:175], v[224:227], v[12:15], 0
 ds_read_b64_tr_b16 v[224:225], v241 offset:4096
 ds_read_b64_tr_b16 v[226:227], v241 offset:5120
 v_mfma_f32_16x16x32_bf16 v[176:179], v[228:231], v[0:3], 0
 s_lshl_b32 s55, s81, 3
 ds_write_b64 v240, v[246:247] offset:16384
 v_mfma_f32_16x16x32_bf16 v[180:183], v[228:231], v[4:7], 0
 buffer_load_dwordx4 v253, s[36:39], s82 offen offset:256 lds
 s_add_u32 s55, s55, s54
 v_mfma_f32_16x16x32_bf16 v[184:187], v[228:231], v[8:11], 0
 s_waitcnt lgkmcnt(5)
 s_mul_i32 s94, s50, 1835008
 v_mfma_f32_16x16x32_bf16 v[188:191], v[228:231], v[12:15], 0
 ds_read_b64_tr_b16 v[228:229], v242 offset:4096
 ds_read_b64_tr_b16 v[230:231], v242 offset:5120
 v_mfma_f32_16x16x32_bf16 v[160:163], v[232:235], v[16:19], v[160:163]
 s_add_u32 m0, s70, 99072
 v_mfma_f32_16x16x32_bf16 v[164:167], v[232:235], v[20:23], v[164:167]
 s_add_u32 s24, s18, s94
 s_addc_u32 s25, s19, 0
 v_mfma_f32_16x16x32_bf16 v[168:171], v[232:235], v[24:27], v[168:171]
 s_waitcnt lgkmcnt(3)
 ds_write_b128 v240, v[136:139] offset:0
 v_mfma_f32_16x16x32_bf16 v[172:175], v[232:235], v[28:31], v[172:175]
 ds_read_b64_tr_b16 v[232:233], v241 offset:6144
 ds_read_b64_tr_b16 v[234:235], v241 offset:7168
 v_mfma_f32_16x16x32_bf16 v[176:179], v[236:239], v[16:19], v[176:179]
 s_and_b32 s25, s25, 0xffff
 buffer_load_dwordx4 v253, s[36:39], s83 offen offset:256 lds
 v_mfma_f32_16x16x32_bf16 v[180:183], v[236:239], v[20:23], v[180:183]
 s_mov_b32 s26, 0
 s_mov_b32 s27, 0x20000
 v_mfma_f32_16x16x32_bf16 v[184:187], v[236:239], v[24:27], v[184:187]
 s_add_u32 m0, s70, 100096
 s_lshl_b32 s94, s50, 1
 v_mfma_f32_16x16x32_bf16 v[188:191], v[236:239], v[28:31], v[188:191]
 ds_read_b64_tr_b16 v[236:237], v242 offset:6144
 ds_read_b64_tr_b16 v[238:239], v242 offset:7168
 v_mfma_f32_16x16x32_bf16 v[160:163], v[224:227], v[32:35], v[160:163]
 s_add_u32 s94, s94, s81
 ds_write_b128 v240, v[152:155] offset:1024
 v_mfma_f32_16x16x32_bf16 v[164:167], v[224:227], v[36:39], v[164:167]
 buffer_load_dwordx4 v253, s[36:39], s84 offen offset:256 lds
 s_lshl_b32 s94, s94, 10
 v_mfma_f32_16x16x32_bf16 v[168:171], v[224:227], v[40:43], v[168:171]
 s_waitcnt lgkmcnt(3)
 s_add_u32 s94, s94, 29360128
 v_mfma_f32_16x16x32_bf16 v[172:175], v[224:227], v[44:47], v[172:175]
 ds_read_b64_tr_b16 v[224:225], v241 offset:8192
 ds_read_b64_tr_b16 v[226:227], v241 offset:9216
 v_mfma_f32_16x16x32_bf16 v[176:179], v[228:231], v[32:35], v[176:179]
 s_add_u32 s28, s18, s94
 s_addc_u32 s29, s19, 0
 v_mfma_f32_16x16x32_bf16 v[180:183], v[228:231], v[36:39], v[180:183]
 s_add_u32 m0, s70, 101120
 v_mfma_f32_16x16x32_bf16 v[184:187], v[228:231], v[40:43], v[184:187]
 s_and_b32 s29, s29, 0xffff
 buffer_load_dwordx4 v253, s[36:39], s85 offen offset:256 lds
 v_mfma_f32_16x16x32_bf16 v[188:191], v[228:231], v[44:47], v[188:191]
 ds_read_b64_tr_b16 v[228:229], v242 offset:8192
 ds_read_b64_tr_b16 v[230:231], v242 offset:9216
 v_mfma_f32_16x16x32_bf16 v[160:163], v[232:235], v[48:51], v[160:163]
 s_mov_b32 s30, 1024
 ds_write_b128 v240, v[140:143] offset:2048
 v_mfma_f32_16x16x32_bf16 v[164:167], v[232:235], v[52:55], v[164:167]
 s_mov_b32 s31, 0x20000
 v_mfma_f32_16x16x32_bf16 v[168:171], v[232:235], v[56:59], v[168:171]
 s_waitcnt lgkmcnt(3)
 s_add_u32 m0, s70, 102144
 v_mfma_f32_16x16x32_bf16 v[172:175], v[232:235], v[60:63], v[172:175]
 ds_read_b64_tr_b16 v[232:233], v241 offset:10240
 ds_read_b64_tr_b16 v[234:235], v241 offset:11264
 v_mfma_f32_16x16x32_bf16 v[176:179], v[236:239], v[48:51], v[176:179]
 s_lshl_b32 s95, s54, 7
 s_add_u32 s94, s94, s95
 v_mfma_f32_16x16x32_bf16 v[180:183], v[236:239], v[52:55], v[180:183]
 s_add_u32 s20, s18, s94
 s_addc_u32 s21, s19, 0
 v_mfma_f32_16x16x32_bf16 v[184:187], v[236:239], v[56:59], v[184:187]
 buffer_load_dwordx4 v253, s[36:39], s86 offen offset:256 lds
 v_mfma_f32_16x16x32_bf16 v[188:191], v[236:239], v[60:63], v[188:191]
 ds_read_b64_tr_b16 v[236:237], v242 offset:10240
 ds_read_b64_tr_b16 v[238:239], v242 offset:11264
 v_mfma_f32_16x16x32_bf16 v[160:163], v[224:227], v[64:67], v[160:163]
 s_and_b32 s21, s21, 0xffff
 s_add_u32 m0, s70, 103168
 v_mfma_f32_16x16x32_bf16 v[164:167], v[224:227], v[68:71], v[164:167]
 ds_write_b128 v240, v[156:159] offset:3072
 s_mov_b32 s22, 0
 v_mfma_f32_16x16x32_bf16 v[168:171], v[224:227], v[72:75], v[168:171]
 s_waitcnt lgkmcnt(3)
 v_mul_f32 v192, v128, v244
 v_mfma_f32_16x16x32_bf16 v[172:175], v[224:227], v[76:79], v[172:175]
 ds_read_b64_tr_b16 v[224:225], v241 offset:12288
 ds_read_b64_tr_b16 v[226:227], v241 offset:13312
 v_mfma_f32_16x16x32_bf16 v[176:179], v[228:231], v[64:67], v[176:179]
 s_mov_b32 s23, 0x20000
 v_mul_f32 v193, v129, v244
 v_mfma_f32_16x16x32_bf16 v[180:183], v[228:231], v[68:71], v[180:183]
 buffer_load_dwordx4 v253, s[36:39], s87 offen offset:256 lds
 v_mfma_f32_16x16x32_bf16 v[184:187], v[228:231], v[72:75], v[184:187]
 s_cmp_eq_u32 s48, 0
 s_cselect_b32 s22, 128, 0
 v_mfma_f32_16x16x32_bf16 v[188:191], v[228:231], v[76:79], v[188:191]
 ds_read_b64_tr_b16 v[228:229], v242 offset:12288
 ds_read_b64_tr_b16 v[230:231], v242 offset:13312
 v_mul_f32 v194, v130, v244
 v_mfma_f32_16x16x32_bf16 v[160:163], v[232:235], v[80:83], v[160:163]
 s_mov_b32 s94, 0
 s_add_u32 m0, s70, 104192
 v_mfma_f32_16x16x32_bf16 v[164:167], v[232:235], v[84:87], v[164:167]
 v_mul_f32 v195, v131, v244
 v_mfma_f32_16x16x32_bf16 v[168:171], v[232:235], v[88:91], v[168:171]
 s_waitcnt lgkmcnt(2)
 s_add_u32 s32, s14, s94
 s_addc_u32 s33, s15, 0
 v_mfma_f32_16x16x32_bf16 v[172:175], v[232:235], v[92:95], v[172:175]
 ds_read_b64_tr_b16 v[232:233], v241 offset:14336
 ds_read_b64_tr_b16 v[234:235], v241 offset:15360
 v_mul_f32 v196, v144, v244
 v_mfma_f32_16x16x32_bf16 v[176:179], v[236:239], v[80:83], v[176:179]
 buffer_load_dwordx4 v253, s[36:39], s88 offen offset:256 lds
 s_and_b32 s33, s33, 0xffff
 v_mfma_f32_16x16x32_bf16 v[180:183], v[236:239], v[84:87], v[180:183]
 v_mul_f32 v197, v145, v244
 s_mov_b32 s34, 0
 v_mfma_f32_16x16x32_bf16 v[184:187], v[236:239], v[88:91], v[184:187]
 v_mul_f32 v198, v146, v244
 s_add_u32 m0, s70, 105216
 v_mfma_f32_16x16x32_bf16 v[188:191], v[236:239], v[92:95], v[188:191]
 ds_read_b64_tr_b16 v[236:237], v242 offset:14336
 ds_read_b64_tr_b16 v[238:239], v242 offset:15360
 s_mov_b32 s35, 0x20000
 v_mfma_f32_16x16x32_bf16 v[160:163], v[224:227], v[96:99], v[160:163]
 s_cmp_eq_u32 s55, 15
 s_cselect_b32 s62, 0, 1835008
 s_cselect_b32 s63, 0, 3440640
 v_mfma_f32_16x16x32_bf16 v[164:167], v[224:227], v[100:103], v[164:167]
 v_mul_f32 v199, v147, v244
 buffer_load_dwordx4 v253, s[36:39], s89 offen offset:256 lds
 v_mfma_f32_16x16x32_bf16 v[168:171], v[224:227], v[104:107], v[168:171]
 s_waitcnt lgkmcnt(2)
 v_add_u32 v241, 32768, v241
 v_mfma_f32_16x16x32_bf16 v[172:175], v[224:227], v[108:111], v[172:175]
 v_mul_f32 v200, v132, v245
 s_mov_b32 s67, 0
 v_mfma_f32_16x16x32_bf16 v[176:179], v[228:231], v[96:99], v[176:179]
 v_mul_f32 v201, v133, v245
 v_add_u32 v242, 32768, v242
 v_mfma_f32_16x16x32_bf16 v[180:183], v[228:231], v[100:103], v[180:183]
 s_add_u32 s98, s98, 1000
 s_addc_u32 s99, s99, 0
 v_mfma_f32_16x16x32_bf16 v[184:187], v[228:231], v[104:107], v[184:187]
 s_waitcnt lgkmcnt(0)
 s_waitcnt vmcnt(16)
 s_barrier
 v_mfma_f32_16x16x32_bf16 v[188:191], v[228:231], v[108:111], v[188:191]
 ds_read_b64 v[246:247], v252 offset:16384
 ds_read_b64_tr_b16 v[224:225], v241 offset:0
 ds_read_b64_tr_b16 v[226:227], v241 offset:1024
 ds_read_b64_tr_b16 v[228:229], v242 offset:0
 ds_read_b64_tr_b16 v[230:231], v242 offset:1024
 v_mfma_f32_16x16x32_bf16 v[160:163], v[232:235], v[112:115], v[160:163]
 v_mul_f32 v202, v134, v245
 s_add_u32 s100, s98, 0x1000000
 s_addc_u32 s101, s99, 0
 v_mfma_f32_16x16x32_bf16 v[164:167], v[232:235], v[116:119], v[164:167]
 v_mul_f32 v203, v135, v245
 ds_read_b128 v[208:211], v252 offset:0
 v_mfma_f32_16x16x32_bf16 v[168:171], v[232:235], v[120:123], v[168:171]
 v_mul_f32 v204, v148, v245
 s_mul_i32 s53, s55, 14
 v_mfma_f32_16x16x32_bf16 v[172:175], v[232:235], v[124:127], v[172:175]
 ds_read_b64_tr_b16 v[232:233], v241 offset:2048
 ds_read_b64_tr_b16 v[234:235], v241 offset:3072
 v_mfma_f32_16x16x32_bf16 v[176:179], v[236:239], v[112:115], v[176:179]
 s_add_u32 s53, s53, s48
 s_lshl_b32 s53, s53, 10
 ds_read_b128 v[212:215], v252 offset:1024
 v_mfma_f32_16x16x32_bf16 v[180:183], v[236:239], v[116:119], v[180:183]
 v_mul_f32 v205, v149, v245
 ds_read_b128 v[216:219], v252 offset:2048
 v_mfma_f32_16x16x32_bf16 v[184:187], v[236:239], v[120:123], v[184:187]
 ds_read_b128 v[220:223], v252 offset:3072
 v_mul_f32 v206, v150, v245
 v_mfma_f32_16x16x32_bf16 v[188:191], v[236:239], v[124:127], v[188:191]
 v_mul_f32 v207, v151, v245
 ds_read_b64_tr_b16 v[236:237], v242 offset:2048
 ds_read_b64_tr_b16 v[238:239], v242 offset:3072
 s_waitcnt lgkmcnt(10)
 v_mfma_f32_16x16x32_bf16 v[128:131], v[224:227], v[0:3], 0
 s_waitcnt lgkmcnt(4)
 v_mfma_f32_16x16x32_bf16 v[132:135], v[224:227], v[4:7], 0
 s_add_u32 s51, s82, 320
 v_fmac_f32 v192, v208, v246
 v_mfma_f32_16x16x32_bf16 v[136:139], v[224:227], v[8:11], 0
 v_fmac_f32 v193, v209, v246
 v_mfma_f32_16x16x32_bf16 v[140:143], v[224:227], v[12:15], 0
 ds_read_b64_tr_b16 v[224:225], v241 offset:4096
 ds_read_b64_tr_b16 v[226:227], v241 offset:5120
 v_mfma_f32_16x16x32_bf16 v[144:147], v[228:231], v[0:3], 0
 v_fmac_f32 v194, v210, v246
 s_add_u32 m0, s70, 0
 v_mfma_f32_16x16x32_bf16 v[148:151], v[228:231], v[4:7], 0
 v_fmac_f32 v195, v211, v246
 v_mfma_f32_16x16x32_bf16 v[152:155], v[228:231], v[8:11], 0
 s_memrealtime s[96:97]
 s_waitcnt lgkmcnt(0)
 s_barrier
 v_mfma_f32_16x16x32_bf16 v[156:159], v[228:231], v[12:15], 0
 ds_read_b64_tr_b16 v[228:229], v242 offset:4096
 ds_read_b64_tr_b16 v[230:231], v242 offset:5120
 v_mfma_f32_16x16x32_bf16 v[128:131], v[232:235], v[16:19], v[128:131]
 v_fmac_f32 v196, v212, v246
 buffer_load_dwordx4 v253, s[36:39], s51 offen offset:0 lds
 v_mfma_f32_16x16x32_bf16 v[132:135], v[232:235], v[20:23], v[132:135]
 v_fmac_f32 v197, v213, v246
 ds_write_b128 v240, v[168:171] offset:16384
 v_mfma_f32_16x16x32_bf16 v[136:139], v[232:235], v[24:27], v[136:139]
 v_fmac_f32 v198, v214, v246
 v_mfma_f32_16x16x32_bf16 v[140:143], v[232:235], v[28:31], v[140:143]
 ds_read_b64_tr_b16 v[232:233], v241 offset:6144
 ds_read_b64_tr_b16 v[234:235], v241 offset:7168
 v_mfma_f32_16x16x32_bf16 v[144:147], v[236:239], v[16:19], v[144:147]
 s_add_u32 m0, s70, 704
 v_fmac_f32 v199, v215, v246
 v_mfma_f32_16x16x32_bf16 v[148:151], v[236:239], v[20:23], v[148:151]
 v_cvt_pk_bf16_f32 v208, v192, v193
 v_cvt_pk_bf16_f32 v209, v194, v195
 v_mfma_f32_16x16x32_bf16 v[152:155], v[236:239], v[24:27], v[152:155]
 buffer_load_dwordx4 v253, s[36:39], s83 offen offset:320 lds
 v_cvt_pk_bf16_f32 v210, v196, v197
 v_mfma_f32_16x16x32_bf16 v[156:159], v[236:239], v[28:31], v[156:159]
 ds_read_b64_tr_b16 v[236:237], v242 offset:6144
 ds_read_b64_tr_b16 v[238:239], v242 offset:7168
 v_mfma_f32_16x16x32_bf16 v[128:131], v[224:227], v[32:35], v[128:131]
 v_cvt_pk_bf16_f32 v211, v198, v199
 s_add_u32 m0, s70, 1728
 v_mfma_f32_16x16x32_bf16 v[132:135], v[224:227], v[36:39], v[132:135]
 ds_write_b128 v240, v[184:187] offset:17408
 v_mfma_f32_16x16x32_bf16 v[136:139], v[224:227], v[40:43], v[136:139]
 s_waitcnt lgkmcnt(3)
 v_fmac_f32 v200, v216, v247
 v_mfma_f32_16x16x32_bf16 v[140:143], v[224:227], v[44:47], v[140:143]
 ds_read_b64_tr_b16 v[224:225], v241 offset:8192
 ds_read_b64_tr_b16 v[226:227], v241 offset:9216
 v_mfma_f32_16x16x32_bf16 v[144:147], v[228:231], v[32:35], v[144:147]
 v_fmac_f32 v201, v217, v247
 buffer_load_dwordx4 v253, s[36:39], s84 offen offset:320 lds
 v_mfma_f32_16x16x32_bf16 v[148:151], v[228:231], v[36:39], v[148:151]
 v_fmac_f32 v202, v218, v247
 v_fmac_f32 v203, v219, v247
 v_mfma_f32_16x16x32_bf16 v[152:155], v[228:231], v[40:43], v[152:155]
 s_add_u32 m0, s70, 2752
 v_fmac_f32 v204, v220, v247
 v_mfma_f32_16x16x32_bf16 v[156:159], v[228:231], v[44:47], v[156:159]
 ds_read_b64_tr_b16 v[228:229], v242 offset:8192
 ds_read_b64_tr_b16 v[230:231], v242 offset:9216
 v_mfma_f32_16x16x32_bf16 v[128:131], v[232:235], v[48:51], v[128:131]
 v_fmac_f32 v205, v221, v247
 ds_write_b128 v240, v[172:175] offset:18432
 v_mfma_f32_16x16x32_bf16 v[132:135], v[232:235], v[52:55], v[132:135]
 buffer_load_dwordx4 v253, s[36:39], s85 offen offset:320 lds
 v_fmac_f32 v206, v222, v247
 v_mfma_f32_16x16x32_bf16 v[136:139], v[232:235], v[56:59], v[136:139]
 s_waitcnt lgkmcnt(3)
 v_fmac_f32 v207, v223, v247
 v_mfma_f32_16x16x32_bf16 v[140:143], v[232:235], v[60:63], v[140:143]
 ds_read_b64_tr_b16 v[232:233], v241 offset:10240
 ds_read_b64_tr_b16 v[234:235], v241 offset:11264
 v_mfma_f32_16x16x32_bf16 v[144:147], v[236:239], v[48:51], v[144:147]
 v_cvt_pk_bf16_f32 v216, v200, v201
 s_add_u32 m0, s70, 3776
 v_mfma_f32_16x16x32_bf16 v[148:151], v[236:239], v[52:55], v[148:151]
 v_cvt_pk_bf16_f32 v217, v202, v203
 v_cvt_pk_bf16_f32 v218, v204, v205
 v_mfma_f32_16x16x32_bf16 v[152:155], v[236:239], v[56:59], v[152:155]
 buffer_load_dwordx4 v253, s[36:39], s86 offen offset:320 lds
 v_cvt_pk_bf16_f32 v219, v206, v207
 v_mfma_f32_16x16x32_bf16 v[156:159], v[236:239], v[60:63], v[156:159]
 ds_read_b64_tr_b16 v[236:237], v242 offset:10240
 ds_read_b64_tr_b16 v[238:239], v242 offset:11264
 v_mfma_f32_16x16x32_bf16 v[128:131], v[224:227], v[64:67], v[128:131]
 ds_write_b128 v240, v[188:191] offset:19456
 v_mfma_f32_16x16x32_bf16 v[132:135], v[224:227], v[68:71], v[132:135]
 v_mul_f32 v192, v160, v244
 s_add_u32 m0, s70, 4800
 v_mfma_f32_16x16x32_bf16 v[136:139], v[224:227], v[72:75], v[136:139]
 s_waitcnt lgkmcnt(3)
 v_mul_f32 v193, v161, v244
 v_mfma_f32_16x16x32_bf16 v[140:143], v[224:227], v[76:79], v[140:143]
 ds_read_b64_tr_b16 v[224:225], v241 offset:12288
 ds_read_b64_tr_b16 v[226:227], v241 offset:13312
 v_mfma_f32_16x16x32_bf16 v[144:147], v[228:231], v[64:67], v[144:147]
 buffer_load_dwordx4 v253, s[36:39], s87 offen offset:320 lds
 v_mul_f32 v194, v162, v244
 v_mfma_f32_16x16x32_bf16 v[148:151], v[228:231], v[68:71], v[148:151]
 v_mfma_f32_16x16x32_bf16 v[152:155], v[228:231], v[72:75], v[152:155]
 v_mul_f32 v195, v163, v244
 v_mfma_f32_16x16x32_bf16 v[156:159], v[228:231], v[76:79], v[156:159]
 ds_read_b64_tr_b16 v[228:229], v242 offset:12288
 ds_read_b64_tr_b16 v[230:231], v242 offset:13312
 v_mfma_f32_16x16x32_bf16 v[128:131], v[232:235], v[80:83], v[128:131]
 s_add_u32 m0, s70, 5824
 v_mul_f32 v196, v176, v244
 v_mfma_f32_16x16x32_bf16 v[132:135], v[232:235], v[84:87], v[132:135]
 v_mfma_f32_16x16x32_bf16 v[136:139], v[232:235], v[88:91], v[136:139]
 s_waitcnt lgkmcnt(2)
 buffer_store_dwordx4 v[208:211], v243, s[40:43], s65 offen sc1
 v_mfma_f32_16x16x32_bf16 v[140:143], v[232:235], v[92:95], v[140:143]
 ds_read_b64_tr_b16 v[232:233], v241 offset:14336
 ds_read_b64_tr_b16 v[234:235], v241 offset:15360
 v_mfma_f32_16x16x32_bf16 v[144:147], v[236:239], v[80:83], v[144:147]
 buffer_load_dwordx4 v253, s[36:39], s88 offen offset:320 lds
 v_mul_f32 v197, v177, v244
 v_mfma_f32_16x16x32_bf16 v[148:151], v[236:239], v[84:87], v[148:151]
 buffer_store_dwordx4 v[216:219], v248, s[40:43], s65 offen sc1
 s_add_u32 s65, s65, 1024
 v_mfma_f32_16x16x32_bf16 v[152:155], v[236:239], v[88:91], v[152:155]
 v_mul_f32 v198, v178, v244
 s_add_u32 m0, s70, 6848
 v_mfma_f32_16x16x32_bf16 v[156:159], v[236:239], v[92:95], v[156:159]
 ds_read_b64_tr_b16 v[236:237], v242 offset:14336
 ds_read_b64_tr_b16 v[238:239], v242 offset:15360
 v_mfma_f32_16x16x32_bf16 v[128:131], v[224:227], v[96:99], v[128:131]
 v_mul_f32 v199, v179, v244
 v_add_u32 v241, 32768, v241
 v_mfma_f32_16x16x32_bf16 v[132:135], v[224:227], v[100:103], v[132:135]
 buffer_load_dwordx4 v253, s[36:39], s89 offen offset:320 lds
 v_mul_f32 v200, v164, v245
 v_mfma_f32_16x16x32_bf16 v[136:139], v[224:227], v[104:107], v[136:139]
 s_waitcnt lgkmcnt(2)
 v_mul_f32 v201, v165, v245
 v_mfma_f32_16x16x32_bf16 v[140:143], v[224:227], v[108:111], v[140:143]
 v_add_u32 v242, 32768, v242
 v_mfma_f32_16x16x32_bf16 v[144:147], v[228:231], v[96:99], v[144:147]
 v_mul_f32 v202, v166, v245
 v_mfma_f32_16x16x32_bf16 v[148:151], v[228:231], v[100:103], v[148:151]
 v_mfma_f32_16x16x32_bf16 v[152:155], v[228:231], v[104:107], v[152:155]
 s_waitcnt lgkmcnt(0)
 s_waitcnt vmcnt(18)
 s_barrier
 v_mfma_f32_16x16x32_bf16 v[156:159], v[228:231], v[108:111], v[156:159]
 ds_read_b64_tr_b16 v[224:225], v241 offset:0
 ds_read_b64_tr_b16 v[226:227], v241 offset:1024
 ds_read_b64_tr_b16 v[228:229], v242 offset:0
 ds_read_b64_tr_b16 v[230:231], v242 offset:1024
 v_mfma_f32_16x16x32_bf16 v[128:131], v[232:235], v[112:115], v[128:131]
 v_mul_f32 v203, v167, v245
 ds_read_b128 v[208:211], v252 offset:16384
 v_mfma_f32_16x16x32_bf16 v[132:135], v[232:235], v[116:119], v[132:135]
 v_mul_f32 v204, v180, v245
 ds_read_b128 v[212:215], v252 offset:17408
 v_mfma_f32_16x16x32_bf16 v[136:139], v[232:235], v[120:123], v[136:139]
 v_mul_f32 v205, v181, v245
 v_mfma_f32_16x16x32_bf16 v[140:143], v[232:235], v[124:127], v[140:143]
 ds_read_b64_tr_b16 v[232:233], v241 offset:2048
 ds_read_b64_tr_b16 v[234:235], v241 offset:3072
 v_mfma_f32_16x16x32_bf16 v[144:147], v[236:239], v[112:115], v[144:147]
 ds_read_b128 v[216:219], v252 offset:18432
 v_mul_f32 v206, v182, v245
 v_mfma_f32_16x16x32_bf16 v[148:151], v[236:239], v[116:119], v[148:151]
 ds_read_b128 v[220:223], v252 offset:19456
 v_mfma_f32_16x16x32_bf16 v[152:155], v[236:239], v[120:123], v[152:155]
 v_mul_f32 v207, v183, v245
 v_mfma_f32_16x16x32_bf16 v[156:159], v[236:239], v[124:127], v[156:159]
 ds_read_b64_tr_b16 v[236:237], v242 offset:2048
 ds_read_b64_tr_b16 v[238:239], v242 offset:3072
 s_waitcnt lgkmcnt(10)
 v_mfma_f32_16x16x32_bf16 v[160:163], v[224:227], v[0:3], 0
 s_waitcnt lgkmcnt(6)
 v_mfma_f32_16x16x32_bf16 v[164:167], v[224:227], v[4:7], 0
 s_add_u32 m0, s70, 32384
 v_fmac_f32 v192, v208, v246
 v_mfma_f32_16x16x32_bf16 v[168:171], v[224:227], v[8:11], 0
 v_lshrrev_b32 v249, 8, v243
 v_mfma_f32_16x16x32_bf16 v[172:175], v[224:227], v[12:15], 0
 ds_read_b64_tr_b16 v[224:225], v241 offset:4096
 ds_read_b64_tr_b16 v[226:227], v241 offset:5120
 v_mfma_f32_16x16x32_bf16 v[176:179], v[228:231], v[0:3], 0
 v_fmac_f32 v193, v209, v246
 v_bfe_u32 v255, v243, 6, 1
 v_mfma_f32_16x16x32_bf16 v[180:183], v[228:231], v[4:7], 0
 v_fmac_f32 v194, v210, v246
 buffer_load_dwordx4 v253, s[36:39], s82 offen offset:384 lds
 v_mfma_f32_16x16x32_bf16 v[184:187], v[228:231], v[8:11], 0
 s_waitcnt lgkmcnt(6)
 v_fmac_f32 v195, v211, v246
 v_mfma_f32_16x16x32_bf16 v[188:191], v[228:231], v[12:15], 0
 ds_read_b64_tr_b16 v[228:229], v242 offset:4096
 ds_read_b64_tr_b16 v[230:231], v242 offset:5120
 v_lshlrev_b32 v255, 1, v255
 v_mfma_f32_16x16x32_bf16 v[160:163], v[232:235], v[16:19], v[160:163]
 v_fmac_f32 v196, v212, v246
 v_sub_u32 v249, v249, v255
 v_mfma_f32_16x16x32_bf16 v[164:167], v[232:235], v[20:23], v[164:167]
 s_add_u32 m0, s70, 33408
 v_fmac_f32 v197, v213, v246
 v_mfma_f32_16x16x32_bf16 v[168:171], v[232:235], v[24:27], v[168:171]
 s_waitcnt lgkmcnt(2)
 ds_write_b128 v240, v[136:139] offset:0
 v_mfma_f32_16x16x32_bf16 v[172:175], v[232:235], v[28:31], v[172:175]
 ds_read_b64_tr_b16 v[232:233], v241 offset:6144
 ds_read_b64_tr_b16 v[234:235], v241 offset:7168
 v_lshlrev_b32 v249, 2, v249
 v_mfma_f32_16x16x32_bf16 v[176:179], v[236:239], v[16:19], v[176:179]
 v_fmac_f32 v198, v214, v246
 v_fmac_f32 v199, v215, v246
 v_bfe_u32 v255, v243, 7, 1
 v_mfma_f32_16x16x32_bf16 v[180:183], v[236:239], v[20:23], v[180:183]
 buffer_load_dwordx4 v253, s[36:39], s83 offen offset:384 lds
 v_cvt_pk_bf16_f32 v208, v192, v193
 v_mfma_f32_16x16x32_bf16 v[184:187], v[236:239], v[24:27], v[184:187]
 v_lshl_add_u32 v249, v255, 1, v249
 v_cvt_pk_bf16_f32 v209, v194, v195
 v_mfma_f32_16x16x32_bf16 v[188:191], v[236:239], v[28:31], v[188:191]
 ds_read_b64_tr_b16 v[236:237], v242 offset:6144
 ds_read_b64_tr_b16 v[238:239], v242 offset:7168
 v_bfe_u32 v255, v243, 5, 1
 v_mfma_f32_16x16x32_bf16 v[160:163], v[224:227], v[32:35], v[160:163]
 s_add_u32 m0, s70, 34432
 v_cvt_pk_bf16_f32 v210, v196, v197
 v_mfma_f32_16x16x32_bf16 v[164:167], v[224:227], v[36:39], v[164:167]
 v_cvt_pk_bf16_f32 v211, v198, v199
 v_add_u32 v249, v249, v255
 v_mfma_f32_16x16x32_bf16 v[168:171], v[224:227], v[40:43], v[168:171]
 s_waitcnt lgkmcnt(2)
 ds_write_b128 v240, v[152:155] offset:1024
 v_mfma_f32_16x16x32_bf16 v[172:175], v[224:227], v[44:47], v[172:175]
 ds_read_b64_tr_b16 v[224:225], v241 offset:8192
 ds_read_b64_tr_b16 v[226:227], v241 offset:9216
 buffer_load_dwordx4 v253, s[36:39], s84 offen offset:384 lds
 v_mfma_f32_16x16x32_bf16 v[176:179], v[228:231], v[32:35], v[176:179]
 v_and_b32 v255, 16, v243
 v_fmac_f32 v200, v216, v247
 v_mov_b32 v254, 0x3f80
 v_mfma_f32_16x16x32_bf16 v[180:183], v[228:231], v[36:39], v[180:183]
 v_fmac_f32 v201, v217, v247
 v_fmac_f32 v202, v218, v247
 v_mfma_f32_16x16x32_bf16 v[184:187], v[228:231], v[40:43], v[184:187]
 s_add_u32 m0, s70, 35456
 v_lshlrev_b32 v254, v255, v254
 v_mfma_f32_16x16x32_bf16 v[188:191], v[228:231], v[44:47], v[188:191]
 ds_read_b64_tr_b16 v[228:229], v242 offset:8192
 ds_read_b64_tr_b16 v[230:231], v242 offset:9216
 v_fmac_f32 v203, v219, v247
 v_mfma_f32_16x16x32_bf16 v[160:163], v[232:235], v[48:51], v[160:163]
 v_cmp_eq_u32 vcc, 0, v249
 v_cndmask_b32 v255, 0, v254, vcc
 v_fmac_f32 v204, v220, v247
 v_mfma_f32_16x16x32_bf16 v[164:167], v[232:235], v[52:55], v[164:167]
 buffer_load_dwordx4 v253, s[36:39], s85 offen offset:384 lds
 v_fmac_f32 v205, v221, v247
 v_mfma_f32_16x16x32_bf16 v[168:171], v[232:235], v[56:59], v[168:171]
 s_waitcnt lgkmcnt(2)
 ds_write_b128 v240, v[140:143] offset:2048
 v_mfma_f32_16x16x32_bf16 v[172:175], v[232:235], v[60:63], v[172:175]
 ds_read_b64_tr_b16 v[232:233], v241 offset:10240
 ds_read_b64_tr_b16 v[234:235], v241 offset:11264
 v_fmac_f32 v206, v222, v247
 v_mfma_f32_16x16x32_bf16 v[176:179], v[236:239], v[48:51], v[176:179]
 v_accvgpr_write_b32 a160, v255
 v_fmac_f32 v207, v223, v247
 s_add_u32 m0, s70, 36480
 v_mfma_f32_16x16x32_bf16 v[180:183], v[236:239], v[52:55], v[180:183]
 v_cmp_eq_u32 vcc, 1, v249
 v_cndmask_b32 v255, 0, v254, vcc
 v_cvt_pk_bf16_f32 v216, v200, v201
 v_mfma_f32_16x16x32_bf16 v[184:187], v[236:239], v[56:59], v[184:187]
 v_cvt_pk_bf16_f32 v217, v202, v203
 buffer_load_dwordx4 v253, s[36:39], s86 offen offset:384 lds
 v_mfma_f32_16x16x32_bf16 v[188:191], v[236:239], v[60:63], v[188:191]
 v_cvt_pk_bf16_f32 v218, v204, v205
 v_cvt_pk_bf16_f32 v219, v206, v207
 ds_read_b64_tr_b16 v[236:237], v242 offset:10240
 ds_read_b64_tr_b16 v[238:239], v242 offset:11264
 v_mfma_f32_16x16x32_bf16 v[160:163], v[224:227], v[64:67], v[160:163]
 v_accvgpr_write_b32 a161, v255
 v_mfma_f32_16x16x32_bf16 v[164:167], v[224:227], v[68:71], v[164:167]
 v_cmp_eq_u32 vcc, 2, v249
 v_cndmask_b32 v255, 0, v254, vcc
 v_mfma_f32_16x16x32_bf16 v[168:171], v[224:227], v[72:75], v[168:171]
 s_waitcnt lgkmcnt(2)
 s_add_u32 m0, s70, 37504
 v_mfma_f32_16x16x32_bf16 v[172:175], v[224:227], v[76:79], v[172:175]
 ds_read_b64_tr_b16 v[224:225], v241 offset:12288
 ds_read_b64_tr_b16 v[226:227], v241 offset:13312
 ds_write_b128 v240, v[156:159] offset:3072
 v_mfma_f32_16x16x32_bf16 v[176:179], v[228:231], v[64:67], v[176:179]
 v_mul_f32 v192, v128, v244
 v_accvgpr_write_b32 a162, v255
 v_mfma_f32_16x16x32_bf16 v[180:183], v[228:231], v[68:71], v[180:183]
 v_mul_f32 v193, v129, v244
 buffer_load_dwordx4 v253, s[36:39], s87 offen offset:384 lds
 v_mfma_f32_16x16x32_bf16 v[184:187], v[228:231], v[72:75], v[184:187]
 v_cmp_eq_u32 vcc, 3, v249
 v_cndmask_b32 v255, 0, v254, vcc
 v_mfma_f32_16x16x32_bf16 v[188:191], v[228:231], v[76:79], v[188:191]
 ds_read_b64_tr_b16 v[228:229], v242 offset:12288
 ds_read_b64_tr_b16 v[230:231], v242 offset:13312
 v_mul_f32 v194, v130, v244
 v_mfma_f32_16x16x32_bf16 v[160:163], v[232:235], v[80:83], v[160:163]
 s_add_u32 m0, s70, 38528
 v_mul_f32 v195, v131, v244
 v_mfma_f32_16x16x32_bf16 v[164:167], v[232:235], v[84:87], v[164:167]
 v_accvgpr_write_b32 a163, v255
 v_mul_f32 v196, v144, v244
 v_mfma_f32_16x16x32_bf16 v[168:171], v[232:235], v[88:91], v[168:171]
 s_waitcnt lgkmcnt(3)
 v_mfma_f32_16x16x32_bf16 v[172:175], v[232:235], v[92:95], v[172:175]
 ds_read_b64_tr_b16 v[232:233], v241 offset:14336
 ds_read_b64_tr_b16 v[234:235], v241 offset:15360
 v_cmp_eq_u32 vcc, 4, v249
 v_cndmask_b32 v255, 0, v254, vcc
 v_mfma_f32_16x16x32_bf16 v[176:179], v[236:239], v[80:83], v[176:179]
 buffer_load_dwordx4 v253, s[36:39], s88 offen offset:384 lds
 buffer_store_dwordx4 v[208:211], v243, s[40:43], s65 offen sc1
 v_mfma_f32_16x16x32_bf16 v[180:183], v[236:239], v[84:87], v[180:183]
 buffer_store_dwordx4 v[216:219], v248, s[40:43], s65 offen sc1
 s_add_u32 s65, s65, 1024
 v_mul_f32 v197, v145, v244
 v_mfma_f32_16x16x32_bf16 v[184:187], v[236:239], v[88:91], v[184:187]
 v_accvgpr_write_b32 a164, v255
 v_mul_f32 v198, v146, v244
 v_mfma_f32_16x16x32_bf16 v[188:191], v[236:239], v[92:95], v[188:191]
 ds_read_b64_tr_b16 v[236:237], v242 offset:14336
 ds_read_b64_tr_b16 v[238:239], v242 offset:15360
 s_add_u32 m0, s70, 39552
 v_mfma_f32_16x16x32_bf16 v[160:163], v[224:227], v[96:99], v[160:163]
 v_cmp_eq_u32 vcc, 5, v249
 v_cndmask_b32 v255, 0, v254, vcc
 v_mfma_f32_16x16x32_bf16 v[164:167], v[224:227], v[100:103], v[164:167]
 v_mul_f32 v199, v147, v244
 buffer_load_dwordx4 v253, s[36:39], s89 offen offset:384 lds
 v_mfma_f32_16x16x32_bf16 v[168:171], v[224:227], v[104:107], v[168:171]
 s_waitcnt lgkmcnt(2)
 v_add_u32 v241, 32768, v241
 v_mfma_f32_16x16x32_bf16 v[172:175], v[224:227], v[108:111], v[172:175]
 v_mul_f32 v200, v132, v245
 v_accvgpr_write_b32 a165, v255
 v_mfma_f32_16x16x32_bf16 v[176:179], v[228:231], v[96:99], v[176:179]
 v_mul_f32 v201, v133, v245
 v_mfma_f32_16x16x32_bf16 v[180:183], v[228:231], v[100:103], v[180:183]
 v_cmp_eq_u32 vcc, 6, v249
 v_cndmask_b32 v255, 0, v254, vcc
 v_mfma_f32_16x16x32_bf16 v[184:187], v[228:231], v[104:107], v[184:187]
 v_add_u32 v242, 32768, v242
 s_waitcnt lgkmcnt(0)
 s_waitcnt vmcnt(20)
 s_barrier
 v_mfma_f32_16x16x32_bf16 v[188:191], v[228:231], v[108:111], v[188:191]
 ds_read_b64_tr_b16 v[224:225], v241 offset:0
 ds_read_b64_tr_b16 v[226:227], v241 offset:1024
 ds_read_b64_tr_b16 v[228:229], v242 offset:0
 ds_read_b64_tr_b16 v[230:231], v242 offset:1024
 v_mfma_f32_16x16x32_bf16 v[160:163], v[232:235], v[112:115], v[160:163]
 v_mul_f32 v202, v134, v245
 v_mul_f32 v203, v135, v245
 v_accvgpr_write_b32 a166, v255
 v_mfma_f32_16x16x32_bf16 v[164:167], v[232:235], v[116:119], v[164:167]
 ds_read_b128 v[208:211], v252 offset:0
 v_mfma_f32_16x16x32_bf16 v[168:171], v[232:235], v[120:123], v[168:171]
 v_cmp_eq_u32 vcc, 7, v249
 v_cndmask_b32 v255, 0, v254, vcc
 v_mul_f32 v204, v148, v245
 v_mfma_f32_16x16x32_bf16 v[172:175], v[232:235], v[124:127], v[172:175]
 ds_read_b64_tr_b16 v[232:233], v241 offset:2048
 ds_read_b64_tr_b16 v[234:235], v241 offset:3072
 v_mfma_f32_16x16x32_bf16 v[176:179], v[236:239], v[112:115], v[176:179]
 v_accvgpr_write_b32 a167, v255
 ds_read_b128 v[212:215], v252 offset:1024
 v_mul_f32 v205, v149, v245
 v_mfma_f32_16x16x32_bf16 v[180:183], v[236:239], v[116:119], v[180:183]
 ds_read_b128 v[216:219], v252 offset:2048
 v_mul_f32 v206, v150, v245
 v_mfma_f32_16x16x32_bf16 v[184:187], v[236:239], v[120:123], v[184:187]
 ds_read_b128 v[220:223], v252 offset:3072
 v_mul_f32 v207, v151, v245
 v_mfma_f32_16x16x32_bf16 v[188:191], v[236:239], v[124:127], v[188:191]
 ds_read_b64_tr_b16 v[236:237], v242 offset:2048
 ds_read_b64_tr_b16 v[238:239], v242 offset:3072
 s_waitcnt lgkmcnt(10)
 v_mfma_f32_16x16x32_bf16 v[128:131], v[224:227], v[0:3], 0
 s_waitcnt lgkmcnt(4)
 v_mfma_f32_16x16x32_bf16 v[132:135], v[224:227], v[4:7], 0
 s_add_u32 m0, s70, 65088
 v_fmac_f32 v192, v208, v246
 v_mfma_f32_16x16x32_bf16 v[136:139], v[224:227], v[8:11], 0
 s_mul_i32 s94, s50, 240
 v_mfma_f32_16x16x32_bf16 v[140:143], v[224:227], v[12:15], 0
 ds_read_b64_tr_b16 v[224:225], v241 offset:4096
 ds_read_b64_tr_b16 v[226:227], v241 offset:5120
 v_mfma_f32_16x16x32_bf16 v[144:147], v[228:231], v[0:3], 0
 v_fmac_f32 v193, v209, v246
 v_fmac_f32 v194, v210, v246
 v_mfma_f32_16x16x32_bf16 v[148:151], v[228:231], v[4:7], 0
 buffer_load_dwordx4 v253, s[36:39], s82 offen offset:448 lds
 v_fmac_f32 v195, v211, v246
 v_mfma_f32_16x16x32_bf16 v[152:155], v[228:231], v[8:11], 0
 v_fmac_f32 v196, v212, v246
 v_mfma_f32_16x16x32_bf16 v[156:159], v[228:231], v[12:15], 0
 ds_read_b64_tr_b16 v[228:229], v242 offset:4096
 ds_read_b64_tr_b16 v[230:231], v242 offset:5120
 v_mfma_f32_16x16x32_bf16 v[128:131], v[232:235], v[16:19], v[128:131]
 s_lshl_b32 s95, s55, 4
 s_add_u32 m0, s70, 66112
 v_mfma_f32_16x16x32_bf16 v[132:135], v[232:235], v[20:23], v[132:135]
 v_fmac_f32 v197, v213, v246
 ds_write_b128 v240, v[168:171] offset:16384
 v_mfma_f32_16x16x32_bf16 v[136:139], v[232:235], v[24:27], v[136:139]
 s_waitcnt lgkmcnt(3)
 v_fmac_f32 v198, v214, v246
 v_mfma_f32_16x16x32_bf16 v[140:143], v[232:235], v[28:31], v[140:143]
 ds_read_b64_tr_b16 v[232:233], v241 offset:6144
 ds_read_b64_tr_b16 v[234:235], v241 offset:7168
 v_mfma_f32_16x16x32_bf16 v[144:147], v[236:239], v[16:19], v[144:147]
 v_fmac_f32 v199, v215, v246
 buffer_load_dwordx4 v253, s[36:39], s83 offen offset:448 lds
 v_mfma_f32_16x16x32_bf16 v[148:151], v[236:239], v[20:23], v[148:151]
 v_cvt_pk_bf16_f32 v208, v192, v193
 s_add_u32 s94, s94, s95
 v_mfma_f32_16x16x32_bf16 v[152:155], v[236:239], v[24:27], v[152:155]
 v_cvt_pk_bf16_f32 v209, v194, v195
 s_add_u32 m0, s70, 67136
 v_mfma_f32_16x16x32_bf16 v[156:159], v[236:239], v[28:31], v[156:159]
 ds_read_b64_tr_b16 v[236:237], v242 offset:6144
 ds_read_b64_tr_b16 v[238:239], v242 offset:7168
 v_mfma_f32_16x16x32_bf16 v[128:131], v[224:227], v[32:35], v[128:131]
 v_cvt_pk_bf16_f32 v210, v196, v197
 v_cvt_pk_bf16_f32 v211, v198, v199
 v_mfma_f32_16x16x32_bf16 v[132:135], v[224:227], v[36:39], v[132:135]
 ds_write_b128 v240, v[184:187] offset:17408
 v_mfma_f32_16x16x32_bf16 v[136:139], v[224:227], v[40:43], v[136:139]
 s_waitcnt lgkmcnt(3)
 buffer_load_dwordx4 v253, s[36:39], s84 offen offset:448 lds
 v_mfma_f32_16x16x32_bf16 v[140:143], v[224:227], v[44:47], v[140:143]
 ds_read_b64_tr_b16 v[224:225], v241 offset:8192
 ds_read_b64_tr_b16 v[226:227], v241 offset:9216
 v_bfe_u32 v249, v243, 4, 4
 v_mfma_f32_16x16x32_bf16 v[144:147], v[228:231], v[32:35], v[144:147]
 v_fmac_f32 v200, v216, v247
 v_fmac_f32 v201, v217, v247
 v_mfma_f32_16x16x32_bf16 v[148:151], v[228:231], v[36:39], v[148:151]
 v_fmac_f32 v202, v218, v247
 s_add_u32 m0, s70, 68160
 v_mfma_f32_16x16x32_bf16 v[152:155], v[228:231], v[40:43], v[152:155]
 v_fmac_f32 v203, v219, v247
 v_add_u32 v249, s94, v249
 v_mfma_f32_16x16x32_bf16 v[156:159], v[228:231], v[44:47], v[156:159]
 ds_read_b64_tr_b16 v[228:229], v242 offset:8192
 ds_read_b64_tr_b16 v[230:231], v242 offset:9216
 v_mfma_f32_16x16x32_bf16 v[128:131], v[232:235], v[48:51], v[128:131]
 v_fmac_f32 v204, v220, v247
 buffer_load_dwordx4 v253, s[36:39], s85 offen offset:448 lds
 v_mfma_f32_16x16x32_bf16 v[132:135], v[232:235], v[52:55], v[132:135]
 v_fmac_f32 v205, v221, v247
 ds_write_b128 v240, v[172:175] offset:18432
 v_mfma_f32_16x16x32_bf16 v[136:139], v[232:235], v[56:59], v[136:139]
 s_waitcnt lgkmcnt(3)
 v_fmac_f32 v206, v222, v247
 v_mfma_f32_16x16x32_bf16 v[140:143], v[232:235], v[60:63], v[140:143]
 ds_read_b64_tr_b16 v[232:233], v241 offset:10240
 ds_read_b64_tr_b16 v[234:235], v241 offset:11264
 v_mfma_f32_16x16x32_bf16 v[144:147], v[236:239], v[48:51], v[144:147]
 v_fmac_f32 v207, v223, v247
 s_add_u32 m0, s70, 69184
 v_mfma_f32_16x16x32_bf16 v[148:151], v[236:239], v[52:55], v[148:151]
 v_mul_u32_u24 v249, 896, v249
 v_cvt_pk_bf16_f32 v216, v200, v201
 v_mfma_f32_16x16x32_bf16 v[152:155], v[236:239], v[56:59], v[152:155]
 v_cvt_pk_bf16_f32 v217, v202, v203
 buffer_load_dwordx4 v253, s[36:39], s86 offen offset:448 lds
 v_mfma_f32_16x16x32_bf16 v[156:159], v[236:239], v[60:63], v[156:159]
 v_cvt_pk_bf16_f32 v218, v204, v205
 v_cvt_pk_bf16_f32 v219, v206, v207
 ds_read_b64_tr_b16 v[236:237], v242 offset:10240
 ds_read_b64_tr_b16 v[238:239], v242 offset:11264
 v_mfma_f32_16x16x32_bf16 v[128:131], v[224:227], v[64:67], v[128:131]
 v_lshrrev_b32 v254, 8, v243
 s_add_u32 m0, s70, 70208
 v_mfma_f32_16x16x32_bf16 v[132:135], v[224:227], v[68:71], v[132:135]
 ds_write_b128 v240, v[188:191] offset:19456
 v_mul_f32 v192, v160, v244
 v_mfma_f32_16x16x32_bf16 v[136:139], v[224:227], v[72:75], v[136:139]
 s_waitcnt lgkmcnt(3)
 v_mul_f32 v193, v161, v244
 v_mfma_f32_16x16x32_bf16 v[140:143], v[224:227], v[76:79], v[140:143]
 ds_read_b64_tr_b16 v[224:225], v241 offset:12288
 ds_read_b64_tr_b16 v[226:227], v241 offset:13312
 v_mfma_f32_16x16x32_bf16 v[144:147], v[228:231], v[64:67], v[144:147]
 buffer_load_dwordx4 v253, s[36:39], s87 offen offset:448 lds
 v_lshl_add_u32 v249, v254, 4, v249
 v_mfma_f32_16x16x32_bf16 v[148:151], v[228:231], v[68:71], v[148:151]
 v_mul_f32 v194, v162, v244
 v_mfma_f32_16x16x32_bf16 v[152:155], v[228:231], v[72:75], v[152:155]
 s_add_u32 m0, s70, 71232
 v_mul_f32 v195, v163, v244
 v_mfma_f32_16x16x32_bf16 v[156:159], v[228:231], v[76:79], v[156:159]
 ds_read_b64_tr_b16 v[228:229], v242 offset:12288
 ds_read_b64_tr_b16 v[230:231], v242 offset:13312
 v_mfma_f32_16x16x32_bf16 v[128:131], v[232:235], v[80:83], v[128:131]
 v_mul_f32 v196, v176, v244
 v_mfma_f32_16x16x32_bf16 v[132:135], v[232:235], v[84:87], v[132:135]
 s_lshl_b32 s95, s48, 6
 buffer_load_dwordx4 v253, s[36:39], s88 offen offset:448 lds
 v_mfma_f32_16x16x32_bf16 v[136:139], v[232:235], v[88:91], v[136:139]
 s_waitcnt lgkmcnt(2)
 buffer_store_dwordx4 v[208:211], v243, s[40:43], s65 offen sc1
 v_mfma_f32_16x16x32_bf16 v[140:143], v[232:235], v[92:95], v[140:143]
 ds_read_b64_tr_b16 v[232:233], v241 offset:14336
 ds_read_b64_tr_b16 v[234:235], v241 offset:15360
 v_mfma_f32_16x16x32_bf16 v[144:147], v[236:239], v[80:83], v[144:147]
 v_mul_f32 v197, v177, v244
 buffer_store_dwordx4 v[216:219], v248, s[40:43], s65 offen sc1
 v_mfma_f32_16x16x32_bf16 v[148:151], v[236:239], v[84:87], v[148:151]
 s_add_u32 s65, s65, 1024
 v_mul_f32 v198, v178, v244
 v_mfma_f32_16x16x32_bf16 v[152:155], v[236:239], v[88:91], v[152:155]
 s_add_u32 m0, s70, 72256
 v_add_u32 v249, s95, v249
 v_mfma_f32_16x16x32_bf16 v[156:159], v[236:239], v[92:95], v[156:159]
 ds_read_b64_tr_b16 v[236:237], v242 offset:14336
 ds_read_b64_tr_b16 v[238:239], v242 offset:15360
 v_mfma_f32_16x16x32_bf16 v[128:131], v[224:227], v[96:99], v[128:131]
 v_mul_f32 v199, v179, v244
 buffer_load_dwordx4 v253, s[36:39], s89 offen offset:448 lds
 v_mfma_f32_16x16x32_bf16 v[132:135], v[224:227], v[100:103], v[132:135]
 v_subrev_u32 v241, 98304, v241
 v_mul_f32 v200, v164, v245
 v_mfma_f32_16x16x32_bf16 v[136:139], v[224:227], v[104:107], v[136:139]
 s_waitcnt lgkmcnt(2)
 v_mul_f32 v201, v165, v245
 v_mfma_f32_16x16x32_bf16 v[140:143], v[224:227], v[108:111], v[140:143]
 v_accvgpr_write_b32 a250, s96
 v_subrev_u32 v242, 98304, v242
 v_mfma_f32_16x16x32_bf16 v[144:147], v[228:231], v[96:99], v[144:147]
 v_mul_f32 v202, v166, v245
 v_mfma_f32_16x16x32_bf16 v[148:151], v[228:231], v[100:103], v[148:151]
 v_mfma_f32_16x16x32_bf16 v[152:155], v[228:231], v[104:107], v[152:155]
 s_waitcnt lgkmcnt(0)
 s_waitcnt vmcnt(20)
 s_barrier
 v_mfma_f32_16x16x32_bf16 v[156:159], v[228:231], v[108:111], v[156:159]
 ds_read_b64_tr_b16 v[224:225], v241 offset:0
 ds_read_b64_tr_b16 v[226:227], v241 offset:1024
 ds_read_b64_tr_b16 v[228:229], v242 offset:0
 ds_read_b64_tr_b16 v[230:231], v242 offset:1024
 v_mfma_f32_16x16x32_bf16 v[128:131], v[232:235], v[112:115], v[128:131]
 v_mul_f32 v203, v167, v245
 ds_read_b128 v[208:211], v252 offset:16384
 v_mfma_f32_16x16x32_bf16 v[132:135], v[232:235], v[116:119], v[132:135]
 v_accvgpr_write_b32 a251, s97
 v_mul_f32 v204, v180, v245
 v_mfma_f32_16x16x32_bf16 v[136:139], v[232:235], v[120:123], v[136:139]
 ds_read_b128 v[212:215], v252 offset:17408
 v_mul_f32 v205, v181, v245
 v_mfma_f32_16x16x32_bf16 v[140:143], v[232:235], v[124:127], v[140:143]
 ds_read_b64_tr_b16 v[232:233], v241 offset:2048
 ds_read_b64_tr_b16 v[234:235], v241 offset:3072
 v_mfma_f32_16x16x32_bf16 v[144:147], v[236:239], v[112:115], v[144:147]
 ds_read_b128 v[216:219], v252 offset:18432
 v_mul_f32 v206, v182, v245
 v_mfma_f32_16x16x32_bf16 v[148:151], v[236:239], v[116:119], v[148:151]
 ds_read_b128 v[220:223], v252 offset:19456
 v_mfma_f32_16x16x32_bf16 v[152:155], v[236:239], v[120:123], v[152:155]
 v_mul_f32 v207, v183, v245
 v_mfma_f32_16x16x32_bf16 v[156:159], v[236:239], v[124:127], v[156:159]
 ds_read_b64_tr_b16 v[236:237], v242 offset:2048
 ds_read_b64_tr_b16 v[238:239], v242 offset:3072
 s_waitcnt lgkmcnt(10)
 v_mfma_f32_16x16x32_bf16 v[160:163], v[224:227], v[0:3], 0
 s_waitcnt lgkmcnt(6)
 v_mfma_f32_16x16x32_bf16 v[164:167], v[224:227], v[4:7], 0
 s_add_u32 m0, s70, 97792
 v_fmac_f32 v192, v208, v246
 v_mfma_f32_16x16x32_bf16 v[168:171], v[224:227], v[8:11], 0
 v_fmac_f32 v193, v209, v246
 v_mfma_f32_16x16x32_bf16 v[172:175], v[224:227], v[12:15], 0
 ds_read_b64_tr_b16 v[224:225], v241 offset:4096
 ds_read_b64_tr_b16 v[226:227], v241 offset:5120
 v_mfma_f32_16x16x32_bf16 v[176:179], v[228:231], v[0:3], 0
 v_fmac_f32 v194, v210, v246
 buffer_load_dwordx4 v253, s[36:39], s82 offen offset:512 lds
 v_mfma_f32_16x16x32_bf16 v[180:183], v[228:231], v[4:7], 0
 v_fmac_f32 v195, v211, v246
 v_mfma_f32_16x16x32_bf16 v[184:187], v[228:231], v[8:11], 0
 s_waitcnt lgkmcnt(6)
 v_fmac_f32 v196, v212, v246
 v_mfma_f32_16x16x32_bf16 v[188:191], v[228:231], v[12:15], 0
 ds_read_b64_tr_b16 v[228:229], v242 offset:4096
 ds_read_b64_tr_b16 v[230:231], v242 offset:5120
 v_mfma_f32_16x16x32_bf16 v[160:163], v[232:235], v[16:19], v[160:163]
 s_add_u32 m0, s70, 98816
 v_fmac_f32 v197, v213, v246
 v_mfma_f32_16x16x32_bf16 v[164:167], v[232:235], v[20:23], v[164:167]
 ds_write_b128 v240, v[136:139] offset:0
 v_fmac_f32 v198, v214, v246
 v_mfma_f32_16x16x32_bf16 v[168:171], v[232:235], v[24:27], v[168:171]
 s_waitcnt lgkmcnt(3)
 v_fmac_f32 v199, v215, v246
 v_mfma_f32_16x16x32_bf16 v[172:175], v[232:235], v[28:31], v[172:175]
 ds_read_b64_tr_b16 v[232:233], v241 offset:6144
 ds_read_b64_tr_b16 v[234:235], v241 offset:7168
 v_mfma_f32_16x16x32_bf16 v[176:179], v[236:239], v[16:19], v[176:179]
 buffer_load_dwordx4 v253, s[36:39], s83 offen offset:512 lds
 v_cvt_pk_bf16_f32 v208, v192, v193
 v_mfma_f32_16x16x32_bf16 v[180:183], v[236:239], v[20:23], v[180:183]
 v_cvt_pk_bf16_f32 v209, v194, v195
 s_add_u32 m0, s70, 99840
 v_mfma_f32_16x16x32_bf16 v[184:187], v[236:239], v[24:27], v[184:187]
 v_cvt_pk_bf16_f32 v210, v196, v197
 v_cvt_pk_bf16_f32 v211, v198, v199
 v_mfma_f32_16x16x32_bf16 v[188:191], v[236:239], v[28:31], v[188:191]
 ds_read_b64_tr_b16 v[236:237], v242 offset:6144
 ds_read_b64_tr_b16 v[238:239], v242 offset:7168
 v_mfma_f32_16x16x32_bf16 v[160:163], v[224:227], v[32:35], v[160:163]
 ds_write_b128 v240, v[152:155] offset:1024
 v_mfma_f32_16x16x32_bf16 v[164:167], v[224:227], v[36:39], v[164:167]
 buffer_load_dwordx4 v253, s[36:39], s84 offen offset:512 lds
 v_fmac_f32 v200, v216, v247
 v_mfma_f32_16x16x32_bf16 v[168:171], v[224:227], v[40:43], v[168:171]
 s_waitcnt lgkmcnt(3)
 v_fmac_f32 v201, v217, v247
 v_mfma_f32_16x16x32_bf16 v[172:175], v[224:227], v[44:47], v[172:175]
 ds_read_b64_tr_b16 v[224:225], v241 offset:8192
 ds_read_b64_tr_b16 v[226:227], v241 offset:9216
 v_mfma_f32_16x16x32_bf16 v[176:179], v[228:231], v[32:35], v[176:179]
 v_fmac_f32 v202, v218, v247
 s_add_u32 m0, s70, 100864
 v_mfma_f32_16x16x32_bf16 v[180:183], v[228:231], v[36:39], v[180:183]
 v_fmac_f32 v203, v219, v247
 v_mfma_f32_16x16x32_bf16 v[184:187], v[228:231], v[40:43], v[184:187]
 v_fmac_f32 v204, v220, v247
 buffer_load_dwordx4 v253, s[36:39], s85 offen offset:512 lds
 v_mfma_f32_16x16x32_bf16 v[188:191], v[228:231], v[44:47], v[188:191]
 ds_read_b64_tr_b16 v[228:229], v242 offset:8192
 ds_read_b64_tr_b16 v[230:231], v242 offset:9216
 v_mfma_f32_16x16x32_bf16 v[160:163], v[232:235], v[48:51], v[160:163]
 v_fmac_f32 v205, v221, v247
 ds_write_b128 v240, v[140:143] offset:2048
 v_mfma_f32_16x16x32_bf16 v[164:167], v[232:235], v[52:55], v[164:167]
 v_fmac_f32 v206, v222, v247
 v_fmac_f32 v207, v223, v247
 v_mfma_f32_16x16x32_bf16 v[168:171], v[232:235], v[56:59], v[168:171]
 s_waitcnt lgkmcnt(3)
 s_add_u32 m0, s70, 101888
 v_mfma_f32_16x16x32_bf16 v[172:175], v[232:235], v[60:63], v[172:175]
 ds_read_b64_tr_b16 v[232:233], v241 offset:10240
 ds_read_b64_tr_b16 v[234:235], v241 offset:11264
 v_mfma_f32_16x16x32_bf16 v[176:179], v[236:239], v[48:51], v[176:179]
 v_cvt_pk_bf16_f32 v216, v200, v201
 v_cvt_pk_bf16_f32 v217, v202, v203
 v_mfma_f32_16x16x32_bf16 v[180:183], v[236:239], v[52:55], v[180:183]
 buffer_load_dwordx4 v253, s[36:39], s86 offen offset:512 lds
 v_cvt_pk_bf16_f32 v218, v204, v205
 v_mfma_f32_16x16x32_bf16 v[184:187], v[236:239], v[56:59], v[184:187]
 v_cvt_pk_bf16_f32 v219, v206, v207
 v_mfma_f32_16x16x32_bf16 v[188:191], v[236:239], v[60:63], v[188:191]
 ds_read_b64_tr_b16 v[236:237], v242 offset:10240
 ds_read_b64_tr_b16 v[238:239], v242 offset:11264
 v_mfma_f32_16x16x32_bf16 v[160:163], v[224:227], v[64:67], v[160:163]
 s_add_u32 m0, s70, 102912
 ds_write_b128 v240, v[156:159] offset:3072
 v_mfma_f32_16x16x32_bf16 v[164:167], v[224:227], v[68:71], v[164:167]
 v_mul_f32 v192, v128, v244
 v_mfma_f32_16x16x32_bf16 v[168:171], v[224:227], v[72:75], v[168:171]
 s_waitcnt lgkmcnt(3)
 v_mul_f32 v193, v129, v244
 v_mfma_f32_16x16x32_bf16 v[172:175], v[224:227], v[76:79], v[172:175]
 ds_read_b64_tr_b16 v[224:225], v241 offset:12288
 ds_read_b64_tr_b16 v[226:227], v241 offset:13312
 v_mfma_f32_16x16x32_bf16 v[176:179], v[228:231], v[64:67], v[176:179]
 buffer_load_dwordx4 v253, s[36:39], s87 offen offset:512 lds
 v_mul_f32 v194, v130, v244
 v_mfma_f32_16x16x32_bf16 v[180:183], v[228:231], v[68:71], v[180:183]
 v_mfma_f32_16x16x32_bf16 v[184:187], v[228:231], v[72:75], v[184:187]
 s_add_u32 m0, s70, 103936
 v_mul_f32 v195, v131, v244
 v_mfma_f32_16x16x32_bf16 v[188:191], v[228:231], v[76:79], v[188:191]
 ds_read_b64_tr_b16 v[228:229], v242 offset:12288
 ds_read_b64_tr_b16 v[230:231], v242 offset:13312
 v_mfma_f32_16x16x32_bf16 v[160:163], v[232:235], v[80:83], v[160:163]
 v_mul_f32 v196, v144, v244
 v_mfma_f32_16x16x32_bf16 v[164:167], v[232:235], v[84:87], v[164:167]
 buffer_load_dwordx4 v253, s[36:39], s88 offen offset:512 lds
 v_mfma_f32_16x16x32_bf16 v[168:171], v[232:235], v[88:91], v[168:171]
 s_waitcnt lgkmcnt(2)
 buffer_store_dwordx4 v[208:211], v243, s[40:43], s65 offen sc1
 v_mfma_f32_16x16x32_bf16 v[172:175], v[232:235], v[92:95], v[172:175]
 ds_read_b64_tr_b16 v[232:233], v241 offset:14336
 ds_read_b64_tr_b16 v[234:235], v241 offset:15360
 v_mfma_f32_16x16x32_bf16 v[176:179], v[236:239], v[80:83], v[176:179]
 v_mul_f32 v197, v145, v244
 buffer_store_dwordx4 v[216:219], v248, s[40:43], s65 offen sc1
 v_mfma_f32_16x16x32_bf16 v[180:183], v[236:239], v[84:87], v[180:183]
 s_add_u32 s65, s65, 1024
 v_mul_f32 v198, v146, v244
 v_mfma_f32_16x16x32_bf16 v[184:187], v[236:239], v[88:91], v[184:187]
 s_add_u32 m0, s70, 104960
 v_mul_f32 v199, v147, v244
 v_mfma_f32_16x16x32_bf16 v[188:191], v[236:239], v[92:95], v[188:191]
 ds_read_b64_tr_b16 v[236:237], v242 offset:14336
 ds_read_b64_tr_b16 v[238:239], v242 offset:15360
 v_mfma_f32_16x16x32_bf16 v[160:163], v[224:227], v[96:99], v[160:163]
 buffer_load_dwordx4 v253, s[36:39], s89 offen offset:512 lds
 v_add_u32 v241, 32768, v241
 v_mfma_f32_16x16x32_bf16 v[164:167], v[224:227], v[100:103], v[164:167]
 v_mul_f32 v200, v132, v245
 v_mfma_f32_16x16x32_bf16 v[168:171], v[224:227], v[104:107], v[168:171]
 s_waitcnt lgkmcnt(2)
 v_mul_f32 v201, v133, v245
 v_mfma_f32_16x16x32_bf16 v[172:175], v[224:227], v[108:111], v[172:175]
 v_add_u32 v242, 32768, v242
 v_mfma_f32_16x16x32_bf16 v[176:179], v[228:231], v[96:99], v[176:179]
 v_mul_f32 v202, v134, v245
 v_mfma_f32_16x16x32_bf16 v[180:183], v[228:231], v[100:103], v[180:183]
 v_mfma_f32_16x16x32_bf16 v[184:187], v[228:231], v[104:107], v[184:187]
 s_waitcnt lgkmcnt(0)
 s_waitcnt vmcnt(20)
 s_barrier
 v_mfma_f32_16x16x32_bf16 v[188:191], v[228:231], v[108:111], v[188:191]
 ds_read_b64_tr_b16 v[224:225], v241 offset:0
 ds_read_b64_tr_b16 v[226:227], v241 offset:1024
 ds_read_b64_tr_b16 v[228:229], v242 offset:0
 ds_read_b64_tr_b16 v[230:231], v242 offset:1024
 v_mfma_f32_16x16x32_bf16 v[160:163], v[232:235], v[112:115], v[160:163]
 v_mul_f32 v203, v135, v245
 ds_read_b128 v[208:211], v252 offset:0
 v_mfma_f32_16x16x32_bf16 v[164:167], v[232:235], v[116:119], v[164:167]
 v_mul_f32 v204, v148, v245
 ds_read_b128 v[212:215], v252 offset:1024
 v_mfma_f32_16x16x32_bf16 v[168:171], v[232:235], v[120:123], v[168:171]
 v_mul_f32 v205, v149, v245
 v_mfma_f32_16x16x32_bf16 v[172:175], v[232:235], v[124:127], v[172:175]
 ds_read_b64_tr_b16 v[232:233], v241 offset:2048
 ds_read_b64_tr_b16 v[234:235], v241 offset:3072
 v_mfma_f32_16x16x32_bf16 v[176:179], v[236:239], v[112:115], v[176:179]
 ds_read_b128 v[216:219], v252 offset:2048
 v_mul_f32 v206, v150, v245
 v_mfma_f32_16x16x32_bf16 v[180:183], v[236:239], v[116:119], v[180:183]
 ds_read_b128 v[220:223], v252 offset:3072
 v_mfma_f32_16x16x32_bf16 v[184:187], v[236:239], v[120:123], v[184:187]
 v_mul_f32 v207, v151, v245
 v_mfma_f32_16x16x32_bf16 v[188:191], v[236:239], v[124:127], v[188:191]
 ds_read_b64_tr_b16 v[236:237], v242 offset:2048
 ds_read_b64_tr_b16 v[238:239], v242 offset:3072
 s_waitcnt lgkmcnt(10)
 v_mfma_f32_16x16x32_bf16 v[128:131], v[224:227], v[0:3], 0
 s_waitcnt lgkmcnt(6)
 v_mfma_f32_16x16x32_bf16 v[132:135], v[224:227], v[4:7], 0
 s_add_u32 s51, s82, 576
 v_fmac_f32 v192, v208, v246
 v_mfma_f32_16x16x32_bf16 v[136:139], v[224:227], v[8:11], 0
 v_fmac_f32 v193, v209, v246
 v_mfma_f32_16x16x32_bf16 v[140:143], v[224:227], v[12:15], 0
 ds_read_b64_tr_b16 v[224:225], v241 offset:4096
 ds_read_b64_tr_b16 v[226:227], v241 offset:5120
 v_mfma_f32_16x16x32_bf16 v[144:147], v[228:231], v[0:3], 0
 v_fmac_f32 v194, v210, v246
 s_add_u32 m0, s70, 0
 v_mfma_f32_16x16x32_bf16 v[148:151], v[228:231], v[4:7], 0
 v_fmac_f32 v195, v211, v246
 v_mfma_f32_16x16x32_bf16 v[152:155], v[228:231], v[8:11], 0
 s_waitcnt lgkmcnt(6)
 v_fmac_f32 v196, v212, v246
 v_mfma_f32_16x16x32_bf16 v[156:159], v[228:231], v[12:15], 0
 ds_read_b64_tr_b16 v[228:229], v242 offset:4096
 ds_read_b64_tr_b16 v[230:231], v242 offset:5120
 v_mfma_f32_16x16x32_bf16 v[128:131], v[232:235], v[16:19], v[128:131]
 buffer_load_dwordx4 v253, s[36:39], s51 offen offset:0 lds
 v_fmac_f32 v197, v213, v246
 v_mfma_f32_16x16x32_bf16 v[132:135], v[232:235], v[20:23], v[132:135]
 ds_write_b128 v240, v[168:171] offset:16384
 v_fmac_f32 v198, v214, v246
 v_mfma_f32_16x16x32_bf16 v[136:139], v[232:235], v[24:27], v[136:139]
 s_waitcnt lgkmcnt(3)
 s_add_u32 m0, s70, 448
 v_mfma_f32_16x16x32_bf16 v[140:143], v[232:235], v[28:31], v[140:143]
 ds_read_b64_tr_b16 v[232:233], v241 offset:6144
 ds_read_b64_tr_b16 v[234:235], v241 offset:7168
 v_mfma_f32_16x16x32_bf16 v[144:147], v[236:239], v[16:19], v[144:147]
 v_fmac_f32 v199, v215, v246
 v_cvt_pk_bf16_f32 v208, v192, v193
 v_mfma_f32_16x16x32_bf16 v[148:151], v[236:239], v[20:23], v[148:151]
 v_cvt_pk_bf16_f32 v209, v194, v195
 buffer_load_dwordx4 v253, s[36:39], s83 offen offset:576 lds
 v_mfma_f32_16x16x32_bf16 v[152:155], v[236:239], v[24:27], v[152:155]
 v_cvt_pk_bf16_f32 v210, v196, v197
 v_cvt_pk_bf16_f32 v211, v198, v199
 v_mfma_f32_16x16x32_bf16 v[156:159], v[236:239], v[28:31], v[156:159]
 ds_read_b64_tr_b16 v[236:237], v242 offset:6144
 ds_read_b64_tr_b16 v[238:239], v242 offset:7168
 v_mfma_f32_16x16x32_bf16 v[128:131], v[224:227], v[32:35], v[128:131]
 s_add_u32 m0, s70, 1472
 v_mfma_f32_16x16x32_bf16 v[132:135], v[224:227], v[36:39], v[132:135]
 ds_write_b128 v240, v[184:187] offset:17408
 v_fmac_f32 v200, v216, v247
 v_mfma_f32_16x16x32_bf16 v[136:139], v[224:227], v[40:43], v[136:139]
 s_waitcnt lgkmcnt(3)
 v_fmac_f32 v201, v217, v247
 v_mfma_f32_16x16x32_bf16 v[140:143], v[224:227], v[44:47], v[140:143]
 ds_read_b64_tr_b16 v[224:225], v241 offset:8192
 ds_read_b64_tr_b16 v[226:227], v241 offset:9216
 v_mfma_f32_16x16x32_bf16 v[144:147], v[228:231], v[32:35], v[144:147]
 buffer_load_dwordx4 v253, s[36:39], s84 offen offset:576 lds
 v_fmac_f32 v202, v218, v247
 v_mfma_f32_16x16x32_bf16 v[148:151], v[228:231], v[36:39], v[148:151]
 v_fmac_f32 v203, v219, v247
 s_add_u32 m0, s70, 2496
 v_mfma_f32_16x16x32_bf16 v[152:155], v[228:231], v[40:43], v[152:155]
 v_fmac_f32 v204, v220, v247
 v_mfma_f32_16x16x32_bf16 v[156:159], v[228:231], v[44:47], v[156:159]
 ds_read_b64_tr_b16 v[228:229], v242 offset:8192
 ds_read_b64_tr_b16 v[230:231], v242 offset:9216
 v_mfma_f32_16x16x32_bf16 v[128:131], v[232:235], v[48:51], v[128:131]
 v_fmac_f32 v205, v221, v247
 ds_write_b128 v240, v[172:175] offset:18432
 v_mfma_f32_16x16x32_bf16 v[132:135], v[232:235], v[52:55], v[132:135]
 buffer_load_dwordx4 v253, s[36:39], s85 offen offset:576 lds
 v_fmac_f32 v206, v222, v247
 v_mfma_f32_16x16x32_bf16 v[136:139], v[232:235], v[56:59], v[136:139]
 s_waitcnt lgkmcnt(3)
 v_fmac_f32 v207, v223, v247
 v_mfma_f32_16x16x32_bf16 v[140:143], v[232:235], v[60:63], v[140:143]
 ds_read_b64_tr_b16 v[232:233], v241 offset:10240
 ds_read_b64_tr_b16 v[234:235], v241 offset:11264
 v_mfma_f32_16x16x32_bf16 v[144:147], v[236:239], v[48:51], v[144:147]
 v_cvt_pk_bf16_f32 v216, v200, v201
 s_add_u32 m0, s70, 3520
 v_mfma_f32_16x16x32_bf16 v[148:151], v[236:239], v[52:55], v[148:151]
 v_cvt_pk_bf16_f32 v217, v202, v203
 v_cvt_pk_bf16_f32 v218, v204, v205
 v_mfma_f32_16x16x32_bf16 v[152:155], v[236:239], v[56:59], v[152:155]
 buffer_load_dwordx4 v253, s[36:39], s86 offen offset:576 lds
 v_cvt_pk_bf16_f32 v219, v206, v207
 v_mfma_f32_16x16x32_bf16 v[156:159], v[236:239], v[60:63], v[156:159]
 ds_read_b64_tr_b16 v[236:237], v242 offset:10240
 ds_read_b64_tr_b16 v[238:239], v242 offset:11264
 v_mfma_f32_16x16x32_bf16 v[128:131], v[224:227], v[64:67], v[128:131]
 ds_write_b128 v240, v[188:191] offset:19456
 v_mfma_f32_16x16x32_bf16 v[132:135], v[224:227], v[68:71], v[132:135]
 v_mul_f32 v192, v160, v244
 s_add_u32 m0, s70, 4544
 v_mfma_f32_16x16x32_bf16 v[136:139], v[224:227], v[72:75], v[136:139]
 s_waitcnt lgkmcnt(3)
 v_mul_f32 v193, v161, v244
 v_mfma_f32_16x16x32_bf16 v[140:143], v[224:227], v[76:79], v[140:143]
 ds_read_b64_tr_b16 v[224:225], v241 offset:12288
 ds_read_b64_tr_b16 v[226:227], v241 offset:13312
 v_mfma_f32_16x16x32_bf16 v[144:147], v[228:231], v[64:67], v[144:147]
 buffer_load_dwordx4 v253, s[36:39], s87 offen offset:576 lds
 v_mul_f32 v194, v162, v244
 v_mfma_f32_16x16x32_bf16 v[148:151], v[228:231], v[68:71], v[148:151]
 v_mfma_f32_16x16x32_bf16 v[152:155], v[228:231], v[72:75], v[152:155]
 v_mul_f32 v195, v163, v244
 v_mfma_f32_16x16x32_bf16 v[156:159], v[228:231], v[76:79], v[156:159]
 ds_read_b64_tr_b16 v[228:229], v242 offset:12288
 ds_read_b64_tr_b16 v[230:231], v242 offset:13312
 v_mfma_f32_16x16x32_bf16 v[128:131], v[232:235], v[80:83], v[128:131]
 s_add_u32 m0, s70, 5568
 v_mul_f32 v196, v176, v244
 v_mfma_f32_16x16x32_bf16 v[132:135], v[232:235], v[84:87], v[132:135]
 v_mfma_f32_16x16x32_bf16 v[136:139], v[232:235], v[88:91], v[136:139]
 s_waitcnt lgkmcnt(2)
 buffer_store_dwordx4 v[208:211], v243, s[40:43], s65 offen sc1
 v_mfma_f32_16x16x32_bf16 v[140:143], v[232:235], v[92:95], v[140:143]
 ds_read_b64_tr_b16 v[232:233], v241 offset:14336
 ds_read_b64_tr_b16 v[234:235], v241 offset:15360
 v_mfma_f32_16x16x32_bf16 v[144:147], v[236:239], v[80:83], v[144:147]
 buffer_load_dwordx4 v253, s[36:39], s88 offen offset:576 lds
 v_mul_f32 v197, v177, v244
 v_mfma_f32_16x16x32_bf16 v[148:151], v[236:239], v[84:87], v[148:151]
 buffer_store_dwordx4 v[216:219], v248, s[40:43], s65 offen sc1
 s_add_u32 s65, s65, 1024
 v_mfma_f32_16x16x32_bf16 v[152:155], v[236:239], v[88:91], v[152:155]
 v_mul_f32 v198, v178, v244
 s_add_u32 m0, s70, 6592
 v_mfma_f32_16x16x32_bf16 v[156:159], v[236:239], v[92:95], v[156:159]
 ds_read_b64_tr_b16 v[236:237], v242 offset:14336
 ds_read_b64_tr_b16 v[238:239], v242 offset:15360
 v_mfma_f32_16x16x32_bf16 v[128:131], v[224:227], v[96:99], v[128:131]
 v_mul_f32 v199, v179, v244
 v_add_u32 v241, 32768, v241
 v_mfma_f32_16x16x32_bf16 v[132:135], v[224:227], v[100:103], v[132:135]
 buffer_load_dwordx4 v253, s[36:39], s89 offen offset:576 lds
 v_mul_f32 v200, v164, v245
 v_mfma_f32_16x16x32_bf16 v[136:139], v[224:227], v[104:107], v[136:139]
 s_waitcnt lgkmcnt(2)
 v_mul_f32 v201, v165, v245
 v_mfma_f32_16x16x32_bf16 v[140:143], v[224:227], v[108:111], v[140:143]
 v_add_u32 v242, 32768, v242
 v_mfma_f32_16x16x32_bf16 v[144:147], v[228:231], v[96:99], v[144:147]
 v_mul_f32 v202, v166, v245
 v_mfma_f32_16x16x32_bf16 v[148:151], v[228:231], v[100:103], v[148:151]
 s_waitcnt vmcnt(11)
 v_mfma_f32_16x16x32_bf16 v[152:155], v[228:231], v[104:107], v[152:155]
 s_waitcnt lgkmcnt(0)
 s_barrier
 v_mfma_f32_16x16x32_bf16 v[156:159], v[228:231], v[108:111], v[156:159]
 ds_read_b64_tr_b16 v[224:225], v241 offset:0
 ds_read_b64_tr_b16 v[226:227], v241 offset:1024
 ds_read_b64_tr_b16 v[228:229], v242 offset:0
 ds_read_b64_tr_b16 v[230:231], v242 offset:1024
 buffer_store_dwordx2 a[250:251], off, s[20:23], 0 offset:0 sc1
 v_mfma_f32_16x16x32_bf16 v[128:131], v[232:235], v[112:115], v[128:131]
 v_mul_f32 v203, v167, v245
 ds_read_b128 v[208:211], v252 offset:16384
 v_mfma_f32_16x16x32_bf16 v[132:135], v[232:235], v[116:119], v[132:135]
 v_mul_f32 v204, v180, v245
 ds_read_b128 v[212:215], v252 offset:17408
 v_mfma_f32_16x16x32_bf16 v[136:139], v[232:235], v[120:123], v[136:139]
 v_mul_f32 v205, v181, v245
 v_mfma_f32_16x16x32_bf16 v[140:143], v[232:235], v[124:127], v[140:143]
 ds_read_b64_tr_b16 v[232:233], v241 offset:2048
 ds_read_b64_tr_b16 v[234:235], v241 offset:3072
 v_mfma_f32_16x16x32_bf16 v[144:147], v[236:239], v[112:115], v[144:147]
 ds_read_b128 v[216:219], v252 offset:18432
 v_mul_f32 v206, v182, v245
 v_mfma_f32_16x16x32_bf16 v[148:151], v[236:239], v[116:119], v[148:151]
 ds_read_b128 v[220:223], v252 offset:19456
 v_mfma_f32_16x16x32_bf16 v[152:155], v[236:239], v[120:123], v[152:155]
 v_mul_f32 v207, v183, v245
 v_mfma_f32_16x16x32_bf16 v[156:159], v[236:239], v[124:127], v[156:159]
 ds_read_b64_tr_b16 v[236:237], v242 offset:2048
 ds_read_b64_tr_b16 v[238:239], v242 offset:3072
 s_waitcnt lgkmcnt(10)
 v_mfma_f32_16x16x32_bf16 v[160:163], v[224:227], v[0:3], 0
 s_waitcnt lgkmcnt(6)
 v_mfma_f32_16x16x32_bf16 v[164:167], v[224:227], v[4:7], 0
 s_add_u32 m0, s70, 32128
 v_fmac_f32 v192, v208, v246
 v_mfma_f32_16x16x32_bf16 v[168:171], v[224:227], v[8:11], 0
 v_fmac_f32 v193, v209, v246
 v_mfma_f32_16x16x32_bf16 v[172:175], v[224:227], v[12:15], 0
 ds_read_b64_tr_b16 v[224:225], v241 offset:4096
 ds_read_b64_tr_b16 v[226:227], v241 offset:5120
 v_mfma_f32_16x16x32_bf16 v[176:179], v[228:231], v[0:3], 0
 v_fmac_f32 v194, v210, v246
 buffer_load_dwordx4 v253, s[36:39], s82 offen offset:640 lds
 v_mfma_f32_16x16x32_bf16 v[180:183], v[228:231], v[4:7], 0
 v_fmac_f32 v195, v211, v246
 v_mfma_f32_16x16x32_bf16 v[184:187], v[228:231], v[8:11], 0
 s_waitcnt lgkmcnt(6)
 v_fmac_f32 v196, v212, v246
 v_mfma_f32_16x16x32_bf16 v[188:191], v[228:231], v[12:15], 0
 ds_read_b64_tr_b16 v[228:229], v242 offset:4096
 ds_read_b64_tr_b16 v[230:231], v242 offset:5120
 v_mfma_f32_16x16x32_bf16 v[160:163], v[232:235], v[16:19], v[160:163]
 s_add_u32 m0, s70, 33152
 v_fmac_f32 v197, v213, v246
 v_mfma_f32_16x16x32_bf16 v[164:167], v[232:235], v[20:23], v[164:167]
 ds_write_b128 v240, v[136:139] offset:0
 v_fmac_f32 v198, v214, v246
 v_mfma_f32_16x16x32_bf16 v[168:171], v[232:235], v[24:27], v[168:171]
 s_waitcnt lgkmcnt(3)
 v_fmac_f32 v199, v215, v246
 v_mfma_f32_16x16x32_bf16 v[172:175], v[232:235], v[28:31], v[172:175]
 ds_read_b64_tr_b16 v[232:233], v241 offset:6144
 ds_read_b64_tr_b16 v[234:235], v241 offset:7168
 v_mfma_f32_16x16x32_bf16 v[176:179], v[236:239], v[16:19], v[176:179]
 buffer_load_dwordx4 v253, s[36:39], s83 offen offset:640 lds
 v_cvt_pk_bf16_f32 v208, v192, v193
 v_mfma_f32_16x16x32_bf16 v[180:183], v[236:239], v[20:23], v[180:183]
 v_cvt_pk_bf16_f32 v209, v194, v195
 s_add_u32 m0, s70, 34176
 v_mfma_f32_16x16x32_bf16 v[184:187], v[236:239], v[24:27], v[184:187]
 v_cvt_pk_bf16_f32 v210, v196, v197
 v_cvt_pk_bf16_f32 v211, v198, v199
 v_mfma_f32_16x16x32_bf16 v[188:191], v[236:239], v[28:31], v[188:191]
 ds_read_b64_tr_b16 v[236:237], v242 offset:6144
 ds_read_b64_tr_b16 v[238:239], v242 offset:7168
 v_mfma_f32_16x16x32_bf16 v[160:163], v[224:227], v[32:35], v[160:163]
 ds_write_b128 v240, v[152:155] offset:1024
 v_mfma_f32_16x16x32_bf16 v[164:167], v[224:227], v[36:39], v[164:167]
 buffer_load_dwordx4 v253, s[36:39], s84 offen offset:640 lds
 v_fmac_f32 v200, v216, v247
 v_mfma_f32_16x16x32_bf16 v[168:171], v[224:227], v[40:43], v[168:171]
 s_waitcnt lgkmcnt(3)
 v_fmac_f32 v201, v217, v247
 v_mfma_f32_16x16x32_bf16 v[172:175], v[224:227], v[44:47], v[172:175]
 ds_read_b64_tr_b16 v[224:225], v241 offset:8192
 ds_read_b64_tr_b16 v[226:227], v241 offset:9216
 v_mfma_f32_16x16x32_bf16 v[176:179], v[228:231], v[32:35], v[176:179]
 v_fmac_f32 v202, v218, v247
 s_add_u32 m0, s70, 35200
 v_mfma_f32_16x16x32_bf16 v[180:183], v[228:231], v[36:39], v[180:183]
 v_fmac_f32 v203, v219, v247
 v_mfma_f32_16x16x32_bf16 v[184:187], v[228:231], v[40:43], v[184:187]
 v_fmac_f32 v204, v220, v247
 buffer_load_dwordx4 v253, s[36:39], s85 offen offset:640 lds
 v_mfma_f32_16x16x32_bf16 v[188:191], v[228:231], v[44:47], v[188:191]
 ds_read_b64_tr_b16 v[228:229], v242 offset:8192
 ds_read_b64_tr_b16 v[230:231], v242 offset:9216
 v_mfma_f32_16x16x32_bf16 v[160:163], v[232:235], v[48:51], v[160:163]
 v_fmac_f32 v205, v221, v247
 ds_write_b128 v240, v[140:143] offset:2048
 v_mfma_f32_16x16x32_bf16 v[164:167], v[232:235], v[52:55], v[164:167]
 v_fmac_f32 v206, v222, v247
 v_fmac_f32 v207, v223, v247
 v_mfma_f32_16x16x32_bf16 v[168:171], v[232:235], v[56:59], v[168:171]
 s_waitcnt lgkmcnt(3)
 s_add_u32 m0, s70, 36224
 v_mfma_f32_16x16x32_bf16 v[172:175], v[232:235], v[60:63], v[172:175]
 ds_read_b64_tr_b16 v[232:233], v241 offset:10240
 ds_read_b64_tr_b16 v[234:235], v241 offset:11264
 v_mfma_f32_16x16x32_bf16 v[176:179], v[236:239], v[48:51], v[176:179]
 v_cvt_pk_bf16_f32 v216, v200, v201
 v_cvt_pk_bf16_f32 v217, v202, v203
 v_mfma_f32_16x16x32_bf16 v[180:183], v[236:239], v[52:55], v[180:183]
 buffer_load_dwordx4 v253, s[36:39], s86 offen offset:640 lds
 v_cvt_pk_bf16_f32 v218, v204, v205
 v_mfma_f32_16x16x32_bf16 v[184:187], v[236:239], v[56:59], v[184:187]
 v_cvt_pk_bf16_f32 v219, v206, v207
 v_mfma_f32_16x16x32_bf16 v[188:191], v[236:239], v[60:63], v[188:191]
 ds_read_b64_tr_b16 v[236:237], v242 offset:10240
 ds_read_b64_tr_b16 v[238:239], v242 offset:11264
 v_mfma_f32_16x16x32_bf16 v[160:163], v[224:227], v[64:67], v[160:163]
 s_add_u32 m0, s70, 37248
 ds_write_b128 v240, v[156:159] offset:3072
 v_mfma_f32_16x16x32_bf16 v[164:167], v[224:227], v[68:71], v[164:167]
 v_mul_f32 v192, v128, v244
 v_mfma_f32_16x16x32_bf16 v[168:171], v[224:227], v[72:75], v[168:171]
 s_waitcnt lgkmcnt(3)
 v_mul_f32 v193, v129, v244
 v_mfma_f32_16x16x32_bf16 v[172:175], v[224:227], v[76:79], v[172:175]
 ds_read_b64_tr_b16 v[224:225], v241 offset:12288
 ds_read_b64_tr_b16 v[226:227], v241 offset:13312
 v_mfma_f32_16x16x32_bf16 v[176:179], v[228:231], v[64:67], v[176:179]
 buffer_load_dwordx4 v253, s[36:39], s87 offen offset:640 lds
 v_mul_f32 v194, v130, v244
 v_mfma_f32_16x16x32_bf16 v[180:183], v[228:231], v[68:71], v[180:183]
 v_mfma_f32_16x16x32_bf16 v[184:187], v[228:231], v[72:75], v[184:187]
 s_add_u32 m0, s70, 38272
 v_mul_f32 v195, v131, v244
 v_mfma_f32_16x16x32_bf16 v[188:191], v[228:231], v[76:79], v[188:191]
 ds_read_b64_tr_b16 v[228:229], v242 offset:12288
 ds_read_b64_tr_b16 v[230:231], v242 offset:13312
 v_mfma_f32_16x16x32_bf16 v[160:163], v[232:235], v[80:83], v[160:163]
 v_mul_f32 v196, v144, v244
 v_mfma_f32_16x16x32_bf16 v[164:167], v[232:235], v[84:87], v[164:167]
 buffer_load_dwordx4 v253, s[36:39], s88 offen offset:640 lds
 v_mfma_f32_16x16x32_bf16 v[168:171], v[232:235], v[88:91], v[168:171]
 s_waitcnt lgkmcnt(2)
 buffer_store_dwordx4 v[208:211], v243, s[40:43], s65 offen sc1
 v_mfma_f32_16x16x32_bf16 v[172:175], v[232:235], v[92:95], v[172:175]
 ds_read_b64_tr_b16 v[232:233], v241 offset:14336
 ds_read_b64_tr_b16 v[234:235], v241 offset:15360
 v_mfma_f32_16x16x32_bf16 v[176:179], v[236:239], v[80:83], v[176:179]
 v_mul_f32 v197, v145, v244
 buffer_store_dwordx4 v[216:219], v248, s[40:43], s65 offen sc1
 v_mfma_f32_16x16x32_bf16 v[180:183], v[236:239], v[84:87], v[180:183]
 s_add_u32 s65, s65, 1024
 v_mul_f32 v198, v146, v244
 v_mfma_f32_16x16x32_bf16 v[184:187], v[236:239], v[88:91], v[184:187]
 s_add_u32 m0, s70, 39296
 v_mul_f32 v199, v147, v244
 v_mfma_f32_16x16x32_bf16 v[188:191], v[236:239], v[92:95], v[188:191]
 ds_read_b64_tr_b16 v[236:237], v242 offset:14336
 ds_read_b64_tr_b16 v[238:239], v242 offset:15360
 v_mfma_f32_16x16x32_bf16 v[160:163], v[224:227], v[96:99], v[160:163]
 buffer_load_dwordx4 v253, s[36:39], s89 offen offset:640 lds
 v_add_u32 v241, 32768, v241
 v_mfma_f32_16x16x32_bf16 v[164:167], v[224:227], v[100:103], v[164:167]
 v_mul_f32 v200, v132, v245
 v_mfma_f32_16x16x32_bf16 v[168:171], v[224:227], v[104:107], v[168:171]
 s_waitcnt lgkmcnt(2)
 v_mul_f32 v201, v133, v245
 v_mfma_f32_16x16x32_bf16 v[172:175], v[224:227], v[108:111], v[172:175]
 v_add_u32 v242, 32768, v242
 v_mfma_f32_16x16x32_bf16 v[176:179], v[228:231], v[96:99], v[176:179]
 v_mul_f32 v202, v134, v245
 v_mfma_f32_16x16x32_bf16 v[180:183], v[228:231], v[100:103], v[180:183]
 v_mfma_f32_16x16x32_bf16 v[184:187], v[228:231], v[104:107], v[184:187]
 s_waitcnt lgkmcnt(0)
 s_waitcnt vmcnt(21)
 s_barrier
 v_mfma_f32_16x16x32_bf16 v[188:191], v[228:231], v[108:111], v[188:191]
 ds_read_b64_tr_b16 v[224:225], v241 offset:0
 ds_read_b64_tr_b16 v[226:227], v241 offset:1024
 ds_read_b64_tr_b16 v[228:229], v242 offset:0
 ds_read_b64_tr_b16 v[230:231], v242 offset:1024
 v_mfma_f32_16x16x32_bf16 v[160:163], v[232:235], v[112:115], v[160:163]
 v_mul_f32 v203, v135, v245
 ds_read_b128 v[208:211], v252 offset:0
 v_mfma_f32_16x16x32_bf16 v[164:167], v[232:235], v[116:119], v[164:167]
 v_mul_f32 v204, v148, v245
 ds_read_b128 v[212:215], v252 offset:1024
 v_mfma_f32_16x16x32_bf16 v[168:171], v[232:235], v[120:123], v[168:171]
 v_mul_f32 v205, v149, v245
 v_mfma_f32_16x16x32_bf16 v[172:175], v[232:235], v[124:127], v[172:175]
 ds_read_b64_tr_b16 v[232:233], v241 offset:2048
 ds_read_b64_tr_b16 v[234:235], v241 offset:3072
 v_mfma_f32_16x16x32_bf16 v[176:179], v[236:239], v[112:115], v[176:179]
 ds_read_b128 v[216:219], v252 offset:2048
 v_mul_f32 v206, v150, v245
 v_mfma_f32_16x16x32_bf16 v[180:183], v[236:239], v[116:119], v[180:183]
 ds_read_b128 v[220:223], v252 offset:3072
 v_mfma_f32_16x16x32_bf16 v[184:187], v[236:239], v[120:123], v[184:187]
 v_mul_f32 v207, v151, v245
 v_mfma_f32_16x16x32_bf16 v[188:191], v[236:239], v[124:127], v[188:191]
 ds_read_b64_tr_b16 v[236:237], v242 offset:2048
 ds_read_b64_tr_b16 v[238:239], v242 offset:3072
 s_waitcnt lgkmcnt(10)
 v_mfma_f32_16x16x32_bf16 v[128:131], v[224:227], v[0:3], 0
 s_waitcnt lgkmcnt(6)
 v_mfma_f32_16x16x32_bf16 v[132:135], v[224:227], v[4:7], 0
 s_add_u32 m0, s70, 64832
 v_fmac_f32 v192, v208, v246
 v_mfma_f32_16x16x32_bf16 v[136:139], v[224:227], v[8:11], 0
 v_fmac_f32 v193, v209, v246
 v_mfma_f32_16x16x32_bf16 v[140:143], v[224:227], v[12:15], 0
 ds_read_b64_tr_b16 v[224:225], v241 offset:4096
 ds_read_b64_tr_b16 v[226:227], v241 offset:5120
 v_mfma_f32_16x16x32_bf16 v[144:147], v[228:231], v[0:3], 0
 v_fmac_f32 v194, v210, v246
 buffer_load_dwordx4 v253, s[36:39], s82 offen offset:704 lds
 v_mfma_f32_16x16x32_bf16 v[148:151], v[228:231], v[4:7], 0
 v_fmac_f32 v195, v211, v246
 v_mfma_f32_16x16x32_bf16 v[152:155], v[228:231], v[8:11], 0
 s_waitcnt lgkmcnt(6)
 v_fmac_f32 v196, v212, v246
 v_mfma_f32_16x16x32_bf16 v[156:159], v[228:231], v[12:15], 0
 ds_read_b64_tr_b16 v[228:229], v242 offset:4096
 ds_read_b64_tr_b16 v[230:231], v242 offset:5120
 v_mfma_f32_16x16x32_bf16 v[128:131], v[232:235], v[16:19], v[128:131]
 s_add_u32 m0, s70, 65856
 v_fmac_f32 v197, v213, v246
 v_mfma_f32_16x16x32_bf16 v[132:135], v[232:235], v[20:23], v[132:135]
 ds_write_b128 v240, v[168:171] offset:16384
 v_fmac_f32 v198, v214, v246
 v_mfma_f32_16x16x32_bf16 v[136:139], v[232:235], v[24:27], v[136:139]
 s_waitcnt lgkmcnt(3)
 v_fmac_f32 v199, v215, v246
 v_mfma_f32_16x16x32_bf16 v[140:143], v[232:235], v[28:31], v[140:143]
 ds_read_b64_tr_b16 v[232:233], v241 offset:6144
 ds_read_b64_tr_b16 v[234:235], v241 offset:7168
 v_mfma_f32_16x16x32_bf16 v[144:147], v[236:239], v[16:19], v[144:147]
 buffer_load_dwordx4 v253, s[36:39], s83 offen offset:704 lds
 v_cvt_pk_bf16_f32 v208, v192, v193
 v_mfma_f32_16x16x32_bf16 v[148:151], v[236:239], v[20:23], v[148:151]
 v_cvt_pk_bf16_f32 v209, v194, v195
 s_add_u32 m0, s70, 66880
 v_mfma_f32_16x16x32_bf16 v[152:155], v[236:239], v[24:27], v[152:155]
 v_cvt_pk_bf16_f32 v210, v196, v197
 v_cvt_pk_bf16_f32 v211, v198, v199
 v_mfma_f32_16x16x32_bf16 v[156:159], v[236:239], v[28:31], v[156:159]
 ds_read_b64_tr_b16 v[236:237], v242 offset:6144
 ds_read_b64_tr_b16 v[238:239], v242 offset:7168
 v_mfma_f32_16x16x32_bf16 v[128:131], v[224:227], v[32:35], v[128:131]
 ds_write_b128 v240, v[184:187] offset:17408
 v_mfma_f32_16x16x32_bf16 v[132:135], v[224:227], v[36:39], v[132:135]
 buffer_load_dwordx4 v253, s[36:39], s84 offen offset:704 lds
 v_fmac_f32 v200, v216, v247
 v_mfma_f32_16x16x32_bf16 v[136:139], v[224:227], v[40:43], v[136:139]
 s_waitcnt lgkmcnt(3)
 v_fmac_f32 v201, v217, v247
 v_mfma_f32_16x16x32_bf16 v[140:143], v[224:227], v[44:47], v[140:143]
 ds_read_b64_tr_b16 v[224:225], v241 offset:8192
 ds_read_b64_tr_b16 v[226:227], v241 offset:9216
 v_mfma_f32_16x16x32_bf16 v[144:147], v[228:231], v[32:35], v[144:147]
 v_fmac_f32 v202, v218, v247
 s_add_u32 m0, s70, 67904
 v_mfma_f32_16x16x32_bf16 v[148:151], v[228:231], v[36:39], v[148:151]
 v_fmac_f32 v203, v219, v247
 v_mfma_f32_16x16x32_bf16 v[152:155], v[228:231], v[40:43], v[152:155]
 v_fmac_f32 v204, v220, v247
 buffer_load_dwordx4 v253, s[36:39], s85 offen offset:704 lds
 v_mfma_f32_16x16x32_bf16 v[156:159], v[228:231], v[44:47], v[156:159]
 ds_read_b64_tr_b16 v[228:229], v242 offset:8192
 ds_read_b64_tr_b16 v[230:231], v242 offset:9216
 v_mfma_f32_16x16x32_bf16 v[128:131], v[232:235], v[48:51], v[128:131]
 v_fmac_f32 v205, v221, v247
 ds_write_b128 v240, v[172:175] offset:18432
 v_mfma_f32_16x16x32_bf16 v[132:135], v[232:235], v[52:55], v[132:135]
 v_fmac_f32 v206, v222, v247
 v_fmac_f32 v207, v223, v247
 v_mfma_f32_16x16x32_bf16 v[136:139], v[232:235], v[56:59], v[136:139]
 s_waitcnt lgkmcnt(3)
 s_add_u32 m0, s70, 68928
 v_mfma_f32_16x16x32_bf16 v[140:143], v[232:235], v[60:63], v[140:143]
 ds_read_b64_tr_b16 v[232:233], v241 offset:10240
 ds_read_b64_tr_b16 v[234:235], v241 offset:11264
 v_mfma_f32_16x16x32_bf16 v[144:147], v[236:239], v[48:51], v[144:147]
 v_cvt_pk_bf16_f32 v216, v200, v201
 v_cvt_pk_bf16_f32 v217, v202, v203
 v_mfma_f32_16x16x32_bf16 v[148:151], v[236:239], v[52:55], v[148:151]
 buffer_load_dwordx4 v253, s[36:39], s86 offen offset:704 lds
 v_cvt_pk_bf16_f32 v218, v204, v205
 v_mfma_f32_16x16x32_bf16 v[152:155], v[236:239], v[56:59], v[152:155]
 v_cvt_pk_bf16_f32 v219, v206, v207
 v_mfma_f32_16x16x32_bf16 v[156:159], v[236:239], v[60:63], v[156:159]
 ds_read_b64_tr_b16 v[236:237], v242 offset:10240
 ds_read_b64_tr_b16 v[238:239], v242 offset:11264
 v_mfma_f32_16x16x32_bf16 v[128:131], v[224:227], v[64:67], v[128:131]
 s_add_u32 m0, s70, 69952
 ds_write_b128 v240, v[188:191] offset:19456
 v_mfma_f32_16x16x32_bf16 v[132:135], v[224:227], v[68:71], v[132:135]
 v_mul_f32 v192, v160, v244
 v_mfma_f32_16x16x32_bf16 v[136:139], v[224:227], v[72:75], v[136:139]
 s_waitcnt lgkmcnt(3)
 v_mul_f32 v193, v161, v244
 v_mfma_f32_16x16x32_bf16 v[140:143], v[224:227], v[76:79], v[140:143]
 ds_read_b64_tr_b16 v[224:225], v241 offset:12288
 ds_read_b64_tr_b16 v[226:227], v241 offset:13312
 v_mfma_f32_16x16x32_bf16 v[144:147], v[228:231], v[64:67], v[144:147]
 buffer_load_dwordx4 v253, s[36:39], s87 offen offset:704 lds
 v_mul_f32 v194, v162, v244
 v_mfma_f32_16x16x32_bf16 v[148:151], v[228:231], v[68:71], v[148:151]
 v_mfma_f32_16x16x32_bf16 v[152:155], v[228:231], v[72:75], v[152:155]
 s_add_u32 m0, s70, 70976
 v_mul_f32 v195, v163, v244
 v_mfma_f32_16x16x32_bf16 v[156:159], v[228:231], v[76:79], v[156:159]
 ds_read_b64_tr_b16 v[228:229], v242 offset:12288
 ds_read_b64_tr_b16 v[230:231], v242 offset:13312
 v_mfma_f32_16x16x32_bf16 v[128:131], v[232:235], v[80:83], v[128:131]
 v_mul_f32 v196, v176, v244
 v_mfma_f32_16x16x32_bf16 v[132:135], v[232:235], v[84:87], v[132:135]
 buffer_load_dwordx4 v253, s[36:39], s88 offen offset:704 lds
 v_mfma_f32_16x16x32_bf16 v[136:139], v[232:235], v[88:91], v[136:139]
 s_waitcnt lgkmcnt(2)
 buffer_store_dwordx4 v[208:211], v243, s[40:43], s65 offen sc1
 v_mfma_f32_16x16x32_bf16 v[140:143], v[232:235], v[92:95], v[140:143]
 ds_read_b64_tr_b16 v[232:233], v241 offset:14336
 ds_read_b64_tr_b16 v[234:235], v241 offset:15360
 v_mfma_f32_16x16x32_bf16 v[144:147], v[236:239], v[80:83], v[144:147]
 v_mul_f32 v197, v177, v244
 buffer_store_dwordx4 v[216:219], v248, s[40:43], s65 offen sc1
 v_mfma_f32_16x16x32_bf16 v[148:151], v[236:239], v[84:87], v[148:151]
 s_add_u32 s65, s65, 1024
 v_mul_f32 v198, v178, v244
 v_mfma_f32_16x16x32_bf16 v[152:155], v[236:239], v[88:91], v[152:155]
 s_add_u32 m0, s70, 72000
 v_mul_f32 v199, v179, v244
 v_mfma_f32_16x16x32_bf16 v[156:159], v[236:239], v[92:95], v[156:159]
 ds_read_b64_tr_b16 v[236:237], v242 offset:14336
 ds_read_b64_tr_b16 v[238:239], v242 offset:15360
 v_mfma_f32_16x16x32_bf16 v[128:131], v[224:227], v[96:99], v[128:131]
 buffer_load_dwordx4 v253, s[36:39], s89 offen offset:704 lds
 v_subrev_u32 v241, 98304, v241
 v_mfma_f32_16x16x32_bf16 v[132:135], v[224:227], v[100:103], v[132:135]
 v_mul_f32 v200, v164, v245
 v_mfma_f32_16x16x32_bf16 v[136:139], v[224:227], v[104:107], v[136:139]
 s_waitcnt lgkmcnt(2)
 v_mul_f32 v201, v165, v245
 v_mfma_f32_16x16x32_bf16 v[140:143], v[224:227], v[108:111], v[140:143]
 v_subrev_u32 v242, 98304, v242
 v_mfma_f32_16x16x32_bf16 v[144:147], v[228:231], v[96:99], v[144:147]
 v_mul_f32 v202, v166, v245
 v_mfma_f32_16x16x32_bf16 v[148:151], v[228:231], v[100:103], v[148:151]
 v_mfma_f32_16x16x32_bf16 v[152:155], v[228:231], v[104:107], v[152:155]
 s_waitcnt lgkmcnt(0)
 s_waitcnt vmcnt(21)
 s_barrier
 v_mfma_f32_16x16x32_bf16 v[156:159], v[228:231], v[108:111], v[156:159]
 ds_read_b64_tr_b16 v[224:225], v241 offset:0
 ds_read_b64_tr_b16 v[226:227], v241 offset:1024
 ds_read_b64_tr_b16 v[228:229], v242 offset:0
 ds_read_b64_tr_b16 v[230:231], v242 offset:1024
 v_mfma_f32_16x16x32_bf16 v[128:131], v[232:235], v[112:115], v[128:131]
 v_mul_f32 v203, v167, v245
 ds_read_b128 v[208:211], v252 offset:16384
 v_mfma_f32_16x16x32_bf16 v[132:135], v[232:235], v[116:119], v[132:135]
 v_mul_f32 v204, v180, v245
 ds_read_b128 v[212:215], v252 offset:17408
 v_mfma_f32_16x16x32_bf16 v[136:139], v[232:235], v[120:123], v[136:139]
 v_mul_f32 v205, v181, v245
 v_mfma_f32_16x16x32_bf16 v[140:143], v[232:235], v[124:127], v[140:143]
 ds_read_b64_tr_b16 v[232:233], v241 offset:2048
 ds_read_b64_tr_b16 v[234:235], v241 offset:3072
 v_mfma_f32_16x16x32_bf16 v[144:147], v[236:239], v[112:115], v[144:147]
 ds_read_b128 v[216:219], v252 offset:18432
 v_mul_f32 v206, v182, v245
 v_mfma_f32_16x16x32_bf16 v[148:151], v[236:239], v[116:119], v[148:151]
 ds_read_b128 v[220:223], v252 offset:19456
 v_mfma_f32_16x16x32_bf16 v[152:155], v[236:239], v[120:123], v[152:155]
 v_mul_f32 v207, v183, v245
 v_mfma_f32_16x16x32_bf16 v[156:159], v[236:239], v[124:127], v[156:159]
 ds_read_b64_tr_b16 v[236:237], v242 offset:2048
 ds_read_b64_tr_b16 v[238:239], v242 offset:3072
 s_waitcnt lgkmcnt(10)
 v_mfma_f32_16x16x32_bf16 v[160:163], v[224:227], v[0:3], 0
 s_waitcnt lgkmcnt(6)
 v_mfma_f32_16x16x32_bf16 v[164:167], v[224:227], v[4:7], 0
 s_add_u32 m0, s70, 97536
 v_fmac_f32 v192, v208, v246
 v_mfma_f32_16x16x32_bf16 v[168:171], v[224:227], v[8:11], 0
 v_fmac_f32 v193, v209, v246
 v_mfma_f32_16x16x32_bf16 v[172:175], v[224:227], v[12:15], 0
 ds_read_b64_tr_b16 v[224:225], v241 offset:4096
 ds_read_b64_tr_b16 v[226:227], v241 offset:5120
 v_mfma_f32_16x16x32_bf16 v[176:179], v[228:231], v[0:3], 0
 v_fmac_f32 v194, v210, v246
 buffer_load_dwordx4 v253, s[36:39], s82 offen offset:768 lds
 v_mfma_f32_16x16x32_bf16 v[180:183], v[228:231], v[4:7], 0
 v_fmac_f32 v195, v211, v246
 v_mfma_f32_16x16x32_bf16 v[184:187], v[228:231], v[8:11], 0
 s_waitcnt lgkmcnt(6)
 v_fmac_f32 v196, v212, v246
 v_mfma_f32_16x16x32_bf16 v[188:191], v[228:231], v[12:15], 0
 ds_read_b64_tr_b16 v[228:229], v242 offset:4096
 ds_read_b64_tr_b16 v[230:231], v242 offset:5120
 v_mfma_f32_16x16x32_bf16 v[160:163], v[232:235], v[16:19], v[160:163]
 s_add_u32 m0, s70, 98560
 v_fmac_f32 v197, v213, v246
 v_mfma_f32_16x16x32_bf16 v[164:167], v[232:235], v[20:23], v[164:167]
 ds_write_b128 v240, v[136:139] offset:0
 v_fmac_f32 v198, v214, v246
 v_mfma_f32_16x16x32_bf16 v[168:171], v[232:235], v[24:27], v[168:171]
 s_waitcnt lgkmcnt(3)
 v_fmac_f32 v199, v215, v246
 v_mfma_f32_16x16x32_bf16 v[172:175], v[232:235], v[28:31], v[172:175]
 ds_read_b64_tr_b16 v[232:233], v241 offset:6144
 ds_read_b64_tr_b16 v[234:235], v241 offset:7168
 v_mfma_f32_16x16x32_bf16 v[176:179], v[236:239], v[16:19], v[176:179]
 buffer_load_dwordx4 v253, s[36:39], s83 offen offset:768 lds
 v_cvt_pk_bf16_f32 v208, v192, v193
 v_mfma_f32_16x16x32_bf16 v[180:183], v[236:239], v[20:23], v[180:183]
 v_cvt_pk_bf16_f32 v209, v194, v195
 s_add_u32 m0, s70, 99584
 v_mfma_f32_16x16x32_bf16 v[184:187], v[236:239], v[24:27], v[184:187]
 v_cvt_pk_bf16_f32 v210, v196, v197
 v_cvt_pk_bf16_f32 v211, v198, v199
 v_mfma_f32_16x16x32_bf16 v[188:191], v[236:239], v[28:31], v[188:191]
 ds_read_b64_tr_b16 v[236:237], v242 offset:6144
 ds_read_b64_tr_b16 v[238:239], v242 offset:7168
 v_mfma_f32_16x16x32_bf16 v[160:163], v[224:227], v[32:35], v[160:163]
 ds_write_b128 v240, v[152:155] offset:1024
 v_mfma_f32_16x16x32_bf16 v[164:167], v[224:227], v[36:39], v[164:167]
 buffer_load_dwordx4 v253, s[36:39], s84 offen offset:768 lds
 v_fmac_f32 v200, v216, v247
 v_mfma_f32_16x16x32_bf16 v[168:171], v[224:227], v[40:43], v[168:171]
 s_waitcnt lgkmcnt(3)
 v_fmac_f32 v201, v217, v247
 v_mfma_f32_16x16x32_bf16 v[172:175], v[224:227], v[44:47], v[172:175]
 ds_read_b64_tr_b16 v[224:225], v241 offset:8192
 ds_read_b64_tr_b16 v[226:227], v241 offset:9216
 v_mfma_f32_16x16x32_bf16 v[176:179], v[228:231], v[32:35], v[176:179]
 v_fmac_f32 v202, v218, v247
 s_add_u32 m0, s70, 100608
 v_mfma_f32_16x16x32_bf16 v[180:183], v[228:231], v[36:39], v[180:183]
 v_fmac_f32 v203, v219, v247
 v_mfma_f32_16x16x32_bf16 v[184:187], v[228:231], v[40:43], v[184:187]
 v_fmac_f32 v204, v220, v247
 buffer_load_dwordx4 v253, s[36:39], s85 offen offset:768 lds
 v_mfma_f32_16x16x32_bf16 v[188:191], v[228:231], v[44:47], v[188:191]
 ds_read_b64_tr_b16 v[228:229], v242 offset:8192
 ds_read_b64_tr_b16 v[230:231], v242 offset:9216
 v_mfma_f32_16x16x32_bf16 v[160:163], v[232:235], v[48:51], v[160:163]
 v_fmac_f32 v205, v221, v247
 ds_write_b128 v240, v[140:143] offset:2048
 v_mfma_f32_16x16x32_bf16 v[164:167], v[232:235], v[52:55], v[164:167]
 v_fmac_f32 v206, v222, v247
 v_fmac_f32 v207, v223, v247
 v_mfma_f32_16x16x32_bf16 v[168:171], v[232:235], v[56:59], v[168:171]
 s_waitcnt lgkmcnt(3)
 s_add_u32 m0, s70, 101632
 v_mfma_f32_16x16x32_bf16 v[172:175], v[232:235], v[60:63], v[172:175]
 ds_read_b64_tr_b16 v[232:233], v241 offset:10240
 ds_read_b64_tr_b16 v[234:235], v241 offset:11264
 v_mfma_f32_16x16x32_bf16 v[176:179], v[236:239], v[48:51], v[176:179]
 v_cvt_pk_bf16_f32 v216, v200, v201
 v_cvt_pk_bf16_f32 v217, v202, v203
 v_mfma_f32_16x16x32_bf16 v[180:183], v[236:239], v[52:55], v[180:183]
 buffer_load_dwordx4 v253, s[36:39], s86 offen offset:768 lds
 v_cvt_pk_bf16_f32 v218, v204, v205
 v_mfma_f32_16x16x32_bf16 v[184:187], v[236:239], v[56:59], v[184:187]
 v_cvt_pk_bf16_f32 v219, v206, v207
 v_mfma_f32_16x16x32_bf16 v[188:191], v[236:239], v[60:63], v[188:191]
 ds_read_b64_tr_b16 v[236:237], v242 offset:10240
 ds_read_b64_tr_b16 v[238:239], v242 offset:11264
 v_mfma_f32_16x16x32_bf16 v[160:163], v[224:227], v[64:67], v[160:163]
 s_add_u32 m0, s70, 102656
 ds_write_b128 v240, v[156:159] offset:3072
 v_mfma_f32_16x16x32_bf16 v[164:167], v[224:227], v[68:71], v[164:167]
 v_mul_f32 v192, v128, v244
 v_mfma_f32_16x16x32_bf16 v[168:171], v[224:227], v[72:75], v[168:171]
 s_waitcnt lgkmcnt(3)
 v_mul_f32 v193, v129, v244
 v_mfma_f32_16x16x32_bf16 v[172:175], v[224:227], v[76:79], v[172:175]
 ds_read_b64_tr_b16 v[224:225], v241 offset:12288
 ds_read_b64_tr_b16 v[226:227], v241 offset:13312
 v_mfma_f32_16x16x32_bf16 v[176:179], v[228:231], v[64:67], v[176:179]
 buffer_load_dwordx4 v253, s[36:39], s87 offen offset:768 lds
 v_mul_f32 v194, v130, v244
 v_mfma_f32_16x16x32_bf16 v[180:183], v[228:231], v[68:71], v[180:183]
 v_mfma_f32_16x16x32_bf16 v[184:187], v[228:231], v[72:75], v[184:187]
 s_add_u32 m0, s70, 103680
 v_mul_f32 v195, v131, v244
 v_mfma_f32_16x16x32_bf16 v[188:191], v[228:231], v[76:79], v[188:191]
 ds_read_b64_tr_b16 v[228:229], v242 offset:12288
 ds_read_b64_tr_b16 v[230:231], v242 offset:13312
 v_mfma_f32_16x16x32_bf16 v[160:163], v[232:235], v[80:83], v[160:163]
 v_mul_f32 v196, v144, v244
 v_mfma_f32_16x16x32_bf16 v[164:167], v[232:235], v[84:87], v[164:167]
 buffer_load_dwordx4 v253, s[36:39], s88 offen offset:768 lds
 v_mfma_f32_16x16x32_bf16 v[168:171], v[232:235], v[88:91], v[168:171]
 s_waitcnt lgkmcnt(2)
 buffer_store_dwordx4 v[208:211], v243, s[40:43], s65 offen sc1
 v_mfma_f32_16x16x32_bf16 v[172:175], v[232:235], v[92:95], v[172:175]
 ds_read_b64_tr_b16 v[232:233], v241 offset:14336
 ds_read_b64_tr_b16 v[234:235], v241 offset:15360
 v_mfma_f32_16x16x32_bf16 v[176:179], v[236:239], v[80:83], v[176:179]
 v_mul_f32 v197, v145, v244
 buffer_store_dwordx4 v[216:219], v248, s[40:43], s65 offen sc1
 v_mfma_f32_16x16x32_bf16 v[180:183], v[236:239], v[84:87], v[180:183]
 s_add_u32 s65, s65, 1024
 v_mul_f32 v198, v146, v244
 v_mfma_f32_16x16x32_bf16 v[184:187], v[236:239], v[88:91], v[184:187]
 s_add_u32 m0, s70, 104704
 v_mul_f32 v199, v147, v244
 v_mfma_f32_16x16x32_bf16 v[188:191], v[236:239], v[92:95], v[188:191]
 ds_read_b64_tr_b16 v[236:237], v242 offset:14336
 ds_read_b64_tr_b16 v[238:239], v242 offset:15360
 v_mfma_f32_16x16x32_bf16 v[160:163], v[224:227], v[96:99], v[160:163]
 buffer_load_dwordx4 v253, s[36:39], s89 offen offset:768 lds
 v_add_u32 v241, 32768, v241
 v_mfma_f32_16x16x32_bf16 v[164:167], v[224:227], v[100:103], v[164:167]
 v_mul_f32 v200, v132, v245
 v_mfma_f32_16x16x32_bf16 v[168:171], v[224:227], v[104:107], v[168:171]
 s_waitcnt lgkmcnt(2)
 v_mul_f32 v201, v133, v245
 v_mfma_f32_16x16x32_bf16 v[172:175], v[224:227], v[108:111], v[172:175]
 v_add_u32 v242, 32768, v242
 v_mfma_f32_16x16x32_bf16 v[176:179], v[228:231], v[96:99], v[176:179]
 v_mul_f32 v202, v134, v245
 v_mfma_f32_16x16x32_bf16 v[180:183], v[228:231], v[100:103], v[180:183]
 v_mfma_f32_16x16x32_bf16 v[184:187], v[228:231], v[104:107], v[184:187]
 s_waitcnt lgkmcnt(0)
 s_waitcnt vmcnt(20)
 s_barrier
 v_mfma_f32_16x16x32_bf16 v[188:191], v[228:231], v[108:111], v[188:191]
 ds_read_b64_tr_b16 v[224:225], v241 offset:0
 ds_read_b64_tr_b16 v[226:227], v241 offset:1024
 ds_read_b64_tr_b16 v[228:229], v242 offset:0
 ds_read_b64_tr_b16 v[230:231], v242 offset:1024
 v_mfma_f32_16x16x32_bf16 v[160:163], v[232:235], v[112:115], v[160:163]
 v_mul_f32 v203, v135, v245
 ds_read_b128 v[208:211], v252 offset:0
 v_mfma_f32_16x16x32_bf16 v[164:167], v[232:235], v[116:119], v[164:167]
 v_mul_f32 v204, v148, v245
 ds_read_b128 v[212:215], v252 offset:1024
 v_mfma_f32_16x16x32_bf16 v[168:171], v[232:235], v[120:123], v[168:171]
 v_mul_f32 v205, v149, v245
 v_mfma_f32_16x16x32_bf16 v[172:175], v[232:235], v[124:127], v[172:175]
 ds_read_b64_tr_b16 v[232:233], v241 offset:2048
 ds_read_b64_tr_b16 v[234:235], v241 offset:3072
 v_mfma_f32_16x16x32_bf16 v[176:179], v[236:239], v[112:115], v[176:179]
 ds_read_b128 v[216:219], v252 offset:2048
 v_mul_f32 v206, v150, v245
 v_mfma_f32_16x16x32_bf16 v[180:183], v[236:239], v[116:119], v[180:183]
 ds_read_b128 v[220:223], v252 offset:3072
 v_mfma_f32_16x16x32_bf16 v[184:187], v[236:239], v[120:123], v[184:187]
 v_mul_f32 v207, v151, v245
 v_mfma_f32_16x16x32_bf16 v[188:191], v[236:239], v[124:127], v[188:191]
 ds_read_b64_tr_b16 v[236:237], v242 offset:2048
 ds_read_b64_tr_b16 v[238:239], v242 offset:3072
 s_waitcnt lgkmcnt(10)
 v_mfma_f32_16x16x32_bf16 v[128:131], v[224:227], v[0:3], 0
 s_waitcnt lgkmcnt(6)
 v_mfma_f32_16x16x32_bf16 v[132:135], v[224:227], v[4:7], 0
 s_add_u32 s51, s82, 832
 v_fmac_f32 v192, v208, v246
 v_mfma_f32_16x16x32_bf16 v[136:139], v[224:227], v[8:11], 0
 v_fmac_f32 v193, v209, v246
 v_mfma_f32_16x16x32_bf16 v[140:143], v[224:227], v[12:15], 0
 ds_read_b64_tr_b16 v[224:225], v241 offset:4096
 ds_read_b64_tr_b16 v[226:227], v241 offset:5120
 v_mfma_f32_16x16x32_bf16 v[144:147], v[228:231], v[0:3], 0
 v_fmac_f32 v194, v210, v246
 s_add_u32 m0, s70, 0
 v_mfma_f32_16x16x32_bf16 v[148:151], v[228:231], v[4:7], 0
 v_and_b32 v254, 0x70, v243
 v_fmac_f32 v195, v211, v246
 v_mfma_f32_16x16x32_bf16 v[152:155], v[228:231], v[8:11], 0
 s_waitcnt lgkmcnt(6)
 v_lshlrev_b32 v254, 3, v254
 v_mfma_f32_16x16x32_bf16 v[156:159], v[228:231], v[12:15], 0
 buffer_load_dwordx2 v[254:255], v254, s[28:31], 0 offen offset:0 sc1
 ds_read_b64_tr_b16 v[228:229], v242 offset:4096
 ds_read_b64_tr_b16 v[230:231], v242 offset:5120
 v_mfma_f32_16x16x32_bf16 v[128:131], v[232:235], v[16:19], v[128:131]
 v_fmac_f32 v196, v212, v246
 buffer_load_dwordx4 v253, s[36:39], s51 offen offset:0 lds
 v_mfma_f32_16x16x32_bf16 v[132:135], v[232:235], v[20:23], v[132:135]
 v_fmac_f32 v197, v213, v246
 ds_write_b128 v240, v[168:171] offset:16384
 v_mfma_f32_16x16x32_bf16 v[136:139], v[232:235], v[24:27], v[136:139]
 s_waitcnt lgkmcnt(3)
 v_fmac_f32 v198, v214, v246
 v_mfma_f32_16x16x32_bf16 v[140:143], v[232:235], v[28:31], v[140:143]
 ds_read_b64_tr_b16 v[232:233], v241 offset:6144
 ds_read_b64_tr_b16 v[234:235], v241 offset:7168
 v_mfma_f32_16x16x32_bf16 v[144:147], v[236:239], v[16:19], v[144:147]
 s_add_u32 m0, s70, 192
 v_fmac_f32 v199, v215, v246
 v_mfma_f32_16x16x32_bf16 v[148:151], v[236:239], v[20:23], v[148:151]
 v_cvt_pk_bf16_f32 v208, v192, v193
 v_cvt_pk_bf16_f32 v209, v194, v195
 v_mfma_f32_16x16x32_bf16 v[152:155], v[236:239], v[24:27], v[152:155]
 buffer_load_dwordx4 v253, s[36:39], s83 offen offset:832 lds
 v_cvt_pk_bf16_f32 v210, v196, v197
 v_mfma_f32_16x16x32_bf16 v[156:159], v[236:239], v[28:31], v[156:159]
 ds_read_b64_tr_b16 v[236:237], v242 offset:6144
 ds_read_b64_tr_b16 v[238:239], v242 offset:7168
 v_mfma_f32_16x16x32_bf16 v[128:131], v[224:227], v[32:35], v[128:131]
 v_cvt_pk_bf16_f32 v211, v198, v199
 s_add_u32 m0, s70, 1216
 v_mfma_f32_16x16x32_bf16 v[132:135], v[224:227], v[36:39], v[132:135]
 ds_write_b128 v240, v[184:187] offset:17408
 v_mfma_f32_16x16x32_bf16 v[136:139], v[224:227], v[40:43], v[136:139]
 s_waitcnt lgkmcnt(3)
 v_fmac_f32 v200, v216, v247
 v_mfma_f32_16x16x32_bf16 v[140:143], v[224:227], v[44:47], v[140:143]
 ds_read_b64_tr_b16 v[224:225], v241 offset:8192
 ds_read_b64_tr_b16 v[226:227], v241 offset:9216
 v_mfma_f32_16x16x32_bf16 v[144:147], v[228:231], v[32:35], v[144:147]
 v_fmac_f32 v201, v217, v247
 buffer_load_dwordx4 v253, s[36:39], s84 offen offset:832 lds
 v_mfma_f32_16x16x32_bf16 v[148:151], v[228:231], v[36:39], v[148:151]
 v_fmac_f32 v202, v218, v247
 v_fmac_f32 v203, v219, v247
 v_mfma_f32_16x16x32_bf16 v[152:155], v[228:231], v[40:43], v[152:155]
 s_add_u32 m0, s70, 2240
 v_fmac_f32 v204, v220, v247
 v_mfma_f32_16x16x32_bf16 v[156:159], v[228:231], v[44:47], v[156:159]
 ds_read_b64_tr_b16 v[228:229], v242 offset:8192
 ds_read_b64_tr_b16 v[230:231], v242 offset:9216
 v_mfma_f32_16x16x32_bf16 v[128:131], v[232:235], v[48:51], v[128:131]
 v_fmac_f32 v205, v221, v247
 ds_write_b128 v240, v[172:175] offset:18432
 v_mfma_f32_16x16x32_bf16 v[132:135], v[232:235], v[52:55], v[132:135]
 buffer_load_dwordx4 v253, s[36:39], s85 offen offset:832 lds
 v_fmac_f32 v206, v222, v247
 v_mfma_f32_16x16x32_bf16 v[136:139], v[232:235], v[56:59], v[136:139]
 s_waitcnt lgkmcnt(3)
 v_fmac_f32 v207, v223, v247
 v_mfma_f32_16x16x32_bf16 v[140:143], v[232:235], v[60:63], v[140:143]
 ds_read_b64_tr_b16 v[232:233], v241 offset:10240
 ds_read_b64_tr_b16 v[234:235], v241 offset:11264
 v_mfma_f32_16x16x32_bf16 v[144:147], v[236:239], v[48:51], v[144:147]
 v_cvt_pk_bf16_f32 v216, v200, v201
 s_add_u32 m0, s70, 3264
 v_mfma_f32_16x16x32_bf16 v[148:151], v[236:239], v[52:55], v[148:151]
 v_cvt_pk_bf16_f32 v217, v202, v203
 v_cvt_pk_bf16_f32 v218, v204, v205
 v_mfma_f32_16x16x32_bf16 v[152:155], v[236:239], v[56:59], v[152:155]
 buffer_load_dwordx4 v253, s[36:39], s86 offen offset:832 lds
 v_cvt_pk_bf16_f32 v219, v206, v207
 v_mfma_f32_16x16x32_bf16 v[156:159], v[236:239], v[60:63], v[156:159]
 ds_read_b64_tr_b16 v[236:237], v242 offset:10240
 ds_read_b64_tr_b16 v[238:239], v242 offset:11264
 v_mfma_f32_16x16x32_bf16 v[128:131], v[224:227], v[64:67], v[128:131]
 ds_write_b128 v240, v[188:191] offset:19456
 v_mfma_f32_16x16x32_bf16 v[132:135], v[224:227], v[68:71], v[132:135]
 v_mul_f32 v192, v160, v244
 s_add_u32 m0, s70, 4288
 v_mfma_f32_16x16x32_bf16 v[136:139], v[224:227], v[72:75], v[136:139]
 s_waitcnt lgkmcnt(3)
 v_mul_f32 v193, v161, v244
 v_mfma_f32_16x16x32_bf16 v[140:143], v[224:227], v[76:79], v[140:143]
 ds_read_b64_tr_b16 v[224:225], v241 offset:12288
 ds_read_b64_tr_b16 v[226:227], v241 offset:13312
 v_mfma_f32_16x16x32_bf16 v[144:147], v[228:231], v[64:67], v[144:147]
 buffer_load_dwordx4 v253, s[36:39], s87 offen offset:832 lds
 v_mul_f32 v194, v162, v244
 v_mfma_f32_16x16x32_bf16 v[148:151], v[228:231], v[68:71], v[148:151]
 v_mfma_f32_16x16x32_bf16 v[152:155], v[228:231], v[72:75], v[152:155]
 v_mul_f32 v195, v163, v244
 v_mfma_f32_16x16x32_bf16 v[156:159], v[228:231], v[76:79], v[156:159]
 ds_read_b64_tr_b16 v[228:229], v242 offset:12288
 ds_read_b64_tr_b16 v[230:231], v242 offset:13312
 v_mfma_f32_16x16x32_bf16 v[128:131], v[232:235], v[80:83], v[128:131]
 s_add_u32 m0, s70, 5312
 v_mul_f32 v196, v176, v244
 v_mfma_f32_16x16x32_bf16 v[132:135], v[232:235], v[84:87], v[132:135]
 v_mfma_f32_16x16x32_bf16 v[136:139], v[232:235], v[88:91], v[136:139]
 s_waitcnt lgkmcnt(2)
 buffer_store_dwordx4 v[208:211], v243, s[40:43], s65 offen sc1
 v_mfma_f32_16x16x32_bf16 v[140:143], v[232:235], v[92:95], v[140:143]
 ds_read_b64_tr_b16 v[232:233], v241 offset:14336
 ds_read_b64_tr_b16 v[234:235], v241 offset:15360
 v_mfma_f32_16x16x32_bf16 v[144:147], v[236:239], v[80:83], v[144:147]
 buffer_load_dwordx4 v253, s[36:39], s88 offen offset:832 lds
 v_mul_f32 v197, v177, v244
 v_mfma_f32_16x16x32_bf16 v[148:151], v[236:239], v[84:87], v[148:151]
 buffer_store_dwordx4 v[216:219], v248, s[40:43], s65 offen sc1
 s_add_u32 s65, s65, 1024
 v_mfma_f32_16x16x32_bf16 v[152:155], v[236:239], v[88:91], v[152:155]
 v_mul_f32 v198, v178, v244
 s_add_u32 m0, s70, 6336
 v_mfma_f32_16x16x32_bf16 v[156:159], v[236:239], v[92:95], v[156:159]
 ds_read_b64_tr_b16 v[236:237], v242 offset:14336
 ds_read_b64_tr_b16 v[238:239], v242 offset:15360
 v_mfma_f32_16x16x32_bf16 v[128:131], v[224:227], v[96:99], v[128:131]
 v_mul_f32 v199, v179, v244
 v_add_u32 v241, 32768, v241
 v_mfma_f32_16x16x32_bf16 v[132:135], v[224:227], v[100:103], v[132:135]
 buffer_load_dwordx4 v253, s[36:39], s89 offen offset:832 lds
 v_mul_f32 v200, v164, v245
 v_mfma_f32_16x16x32_bf16 v[136:139], v[224:227], v[104:107], v[136:139]
 s_waitcnt lgkmcnt(2)
 v_mul_f32 v201, v165, v245
 v_mfma_f32_16x16x32_bf16 v[140:143], v[224:227], v[108:111], v[140:143]
 v_add_u32 v242, 32768, v242
 v_mfma_f32_16x16x32_bf16 v[144:147], v[228:231], v[96:99], v[144:147]
 v_mul_f32 v202, v166, v245
 v_mfma_f32_16x16x32_bf16 v[148:151], v[228:231], v[100:103], v[148:151]
 s_waitcnt vmcnt(12)
 v_mfma_f32_16x16x32_bf16 v[152:155], v[228:231], v[104:107], v[152:155]
 s_waitcnt lgkmcnt(0)
 s_barrier
 v_mfma_f32_16x16x32_bf16 v[156:159], v[228:231], v[108:111], v[156:159]
 ds_read_b64_tr_b16 v[224:225], v241 offset:0
 ds_read_b64_tr_b16 v[226:227], v241 offset:1024
 ds_read_b64_tr_b16 v[228:229], v242 offset:0
 ds_read_b64_tr_b16 v[230:231], v242 offset:1024
 buffer_store_dwordx2 a[250:251], off, s[20:23], 0 offset:8 sc1
 v_mfma_f32_16x16x32_bf16 v[128:131], v[232:235], v[112:115], v[128:131]
 v_mul_f32 v203, v167, v245
 ds_read_b128 v[208:211], v252 offset:16384
 v_mfma_f32_16x16x32_bf16 v[132:135], v[232:235], v[116:119], v[132:135]
 v_mul_f32 v204, v180, v245
 ds_read_b128 v[212:215], v252 offset:17408
 v_mfma_f32_16x16x32_bf16 v[136:139], v[232:235], v[120:123], v[136:139]
 v_mul_f32 v205, v181, v245
 v_mfma_f32_16x16x32_bf16 v[140:143], v[232:235], v[124:127], v[140:143]
 ds_read_b64_tr_b16 v[232:233], v241 offset:2048
 ds_read_b64_tr_b16 v[234:235], v241 offset:3072
 v_mfma_f32_16x16x32_bf16 v[144:147], v[236:239], v[112:115], v[144:147]
 ds_read_b128 v[216:219], v252 offset:18432
 v_mul_f32 v206, v182, v245
 v_mfma_f32_16x16x32_bf16 v[148:151], v[236:239], v[116:119], v[148:151]
 ds_read_b128 v[220:223], v252 offset:19456
 v_mfma_f32_16x16x32_bf16 v[152:155], v[236:239], v[120:123], v[152:155]
 v_mul_f32 v207, v183, v245
 v_mfma_f32_16x16x32_bf16 v[156:159], v[236:239], v[124:127], v[156:159]
 ds_read_b64_tr_b16 v[236:237], v242 offset:2048
 ds_read_b64_tr_b16 v[238:239], v242 offset:3072
 s_waitcnt lgkmcnt(10)
 v_mfma_f32_16x16x32_bf16 v[160:163], v[224:227], v[0:3], 0
 s_waitcnt lgkmcnt(6)
 v_mfma_f32_16x16x32_bf16 v[164:167], v[224:227], v[4:7], 0
 v_fmac_f32 v192, v208, v246
 v_mfma_f32_16x16x32_bf16 v[168:171], v[224:227], v[8:11], 0
 v_mfma_f32_16x16x32_bf16 v[172:175], v[224:227], v[12:15], 0
 ds_read_b64_tr_b16 v[224:225], v241 offset:4096
 ds_read_b64_tr_b16 v[226:227], v241 offset:5120
 v_mfma_f32_16x16x32_bf16 v[176:179], v[228:231], v[0:3], 0
 s_waitcnt vmcnt(11)
 v_cmp_ge_u64 s[92:93], v[254:255], s[98:99]
 v_cmp_lt_u64 vcc, v[254:255], s[100:101]
 s_nop 3
 s_and_b64 s[92:93], s[92:93], vcc
 s_cmp_eq_u64 s[92:93], -1
 s_cselect_b32 s26, s62, 0
 s_cselect_b32 s95, 0, 1
 s_or_b32 s67, s67, s95
 v_mfma_f32_16x16x32_bf16 v[180:183], v[228:231], v[4:7], 0
 v_fmac_f32 v193, v209, v246
 v_fmac_f32 v194, v210, v246
 v_mfma_f32_16x16x32_bf16 v[184:187], v[228:231], v[8:11], 0
 s_waitcnt lgkmcnt(6)
 v_fmac_f32 v195, v211, v246
 v_mfma_f32_16x16x32_bf16 v[188:191], v[228:231], v[12:15], 0
 ds_read_b64_tr_b16 v[228:229], v242 offset:4096
 ds_read_b64_tr_b16 v[230:231], v242 offset:5120
 v_mfma_f32_16x16x32_bf16 v[160:163], v[232:235], v[16:19], v[160:163]
 v_fmac_f32 v196, v212, v246
 v_fmac_f32 v197, v213, v246
 v_mfma_f32_16x16x32_bf16 v[164:167], v[232:235], v[20:23], v[164:167]
 ds_write_b128 v240, v[136:139] offset:0
 v_fmac_f32 v198, v214, v246
 v_mfma_f32_16x16x32_bf16 v[168:171], v[232:235], v[24:27], v[168:171]
 s_waitcnt lgkmcnt(3)
 v_fmac_f32 v199, v215, v246
 v_mfma_f32_16x16x32_bf16 v[172:175], v[232:235], v[28:31], v[172:175]
 ds_read_b64_tr_b16 v[232:233], v241 offset:6144
 ds_read_b64_tr_b16 v[234:235], v241 offset:7168
 v_mfma_f32_16x16x32_bf16 v[176:179], v[236:239], v[16:19], v[176:179]
 s_add_u32 s94, s53, 0
 v_cvt_pk_bf16_f32 v208, v192, v193
 v_mfma_f32_16x16x32_bf16 v[180:183], v[236:239], v[20:23], v[180:183]
 buffer_load_dwordx4 a[0:3], v243, s[24:27], s94 offen sc1
 s_add_u32 s94, s94, 229376
 v_mfma_f32_16x16x32_bf16 v[184:187], v[236:239], v[24:27], v[184:187]
 v_cvt_pk_bf16_f32 v209, v194, v195
 buffer_load_dwordx4 a[4:7], v243, s[24:27], s94 offen sc1
 v_mfma_f32_16x16x32_bf16 v[188:191], v[236:239], v[28:31], v[188:191]
 ds_read_b64_tr_b16 v[236:237], v242 offset:6144
 ds_read_b64_tr_b16 v[238:239], v242 offset:7168
 v_mfma_f32_16x16x32_bf16 v[160:163], v[224:227], v[32:35], v[160:163]
 v_cvt_pk_bf16_f32 v210, v196, v197
 s_add_u32 s94, s94, 229376
 v_mfma_f32_16x16x32_bf16 v[164:167], v[224:227], v[36:39], v[164:167]
 v_cvt_pk_bf16_f32 v211, v198, v199
 buffer_load_dwordx4 a[8:11], v243, s[24:27], s94 offen sc1
 v_mfma_f32_16x16x32_bf16 v[168:171], v[224:227], v[40:43], v[168:171]
 s_waitcnt lgkmcnt(2)
 s_add_u32 s94, s94, 229376
 v_mfma_f32_16x16x32_bf16 v[172:175], v[224:227], v[44:47], v[172:175]
 ds_read_b64_tr_b16 v[224:225], v241 offset:8192
 ds_read_b64_tr_b16 v[226:227], v241 offset:9216
 ds_write_b128 v240, v[152:155] offset:1024
 v_mfma_f32_16x16x32_bf16 v[176:179], v[228:231], v[32:35], v[176:179]
 buffer_load_dwordx4 a[12:15], v243, s[24:27], s94 offen sc1
 v_fmac_f32 v200, v216, v247
 s_add_u32 s94, s94, 229376
 v_mfma_f32_16x16x32_bf16 v[180:183], v[228:231], v[36:39], v[180:183]
 v_fmac_f32 v201, v217, v247
 buffer_load_dwordx4 a[16:19], v243, s[24:27], s94 offen sc1
 s_add_u32 s94, s94, 229376
 v_mfma_f32_16x16x32_bf16 v[184:187], v[228:231], v[40:43], v[184:187]
 v_fmac_f32 v202, v218, v247
 buffer_load_dwordx4 a[20:23], v243, s[24:27], s94 offen sc1
 v_mfma_f32_16x16x32_bf16 v[188:191], v[228:231], v[44:47], v[188:191]
 ds_read_b64_tr_b16 v[228:229], v242 offset:8192
 ds_read_b64_tr_b16 v[230:231], v242 offset:9216
 v_fmac_f32 v203, v219, v247
 v_mfma_f32_16x16x32_bf16 v[160:163], v[232:235], v[48:51], v[160:163]
 s_add_u32 s94, s94, 229376
 buffer_load_dwordx4 a[24:27], v243, s[24:27], s94 offen sc1
 s_add_u32 s94, s94, 229376
 buffer_load_dwordx4 a[28:31], v243, s[24:27], s94 offen sc1
 v_mfma_f32_16x16x32_bf16 v[164:167], v[232:235], v[52:55], v[164:167]
 v_fmac_f32 v204, v220, v247
 v_fmac_f32 v205, v221, v247
 v_mfma_f32_16x16x32_bf16 v[168:171], v[232:235], v[56:59], v[168:171]
 s_waitcnt lgkmcnt(3)
 ds_write_b128 v240, v[140:143] offset:2048
 v_mfma_f32_16x16x32_bf16 v[172:175], v[232:235], v[60:63], v[172:175]
 ds_read_b64_tr_b16 v[232:233], v241 offset:10240
 ds_read_b64_tr_b16 v[234:235], v241 offset:11264
 v_fmac_f32 v206, v222, v247
 v_mfma_f32_16x16x32_bf16 v[176:179], v[236:239], v[48:51], v[176:179]
 v_fmac_f32 v207, v223, v247
 v_cvt_pk_bf16_f32 v216, v200, v201
 v_mfma_f32_16x16x32_bf16 v[180:183], v[236:239], v[52:55], v[180:183]
 v_cvt_pk_bf16_f32 v217, v202, v203
 v_cvt_pk_bf16_f32 v218, v204, v205
 v_mfma_f32_16x16x32_bf16 v[184:187], v[236:239], v[56:59], v[184:187]
 v_cvt_pk_bf16_f32 v219, v206, v207
 v_mfma_f32_16x16x32_bf16 v[188:191], v[236:239], v[60:63], v[188:191]
 ds_read_b64_tr_b16 v[236:237], v242 offset:10240
 ds_read_b64_tr_b16 v[238:239], v242 offset:11264
 v_mfma_f32_16x16x32_bf16 v[160:163], v[224:227], v[64:67], v[160:163]
 ds_write_b128 v240, v[156:159] offset:3072
 v_mfma_f32_16x16x32_bf16 v[164:167], v[224:227], v[68:71], v[164:167]
 v_mul_f32 v192, v128, v244
 v_mfma_f32_16x16x32_bf16 v[168:171], v[224:227], v[72:75], v[168:171]
 s_waitcnt lgkmcnt(3)
 v_mul_f32 v193, v129, v244
 v_mfma_f32_16x16x32_bf16 v[172:175], v[224:227], v[76:79], v[172:175]
 ds_read_b64_tr_b16 v[224:225], v241 offset:12288
 ds_read_b64_tr_b16 v[226:227], v241 offset:13312
 v_mfma_f32_16x16x32_bf16 v[176:179], v[228:231], v[64:67], v[176:179]
 v_mul_f32 v194, v130, v244
 v_mfma_f32_16x16x32_bf16 v[180:183], v[228:231], v[68:71], v[180:183]
 v_mfma_f32_16x16x32_bf16 v[184:187], v[228:231], v[72:75], v[184:187]
 v_mul_f32 v195, v131, v244
 v_mfma_f32_16x16x32_bf16 v[188:191], v[228:231], v[76:79], v[188:191]
 ds_read_b64_tr_b16 v[228:229], v242 offset:12288
 ds_read_b64_tr_b16 v[230:231], v242 offset:13312
 v_mfma_f32_16x16x32_bf16 v[160:163], v[232:235], v[80:83], v[160:163]
 v_mul_f32 v196, v144, v244
 v_mfma_f32_16x16x32_bf16 v[164:167], v[232:235], v[84:87], v[164:167]
 v_mfma_f32_16x16x32_bf16 v[168:171], v[232:235], v[88:91], v[168:171]
 s_waitcnt lgkmcnt(2)
 buffer_store_dwordx4 v[208:211], v243, s[40:43], s65 offen sc1
 v_mfma_f32_16x16x32_bf16 v[172:175], v[232:235], v[92:95], v[172:175]
 ds_read_b64_tr_b16 v[232:233], v241 offset:14336
 ds_read_b64_tr_b16 v[234:235], v241 offset:15360
 v_mfma_f32_16x16x32_bf16 v[176:179], v[236:239], v[80:83], v[176:179]
 v_mul_f32 v197, v145, v244
 buffer_store_dwordx4 v[216:219], v248, s[40:43], s65 offen sc1
 v_mfma_f32_16x16x32_bf16 v[180:183], v[236:239], v[84:87], v[180:183]
 s_add_u32 s65, s65, 1024
 v_mul_f32 v198, v146, v244
 v_mfma_f32_16x16x32_bf16 v[184:187], v[236:239], v[88:91], v[184:187]
 v_mul_f32 v199, v147, v244
 v_mfma_f32_16x16x32_bf16 v[188:191], v[236:239], v[92:95], v[188:191]
 ds_read_b64_tr_b16 v[236:237], v242 offset:14336
 ds_read_b64_tr_b16 v[238:239], v242 offset:15360
 v_mfma_f32_16x16x32_bf16 v[160:163], v[224:227], v[96:99], v[160:163]
 v_add_u32 v241, 32768, v241
 v_mul_f32 v200, v132, v245
 v_mfma_f32_16x16x32_bf16 v[164:167], v[224:227], v[100:103], v[164:167]
 v_mfma_f32_16x16x32_bf16 v[168:171], v[224:227], v[104:107], v[168:171]
 s_waitcnt lgkmcnt(2)
 v_mul_f32 v201, v133, v245
 v_mfma_f32_16x16x32_bf16 v[172:175], v[224:227], v[108:111], v[172:175]
 v_add_u32 v242, 32768, v242
 v_mfma_f32_16x16x32_bf16 v[176:179], v[228:231], v[96:99], v[176:179]
 v_mul_f32 v202, v134, v245
 v_mfma_f32_16x16x32_bf16 v[180:183], v[228:231], v[100:103], v[180:183]
 v_mfma_f32_16x16x32_bf16 v[184:187], v[228:231], v[104:107], v[184:187]
 s_waitcnt lgkmcnt(0)
 s_barrier
 v_mfma_f32_16x16x32_bf16 v[188:191], v[228:231], v[108:111], v[188:191]
 ds_read_b64_tr_b16 v[224:225], v241 offset:0
 ds_read_b64_tr_b16 v[226:227], v241 offset:1024
 ds_read_b64_tr_b16 v[228:229], v242 offset:0
 ds_read_b64_tr_b16 v[230:231], v242 offset:1024
 v_mfma_f32_16x16x32_bf16 v[160:163], v[232:235], v[112:115], v[160:163]
 v_mul_f32 v203, v135, v245
 ds_read_b128 v[208:211], v252 offset:0
 v_mfma_f32_16x16x32_bf16 v[164:167], v[232:235], v[116:119], v[164:167]
 v_mul_f32 v204, v148, v245
 ds_read_b128 v[212:215], v252 offset:1024
 v_mfma_f32_16x16x32_bf16 v[168:171], v[232:235], v[120:123], v[168:171]
 v_mul_f32 v205, v149, v245
 v_mfma_f32_16x16x32_bf16 v[172:175], v[232:235], v[124:127], v[172:175]
 ds_read_b64_tr_b16 v[232:233], v241 offset:2048
 ds_read_b64_tr_b16 v[234:235], v241 offset:3072
 v_mfma_f32_16x16x32_bf16 v[176:179], v[236:239], v[112:115], v[176:179]
 ds_read_b128 v[216:219], v252 offset:2048
 v_mul_f32 v206, v150, v245
 v_mfma_f32_16x16x32_bf16 v[180:183], v[236:239], v[116:119], v[180:183]
 ds_read_b128 v[220:223], v252 offset:3072
 v_mfma_f32_16x16x32_bf16 v[184:187], v[236:239], v[120:123], v[184:187]
 v_mul_f32 v207, v151, v245
 v_mfma_f32_16x16x32_bf16 v[188:191], v[236:239], v[124:127], v[188:191]
 ds_read_b64_tr_b16 v[236:237], v242 offset:2048
 ds_read_b64_tr_b16 v[238:239], v242 offset:3072
 s_waitcnt lgkmcnt(10)
 v_mfma_f32_16x16x32_bf16 v[128:131], v[224:227], v[0:3], 0
 s_waitcnt lgkmcnt(6)
 v_mfma_f32_16x16x32_bf16 v[132:135], v[224:227], v[4:7], 0
 v_fmac_f32 v192, v208, v246
 v_mfma_f32_16x16x32_bf16 v[136:139], v[224:227], v[8:11], 0
 v_fmac_f32 v193, v209, v246
 v_mfma_f32_16x16x32_bf16 v[140:143], v[224:227], v[12:15], 0
 ds_read_b64_tr_b16 v[224:225], v241 offset:4096
 ds_read_b64_tr_b16 v[226:227], v241 offset:5120
 v_mfma_f32_16x16x32_bf16 v[144:147], v[228:231], v[0:3], 0
 v_fmac_f32 v194, v210, v246
 v_fmac_f32 v195, v211, v246
 v_mfma_f32_16x16x32_bf16 v[148:151], v[228:231], v[4:7], 0
 v_mfma_f32_16x16x32_bf16 v[152:155], v[228:231], v[8:11], 0
 s_waitcnt lgkmcnt(6)
 v_fmac_f32 v196, v212, v246
 v_mfma_f32_16x16x32_bf16 v[156:159], v[228:231], v[12:15], 0
 ds_read_b64_tr_b16 v[228:229], v242 offset:4096
 ds_read_b64_tr_b16 v[230:231], v242 offset:5120
 v_mfma_f32_16x16x32_bf16 v[128:131], v[232:235], v[16:19], v[128:131]
 v_fmac_f32 v197, v213, v246
 ds_write_b128 v240, v[168:171] offset:16384
 v_mfma_f32_16x16x32_bf16 v[132:135], v[232:235], v[20:23], v[132:135]
 v_fmac_f32 v198, v214, v246
 v_fmac_f32 v199, v215, v246
 v_mfma_f32_16x16x32_bf16 v[136:139], v[232:235], v[24:27], v[136:139]
 s_waitcnt lgkmcnt(3)
 v_and_b32 v254, 0x70, v243
 v_mfma_f32_16x16x32_bf16 v[140:143], v[232:235], v[28:31], v[140:143]
 ds_read_b64_tr_b16 v[232:233], v241 offset:6144
 ds_read_b64_tr_b16 v[234:235], v241 offset:7168
 v_mfma_f32_16x16x32_bf16 v[144:147], v[236:239], v[16:19], v[144:147]
 v_cvt_pk_bf16_f32 v208, v192, v193
 v_lshlrev_b32 v254, 3, v254
 v_mfma_f32_16x16x32_bf16 v[148:151], v[236:239], v[20:23], v[148:151]
 buffer_load_dwordx2 v[254:255], v254, s[28:31], 0 offen offset:8 sc1
 v_cvt_pk_bf16_f32 v209, v194, v195
 v_mfma_f32_16x16x32_bf16 v[152:155], v[236:239], v[24:27], v[152:155]
 v_cvt_pk_bf16_f32 v210, v196, v197
 v_cvt_pk_bf16_f32 v211, v198, v199
 v_mfma_f32_16x16x32_bf16 v[156:159], v[236:239], v[28:31], v[156:159]
 ds_read_b64_tr_b16 v[236:237], v242 offset:6144
 ds_read_b64_tr_b16 v[238:239], v242 offset:7168
 v_mfma_f32_16x16x32_bf16 v[128:131], v[224:227], v[32:35], v[128:131]
 ds_write_b128 v240, v[184:187] offset:17408
 v_mfma_f32_16x16x32_bf16 v[132:135], v[224:227], v[36:39], v[132:135]
 v_fmac_f32 v200, v216, v247
 v_mfma_f32_16x16x32_bf16 v[136:139], v[224:227], v[40:43], v[136:139]
 s_waitcnt lgkmcnt(3)
 v_fmac_f32 v201, v217, v247
 v_mfma_f32_16x16x32_bf16 v[140:143], v[224:227], v[44:47], v[140:143]
 ds_read_b64_tr_b16 v[224:225], v241 offset:8192
 ds_read_b64_tr_b16 v[226:227], v241 offset:9216
 v_mfma_f32_16x16x32_bf16 v[144:147], v[228:231], v[32:35], v[144:147]
 v_fmac_f32 v202, v218, v247
 v_fmac_f32 v203, v219, v247
 v_mfma_f32_16x16x32_bf16 v[148:151], v[228:231], v[36:39], v[148:151]
 v_mfma_f32_16x16x32_bf16 v[152:155], v[228:231], v[40:43], v[152:155]
 v_fmac_f32 v204, v220, v247
 v_mfma_f32_16x16x32_bf16 v[156:159], v[228:231], v[44:47], v[156:159]
 ds_read_b64_tr_b16 v[228:229], v242 offset:8192
 ds_read_b64_tr_b16 v[230:231], v242 offset:9216
 v_mfma_f32_16x16x32_bf16 v[128:131], v[232:235], v[48:51], v[128:131]
 v_fmac_f32 v205, v221, v247
 ds_write_b128 v240, v[172:175] offset:18432
 v_mfma_f32_16x16x32_bf16 v[132:135], v[232:235], v[52:55], v[132:135]
 v_fmac_f32 v206, v222, v247
 v_fmac_f32 v207, v223, v247
 v_mfma_f32_16x16x32_bf16 v[136:139], v[232:235], v[56:59], v[136:139]
 s_waitcnt lgkmcnt(3)
 v_mfma_f32_16x16x32_bf16 v[140:143], v[232:235], v[60:63], v[140:143]
 ds_read_b64_tr_b16 v[232:233], v241 offset:10240
 ds_read_b64_tr_b16 v[234:235], v241 offset:11264
 v_mfma_f32_16x16x32_bf16 v[144:147], v[236:239], v[48:51], v[144:147]
 v_cvt_pk_bf16_f32 v216, v200, v201
 v_cvt_pk_bf16_f32 v217, v202, v203
 v_mfma_f32_16x16x32_bf16 v[148:151], v[236:239], v[52:55], v[148:151]
 v_cvt_pk_bf16_f32 v218, v204, v205
 v_mfma_f32_16x16x32_bf16 v[152:155], v[236:239], v[56:59], v[152:155]
 v_cvt_pk_bf16_f32 v219, v206, v207
 v_mfma_f32_16x16x32_bf16 v[156:159], v[236:239], v[60:63], v[156:159]
 ds_read_b64_tr_b16 v[236:237], v242 offset:10240
 ds_read_b64_tr_b16 v[238:239], v242 offset:11264
 v_mfma_f32_16x16x32_bf16 v[128:131], v[224:227], v[64:67], v[128:131]
 ds_write_b128 v240, v[188:191] offset:19456
 v_mfma_f32_16x16x32_bf16 v[132:135], v[224:227], v[68:71], v[132:135]
 v_mul_f32 v192, v160, v244
 v_mfma_f32_16x16x32_bf16 v[136:139], v[224:227], v[72:75], v[136:139]
 s_waitcnt lgkmcnt(3)
 v_mul_f32 v193, v161, v244
 v_mfma_f32_16x16x32_bf16 v[140:143], v[224:227], v[76:79], v[140:143]
 ds_read_b64_tr_b16 v[224:225], v241 offset:12288
 ds_read_b64_tr_b16 v[226:227], v241 offset:13312
 v_mfma_f32_16x16x32_bf16 v[144:147], v[228:231], v[64:67], v[144:147]
 s_waitcnt vmcnt(10)
 v_mul_f32 v194, v162, v244
 v_mfma_f32_16x16x32_bf16 v[148:151], v[228:231], v[68:71], v[148:151]
 v_mfma_f32_16x16x32_bf16 a[128:131], a[160:163], a[0:3], 0
 v_mfma_f32_16x16x32_bf16 v[152:155], v[228:231], v[72:75], v[152:155]
 v_mfma_f32_16x16x32_bf16 a[132:135], a[164:167], a[0:3], 0
 v_mul_f32 v195, v163, v244
 v_mfma_f32_16x16x32_bf16 v[156:159], v[228:231], v[76:79], v[156:159]
 ds_read_b64_tr_b16 v[228:229], v242 offset:12288
 ds_read_b64_tr_b16 v[230:231], v242 offset:13312
 v_mfma_f32_16x16x32_bf16 v[128:131], v[232:235], v[80:83], v[128:131]
 s_waitcnt vmcnt(9)
 v_mfma_f32_16x16x32_bf16 a[128:131], a[160:163], a[4:7], a[128:131]
 v_mfma_f32_16x16x32_bf16 v[132:135], v[232:235], v[84:87], v[132:135]
 v_mul_f32 v196, v176, v244
 v_mfma_f32_16x16x32_bf16 a[132:135], a[164:167], a[4:7], a[132:135]
 v_mfma_f32_16x16x32_bf16 v[136:139], v[232:235], v[88:91], v[136:139]
 s_waitcnt lgkmcnt(2)
 buffer_store_dwordx4 v[208:211], v243, s[40:43], s65 offen sc1
 v_mfma_f32_16x16x32_bf16 v[140:143], v[232:235], v[92:95], v[140:143]
 ds_read_b64_tr_b16 v[232:233], v241 offset:14336
 ds_read_b64_tr_b16 v[234:235], v241 offset:15360
 v_mfma_f32_16x16x32_bf16 v[144:147], v[236:239], v[80:83], v[144:147]
 v_mul_f32 v197, v177, v244
 s_waitcnt vmcnt(9)
 v_mfma_f32_16x16x32_bf16 v[148:151], v[236:239], v[84:87], v[148:151]
 buffer_store_dwordx4 v[216:219], v248, s[40:43], s65 offen sc1
 s_add_u32 s65, s65, 1024
 v_mfma_f32_16x16x32_bf16 v[152:155], v[236:239], v[88:91], v[152:155]
 v_mfma_f32_16x16x32_bf16 a[128:131], a[160:163], a[8:11], a[128:131]
 v_mul_f32 v198, v178, v244
 v_mfma_f32_16x16x32_bf16 v[156:159], v[236:239], v[92:95], v[156:159]
 ds_read_b64_tr_b16 v[236:237], v242 offset:14336
 ds_read_b64_tr_b16 v[238:239], v242 offset:15360
 v_mfma_f32_16x16x32_bf16 a[132:135], a[164:167], a[8:11], a[132:135]
 v_mfma_f32_16x16x32_bf16 v[128:131], v[224:227], v[96:99], v[128:131]
 s_waitcnt vmcnt(9)
 v_mul_f32 v199, v179, v244
 v_mfma_f32_16x16x32_bf16 v[132:135], v[224:227], v[100:103], v[132:135]
 v_mfma_f32_16x16x32_bf16 a[128:131], a[160:163], a[12:15], a[128:131]
 v_subrev_u32 v241, 98304, v241
 v_mfma_f32_16x16x32_bf16 v[136:139], v[224:227], v[104:107], v[136:139]
 s_waitcnt lgkmcnt(2)
 v_mul_f32 v200, v164, v245
 v_mfma_f32_16x16x32_bf16 v[140:143], v[224:227], v[108:111], v[140:143]
 v_mfma_f32_16x16x32_bf16 a[132:135], a[164:167], a[12:15], a[132:135]
 s_waitcnt vmcnt(8)
 v_mfma_f32_16x16x32_bf16 v[144:147], v[228:231], v[96:99], v[144:147]
 v_mul_f32 v201, v165, v245
 v_mfma_f32_16x16x32_bf16 a[128:131], a[160:163], a[16:19], a[128:131]
 v_mfma_f32_16x16x32_bf16 v[148:151], v[228:231], v[100:103], v[148:151]
 v_subrev_u32 v242, 98304, v242
 v_mfma_f32_16x16x32_bf16 a[132:135], a[164:167], a[16:19], a[132:135]
 v_mfma_f32_16x16x32_bf16 v[152:155], v[228:231], v[104:107], v[152:155]
 s_waitcnt lgkmcnt(0)
 s_barrier
 v_mfma_f32_16x16x32_bf16 v[156:159], v[228:231], v[108:111], v[156:159]
 ds_read_b64_tr_b16 v[224:225], v241 offset:0
 ds_read_b64_tr_b16 v[226:227], v241 offset:1024
 ds_read_b64_tr_b16 v[228:229], v242 offset:0
 ds_read_b64_tr_b16 v[230:231], v242 offset:1024
 v_mfma_f32_16x16x32_bf16 v[128:131], v[232:235], v[112:115], v[128:131]
 v_mul_f32 v202, v166, v245
 s_waitcnt vmcnt(7)
 v_mul_f32 v203, v167, v245
 v_mfma_f32_16x16x32_bf16 v[132:135], v[232:235], v[116:119], v[132:135]
 v_mfma_f32_16x16x32_bf16 a[128:131], a[160:163], a[20:23], a[128:131]
 v_mfma_f32_16x16x32_bf16 a[132:135], a[164:167], a[20:23], a[132:135]
 v_mfma_f32_16x16x32_bf16 v[136:139], v[232:235], v[120:123], v[136:139]
 ds_read_b128 v[208:211], v252 offset:16384
 v_mul_f32 v204, v180, v245
 v_mfma_f32_16x16x32_bf16 v[140:143], v[232:235], v[124:127], v[140:143]
 ds_read_b64_tr_b16 v[232:233], v241 offset:2048
 ds_read_b64_tr_b16 v[234:235], v241 offset:3072
 s_waitcnt vmcnt(6)
 v_mfma_f32_16x16x32_bf16 v[144:147], v[236:239], v[112:115], v[144:147]
 ds_read_b128 v[212:215], v252 offset:17408
 v_mfma_f32_16x16x32_bf16 a[128:131], a[160:163], a[24:27], a[128:131]
 v_mul_f32 v205, v181, v245
 v_mfma_f32_16x16x32_bf16 v[148:151], v[236:239], v[116:119], v[148:151]
 v_mfma_f32_16x16x32_bf16 a[132:135], a[164:167], a[24:27], a[132:135]
 ds_read_b128 v[216:219], v252 offset:18432
 v_mfma_f32_16x16x32_bf16 v[152:155], v[236:239], v[120:123], v[152:155]
 ds_read_b128 v[220:223], v252 offset:19456
 v_mul_f32 v206, v182, v245
 v_mfma_f32_16x16x32_bf16 v[156:159], v[236:239], v[124:127], v[156:159]
 s_waitcnt vmcnt(5)
 v_mfma_f32_16x16x32_bf16 a[128:131], a[160:163], a[28:31], a[128:131]
 v_mul_f32 v207, v183, v245
 v_mfma_f32_16x16x32_bf16 a[132:135], a[164:167], a[28:31], a[132:135]
 ds_read_b64_tr_b16 v[236:237], v242 offset:2048
 ds_read_b64_tr_b16 v[238:239], v242 offset:3072
 s_waitcnt lgkmcnt(10)
 v_mfma_f32_16x16x32_bf16 v[160:163], v[224:227], v[0:3], 0
 s_waitcnt lgkmcnt(4)
 v_mfma_f32_16x16x32_bf16 v[164:167], v[224:227], v[4:7], 0
 v_fmac_f32 v192, v208, v246
 v_mfma_f32_16x16x32_bf16 v[168:171], v[224:227], v[8:11], 0
 v_fmac_f32 v193, v209, v246
 v_mfma_f32_16x16x32_bf16 v[172:175], v[224:227], v[12:15], 0
 ds_read_b64_tr_b16 v[224:225], v241 offset:4096
 ds_read_b64_tr_b16 v[226:227], v241 offset:5120
 v_mfma_f32_16x16x32_bf16 v[176:179], v[228:231], v[0:3], 0
 v_fmac_f32 v194, v210, v246
 v_mfma_f32_16x16x32_bf16 v[180:183], v[228:231], v[4:7], 0
 v_mfma_f32_16x16x32_bf16 v[184:187], v[228:231], v[8:11], 0
 s_waitcnt vmcnt(2)
 v_cmp_ge_u64 s[92:93], v[254:255], s[98:99]
 v_cmp_lt_u64 vcc, v[254:255], s[100:101]
 s_nop 3
 s_and_b64 s[92:93], s[92:93], vcc
 s_cmp_eq_u64 s[92:93], -1
 s_cselect_b32 s26, s62, 0
 s_cselect_b32 s95, 0, 2
 s_or_b32 s67, s67, s95
 v_mfma_f32_16x16x32_bf16 v[188:191], v[228:231], v[12:15], 0
 ds_read_b64_tr_b16 v[228:229], v242 offset:4096
 ds_read_b64_tr_b16 v[230:231], v242 offset:5120
 v_fmac_f32 v195, v211, v246
 v_mfma_f32_16x16x32_bf16 v[160:163], v[232:235], v[16:19], v[160:163]
 v_fmac_f32 v196, v212, v246
 v_fmac_f32 v197, v213, v246
 v_mfma_f32_16x16x32_bf16 v[164:167], v[232:235], v[20:23], v[164:167]
 ds_write_b128 v240, v[136:139] offset:0
 v_fmac_f32 v198, v214, v246
 v_mfma_f32_16x16x32_bf16 v[168:171], v[232:235], v[24:27], v[168:171]
 s_waitcnt lgkmcnt(3)
 v_fmac_f32 v199, v215, v246
 v_mfma_f32_16x16x32_bf16 v[172:175], v[232:235], v[28:31], v[172:175]
 ds_read_b64_tr_b16 v[232:233], v241 offset:6144
 ds_read_b64_tr_b16 v[234:235], v241 offset:7168
 v_mfma_f32_16x16x32_bf16 v[176:179], v[236:239], v[16:19], v[176:179]
 v_cvt_pk_bf16_f32 v208, v192, v193
 v_cvt_pk_bf16_f32 v209, v194, v195
 v_mfma_f32_16x16x32_bf16 v[180:183], v[236:239], v[20:23], v[180:183]
 v_cvt_pk_bf16_f32 v210, v196, v197
 v_mfma_f32_16x16x32_bf16 v[184:187], v[236:239], v[24:27], v[184:187]
 v_cvt_pk_bf16_f32 v211, v198, v199
 v_mfma_f32_16x16x32_bf16 v[188:191], v[236:239], v[28:31], v[188:191]
 ds_read_b64_tr_b16 v[236:237], v242 offset:6144
 ds_read_b64_tr_b16 v[238:239], v242 offset:7168
 v_mfma_f32_16x16x32_bf16 v[160:163], v[224:227], v[32:35], v[160:163]
 s_add_u32 s94, s53, 4096
 v_mfma_f32_16x16x32_bf16 v[164:167], v[224:227], v[36:39], v[164:167]
 ds_write_b128 v240, v[152:155] offset:1024
 buffer_load_dwordx4 a[32:35], v243, s[24:27], s94 offen sc1
 v_mfma_f32_16x16x32_bf16 v[168:171], v[224:227], v[40:43], v[168:171]
 s_waitcnt lgkmcnt(3)
 v_fmac_f32 v200, v216, v247
 v_mfma_f32_16x16x32_bf16 v[172:175], v[224:227], v[44:47], v[172:175]
 ds_read_b64_tr_b16 v[224:225], v241 offset:8192
 ds_read_b64_tr_b16 v[226:227], v241 offset:9216
 v_mfma_f32_16x16x32_bf16 v[176:179], v[228:231], v[32:35], v[176:179]
 s_add_u32 s94, s94, 229376
 v_fmac_f32 v201, v217, v247
 v_mfma_f32_16x16x32_bf16 v[180:183], v[228:231], v[36:39], v[180:183]
 buffer_load_dwordx4 a[36:39], v243, s[24:27], s94 offen sc1
 v_fmac_f32 v202, v218, v247
 v_mfma_f32_16x16x32_bf16 v[184:187], v[228:231], v[40:43], v[184:187]
 s_add_u32 s94, s94, 229376
 v_fmac_f32 v203, v219, v247
 v_mfma_f32_16x16x32_bf16 v[188:191], v[228:231], v[44:47], v[188:191]
 ds_read_b64_tr_b16 v[228:229], v242 offset:8192
 ds_read_b64_tr_b16 v[230:231], v242 offset:9216
 v_mfma_f32_16x16x32_bf16 v[160:163], v[232:235], v[48:51], v[160:163]
 buffer_load_dwordx4 a[40:43], v243, s[24:27], s94 offen sc1
 v_fmac_f32 v204, v220, v247
 v_mfma_f32_16x16x32_bf16 v[164:167], v[232:235], v[52:55], v[164:167]
 v_fmac_f32 v205, v221, v247
 s_add_u32 s94, s94, 229376
 v_mfma_f32_16x16x32_bf16 v[168:171], v[232:235], v[56:59], v[168:171]
 s_waitcnt lgkmcnt(2)
 ds_write_b128 v240, v[140:143] offset:2048
 v_mfma_f32_16x16x32_bf16 v[172:175], v[232:235], v[60:63], v[172:175]
 ds_read_b64_tr_b16 v[232:233], v241 offset:10240
 ds_read_b64_tr_b16 v[234:235], v241 offset:11264
 v_fmac_f32 v206, v222, v247
 v_mfma_f32_16x16x32_bf16 v[176:179], v[236:239], v[48:51], v[176:179]
 buffer_load_dwordx4 a[44:47], v243, s[24:27], s94 offen sc1
 v_fmac_f32 v207, v223, v247
 s_add_u32 s94, s94, 229376
 v_mfma_f32_16x16x32_bf16 v[180:183], v[236:239], v[52:55], v[180:183]
 v_cvt_pk_bf16_f32 v216, v200, v201
 buffer_load_dwordx4 a[48:51], v243, s[24:27], s94 offen sc1
 v_mfma_f32_16x16x32_bf16 v[184:187], v[236:239], v[56:59], v[184:187]
 v_cvt_pk_bf16_f32 v217, v202, v203
 s_add_u32 s94, s94, 229376
 v_mfma_f32_16x16x32_bf16 v[188:191], v[236:239], v[60:63], v[188:191]
 v_cvt_pk_bf16_f32 v218, v204, v205
 v_cvt_pk_bf16_f32 v219, v206, v207
 ds_read_b64_tr_b16 v[236:237], v242 offset:10240
 ds_read_b64_tr_b16 v[238:239], v242 offset:11264
 v_mfma_f32_16x16x32_bf16 v[160:163], v[224:227], v[64:67], v[160:163]
 buffer_load_dwordx4 a[52:55], v243, s[24:27], s94 offen sc1
 s_add_u32 s94, s94, 229376
 v_mfma_f32_16x16x32_bf16 v[164:167], v[224:227], v[68:71], v[164:167]
 buffer_load_dwordx4 a[56:59], v243, s[24:27], s94 offen sc1
 ds_write_b128 v240, v[156:159] offset:3072
 v_mfma_f32_16x16x32_bf16 v[168:171], v[224:227], v[72:75], v[168:171]
 s_waitcnt lgkmcnt(3)
 v_mul_f32 v192, v128, v244
 v_mfma_f32_16x16x32_bf16 v[172:175], v[224:227], v[76:79], v[172:175]
 ds_read_b64_tr_b16 v[224:225], v241 offset:12288
 ds_read_b64_tr_b16 v[226:227], v241 offset:13312
 v_mfma_f32_16x16x32_bf16 v[176:179], v[228:231], v[64:67], v[176:179]
 s_add_u32 s94, s94, 229376
 v_mul_f32 v193, v129, v244
 v_mfma_f32_16x16x32_bf16 v[180:183], v[228:231], v[68:71], v[180:183]
 buffer_load_dwordx4 a[60:63], v243, s[24:27], s94 offen sc1
 v_accvgpr_read_b32 v254, a128
 v_mfma_f32_16x16x32_bf16 v[184:187], v[228:231], v[72:75], v[184:187]
 v_mul_f32 v194, v130, v244
 v_accvgpr_read_b32 v255, a129
 v_mfma_f32_16x16x32_bf16 v[188:191], v[228:231], v[76:79], v[188:191]
 ds_read_b64_tr_b16 v[228:229], v242 offset:12288
 ds_read_b64_tr_b16 v[230:231], v242 offset:13312
 v_mfma_f32_16x16x32_bf16 v[160:163], v[232:235], v[80:83], v[160:163]
 v_mul_f32 v195, v131, v244
 v_cvt_pk_bf16_f32 v254, v254, v255
 v_mfma_f32_16x16x32_bf16 v[164:167], v[232:235], v[84:87], v[164:167]
 v_accvgpr_write_b32 a168, v254
 v_mul_f32 v196, v144, v244
 v_mfma_f32_16x16x32_bf16 v[168:171], v[232:235], v[88:91], v[168:171]
 s_waitcnt lgkmcnt(2)
 v_accvgpr_read_b32 v254, a130
 v_mfma_f32_16x16x32_bf16 v[172:175], v[232:235], v[92:95], v[172:175]
 ds_read_b64_tr_b16 v[232:233], v241 offset:14336
 ds_read_b64_tr_b16 v[234:235], v241 offset:15360
 v_mfma_f32_16x16x32_bf16 v[176:179], v[236:239], v[80:83], v[176:179]
 buffer_store_dwordx4 v[208:211], v243, s[40:43], s65 offen sc1
 v_mul_f32 v197, v145, v244
 v_mfma_f32_16x16x32_bf16 v[180:183], v[236:239], v[84:87], v[180:183]
 buffer_store_dwordx4 v[216:219], v248, s[40:43], s65 offen sc1
 s_add_u32 s65, s65, 1024
 v_accvgpr_read_b32 v255, a131
 v_mfma_f32_16x16x32_bf16 v[184:187], v[236:239], v[88:91], v[184:187]
 v_cvt_pk_bf16_f32 v254, v254, v255
 v_mul_f32 v198, v146, v244
 v_mfma_f32_16x16x32_bf16 v[188:191], v[236:239], v[92:95], v[188:191]
 ds_read_b64_tr_b16 v[236:237], v242 offset:14336
 ds_read_b64_tr_b16 v[238:239], v242 offset:15360
 v_accvgpr_write_b32 a169, v254
 v_mfma_f32_16x16x32_bf16 v[160:163], v[224:227], v[96:99], v[160:163]
 v_mul_f32 v199, v147, v244
 v_accvgpr_read_b32 v254, a132
 v_mfma_f32_16x16x32_bf16 v[164:167], v[224:227], v[100:103], v[164:167]
 v_accvgpr_read_b32 v255, a133
 v_mul_f32 v200, v132, v245
 v_mfma_f32_16x16x32_bf16 v[168:171], v[224:227], v[104:107], v[168:171]
 s_waitcnt lgkmcnt(2)
 v_cvt_pk_bf16_f32 v254, v254, v255
 v_mfma_f32_16x16x32_bf16 v[172:175], v[224:227], v[108:111], v[172:175]
 v_mul_f32 v201, v133, v245
 v_accvgpr_write_b32 a170, v254
 v_mfma_f32_16x16x32_bf16 v[176:179], v[228:231], v[96:99], v[176:179]
 v_accvgpr_read_b32 v254, a134
 v_mul_f32 v202, v134, v245
 v_mfma_f32_16x16x32_bf16 v[180:183], v[228:231], v[100:103], v[180:183]
 s_waitcnt vmcnt(10)
 v_accvgpr_read_b32 v255, a135
 v_mfma_f32_16x16x32_bf16 v[184:187], v[228:231], v[104:107], v[184:187]
 s_waitcnt lgkmcnt(0)
 s_barrier
 v_mfma_f32_16x16x32_bf16 v[188:191], v[228:231], v[108:111], v[188:191]
 buffer_store_dwordx2 a[250:251], off, s[20:23], 0 offset:16 sc1
 v_mul_f32 v203, v135, v245
 v_mfma_f32_16x16x32_bf16 v[160:163], v[232:235], v[112:115], v[160:163]
 v_cvt_pk_bf16_f32 v254, v254, v255
 v_accvgpr_write_b32 a171, v254
 v_mfma_f32_16x16x32_bf16 v[164:167], v[232:235], v[116:119], v[164:167]
 ds_read_b128 v[208:211], v252 offset:0
 v_mul_f32 v204, v148, v245
 v_mfma_f32_16x16x32_bf16 v[168:171], v[232:235], v[120:123], v[168:171]
 s_bitcmp0_b32 s67, 0
 s_cselect_b32 s34, s63, 0
 v_mfma_f32_16x16x32_bf16 v[172:175], v[232:235], v[124:127], v[172:175]
 ds_read_b128 v[212:215], v252 offset:1024
 v_mul_f32 v205, v149, v245
 v_mfma_f32_16x16x32_bf16 v[176:179], v[236:239], v[112:115], v[176:179]
 buffer_store_dwordx4 a[168:171], v249, s[32:35], 0 offen offset:0
 ds_read_b128 v[216:219], v252 offset:2048
 v_mfma_f32_16x16x32_bf16 v[180:183], v[236:239], v[116:119], v[180:183]
 v_mul_f32 v206, v150, v245
 ds_read_b128 v[220:223], v252 offset:3072
 v_mfma_f32_16x16x32_bf16 v[184:187], v[236:239], v[120:123], v[184:187]
 v_mul_f32 v207, v151, v245
 v_mfma_f32_16x16x32_bf16 v[188:191], v[236:239], v[124:127], v[188:191]
 s_waitcnt lgkmcnt(2)
 v_fmac_f32 v192, v208, v246
 v_fmac_f32 v193, v209, v246
 v_fmac_f32 v194, v210, v246
 v_fmac_f32 v195, v211, v246
 v_fmac_f32 v196, v212, v246
 v_fmac_f32 v197, v213, v246
 v_fmac_f32 v198, v214, v246
 v_fmac_f32 v199, v215, v246
 v_cvt_pk_bf16_f32 v208, v192, v193
 v_cvt_pk_bf16_f32 v209, v194, v195
 v_cvt_pk_bf16_f32 v210, v196, v197
 v_cvt_pk_bf16_f32 v211, v198, v199
 s_waitcnt lgkmcnt(0)
 v_fmac_f32 v200, v216, v247
 v_fmac_f32 v201, v217, v247
 v_fmac_f32 v202, v218, v247
 v_fmac_f32 v203, v219, v247
 v_fmac_f32 v204, v220, v247
 v_fmac_f32 v205, v221, v247
 v_fmac_f32 v206, v222, v247
 v_fmac_f32 v207, v223, v247
 v_cvt_pk_bf16_f32 v216, v200, v201
 v_cvt_pk_bf16_f32 v217, v202, v203
 v_cvt_pk_bf16_f32 v218, v204, v205
 v_cvt_pk_bf16_f32 v219, v206, v207
 ds_write_b128 v240, v[168:171] offset:16384
 ds_write_b128 v240, v[184:187] offset:17408
 ds_write_b128 v240, v[172:175] offset:18432
 ds_write_b128 v240, v[188:191] offset:19456
 buffer_store_dwordx4 v[208:211], v243, s[40:43], s65 offen sc1
 buffer_store_dwordx4 v[216:219], v248, s[40:43], s65 offen sc1
 s_add_u32 s65, s65, 1024
 v_mul_f32 v192, v160, v244
 v_mul_f32 v193, v161, v244
 v_mul_f32 v194, v162, v244
 v_mul_f32 v195, v163, v244
 v_mul_f32 v196, v176, v244
 v_mul_f32 v197, v177, v244
 v_mul_f32 v198, v178, v244
 v_mul_f32 v199, v179, v244
 v_mul_f32 v200, v164, v245
 v_mul_f32 v201, v165, v245
 v_mul_f32 v202, v166, v245
 v_mul_f32 v203, v167, v245
 v_mul_f32 v204, v180, v245
 v_mul_f32 v205, v181, v245
 v_mul_f32 v206, v182, v245
 v_mul_f32 v207, v183, v245
 s_waitcnt lgkmcnt(0)
 s_barrier
 ds_read_b128 v[208:211], v252 offset:16384
 ds_read_b128 v[212:215], v252 offset:17408
 ds_read_b128 v[216:219], v252 offset:18432
 ds_read_b128 v[220:223], v252 offset:19456
 s_waitcnt lgkmcnt(2)
 v_fmac_f32 v192, v208, v246
 v_fmac_f32 v193, v209, v246
 v_fmac_f32 v194, v210, v246
 v_fmac_f32 v195, v211, v246
 v_fmac_f32 v196, v212, v246
 v_fmac_f32 v197, v213, v246
 v_fmac_f32 v198, v214, v246
 v_fmac_f32 v199, v215, v246
 v_cvt_pk_bf16_f32 v208, v192, v193
 v_cvt_pk_bf16_f32 v209, v194, v195
 v_cvt_pk_bf16_f32 v210, v196, v197
 v_cvt_pk_bf16_f32 v211, v198, v199
 s_waitcnt lgkmcnt(0)
 v_fmac_f32 v200, v216, v247
 v_fmac_f32 v201, v217, v247
 v_fmac_f32 v202, v218, v247
 v_fmac_f32 v203, v219, v247
 v_fmac_f32 v204, v220, v247
 v_fmac_f32 v205, v221, v247
 v_fmac_f32 v206, v222, v247
 v_fmac_f32 v207, v223, v247
 v_cvt_pk_bf16_f32 v216, v200, v201
 v_cvt_pk_bf16_f32 v217, v202, v203
 v_cvt_pk_bf16_f32 v218, v204, v205
 v_cvt_pk_bf16_f32 v219, v206, v207
 buffer_store_dwordx4 v[208:211], v243, s[40:43], s65 offen sc1
 buffer_store_dwordx4 v[216:219], v248, s[40:43], s65 offen sc1
 s_add_u32 s65, s65, 1024
 v_and_b32 v2, 0x70, v243
 v_lshlrev_b32 v2, 3, v2
 buffer_load_dwordx2 v[8:9], v2, s[28:31], 0 offen offset:16 sc1
 s_waitcnt vmcnt(16)
 v_mfma_f32_16x16x32_bf16 a[136:139], a[160:163], a[32:35], 0
 v_mfma_f32_16x16x32_bf16 a[140:143], a[164:167], a[32:35], 0
 s_waitcnt vmcnt(15)
 v_mfma_f32_16x16x32_bf16 a[136:139], a[160:163], a[36:39], a[136:139]
 v_mfma_f32_16x16x32_bf16 a[140:143], a[164:167], a[36:39], a[140:143]
 s_waitcnt vmcnt(14)
 v_mfma_f32_16x16x32_bf16 a[136:139], a[160:163], a[40:43], a[136:139]
 v_mfma_f32_16x16x32_bf16 a[140:143], a[164:167], a[40:43], a[140:143]
 s_waitcnt vmcnt(13)
 v_mfma_f32_16x16x32_bf16 a[136:139], a[160:163], a[44:47], a[136:139]
 v_mfma_f32_16x16x32_bf16 a[140:143], a[164:167], a[44:47], a[140:143]
 s_waitcnt vmcnt(12)
 v_mfma_f32_16x16x32_bf16 a[136:139], a[160:163], a[48:51], a[136:139]
 v_mfma_f32_16x16x32_bf16 a[140:143], a[164:167], a[48:51], a[140:143]
 s_waitcnt vmcnt(11)
 v_mfma_f32_16x16x32_bf16 a[136:139], a[160:163], a[52:55], a[136:139]
 v_mfma_f32_16x16x32_bf16 a[140:143], a[164:167], a[52:55], a[140:143]
 s_waitcnt vmcnt(10)
 v_mfma_f32_16x16x32_bf16 a[136:139], a[160:163], a[56:59], a[136:139]
 v_mfma_f32_16x16x32_bf16 a[140:143], a[164:167], a[56:59], a[140:143]
 s_waitcnt vmcnt(9)
 v_mfma_f32_16x16x32_bf16 a[136:139], a[160:163], a[60:63], a[136:139]
 v_mfma_f32_16x16x32_bf16 a[140:143], a[164:167], a[60:63], a[140:143]
 s_nop 6
 v_accvgpr_read_b32 v254, a136
 v_accvgpr_read_b32 v255, a137
 v_cvt_pk_bf16_f32 v254, v254, v255
 v_accvgpr_write_b32 a172, v254
 v_accvgpr_read_b32 v254, a138
 v_accvgpr_read_b32 v255, a139
 v_cvt_pk_bf16_f32 v254, v254, v255
 v_accvgpr_write_b32 a173, v254
 v_accvgpr_read_b32 v254, a140
 v_accvgpr_read_b32 v255, a141
 v_cvt_pk_bf16_f32 v254, v254, v255
 v_accvgpr_write_b32 a174, v254
 v_accvgpr_read_b32 v254, a142
 v_accvgpr_read_b32 v255, a143
 v_cvt_pk_bf16_f32 v254, v254, v255
 v_accvgpr_write_b32 a175, v254
 s_waitcnt vmcnt(0)
 s_barrier
 buffer_store_dwordx2 a[250:251], off, s[20:23], 0 offset:24 sc1
 v_mov_b32 v254, v8
 v_mov_b32 v255, v9
 v_cmp_ge_u64 s[92:93], v[254:255], s[98:99]
 v_cmp_lt_u64 vcc, v[254:255], s[100:101]
 s_nop 3
 s_and_b64 s[92:93], s[92:93], vcc
 s_cmp_eq_u64 s[92:93], -1
 s_cselect_b32 s26, s62, 0
 s_cselect_b32 s95, 0, 4
 s_or_b32 s67, s67, s95
 s_cmp_lg_u32 s48, 0
 s_cbranch_scc1 L_w
 s_bitcmp0_b32 s67, 1
 s_cselect_b32 s34, s63, 0
 buffer_store_dwordx4 a[172:175], v249, s[32:35], 0 offen offset:256
 s_mov_b32 s26, s62
 s_mov_b32 s34, s63
 s_mov_b32 s61, 20000
 s_bitcmp0_b32 s67, 2
 s_cbranch_scc1 L_go1
L_poll1:
 buffer_load_dwordx2 v[254:255], v2, s[28:31], 0 offen offset:8 sc1
 s_sub_u32 s61, s61, 1
 s_cmp_lt_i32 s61, 0
 s_cbranch_scc1 L_go1
 s_waitcnt vmcnt(0)
 v_cmp_ge_u64 s[92:93], v[254:255], s[98:99]
 v_cmp_lt_u64 vcc, v[254:255], s[100:101]
 s_nop 3
 s_and_b64 s[92:93], s[92:93], vcc
 s_cmp_eq_u64 s[92:93], -1
 s_cbranch_scc0 L_poll1
L_go1:
 s_barrier
 s_bitcmp0_b32 s67, 1
 s_cbranch_scc1 L_na1
 s_add_u32 s94, s53, 4096
 buffer_load_dwordx4 a[32:35], v243, s[24:27], s94 offen sc1
 s_add_u32 s94, s94, 229376
 buffer_load_dwordx4 a[36:39], v243, s[24:27], s94 offen sc1
 s_add_u32 s94, s94, 229376
 buffer_load_dwordx4 a[40:43], v243, s[24:27], s94 offen sc1
 s_add_u32 s94, s94, 229376
 buffer_load_dwordx4 a[44:47], v243, s[24:27], s94 offen sc1
 s_add_u32 s94, s94, 229376
 buffer_load_dwordx4 a[48:51], v243, s[24:27], s94 offen sc1
 s_add_u32 s94, s94, 229376
 buffer_load_dwordx4 a[52:55], v243, s[24:27], s94 offen sc1
 s_add_u32 s94, s94, 229376
 buffer_load_dwordx4 a[56:59], v243, s[24:27], s94 offen sc1
 s_add_u32 s94, s94, 229376
 buffer_load_dwordx4 a[60:63], v243, s[24:27], s94 offen sc1
L_na1:
 s_bitcmp0_b32 s67, 0
 s_cbranch_scc1 L_na0
 s_add_u32 s94, s53, 0
 buffer_load_dwordx4 a[0:3], v243, s[24:27], s94 offen sc1
 s_add_u32 s94, s94, 229376
 buffer_load_dwordx4 a[4:7], v243, s[24:27], s94 offen sc1
 s_add_u32 s94, s94, 229376
 buffer_load_dwordx4 a[8:11], v243, s[24:27], s94 offen sc1
 s_add_u32 s94, s94, 229376
 buffer_load_dwordx4 a[12:15], v243, s[24:27], s94 offen sc1
 s_add_u32 s94, s94, 229376
 buffer_load_dwordx4 a[16:19], v243, s[24:27], s94 offen sc1
 s_add_u32 s94, s94, 229376
 buffer_load_dwordx4 a[20:23], v243, s[24:27], s94 offen sc1
 s_add_u32 s94, s94, 229376
 buffer_load_dwordx4 a[24:27], v243, s[24:27], s94 offen sc1
 s_add_u32 s94, s94, 229376
 buffer_load_dwordx4 a[28:31], v243, s[24:27], s94 offen sc1
L_na0:
 s_bitcmp0_b32 s67, 0
 s_cbranch_scc1 L_ma0
 s_waitcnt vmcnt(0)
 v_mfma_f32_16x16x32_bf16 a[128:131], a[160:163], a[0:3], 0
 v_mfma_f32_16x16x32_bf16 a[132:135], a[164:167], a[0:3], 0
 v_mfma_f32_16x16x32_bf16 a[128:131], a[160:163], a[4:7], a[128:131]
 v_mfma_f32_16x16x32_bf16 a[132:135], a[164:167], a[4:7], a[132:135]
 v_mfma_f32_16x16x32_bf16 a[128:131], a[160:163], a[8:11], a[128:131]
 v_mfma_f32_16x16x32_bf16 a[132:135], a[164:167], a[8:11], a[132:135]
 v_mfma_f32_16x16x32_bf16 a[128:131], a[160:163], a[12:15], a[128:131]
 v_mfma_f32_16x16x32_bf16 a[132:135], a[164:167], a[12:15], a[132:135]
 v_mfma_f32_16x16x32_bf16 a[128:131], a[160:163], a[16:19], a[128:131]
 v_mfma_f32_16x16x32_bf16 a[132:135], a[164:167], a[16:19], a[132:135]
 v_mfma_f32_16x16x32_bf16 a[128:131], a[160:163], a[20:23], a[128:131]
 v_mfma_f32_16x16x32_bf16 a[132:135], a[164:167], a[20:23], a[132:135]
 v_mfma_f32_16x16x32_bf16 a[128:131], a[160:163], a[24:27], a[128:131]
 v_mfma_f32_16x16x32_bf16 a[132:135], a[164:167], a[24:27], a[132:135]
 v_mfma_f32_16x16x32_bf16 a[128:131], a[160:163], a[28:31], a[128:131]
 v_mfma_f32_16x16x32_bf16 a[132:135], a[164:167], a[28:31], a[132:135]
 s_nop 6
 v_accvgpr_read_b32 v254, a128
 v_accvgpr_read_b32 v255, a129
 v_cvt_pk_bf16_f32 v254, v254, v255
 v_accvgpr_write_b32 a168, v254
 v_accvgpr_read_b32 v254, a130
 v_accvgpr_read_b32 v255, a131
 v_cvt_pk_bf16_f32 v254, v254, v255
 v_accvgpr_write_b32 a169, v254
 v_accvgpr_read_b32 v254, a132
 v_accvgpr_read_b32 v255, a133
 v_cvt_pk_bf16_f32 v254, v254, v255
 v_accvgpr_write_b32 a170, v254
 v_accvgpr_read_b32 v254, a134
 v_accvgpr_read_b32 v255, a135
 v_cvt_pk_bf16_f32 v254, v254, v255
 v_accvgpr_write_b32 a171, v254
 buffer_store_dwordx4 a[168:171], v249, s[32:35], 0 offen offset:0
L_ma0:
 s_bitcmp0_b32 s67, 1
 s_cbranch_scc1 L_ma1
 s_waitcnt vmcnt(0)
 v_mfma_f32_16x16x32_bf16 a[136:139], a[160:163], a[32:35], 0
 v_mfma_f32_16x16x32_bf16 a[140:143], a[164:167], a[32:35], 0
 v_mfma_f32_16x16x32_bf16 a[136:139], a[160:163], a[36:39], a[136:139]
 v_mfma_f32_16x16x32_bf16 a[140:143], a[164:167], a[36:39], a[140:143]
 v_mfma_f32_16x16x32_bf16 a[136:139], a[160:163], a[40:43], a[136:139]
 v_mfma_f32_16x16x32_bf16 a[140:143], a[164:167], a[40:43], a[140:143]
 v_mfma_f32_16x16x32_bf16 a[136:139], a[160:163], a[44:47], a[136:139]
 v_mfma_f32_16x16x32_bf16 a[140:143], a[164:167], a[44:47], a[140:143]
 v_mfma_f32_16x16x32_bf16 a[136:139], a[160:163], a[48:51], a[136:139]
 v_mfma_f32_16x16x32_bf16 a[140:143], a[164:167], a[48:51], a[140:143]
 v_mfma_f32_16x16x32_bf16 a[136:139], a[160:163], a[52:55], a[136:139]
 v_mfma_f32_16x16x32_bf16 a[140:143], a[164:167], a[52:55], a[140:143]
 v_mfma_f32_16x16x32_bf16 a[136:139], a[160:163], a[56:59], a[136:139]
 v_mfma_f32_16x16x32_bf16 a[140:143], a[164:167], a[56:59], a[140:143]
 v_mfma_f32_16x16x32_bf16 a[136:139], a[160:163], a[60:63], a[136:139]
 v_mfma_f32_16x16x32_bf16 a[140:143], a[164:167], a[60:63], a[140:143]
 s_nop 6
 v_accvgpr_read_b32 v254, a136
 v_accvgpr_read_b32 v255, a137
 v_cvt_pk_bf16_f32 v254, v254, v255
 v_accvgpr_write_b32 a172, v254
 v_accvgpr_read_b32 v254, a138
 v_accvgpr_read_b32 v255, a139
 v_cvt_pk_bf16_f32 v254, v254, v255
 v_accvgpr_write_b32 a173, v254
 v_accvgpr_read_b32 v254, a140
 v_accvgpr_read_b32 v255, a141
 v_cvt_pk_bf16_f32 v254, v254, v255
 v_accvgpr_write_b32 a174, v254
 v_accvgpr_read_b32 v254, a142
 v_accvgpr_read_b32 v255, a143
 v_cvt_pk_bf16_f32 v254, v254, v255
 v_accvgpr_write_b32 a175, v254
 buffer_store_dwordx4 a[172:175], v249, s[32:35], 0 offen offset:256
L_ma1:
 s_bitcmp0_b32 s67, 2
 s_cbranch_scc1 L_go2
L_poll2:
 buffer_load_dwordx2 v[254:255], v2, s[28:31], 0 offen offset:16 sc1
 s_sub_u32 s61, s61, 1
 s_cmp_lt_i32 s61, 0
 s_cbranch_scc1 L_go2
 s_waitcnt vmcnt(0)
 v_cmp_ge_u64 s[92:93], v[254:255], s[98:99]
 v_cmp_lt_u64 vcc, v[254:255], s[100:101]
 s_nop 3
 s_and_b64 s[92:93], s[92:93], vcc
 s_cmp_eq_u64 s[92:93], -1
 s_cbranch_scc0 L_poll2
L_go2:
 s_barrier
L_poll3:
 buffer_load_dwordx2 v[254:255], v2, s[28:31], 0 offen offset:24 sc1
 s_sub_u32 s61, s61, 1
 s_cmp_lt_i32 s61, 0
 s_cbranch_scc1 L_go3
 s_waitcnt vmcnt(0)
 v_cmp_ge_u64 s[92:93], v[254:255], s[98:99]
 v_cmp_lt_u64 vcc, v[254:255], s[100:101]
 s_nop 3
 s_and_b64 s[92:93], s[92:93], vcc
 s_cmp_eq_u64 s[92:93], -1
 s_cbranch_scc0 L_poll3
L_go3:
 s_barrier
 s_branch L_fb
L_w:
 s_add_u32 s94, s53, 7168
 buffer_load_dwordx4 a[64:67], v243, s[24:27], s94 offen sc1
 s_add_u32 s94, s94, 229376
 buffer_load_dwordx4 a[68:71], v243, s[24:27], s94 offen sc1
 s_add_u32 s94, s94, 229376
 buffer_load_dwordx4 a[72:75], v243, s[24:27], s94 offen sc1
 s_add_u32 s94, s94, 229376
 buffer_load_dwordx4 a[76:79], v243, s[24:27], s94 offen sc1
 s_add_u32 s94, s94, 229376
 buffer_load_dwordx4 a[80:83], v243, s[24:27], s94 offen sc1
 s_add_u32 s94, s94, 229376
 buffer_load_dwordx4 a[84:87], v243, s[24:27], s94 offen sc1
 s_add_u32 s94, s94, 229376
 buffer_load_dwordx4 a[88:91], v243, s[24:27], s94 offen sc1
 s_add_u32 s94, s94, 229376
 buffer_load_dwordx4 a[92:95], v243, s[24:27], s94 offen sc1
 s_bitcmp0_b32 s67, 1
 s_cselect_b32 s34, s63, 0
 buffer_store_dwordx4 a[172:175], v249, s[32:35], 0 offen offset:256
 s_mov_b32 s26, s62
 s_mov_b32 s34, s63
 s_barrier
 s_bitcmp0_b32 s67, 1
 s_cbranch_scc1 L_nb1
 s_add_u32 s94, s53, 4096
 buffer_load_dwordx4 a[32:35], v243, s[24:27], s94 offen sc1
 s_add_u32 s94, s94, 229376
 buffer_load_dwordx4 a[36:39], v243, s[24:27], s94 offen sc1
 s_add_u32 s94, s94, 229376
 buffer_load_dwordx4 a[40:43], v243, s[24:27], s94 offen sc1
 s_add_u32 s94, s94, 229376
 buffer_load_dwordx4 a[44:47], v243, s[24:27], s94 offen sc1
 s_add_u32 s94, s94, 229376
 buffer_load_dwordx4 a[48:51], v243, s[24:27], s94 offen sc1
 s_add_u32 s94, s94, 229376
 buffer_load_dwordx4 a[52:55], v243, s[24:27], s94 offen sc1
 s_add_u32 s94, s94, 229376
 buffer_load_dwordx4 a[56:59], v243, s[24:27], s94 offen sc1
 s_add_u32 s94, s94, 229376
 buffer_load_dwordx4 a[60:63], v243, s[24:27], s94 offen sc1
L_nb1:
 s_bitcmp0_b32 s67, 0
 s_cbranch_scc1 L_nb0
 s_add_u32 s94, s53, 0
 buffer_load_dwordx4 a[0:3], v243, s[24:27], s94 offen sc1
 s_add_u32 s94, s94, 229376
 buffer_load_dwordx4 a[4:7], v243, s[24:27], s94 offen sc1
 s_add_u32 s94, s94, 229376
 buffer_load_dwordx4 a[8:11], v243, s[24:27], s94 offen sc1
 s_add_u32 s94, s94, 229376
 buffer_load_dwordx4 a[12:15], v243, s[24:27], s94 offen sc1
 s_add_u32 s94, s94, 229376
 buffer_load_dwordx4 a[16:19], v243, s[24:27], s94 offen sc1
 s_add_u32 s94, s94, 229376
 buffer_load_dwordx4 a[20:23], v243, s[24:27], s94 offen sc1
 s_add_u32 s94, s94, 229376
 buffer_load_dwordx4 a[24:27], v243, s[24:27], s94 offen sc1
 s_add_u32 s94, s94, 229376
 buffer_load_dwordx4 a[28:31], v243, s[24:27], s94 offen sc1
L_nb0:
 s_bitcmp0_b32 s67, 0
 s_cbranch_scc1 L_mb0
 s_waitcnt vmcnt(0)
 v_mfma_f32_16x16x32_bf16 a[128:131], a[160:163], a[0:3], 0
 v_mfma_f32_16x16x32_bf16 a[132:135], a[164:167], a[0:3], 0
 v_mfma_f32_16x16x32_bf16 a[128:131], a[160:163], a[4:7], a[128:131]
 v_mfma_f32_16x16x32_bf16 a[132:135], a[164:167], a[4:7], a[132:135]
 v_mfma_f32_16x16x32_bf16 a[128:131], a[160:163], a[8:11], a[128:131]
 v_mfma_f32_16x16x32_bf16 a[132:135], a[164:167], a[8:11], a[132:135]
 v_mfma_f32_16x16x32_bf16 a[128:131], a[160:163], a[12:15], a[128:131]
 v_mfma_f32_16x16x32_bf16 a[132:135], a[164:167], a[12:15], a[132:135]
 v_mfma_f32_16x16x32_bf16 a[128:131], a[160:163], a[16:19], a[128:131]
 v_mfma_f32_16x16x32_bf16 a[132:135], a[164:167], a[16:19], a[132:135]
 v_mfma_f32_16x16x32_bf16 a[128:131], a[160:163], a[20:23], a[128:131]
 v_mfma_f32_16x16x32_bf16 a[132:135], a[164:167], a[20:23], a[132:135]
 v_mfma_f32_16x16x32_bf16 a[128:131], a[160:163], a[24:27], a[128:131]
 v_mfma_f32_16x16x32_bf16 a[132:135], a[164:167], a[24:27], a[132:135]
 v_mfma_f32_16x16x32_bf16 a[128:131], a[160:163], a[28:31], a[128:131]
 v_mfma_f32_16x16x32_bf16 a[132:135], a[164:167], a[28:31], a[132:135]
 s_nop 6
 v_accvgpr_read_b32 v254, a128
 v_accvgpr_read_b32 v255, a129
 v_cvt_pk_bf16_f32 v254, v254, v255
 v_accvgpr_write_b32 a168, v254
 v_accvgpr_read_b32 v254, a130
 v_accvgpr_read_b32 v255, a131
 v_cvt_pk_bf16_f32 v254, v254, v255
 v_accvgpr_write_b32 a169, v254
 v_accvgpr_read_b32 v254, a132
 v_accvgpr_read_b32 v255, a133
 v_cvt_pk_bf16_f32 v254, v254, v255
 v_accvgpr_write_b32 a170, v254
 v_accvgpr_read_b32 v254, a134
 v_accvgpr_read_b32 v255, a135
 v_cvt_pk_bf16_f32 v254, v254, v255
 v_accvgpr_write_b32 a171, v254
 buffer_store_dwordx4 a[168:171], v249, s[32:35], 0 offen offset:0
L_mb0:
 s_bitcmp0_b32 s67, 1
 s_cbranch_scc1 L_mb1
 s_waitcnt vmcnt(0)
 v_mfma_f32_16x16x32_bf16 a[136:139], a[160:163], a[32:35], 0
 v_mfma_f32_16x16x32_bf16 a[140:143], a[164:167], a[32:35], 0
 v_mfma_f32_16x16x32_bf16 a[136:139], a[160:163], a[36:39], a[136:139]
 v_mfma_f32_16x16x32_bf16 a[140:143], a[164:167], a[36:39], a[140:143]
 v_mfma_f32_16x16x32_bf16 a[136:139], a[160:163], a[40:43], a[136:139]
 v_mfma_f32_16x16x32_bf16 a[140:143], a[164:167], a[40:43], a[140:143]
 v_mfma_f32_16x16x32_bf16 a[136:139], a[160:163], a[44:47], a[136:139]
 v_mfma_f32_16x16x32_bf16 a[140:143], a[164:167], a[44:47], a[140:143]
 v_mfma_f32_16x16x32_bf16 a[136:139], a[160:163], a[48:51], a[136:139]
 v_mfma_f32_16x16x32_bf16 a[140:143], a[164:167], a[48:51], a[140:143]
 v_mfma_f32_16x16x32_bf16 a[136:139], a[160:163], a[52:55], a[136:139]
 v_mfma_f32_16x16x32_bf16 a[140:143], a[164:167], a[52:55], a[140:143]
 v_mfma_f32_16x16x32_bf16 a[136:139], a[160:163], a[56:59], a[136:139]
 v_mfma_f32_16x16x32_bf16 a[140:143], a[164:167], a[56:59], a[140:143]
 v_mfma_f32_16x16x32_bf16 a[136:139], a[160:163], a[60:63], a[136:139]
 v_mfma_f32_16x16x32_bf16 a[140:143], a[164:167], a[60:63], a[140:143]
 s_nop 6
 v_accvgpr_read_b32 v254, a136
 v_accvgpr_read_b32 v255, a137
 v_cvt_pk_bf16_f32 v254, v254, v255
 v_accvgpr_write_b32 a172, v254
 v_accvgpr_read_b32 v254, a138
 v_accvgpr_read_b32 v255, a139
 v_cvt_pk_bf16_f32 v254, v254, v255
 v_accvgpr_write_b32 a173, v254
 v_accvgpr_read_b32 v254, a140
 v_accvgpr_read_b32 v255, a141
 v_cvt_pk_bf16_f32 v254, v254, v255
 v_accvgpr_write_b32 a174, v254
 v_accvgpr_read_b32 v254, a142
 v_accvgpr_read_b32 v255, a143
 v_cvt_pk_bf16_f32 v254, v254, v255
 v_accvgpr_write_b32 a175, v254
 buffer_store_dwordx4 a[172:175], v249, s[32:35], 0 offen offset:256
L_mb1:
 s_barrier
 s_bitcmp0_b32 s67, 2
 s_cbranch_scc1 L_nb2
 s_add_u32 s94, s53, 7168
 buffer_load_dwordx4 a[64:67], v243, s[24:27], s94 offen sc1
 s_add_u32 s94, s94, 229376
 buffer_load_dwordx4 a[68:71], v243, s[24:27], s94 offen sc1
 s_add_u32 s94, s94, 229376
 buffer_load_dwordx4 a[72:75], v243, s[24:27], s94 offen sc1
 s_add_u32 s94, s94, 229376
 buffer_load_dwordx4 a[76:79], v243, s[24:27], s94 offen sc1
 s_add_u32 s94, s94, 229376
 buffer_load_dwordx4 a[80:83], v243, s[24:27], s94 offen sc1
 s_add_u32 s94, s94, 229376
 buffer_load_dwordx4 a[84:87], v243, s[24:27], s94 offen sc1
 s_add_u32 s94, s94, 229376
 buffer_load_dwordx4 a[88:91], v243, s[24:27], s94 offen sc1
 s_add_u32 s94, s94, 229376
 buffer_load_dwordx4 a[92:95], v243, s[24:27], s94 offen sc1
L_nb2:
 s_barrier
 s_add_u32 s94, s53, 10240
 buffer_load_dwordx4 a[96:99], v243, s[24:27], s94 offen sc1
 s_add_u32 s94, s94, 229376
 buffer_load_dwordx4 a[100:103], v243, s[24:27], s94 offen sc1
 s_add_u32 s94, s94, 229376
 buffer_load_dwordx4 a[104:107], v243, s[24:27], s94 offen sc1
 s_add_u32 s94, s94, 229376
 buffer_load_dwordx4 a[108:111], v243, s[24:27], s94 offen sc1
 s_add_u32 s94, s94, 229376
 buffer_load_dwordx4 a[112:115], v243, s[24:27], s94 offen sc1
 s_add_u32 s94, s94, 229376
 buffer_load_dwordx4 a[116:119], v243, s[24:27], s94 offen sc1
 s_add_u32 s94, s94, 229376
 buffer_load_dwordx4 a[120:123], v243, s[24:27], s94 offen sc1
 s_add_u32 s94, s94, 229376
 buffer_load_dwordx4 a[124:127], v243, s[24:27], s94 offen sc1
 s_waitcnt vmcnt(15)
 v_mfma_f32_16x16x32_bf16 a[144:147], a[160:163], a[64:67], 0
 v_mfma_f32_16x16x32_bf16 a[148:151], a[164:167], a[64:67], 0
 s_waitcnt vmcnt(14)
 v_mfma_f32_16x16x32_bf16 a[144:147], a[160:163], a[68:71], a[144:147]
 v_mfma_f32_16x16x32_bf16 a[148:151], a[164:167], a[68:71], a[148:151]
 s_waitcnt vmcnt(13)
 v_mfma_f32_16x16x32_bf16 a[144:147], a[160:163], a[72:75], a[144:147]
 v_mfma_f32_16x16x32_bf16 a[148:151], a[164:167], a[72:75], a[148:151]
 s_waitcnt vmcnt(12)
 v_mfma_f32_16x16x32_bf16 a[144:147], a[160:163], a[76:79], a[144:147]
 v_mfma_f32_16x16x32_bf16 a[148:151], a[164:167], a[76:79], a[148:151]
 s_waitcnt vmcnt(11)
 v_mfma_f32_16x16x32_bf16 a[144:147], a[160:163], a[80:83], a[144:147]
 v_mfma_f32_16x16x32_bf16 a[148:151], a[164:167], a[80:83], a[148:151]
 s_waitcnt vmcnt(10)
 v_mfma_f32_16x16x32_bf16 a[144:147], a[160:163], a[84:87], a[144:147]
 v_mfma_f32_16x16x32_bf16 a[148:151], a[164:167], a[84:87], a[148:151]
 s_waitcnt vmcnt(9)
 v_mfma_f32_16x16x32_bf16 a[144:147], a[160:163], a[88:91], a[144:147]
 v_mfma_f32_16x16x32_bf16 a[148:151], a[164:167], a[88:91], a[148:151]
 s_waitcnt vmcnt(8)
 v_mfma_f32_16x16x32_bf16 a[144:147], a[160:163], a[92:95], a[144:147]
 v_mfma_f32_16x16x32_bf16 a[148:151], a[164:167], a[92:95], a[148:151]
 s_nop 6
 v_accvgpr_read_b32 v254, a144
 v_accvgpr_read_b32 v255, a145
 v_cvt_pk_bf16_f32 v254, v254, v255
 v_accvgpr_write_b32 a176, v254
 v_accvgpr_read_b32 v254, a146
 v_accvgpr_read_b32 v255, a147
 v_cvt_pk_bf16_f32 v254, v254, v255
 v_accvgpr_write_b32 a177, v254
 v_accvgpr_read_b32 v254, a148
 v_accvgpr_read_b32 v255, a149
 v_cvt_pk_bf16_f32 v254, v254, v255
 v_accvgpr_write_b32 a178, v254
 v_accvgpr_read_b32 v254, a150
 v_accvgpr_read_b32 v255, a151
 v_cvt_pk_bf16_f32 v254, v254, v255
 v_accvgpr_write_b32 a179, v254
 buffer_store_dwordx4 a[176:179], v249, s[32:35], 0 offen offset:448
 s_waitcnt vmcnt(8)
 v_mfma_f32_16x16x32_bf16 a[152:155], a[160:163], a[96:99], 0
 v_mfma_f32_16x16x32_bf16 a[156:159], a[164:167], a[96:99], 0
 s_waitcnt vmcnt(7)
 v_mfma_f32_16x16x32_bf16 a[152:155], a[160:163], a[100:103], a[152:155]
 v_mfma_f32_16x16x32_bf16 a[156:159], a[164:167], a[100:103], a[156:159]
 s_waitcnt vmcnt(6)
 v_mfma_f32_16x16x32_bf16 a[152:155], a[160:163], a[104:107], a[152:155]
 v_mfma_f32_16x16x32_bf16 a[156:159], a[164:167], a[104:107], a[156:159]
 s_waitcnt vmcnt(5)
 v_mfma_f32_16x16x32_bf16 a[152:155], a[160:163], a[108:111], a[152:155]
 v_mfma_f32_16x16x32_bf16 a[156:159], a[164:167], a[108:111], a[156:159]
 s_waitcnt vmcnt(4)
 v_mfma_f32_16x16x32_bf16 a[152:155], a[160:163], a[112:115], a[152:155]
 v_mfma_f32_16x16x32_bf16 a[156:159], a[164:167], a[112:115], a[156:159]
 s_waitcnt vmcnt(3)
 v_mfma_f32_16x16x32_bf16 a[152:155], a[160:163], a[116:119], a[152:155]
 v_mfma_f32_16x16x32_bf16 a[156:159], a[164:167], a[116:119], a[156:159]
 s_waitcnt vmcnt(2)
 v_mfma_f32_16x16x32_bf16 a[152:155], a[160:163], a[120:123], a[152:155]
 v_mfma_f32_16x16x32_bf16 a[156:159], a[164:167], a[120:123], a[156:159]
 s_waitcnt vmcnt(1)
 v_mfma_f32_16x16x32_bf16 a[152:155], a[160:163], a[124:127], a[152:155]
 v_mfma_f32_16x16x32_bf16 a[156:159], a[164:167], a[124:127], a[156:159]
 s_nop 6
 v_accvgpr_read_b32 v254, a152
 v_accvgpr_read_b32 v255, a153
 v_cvt_pk_bf16_f32 v254, v254, v255
 v_accvgpr_write_b32 a180, v254
 v_accvgpr_read_b32 v254, a154
 v_accvgpr_read_b32 v255, a155
 v_cvt_pk_bf16_f32 v254, v254, v255
 v_accvgpr_write_b32 a181, v254
 v_accvgpr_read_b32 v254, a156
 v_accvgpr_read_b32 v255, a157
 v_cvt_pk_bf16_f32 v254, v254, v255
 v_accvgpr_write_b32 a182, v254
 v_accvgpr_read_b32 v254, a158
 v_accvgpr_read_b32 v255, a159
 v_cvt_pk_bf16_f32 v254, v254, v255
 v_accvgpr_write_b32 a183, v254
 buffer_store_dwordx4 a[180:183], v249, s[32:35], 0 offen offset:640
L_fb:
L_end1:
 s_endpgm
L_tr_1:
 s_mov_b32 s67, 1
 s_branch L_slow_1
L_tr_2:
 s_mov_b32 s67, 2
 s_branch L_slow_0
L_tr_3:
 s_mov_b32 s67, 3
 s_branch L_slow_1
L_tr_14:
 s_mov_b32 s67, 14
 s_branch L_slow_0
L_tr_15:
 s_mov_b32 s67, 15
 s_branch L_slow_1
L_slow_0:
 s_nop 7
 s_nop 7
 v_max3_f32 v249, v128, v129, v130
 v_max3_f32 v249, v249, v131, v144
 v_max3_f32 v249, v249, v145, v146
 v_max_f32 v249, v249, v147
 v_mov_b32 v250, v249
 s_nop 1
 v_permlane16_swap_b32 v249, v250
 v_max_f32 v249, v249, v250
 v_mov_b32 v250, v249
 s_nop 1
 v_permlane32_swap_b32 v249, v250
 v_max_f32 v249, v249, v250
 v_ceil_f32 v249, v249
 v_max_f32 v249, 0, v249
 v_cvt_i32_f32 v250, v249
 v_sub_u32 v250, 0, v250
 v_ldexp_f32 v251, 1.0, v250
 v_sub_f32 v128, v128, v249
 v_sub_f32 v129, v129, v249
 v_sub_f32 v130, v130, v249
 v_sub_f32 v131, v131, v249
 v_sub_f32 v144, v144, v249
 v_sub_f32 v145, v145, v249
 v_sub_f32 v146, v146, v249
 v_sub_f32 v147, v147, v249
 v_sub_f32 v208, v208, v249
 v_sub_f32 v209, v209, v249
 v_sub_f32 v210, v210, v249
 v_sub_f32 v211, v211, v249
 v_mul_f32 v244, v244, v251
 v_lshlrev_b32 v250, 16, v192
 v_and_b32 v252, s68, v192
 v_mul_f32 v250, v250, v251
 v_mul_f32 v252, v252, v251
 v_cvt_pk_bf16_f32 v192, v250, v252
 v_lshlrev_b32 v250, 16, v193
 v_and_b32 v252, s68, v193
 v_mul_f32 v250, v250, v251
 v_mul_f32 v252, v252, v251
 v_cvt_pk_bf16_f32 v193, v250, v252
 v_lshlrev_b32 v250, 16, v194
 v_and_b32 v252, s68, v194
 v_mul_f32 v250, v250, v251
 v_mul_f32 v252, v252, v251
 v_cvt_pk_bf16_f32 v194, v250, v252
 v_lshlrev_b32 v250, 16, v195
 v_and_b32 v252, s68, v195
 v_mul_f32 v250, v250, v251
 v_mul_f32 v252, v252, v251
 v_cvt_pk_bf16_f32 v195, v250, v252
 v_accvgpr_read_b32 v250, a0
 v_accvgpr_read_b32 v252, a1
 v_mul_f32 v250, v250, v251
 v_mul_f32 v252, v252, v251
 v_accvgpr_write_b32 a0, v250
 v_accvgpr_write_b32 a1, v252
 v_accvgpr_read_b32 v250, a2
 v_accvgpr_read_b32 v252, a3
 v_mul_f32 v250, v250, v251
 v_mul_f32 v252, v252, v251
 v_accvgpr_write_b32 a2, v250
 v_accvgpr_write_b32 a3, v252
 v_accvgpr_read_b32 v250, a16
 v_accvgpr_read_b32 v252, a17
 v_mul_f32 v250, v250, v251
 v_mul_f32 v252, v252, v251
 v_accvgpr_write_b32 a16, v250
 v_accvgpr_write_b32 a17, v252
 v_accvgpr_read_b32 v250, a18
 v_accvgpr_read_b32 v252, a19
 v_mul_f32 v250, v250, v251
 v_mul_f32 v252, v252, v251
 v_accvgpr_write_b32 a18, v250
 v_accvgpr_write_b32 a19, v252
 v_accvgpr_read_b32 v250, a32
 v_accvgpr_read_b32 v252, a33
 v_mul_f32 v250, v250, v251
 v_mul_f32 v252, v252, v251
 v_accvgpr_write_b32 a32, v250
 v_accvgpr_write_b32 a33, v252
 v_accvgpr_read_b32 v250, a34
 v_accvgpr_read_b32 v252, a35
 v_mul_f32 v250, v250, v251
 v_mul_f32 v252, v252, v251
 v_accvgpr_write_b32 a34, v250
 v_accvgpr_write_b32 a35, v252
 v_accvgpr_read_b32 v250, a48
 v_accvgpr_read_b32 v252, a49
 v_mul_f32 v250, v250, v251
 v_mul_f32 v252, v252, v251
 v_accvgpr_write_b32 a48, v250
 v_accvgpr_write_b32 a49, v252
 v_accvgpr_read_b32 v250, a50
 v_accvgpr_read_b32 v252, a51
 v_mul_f32 v250, v250, v251
 v_mul_f32 v252, v252, v251
 v_accvgpr_write_b32 a50, v250
 v_accvgpr_write_b32 a51, v252
 v_accvgpr_read_b32 v250, a64
 v_accvgpr_read_b32 v252, a65
 v_mul_f32 v250, v250, v251
 v_mul_f32 v252, v252, v251
 v_accvgpr_write_b32 a64, v250
 v_accvgpr_write_b32 a65, v252
 v_accvgpr_read_b32 v250, a66
 v_accvgpr_read_b32 v252, a67
 v_mul_f32 v250, v250, v251
 v_mul_f32 v252, v252, v251
 v_accvgpr_write_b32 a66, v250
 v_accvgpr_write_b32 a67, v252
 v_accvgpr_read_b32 v250, a80
 v_accvgpr_read_b32 v252, a81
 v_mul_f32 v250, v250, v251
 v_mul_f32 v252, v252, v251
 v_accvgpr_write_b32 a80, v250
 v_accvgpr_write_b32 a81, v252
 v_accvgpr_read_b32 v250, a82
 v_accvgpr_read_b32 v252, a83
 v_mul_f32 v250, v250, v251
 v_mul_f32 v252, v252, v251
 v_accvgpr_write_b32 a82, v250
 v_accvgpr_write_b32 a83, v252
 v_accvgpr_read_b32 v250, a96
 v_accvgpr_read_b32 v252, a97
 v_mul_f32 v250, v250, v251
 v_mul_f32 v252, v252, v251
 v_accvgpr_write_b32 a96, v250
 v_accvgpr_write_b32 a97, v252
 v_accvgpr_read_b32 v250, a98
 v_accvgpr_read_b32 v252, a99
 v_mul_f32 v250, v250, v251
 v_mul_f32 v252, v252, v251
 v_accvgpr_write_b32 a98, v250
 v_accvgpr_write_b32 a99, v252
 v_accvgpr_read_b32 v250, a112
 v_accvgpr_read_b32 v252, a113
 v_mul_f32 v250, v250, v251
 v_mul_f32 v252, v252, v251
 v_accvgpr_write_b32 a112, v250
 v_accvgpr_write_b32 a113, v252
 v_accvgpr_read_b32 v250, a114
 v_accvgpr_read_b32 v252, a115
 v_mul_f32 v250, v250, v251
 v_mul_f32 v252, v252, v251
 v_accvgpr_write_b32 a114, v250
 v_accvgpr_write_b32 a115, v252
 v_accvgpr_read_b32 v250, a128
 v_accvgpr_read_b32 v252, a129
 v_mul_f32 v250, v250, v251
 v_mul_f32 v252, v252, v251
 v_accvgpr_write_b32 a128, v250
 v_accvgpr_write_b32 a129, v252
 v_accvgpr_read_b32 v250, a130
 v_accvgpr_read_b32 v252, a131
 v_mul_f32 v250, v250, v251
 v_mul_f32 v252, v252, v251
 v_accvgpr_write_b32 a130, v250
 v_accvgpr_write_b32 a131, v252
 v_accvgpr_read_b32 v250, a144
 v_accvgpr_read_b32 v252, a145
 v_mul_f32 v250, v250, v251
 v_mul_f32 v252, v252, v251
 v_accvgpr_write_b32 a144, v250
 v_accvgpr_write_b32 a145, v252
 v_accvgpr_read_b32 v250, a146
 v_accvgpr_read_b32 v252, a147
 v_mul_f32 v250, v250, v251
 v_mul_f32 v252, v252, v251
 v_accvgpr_write_b32 a146, v250
 v_accvgpr_write_b32 a147, v252
 v_accvgpr_read_b32 v250, a160
 v_accvgpr_read_b32 v252, a161
 v_mul_f32 v250, v250, v251
 v_mul_f32 v252, v252, v251
 v_accvgpr_write_b32 a160, v250
 v_accvgpr_write_b32 a161, v252
 v_accvgpr_read_b32 v250, a162
 v_accvgpr_read_b32 v252, a163
 v_mul_f32 v250, v250, v251
 v_mul_f32 v252, v252, v251
 v_accvgpr_write_b32 a162, v250
 v_accvgpr_write_b32 a163, v252
 v_accvgpr_read_b32 v250, a176
 v_accvgpr_read_b32 v252, a177
 v_mul_f32 v250, v250, v251
 v_mul_f32 v252, v252, v251
 v_accvgpr_write_b32 a176, v250
 v_accvgpr_write_b32 a177, v252
 v_accvgpr_read_b32 v250, a178
 v_accvgpr_read_b32 v252, a179
 v_mul_f32 v250, v250, v251
 v_mul_f32 v252, v252, v251
 v_accvgpr_write_b32 a178, v250
 v_accvgpr_write_b32 a179, v252
 v_accvgpr_read_b32 v250, a192
 v_accvgpr_read_b32 v252, a193
 v_mul_f32 v250, v250, v251
 v_mul_f32 v252, v252, v251
 v_accvgpr_write_b32 a192, v250
 v_accvgpr_write_b32 a193, v252
 v_accvgpr_read_b32 v250, a194
 v_accvgpr_read_b32 v252, a195
 v_mul_f32 v250, v250, v251
 v_mul_f32 v252, v252, v251
 v_accvgpr_write_b32 a194, v250
 v_accvgpr_write_b32 a195, v252
 v_accvgpr_read_b32 v250, a208
 v_accvgpr_read_b32 v252, a209
 v_mul_f32 v250, v250, v251
 v_mul_f32 v252, v252, v251
 v_accvgpr_write_b32 a208, v250
 v_accvgpr_write_b32 a209, v252
 v_accvgpr_read_b32 v250, a210
 v_accvgpr_read_b32 v252, a211
 v_mul_f32 v250, v250, v251
 v_mul_f32 v252, v252, v251
 v_accvgpr_write_b32 a210, v250
 v_accvgpr_write_b32 a211, v252
 v_accvgpr_read_b32 v250, a224
 v_accvgpr_read_b32 v252, a225
 v_mul_f32 v250, v250, v251
 v_mul_f32 v252, v252, v251
 v_accvgpr_write_b32 a224, v250
 v_accvgpr_write_b32 a225, v252
 v_accvgpr_read_b32 v250, a226
 v_accvgpr_read_b32 v252, a227
 v_mul_f32 v250, v250, v251
 v_mul_f32 v252, v252, v251
 v_accvgpr_write_b32 a226, v250
 v_accvgpr_write_b32 a227, v252
 v_accvgpr_read_b32 v250, a240
 v_accvgpr_read_b32 v252, a241
 v_mul_f32 v250, v250, v251
 v_mul_f32 v252, v252, v251
 v_accvgpr_write_b32 a240, v250
 v_accvgpr_write_b32 a241, v252
 v_accvgpr_read_b32 v250, a242
 v_accvgpr_read_b32 v252, a243
 v_mul_f32 v250, v250, v251
 v_mul_f32 v252, v252, v251
 v_accvgpr_write_b32 a242, v250
 v_accvgpr_write_b32 a243, v252
 v_max3_f32 v249, v132, v133, v134
 v_max3_f32 v249, v249, v135, v148
 v_max3_f32 v249, v249, v149, v150
 v_max_f32 v249, v249, v151
 v_mov_b32 v250, v249
 s_nop 1
 v_permlane16_swap_b32 v249, v250
 v_max_f32 v249, v249, v250
 v_mov_b32 v250, v249
 s_nop 1
 v_permlane32_swap_b32 v249, v250
 v_max_f32 v249, v249, v250
 v_ceil_f32 v249, v249
 v_max_f32 v249, 0, v249
 v_cvt_i32_f32 v250, v249
 v_sub_u32 v250, 0, v250
 v_ldexp_f32 v251, 1.0, v250
 v_sub_f32 v132, v132, v249
 v_sub_f32 v133, v133, v249
 v_sub_f32 v134, v134, v249
 v_sub_f32 v135, v135, v249
 v_sub_f32 v148, v148, v249
 v_sub_f32 v149, v149, v249
 v_sub_f32 v150, v150, v249
 v_sub_f32 v151, v151, v249
 v_sub_f32 v212, v212, v249
 v_sub_f32 v213, v213, v249
 v_sub_f32 v214, v214, v249
 v_sub_f32 v215, v215, v249
 v_mul_f32 v245, v245, v251
 v_lshlrev_b32 v250, 16, v196
 v_and_b32 v252, s68, v196
 v_mul_f32 v250, v250, v251
 v_mul_f32 v252, v252, v251
 v_cvt_pk_bf16_f32 v196, v250, v252
 v_lshlrev_b32 v250, 16, v197
 v_and_b32 v252, s68, v197
 v_mul_f32 v250, v250, v251
 v_mul_f32 v252, v252, v251
 v_cvt_pk_bf16_f32 v197, v250, v252
 v_lshlrev_b32 v250, 16, v198
 v_and_b32 v252, s68, v198
 v_mul_f32 v250, v250, v251
 v_mul_f32 v252, v252, v251
 v_cvt_pk_bf16_f32 v198, v250, v252
 v_lshlrev_b32 v250, 16, v199
 v_and_b32 v252, s68, v199
 v_mul_f32 v250, v250, v251
 v_mul_f32 v252, v252, v251
 v_cvt_pk_bf16_f32 v199, v250, v252
 v_accvgpr_read_b32 v250, a4
 v_accvgpr_read_b32 v252, a5
 v_mul_f32 v250, v250, v251
 v_mul_f32 v252, v252, v251
 v_accvgpr_write_b32 a4, v250
 v_accvgpr_write_b32 a5, v252
 v_accvgpr_read_b32 v250, a6
 v_accvgpr_read_b32 v252, a7
 v_mul_f32 v250, v250, v251
 v_mul_f32 v252, v252, v251
 v_accvgpr_write_b32 a6, v250
 v_accvgpr_write_b32 a7, v252
 v_accvgpr_read_b32 v250, a20
 v_accvgpr_read_b32 v252, a21
 v_mul_f32 v250, v250, v251
 v_mul_f32 v252, v252, v251
 v_accvgpr_write_b32 a20, v250
 v_accvgpr_write_b32 a21, v252
 v_accvgpr_read_b32 v250, a22
 v_accvgpr_read_b32 v252, a23
 v_mul_f32 v250, v250, v251
 v_mul_f32 v252, v252, v251
 v_accvgpr_write_b32 a22, v250
 v_accvgpr_write_b32 a23, v252
 v_accvgpr_read_b32 v250, a36
 v_accvgpr_read_b32 v252, a37
 v_mul_f32 v250, v250, v251
 v_mul_f32 v252, v252, v251
 v_accvgpr_write_b32 a36, v250
 v_accvgpr_write_b32 a37, v252
 v_accvgpr_read_b32 v250, a38
 v_accvgpr_read_b32 v252, a39
 v_mul_f32 v250, v250, v251
 v_mul_f32 v252, v252, v251
 v_accvgpr_write_b32 a38, v250
 v_accvgpr_write_b32 a39, v252
 v_accvgpr_read_b32 v250, a52
 v_accvgpr_read_b32 v252, a53
 v_mul_f32 v250, v250, v251
 v_mul_f32 v252, v252, v251
 v_accvgpr_write_b32 a52, v250
 v_accvgpr_write_b32 a53, v252
 v_accvgpr_read_b32 v250, a54
 v_accvgpr_read_b32 v252, a55
 v_mul_f32 v250, v250, v251
 v_mul_f32 v252, v252, v251
 v_accvgpr_write_b32 a54, v250
 v_accvgpr_write_b32 a55, v252
 v_accvgpr_read_b32 v250, a68
 v_accvgpr_read_b32 v252, a69
 v_mul_f32 v250, v250, v251
 v_mul_f32 v252, v252, v251
 v_accvgpr_write_b32 a68, v250
 v_accvgpr_write_b32 a69, v252
 v_accvgpr_read_b32 v250, a70
 v_accvgpr_read_b32 v252, a71
 v_mul_f32 v250, v250, v251
 v_mul_f32 v252, v252, v251
 v_accvgpr_write_b32 a70, v250
 v_accvgpr_write_b32 a71, v252
 v_accvgpr_read_b32 v250, a84
 v_accvgpr_read_b32 v252, a85
 v_mul_f32 v250, v250, v251
 v_mul_f32 v252, v252, v251
 v_accvgpr_write_b32 a84, v250
 v_accvgpr_write_b32 a85, v252
 v_accvgpr_read_b32 v250, a86
 v_accvgpr_read_b32 v252, a87
 v_mul_f32 v250, v250, v251
 v_mul_f32 v252, v252, v251
 v_accvgpr_write_b32 a86, v250
 v_accvgpr_write_b32 a87, v252
 v_accvgpr_read_b32 v250, a100
 v_accvgpr_read_b32 v252, a101
 v_mul_f32 v250, v250, v251
 v_mul_f32 v252, v252, v251
 v_accvgpr_write_b32 a100, v250
 v_accvgpr_write_b32 a101, v252
 v_accvgpr_read_b32 v250, a102
 v_accvgpr_read_b32 v252, a103
 v_mul_f32 v250, v250, v251
 v_mul_f32 v252, v252, v251
 v_accvgpr_write_b32 a102, v250
 v_accvgpr_write_b32 a103, v252
 v_accvgpr_read_b32 v250, a116
 v_accvgpr_read_b32 v252, a117
 v_mul_f32 v250, v250, v251
 v_mul_f32 v252, v252, v251
 v_accvgpr_write_b32 a116, v250
 v_accvgpr_write_b32 a117, v252
 v_accvgpr_read_b32 v250, a118
 v_accvgpr_read_b32 v252, a119
 v_mul_f32 v250, v250, v251
 v_mul_f32 v252, v252, v251
 v_accvgpr_write_b32 a118, v250
 v_accvgpr_write_b32 a119, v252
 v_accvgpr_read_b32 v250, a132
 v_accvgpr_read_b32 v252, a133
 v_mul_f32 v250, v250, v251
 v_mul_f32 v252, v252, v251
 v_accvgpr_write_b32 a132, v250
 v_accvgpr_write_b32 a133, v252
 v_accvgpr_read_b32 v250, a134
 v_accvgpr_read_b32 v252, a135
 v_mul_f32 v250, v250, v251
 v_mul_f32 v252, v252, v251
 v_accvgpr_write_b32 a134, v250
 v_accvgpr_write_b32 a135, v252
 v_accvgpr_read_b32 v250, a148
 v_accvgpr_read_b32 v252, a149
 v_mul_f32 v250, v250, v251
 v_mul_f32 v252, v252, v251
 v_accvgpr_write_b32 a148, v250
 v_accvgpr_write_b32 a149, v252
 v_accvgpr_read_b32 v250, a150
 v_accvgpr_read_b32 v252, a151
 v_mul_f32 v250, v250, v251
 v_mul_f32 v252, v252, v251
 v_accvgpr_write_b32 a150, v250
 v_accvgpr_write_b32 a151, v252
 v_accvgpr_read_b32 v250, a164
 v_accvgpr_read_b32 v252, a165
 v_mul_f32 v250, v250, v251
 v_mul_f32 v252, v252, v251
 v_accvgpr_write_b32 a164, v250
 v_accvgpr_write_b32 a165, v252
 v_accvgpr_read_b32 v250, a166
 v_accvgpr_read_b32 v252, a167
 v_mul_f32 v250, v250, v251
 v_mul_f32 v252, v252, v251
 v_accvgpr_write_b32 a166, v250
 v_accvgpr_write_b32 a167, v252
 v_accvgpr_read_b32 v250, a180
 v_accvgpr_read_b32 v252, a181
 v_mul_f32 v250, v250, v251
 v_mul_f32 v252, v252, v251
 v_accvgpr_write_b32 a180, v250
 v_accvgpr_write_b32 a181, v252
 v_accvgpr_read_b32 v250, a182
 v_accvgpr_read_b32 v252, a183
 v_mul_f32 v250, v250, v251
 v_mul_f32 v252, v252, v251
 v_accvgpr_write_b32 a182, v250
 v_accvgpr_write_b32 a183, v252
 v_accvgpr_read_b32 v250, a196
 v_accvgpr_read_b32 v252, a197
 v_mul_f32 v250, v250, v251
 v_mul_f32 v252, v252, v251
 v_accvgpr_write_b32 a196, v250
 v_accvgpr_write_b32 a197, v252
 v_accvgpr_read_b32 v250, a198
 v_accvgpr_read_b32 v252, a199
 v_mul_f32 v250, v250, v251
 v_mul_f32 v252, v252, v251
 v_accvgpr_write_b32 a198, v250
 v_accvgpr_write_b32 a199, v252
 v_accvgpr_read_b32 v250, a212
 v_accvgpr_read_b32 v252, a213
 v_mul_f32 v250, v250, v251
 v_mul_f32 v252, v252, v251
 v_accvgpr_write_b32 a212, v250
 v_accvgpr_write_b32 a213, v252
 v_accvgpr_read_b32 v250, a214
 v_accvgpr_read_b32 v252, a215
 v_mul_f32 v250, v250, v251
 v_mul_f32 v252, v252, v251
 v_accvgpr_write_b32 a214, v250
 v_accvgpr_write_b32 a215, v252
 v_accvgpr_read_b32 v250, a228
 v_accvgpr_read_b32 v252, a229
 v_mul_f32 v250, v250, v251
 v_mul_f32 v252, v252, v251
 v_accvgpr_write_b32 a228, v250
 v_accvgpr_write_b32 a229, v252
 v_accvgpr_read_b32 v250, a230
 v_accvgpr_read_b32 v252, a231
 v_mul_f32 v250, v250, v251
 v_mul_f32 v252, v252, v251
 v_accvgpr_write_b32 a230, v250
 v_accvgpr_write_b32 a231, v252
 v_accvgpr_read_b32 v250, a244
 v_accvgpr_read_b32 v252, a245
 v_mul_f32 v250, v250, v251
 v_mul_f32 v252, v252, v251
 v_accvgpr_write_b32 a244, v250
 v_accvgpr_write_b32 a245, v252
 v_accvgpr_read_b32 v250, a246
 v_accvgpr_read_b32 v252, a247
 v_mul_f32 v250, v250, v251
 v_mul_f32 v252, v252, v251
 v_accvgpr_write_b32 a246, v250
 v_accvgpr_write_b32 a247, v252
 v_max3_f32 v249, v136, v137, v138
 v_max3_f32 v249, v249, v139, v152
 v_max3_f32 v249, v249, v153, v154
 v_max_f32 v249, v249, v155
 v_mov_b32 v250, v249
 s_nop 1
 v_permlane16_swap_b32 v249, v250
 v_max_f32 v249, v249, v250
 v_mov_b32 v250, v249
 s_nop 1
 v_permlane32_swap_b32 v249, v250
 v_max_f32 v249, v249, v250
 v_ceil_f32 v249, v249
 v_max_f32 v249, 0, v249
 v_cvt_i32_f32 v250, v249
 v_sub_u32 v250, 0, v250
 v_ldexp_f32 v251, 1.0, v250
 v_sub_f32 v136, v136, v249
 v_sub_f32 v137, v137, v249
 v_sub_f32 v138, v138, v249
 v_sub_f32 v139, v139, v249
 v_sub_f32 v152, v152, v249
 v_sub_f32 v153, v153, v249
 v_sub_f32 v154, v154, v249
 v_sub_f32 v155, v155, v249
 v_sub_f32 v216, v216, v249
 v_sub_f32 v217, v217, v249
 v_sub_f32 v218, v218, v249
 v_sub_f32 v219, v219, v249
 v_mul_f32 v246, v246, v251
 v_lshlrev_b32 v250, 16, v200
 v_and_b32 v252, s68, v200
 v_mul_f32 v250, v250, v251
 v_mul_f32 v252, v252, v251
 v_cvt_pk_bf16_f32 v200, v250, v252
 v_lshlrev_b32 v250, 16, v201
 v_and_b32 v252, s68, v201
 v_mul_f32 v250, v250, v251
 v_mul_f32 v252, v252, v251
 v_cvt_pk_bf16_f32 v201, v250, v252
 v_lshlrev_b32 v250, 16, v202
 v_and_b32 v252, s68, v202
 v_mul_f32 v250, v250, v251
 v_mul_f32 v252, v252, v251
 v_cvt_pk_bf16_f32 v202, v250, v252
 v_lshlrev_b32 v250, 16, v203
 v_and_b32 v252, s68, v203
 v_mul_f32 v250, v250, v251
 v_mul_f32 v252, v252, v251
 v_cvt_pk_bf16_f32 v203, v250, v252
 v_accvgpr_read_b32 v250, a8
 v_accvgpr_read_b32 v252, a9
 v_mul_f32 v250, v250, v251
 v_mul_f32 v252, v252, v251
 v_accvgpr_write_b32 a8, v250
 v_accvgpr_write_b32 a9, v252
 v_accvgpr_read_b32 v250, a10
 v_accvgpr_read_b32 v252, a11
 v_mul_f32 v250, v250, v251
 v_mul_f32 v252, v252, v251
 v_accvgpr_write_b32 a10, v250
 v_accvgpr_write_b32 a11, v252
 v_accvgpr_read_b32 v250, a24
 v_accvgpr_read_b32 v252, a25
 v_mul_f32 v250, v250, v251
 v_mul_f32 v252, v252, v251
 v_accvgpr_write_b32 a24, v250
 v_accvgpr_write_b32 a25, v252
 v_accvgpr_read_b32 v250, a26
 v_accvgpr_read_b32 v252, a27
 v_mul_f32 v250, v250, v251
 v_mul_f32 v252, v252, v251
 v_accvgpr_write_b32 a26, v250
 v_accvgpr_write_b32 a27, v252
 v_accvgpr_read_b32 v250, a40
 v_accvgpr_read_b32 v252, a41
 v_mul_f32 v250, v250, v251
 v_mul_f32 v252, v252, v251
 v_accvgpr_write_b32 a40, v250
 v_accvgpr_write_b32 a41, v252
 v_accvgpr_read_b32 v250, a42
 v_accvgpr_read_b32 v252, a43
 v_mul_f32 v250, v250, v251
 v_mul_f32 v252, v252, v251
 v_accvgpr_write_b32 a42, v250
 v_accvgpr_write_b32 a43, v252
 v_accvgpr_read_b32 v250, a56
 v_accvgpr_read_b32 v252, a57
 v_mul_f32 v250, v250, v251
 v_mul_f32 v252, v252, v251
 v_accvgpr_write_b32 a56, v250
 v_accvgpr_write_b32 a57, v252
 v_accvgpr_read_b32 v250, a58
 v_accvgpr_read_b32 v252, a59
 v_mul_f32 v250, v250, v251
 v_mul_f32 v252, v252, v251
 v_accvgpr_write_b32 a58, v250
 v_accvgpr_write_b32 a59, v252
 v_accvgpr_read_b32 v250, a72
 v_accvgpr_read_b32 v252, a73
 v_mul_f32 v250, v250, v251
 v_mul_f32 v252, v252, v251
 v_accvgpr_write_b32 a72, v250
 v_accvgpr_write_b32 a73, v252
 v_accvgpr_read_b32 v250, a74
 v_accvgpr_read_b32 v252, a75
 v_mul_f32 v250, v250, v251
 v_mul_f32 v252, v252, v251
 v_accvgpr_write_b32 a74, v250
 v_accvgpr_write_b32 a75, v252
 v_accvgpr_read_b32 v250, a88
 v_accvgpr_read_b32 v252, a89
 v_mul_f32 v250, v250, v251
 v_mul_f32 v252, v252, v251
 v_accvgpr_write_b32 a88, v250
 v_accvgpr_write_b32 a89, v252
 v_accvgpr_read_b32 v250, a90
 v_accvgpr_read_b32 v252, a91
 v_mul_f32 v250, v250, v251
 v_mul_f32 v252, v252, v251
 v_accvgpr_write_b32 a90, v250
 v_accvgpr_write_b32 a91, v252
 v_accvgpr_read_b32 v250, a104
 v_accvgpr_read_b32 v252, a105
 v_mul_f32 v250, v250, v251
 v_mul_f32 v252, v252, v251
 v_accvgpr_write_b32 a104, v250
 v_accvgpr_write_b32 a105, v252
 v_accvgpr_read_b32 v250, a106
 v_accvgpr_read_b32 v252, a107
 v_mul_f32 v250, v250, v251
 v_mul_f32 v252, v252, v251
 v_accvgpr_write_b32 a106, v250
 v_accvgpr_write_b32 a107, v252
 v_accvgpr_read_b32 v250, a120
 v_accvgpr_read_b32 v252, a121
 v_mul_f32 v250, v250, v251
 v_mul_f32 v252, v252, v251
 v_accvgpr_write_b32 a120, v250
 v_accvgpr_write_b32 a121, v252
 v_accvgpr_read_b32 v250, a122
 v_accvgpr_read_b32 v252, a123
 v_mul_f32 v250, v250, v251
 v_mul_f32 v252, v252, v251
 v_accvgpr_write_b32 a122, v250
 v_accvgpr_write_b32 a123, v252
 v_accvgpr_read_b32 v250, a136
 v_accvgpr_read_b32 v252, a137
 v_mul_f32 v250, v250, v251
 v_mul_f32 v252, v252, v251
 v_accvgpr_write_b32 a136, v250
 v_accvgpr_write_b32 a137, v252
 v_accvgpr_read_b32 v250, a138
 v_accvgpr_read_b32 v252, a139
 v_mul_f32 v250, v250, v251
 v_mul_f32 v252, v252, v251
 v_accvgpr_write_b32 a138, v250
 v_accvgpr_write_b32 a139, v252
 v_accvgpr_read_b32 v250, a152
 v_accvgpr_read_b32 v252, a153
 v_mul_f32 v250, v250, v251
 v_mul_f32 v252, v252, v251
 v_accvgpr_write_b32 a152, v250
 v_accvgpr_write_b32 a153, v252
 v_accvgpr_read_b32 v250, a154
 v_accvgpr_read_b32 v252, a155
 v_mul_f32 v250, v250, v251
 v_mul_f32 v252, v252, v251
 v_accvgpr_write_b32 a154, v250
 v_accvgpr_write_b32 a155, v252
 v_accvgpr_read_b32 v250, a168
 v_accvgpr_read_b32 v252, a169
 v_mul_f32 v250, v250, v251
 v_mul_f32 v252, v252, v251
 v_accvgpr_write_b32 a168, v250
 v_accvgpr_write_b32 a169, v252
 v_accvgpr_read_b32 v250, a170
 v_accvgpr_read_b32 v252, a171
 v_mul_f32 v250, v250, v251
 v_mul_f32 v252, v252, v251
 v_accvgpr_write_b32 a170, v250
 v_accvgpr_write_b32 a171, v252
 v_accvgpr_read_b32 v250, a184
 v_accvgpr_read_b32 v252, a185
 v_mul_f32 v250, v250, v251
 v_mul_f32 v252, v252, v251
 v_accvgpr_write_b32 a184, v250
 v_accvgpr_write_b32 a185, v252
 v_accvgpr_read_b32 v250, a186
 v_accvgpr_read_b32 v252, a187
 v_mul_f32 v250, v250, v251
 v_mul_f32 v252, v252, v251
 v_accvgpr_write_b32 a186, v250
 v_accvgpr_write_b32 a187, v252
 v_accvgpr_read_b32 v250, a200
 v_accvgpr_read_b32 v252, a201
 v_mul_f32 v250, v250, v251
 v_mul_f32 v252, v252, v251
 v_accvgpr_write_b32 a200, v250
 v_accvgpr_write_b32 a201, v252
 v_accvgpr_read_b32 v250, a202
 v_accvgpr_read_b32 v252, a203
 v_mul_f32 v250, v250, v251
 v_mul_f32 v252, v252, v251
 v_accvgpr_write_b32 a202, v250
 v_accvgpr_write_b32 a203, v252
 v_accvgpr_read_b32 v250, a216
 v_accvgpr_read_b32 v252, a217
 v_mul_f32 v250, v250, v251
 v_mul_f32 v252, v252, v251
 v_accvgpr_write_b32 a216, v250
 v_accvgpr_write_b32 a217, v252
 v_accvgpr_read_b32 v250, a218
 v_accvgpr_read_b32 v252, a219
 v_mul_f32 v250, v250, v251
 v_mul_f32 v252, v252, v251
 v_accvgpr_write_b32 a218, v250
 v_accvgpr_write_b32 a219, v252
 v_accvgpr_read_b32 v250, a232
 v_accvgpr_read_b32 v252, a233
 v_mul_f32 v250, v250, v251
 v_mul_f32 v252, v252, v251
 v_accvgpr_write_b32 a232, v250
 v_accvgpr_write_b32 a233, v252
 v_accvgpr_read_b32 v250, a234
 v_accvgpr_read_b32 v252, a235
 v_mul_f32 v250, v250, v251
 v_mul_f32 v252, v252, v251
 v_accvgpr_write_b32 a234, v250
 v_accvgpr_write_b32 a235, v252
 v_accvgpr_read_b32 v250, a248
 v_accvgpr_read_b32 v252, a249
 v_mul_f32 v250, v250, v251
 v_mul_f32 v252, v252, v251
 v_accvgpr_write_b32 a248, v250
 v_accvgpr_write_b32 a249, v252
 v_accvgpr_read_b32 v250, a250
 v_accvgpr_read_b32 v252, a251
 v_mul_f32 v250, v250, v251
 v_mul_f32 v252, v252, v251
 v_accvgpr_write_b32 a250, v250
 v_accvgpr_write_b32 a251, v252
 v_max3_f32 v249, v140, v141, v142
 v_max3_f32 v249, v249, v143, v156
 v_max3_f32 v249, v249, v157, v158
 v_max_f32 v249, v249, v159
 v_mov_b32 v250, v249
 s_nop 1
 v_permlane16_swap_b32 v249, v250
 v_max_f32 v249, v249, v250
 v_mov_b32 v250, v249
 s_nop 1
 v_permlane32_swap_b32 v249, v250
 v_max_f32 v249, v249, v250
 v_ceil_f32 v249, v249
 v_max_f32 v249, 0, v249
 v_cvt_i32_f32 v250, v249
 v_sub_u32 v250, 0, v250
 v_ldexp_f32 v251, 1.0, v250
 v_sub_f32 v140, v140, v249
 v_sub_f32 v141, v141, v249
 v_sub_f32 v142, v142, v249
 v_sub_f32 v143, v143, v249
 v_sub_f32 v156, v156, v249
 v_sub_f32 v157, v157, v249
 v_sub_f32 v158, v158, v249
 v_sub_f32 v159, v159, v249
 v_sub_f32 v220, v220, v249
 v_sub_f32 v221, v221, v249
 v_sub_f32 v222, v222, v249
 v_sub_f32 v223, v223, v249
 v_mul_f32 v247, v247, v251
 v_lshlrev_b32 v250, 16, v204
 v_and_b32 v252, s68, v204
 v_mul_f32 v250, v250, v251
 v_mul_f32 v252, v252, v251
 v_cvt_pk_bf16_f32 v204, v250, v252
 v_lshlrev_b32 v250, 16, v205
 v_and_b32 v252, s68, v205
 v_mul_f32 v250, v250, v251
 v_mul_f32 v252, v252, v251
 v_cvt_pk_bf16_f32 v205, v250, v252
 v_lshlrev_b32 v250, 16, v206
 v_and_b32 v252, s68, v206
 v_mul_f32 v250, v250, v251
 v_mul_f32 v252, v252, v251
 v_cvt_pk_bf16_f32 v206, v250, v252
 v_lshlrev_b32 v250, 16, v207
 v_and_b32 v252, s68, v207
 v_mul_f32 v250, v250, v251
 v_mul_f32 v252, v252, v251
 v_cvt_pk_bf16_f32 v207, v250, v252
 v_accvgpr_read_b32 v250, a12
 v_accvgpr_read_b32 v252, a13
 v_mul_f32 v250, v250, v251
 v_mul_f32 v252, v252, v251
 v_accvgpr_write_b32 a12, v250
 v_accvgpr_write_b32 a13, v252
 v_accvgpr_read_b32 v250, a14
 v_accvgpr_read_b32 v252, a15
 v_mul_f32 v250, v250, v251
 v_mul_f32 v252, v252, v251
 v_accvgpr_write_b32 a14, v250
 v_accvgpr_write_b32 a15, v252
 v_accvgpr_read_b32 v250, a28
 v_accvgpr_read_b32 v252, a29
 v_mul_f32 v250, v250, v251
 v_mul_f32 v252, v252, v251
 v_accvgpr_write_b32 a28, v250
 v_accvgpr_write_b32 a29, v252
 v_accvgpr_read_b32 v250, a30
 v_accvgpr_read_b32 v252, a31
 v_mul_f32 v250, v250, v251
 v_mul_f32 v252, v252, v251
 v_accvgpr_write_b32 a30, v250
 v_accvgpr_write_b32 a31, v252
 v_accvgpr_read_b32 v250, a44
 v_accvgpr_read_b32 v252, a45
 v_mul_f32 v250, v250, v251
 v_mul_f32 v252, v252, v251
 v_accvgpr_write_b32 a44, v250
 v_accvgpr_write_b32 a45, v252
 v_accvgpr_read_b32 v250, a46
 v_accvgpr_read_b32 v252, a47
 v_mul_f32 v250, v250, v251
 v_mul_f32 v252, v252, v251
 v_accvgpr_write_b32 a46, v250
 v_accvgpr_write_b32 a47, v252
 v_accvgpr_read_b32 v250, a60
 v_accvgpr_read_b32 v252, a61
 v_mul_f32 v250, v250, v251
 v_mul_f32 v252, v252, v251
 v_accvgpr_write_b32 a60, v250
 v_accvgpr_write_b32 a61, v252
 v_accvgpr_read_b32 v250, a62
 v_accvgpr_read_b32 v252, a63
 v_mul_f32 v250, v250, v251
 v_mul_f32 v252, v252, v251
 v_accvgpr_write_b32 a62, v250
 v_accvgpr_write_b32 a63, v252
 v_accvgpr_read_b32 v250, a76
 v_accvgpr_read_b32 v252, a77
 v_mul_f32 v250, v250, v251
 v_mul_f32 v252, v252, v251
 v_accvgpr_write_b32 a76, v250
 v_accvgpr_write_b32 a77, v252
 v_accvgpr_read_b32 v250, a78
 v_accvgpr_read_b32 v252, a79
 v_mul_f32 v250, v250, v251
 v_mul_f32 v252, v252, v251
 v_accvgpr_write_b32 a78, v250
 v_accvgpr_write_b32 a79, v252
 v_accvgpr_read_b32 v250, a92
 v_accvgpr_read_b32 v252, a93
 v_mul_f32 v250, v250, v251
 v_mul_f32 v252, v252, v251
 v_accvgpr_write_b32 a92, v250
 v_accvgpr_write_b32 a93, v252
 v_accvgpr_read_b32 v250, a94
 v_accvgpr_read_b32 v252, a95
 v_mul_f32 v250, v250, v251
 v_mul_f32 v252, v252, v251
 v_accvgpr_write_b32 a94, v250
 v_accvgpr_write_b32 a95, v252
 v_accvgpr_read_b32 v250, a108
 v_accvgpr_read_b32 v252, a109
 v_mul_f32 v250, v250, v251
 v_mul_f32 v252, v252, v251
 v_accvgpr_write_b32 a108, v250
 v_accvgpr_write_b32 a109, v252
 v_accvgpr_read_b32 v250, a110
 v_accvgpr_read_b32 v252, a111
 v_mul_f32 v250, v250, v251
 v_mul_f32 v252, v252, v251
 v_accvgpr_write_b32 a110, v250
 v_accvgpr_write_b32 a111, v252
 v_accvgpr_read_b32 v250, a124
 v_accvgpr_read_b32 v252, a125
 v_mul_f32 v250, v250, v251
 v_mul_f32 v252, v252, v251
 v_accvgpr_write_b32 a124, v250
 v_accvgpr_write_b32 a125, v252
 v_accvgpr_read_b32 v250, a126
 v_accvgpr_read_b32 v252, a127
 v_mul_f32 v250, v250, v251
 v_mul_f32 v252, v252, v251
 v_accvgpr_write_b32 a126, v250
 v_accvgpr_write_b32 a127, v252
 v_accvgpr_read_b32 v250, a140
 v_accvgpr_read_b32 v252, a141
 v_mul_f32 v250, v250, v251
 v_mul_f32 v252, v252, v251
 v_accvgpr_write_b32 a140, v250
 v_accvgpr_write_b32 a141, v252
 v_accvgpr_read_b32 v250, a142
 v_accvgpr_read_b32 v252, a143
 v_mul_f32 v250, v250, v251
 v_mul_f32 v252, v252, v251
 v_accvgpr_write_b32 a142, v250
 v_accvgpr_write_b32 a143, v252
 v_accvgpr_read_b32 v250, a156
 v_accvgpr_read_b32 v252, a157
 v_mul_f32 v250, v250, v251
 v_mul_f32 v252, v252, v251
 v_accvgpr_write_b32 a156, v250
 v_accvgpr_write_b32 a157, v252
 v_accvgpr_read_b32 v250, a158
 v_accvgpr_read_b32 v252, a159
 v_mul_f32 v250, v250, v251
 v_mul_f32 v252, v252, v251
 v_accvgpr_write_b32 a158, v250
 v_accvgpr_write_b32 a159, v252
 v_accvgpr_read_b32 v250, a172
 v_accvgpr_read_b32 v252, a173
 v_mul_f32 v250, v250, v251
 v_mul_f32 v252, v252, v251
 v_accvgpr_write_b32 a172, v250
 v_accvgpr_write_b32 a173, v252
 v_accvgpr_read_b32 v250, a174
 v_accvgpr_read_b32 v252, a175
 v_mul_f32 v250, v250, v251
 v_mul_f32 v252, v252, v251
 v_accvgpr_write_b32 a174, v250
 v_accvgpr_write_b32 a175, v252
 v_accvgpr_read_b32 v250, a188
 v_accvgpr_read_b32 v252, a189
 v_mul_f32 v250, v250, v251
 v_mul_f32 v252, v252, v251
 v_accvgpr_write_b32 a188, v250
 v_accvgpr_write_b32 a189, v252
 v_accvgpr_read_b32 v250, a190
 v_accvgpr_read_b32 v252, a191
 v_mul_f32 v250, v250, v251
 v_mul_f32 v252, v252, v251
 v_accvgpr_write_b32 a190, v250
 v_accvgpr_write_b32 a191, v252
 v_accvgpr_read_b32 v250, a204
 v_accvgpr_read_b32 v252, a205
 v_mul_f32 v250, v250, v251
 v_mul_f32 v252, v252, v251
 v_accvgpr_write_b32 a204, v250
 v_accvgpr_write_b32 a205, v252
 v_accvgpr_read_b32 v250, a206
 v_accvgpr_read_b32 v252, a207
 v_mul_f32 v250, v250, v251
 v_mul_f32 v252, v252, v251
 v_accvgpr_write_b32 a206, v250
 v_accvgpr_write_b32 a207, v252
 v_accvgpr_read_b32 v250, a220
 v_accvgpr_read_b32 v252, a221
 v_mul_f32 v250, v250, v251
 v_mul_f32 v252, v252, v251
 v_accvgpr_write_b32 a220, v250
 v_accvgpr_write_b32 a221, v252
 v_accvgpr_read_b32 v250, a222
 v_accvgpr_read_b32 v252, a223
 v_mul_f32 v250, v250, v251
 v_mul_f32 v252, v252, v251
 v_accvgpr_write_b32 a222, v250
 v_accvgpr_write_b32 a223, v252
 v_accvgpr_read_b32 v250, a236
 v_accvgpr_read_b32 v252, a237
 v_mul_f32 v250, v250, v251
 v_mul_f32 v252, v252, v251
 v_accvgpr_write_b32 a236, v250
 v_accvgpr_write_b32 a237, v252
 v_accvgpr_read_b32 v250, a238
 v_accvgpr_read_b32 v252, a239
 v_mul_f32 v250, v250, v251
 v_mul_f32 v252, v252, v251
 v_accvgpr_write_b32 a238, v250
 v_accvgpr_write_b32 a239, v252
 v_accvgpr_read_b32 v250, a252
 v_accvgpr_read_b32 v252, a253
 v_mul_f32 v250, v250, v251
 v_mul_f32 v252, v252, v251
 v_accvgpr_write_b32 a252, v250
 v_accvgpr_write_b32 a253, v252
 v_accvgpr_read_b32 v250, a254
 v_accvgpr_read_b32 v252, a255
 v_mul_f32 v250, v250, v251
 v_mul_f32 v252, v252, v251
 v_accvgpr_write_b32 a254, v250
 v_accvgpr_write_b32 a255, v252
 s_nop 3
 s_cmp_eq_u32 s67, 2
 s_cbranch_scc1 L_back_2
 s_branch L_back_14
L_slow_1:
 s_nop 7
 s_nop 7
 v_max3_f32 v249, v160, v161, v162
 v_max3_f32 v249, v249, v163, v176
 v_max3_f32 v249, v249, v177, v178
 v_max_f32 v249, v249, v179
 v_mov_b32 v250, v249
 s_nop 1
 v_permlane16_swap_b32 v249, v250
 v_max_f32 v249, v249, v250
 v_mov_b32 v250, v249
 s_nop 1
 v_permlane32_swap_b32 v249, v250
 v_max_f32 v249, v249, v250
 v_ceil_f32 v249, v249
 v_max_f32 v249, 0, v249
 v_cvt_i32_f32 v250, v249
 v_sub_u32 v250, 0, v250
 v_ldexp_f32 v251, 1.0, v250
 v_sub_f32 v160, v160, v249
 v_sub_f32 v161, v161, v249
 v_sub_f32 v162, v162, v249
 v_sub_f32 v163, v163, v249
 v_sub_f32 v176, v176, v249
 v_sub_f32 v177, v177, v249
 v_sub_f32 v178, v178, v249
 v_sub_f32 v179, v179, v249
 v_sub_f32 v208, v208, v249
 v_sub_f32 v209, v209, v249
 v_sub_f32 v210, v210, v249
 v_sub_f32 v211, v211, v249
 v_mul_f32 v244, v244, v251
 v_lshlrev_b32 v250, 16, v192
 v_and_b32 v252, s68, v192
 v_mul_f32 v250, v250, v251
 v_mul_f32 v252, v252, v251
 v_cvt_pk_bf16_f32 v192, v250, v252
 v_lshlrev_b32 v250, 16, v193
 v_and_b32 v252, s68, v193
 v_mul_f32 v250, v250, v251
 v_mul_f32 v252, v252, v251
 v_cvt_pk_bf16_f32 v193, v250, v252
 v_lshlrev_b32 v250, 16, v194
 v_and_b32 v252, s68, v194
 v_mul_f32 v250, v250, v251
 v_mul_f32 v252, v252, v251
 v_cvt_pk_bf16_f32 v194, v250, v252
 v_lshlrev_b32 v250, 16, v195
 v_and_b32 v252, s68, v195
 v_mul_f32 v250, v250, v251
 v_mul_f32 v252, v252, v251
 v_cvt_pk_bf16_f32 v195, v250, v252
 v_accvgpr_read_b32 v250, a0
 v_accvgpr_read_b32 v252, a1
 v_mul_f32 v250, v250, v251
 v_mul_f32 v252, v252, v251
 v_accvgpr_write_b32 a0, v250
 v_accvgpr_write_b32 a1, v252
 v_accvgpr_read_b32 v250, a2
 v_accvgpr_read_b32 v252, a3
 v_mul_f32 v250, v250, v251
 v_mul_f32 v252, v252, v251
 v_accvgpr_write_b32 a2, v250
 v_accvgpr_write_b32 a3, v252
 v_accvgpr_read_b32 v250, a16
 v_accvgpr_read_b32 v252, a17
 v_mul_f32 v250, v250, v251
 v_mul_f32 v252, v252, v251
 v_accvgpr_write_b32 a16, v250
 v_accvgpr_write_b32 a17, v252
 v_accvgpr_read_b32 v250, a18
 v_accvgpr_read_b32 v252, a19
 v_mul_f32 v250, v250, v251
 v_mul_f32 v252, v252, v251
 v_accvgpr_write_b32 a18, v250
 v_accvgpr_write_b32 a19, v252
 v_accvgpr_read_b32 v250, a32
 v_accvgpr_read_b32 v252, a33
 v_mul_f32 v250, v250, v251
 v_mul_f32 v252, v252, v251
 v_accvgpr_write_b32 a32, v250
 v_accvgpr_write_b32 a33, v252
 v_accvgpr_read_b32 v250, a34
 v_accvgpr_read_b32 v252, a35
 v_mul_f32 v250, v250, v251
 v_mul_f32 v252, v252, v251
 v_accvgpr_write_b32 a34, v250
 v_accvgpr_write_b32 a35, v252
 v_accvgpr_read_b32 v250, a48
 v_accvgpr_read_b32 v252, a49
 v_mul_f32 v250, v250, v251
 v_mul_f32 v252, v252, v251
 v_accvgpr_write_b32 a48, v250
 v_accvgpr_write_b32 a49, v252
 v_accvgpr_read_b32 v250, a50
 v_accvgpr_read_b32 v252, a51
 v_mul_f32 v250, v250, v251
 v_mul_f32 v252, v252, v251
 v_accvgpr_write_b32 a50, v250
 v_accvgpr_write_b32 a51, v252
 v_accvgpr_read_b32 v250, a64
 v_accvgpr_read_b32 v252, a65
 v_mul_f32 v250, v250, v251
 v_mul_f32 v252, v252, v251
 v_accvgpr_write_b32 a64, v250
 v_accvgpr_write_b32 a65, v252
 v_accvgpr_read_b32 v250, a66
 v_accvgpr_read_b32 v252, a67
 v_mul_f32 v250, v250, v251
 v_mul_f32 v252, v252, v251
 v_accvgpr_write_b32 a66, v250
 v_accvgpr_write_b32 a67, v252
 v_accvgpr_read_b32 v250, a80
 v_accvgpr_read_b32 v252, a81
 v_mul_f32 v250, v250, v251
 v_mul_f32 v252, v252, v251
 v_accvgpr_write_b32 a80, v250
 v_accvgpr_write_b32 a81, v252
 v_accvgpr_read_b32 v250, a82
 v_accvgpr_read_b32 v252, a83
 v_mul_f32 v250, v250, v251
 v_mul_f32 v252, v252, v251
 v_accvgpr_write_b32 a82, v250
 v_accvgpr_write_b32 a83, v252
 v_accvgpr_read_b32 v250, a96
 v_accvgpr_read_b32 v252, a97
 v_mul_f32 v250, v250, v251
 v_mul_f32 v252, v252, v251
 v_accvgpr_write_b32 a96, v250
 v_accvgpr_write_b32 a97, v252
 v_accvgpr_read_b32 v250, a98
 v_accvgpr_read_b32 v252, a99
 v_mul_f32 v250, v250, v251
 v_mul_f32 v252, v252, v251
 v_accvgpr_write_b32 a98, v250
 v_accvgpr_write_b32 a99, v252
 v_accvgpr_read_b32 v250, a112
 v_accvgpr_read_b32 v252, a113
 v_mul_f32 v250, v250, v251
 v_mul_f32 v252, v252, v251
 v_accvgpr_write_b32 a112, v250
 v_accvgpr_write_b32 a113, v252
 v_accvgpr_read_b32 v250, a114
 v_accvgpr_read_b32 v252, a115
 v_mul_f32 v250, v250, v251
 v_mul_f32 v252, v252, v251
 v_accvgpr_write_b32 a114, v250
 v_accvgpr_write_b32 a115, v252
 v_accvgpr_read_b32 v250, a128
 v_accvgpr_read_b32 v252, a129
 v_mul_f32 v250, v250, v251
 v_mul_f32 v252, v252, v251
 v_accvgpr_write_b32 a128, v250
 v_accvgpr_write_b32 a129, v252
 v_accvgpr_read_b32 v250, a130
 v_accvgpr_read_b32 v252, a131
 v_mul_f32 v250, v250, v251
 v_mul_f32 v252, v252, v251
 v_accvgpr_write_b32 a130, v250
 v_accvgpr_write_b32 a131, v252
 v_accvgpr_read_b32 v250, a144
 v_accvgpr_read_b32 v252, a145
 v_mul_f32 v250, v250, v251
 v_mul_f32 v252, v252, v251
 v_accvgpr_write_b32 a144, v250
 v_accvgpr_write_b32 a145, v252
 v_accvgpr_read_b32 v250, a146
 v_accvgpr_read_b32 v252, a147
 v_mul_f32 v250, v250, v251
 v_mul_f32 v252, v252, v251
 v_accvgpr_write_b32 a146, v250
 v_accvgpr_write_b32 a147, v252
 v_accvgpr_read_b32 v250, a160
 v_accvgpr_read_b32 v252, a161
 v_mul_f32 v250, v250, v251
 v_mul_f32 v252, v252, v251
 v_accvgpr_write_b32 a160, v250
 v_accvgpr_write_b32 a161, v252
 v_accvgpr_read_b32 v250, a162
 v_accvgpr_read_b32 v252, a163
 v_mul_f32 v250, v250, v251
 v_mul_f32 v252, v252, v251
 v_accvgpr_write_b32 a162, v250
 v_accvgpr_write_b32 a163, v252
 v_accvgpr_read_b32 v250, a176
 v_accvgpr_read_b32 v252, a177
 v_mul_f32 v250, v250, v251
 v_mul_f32 v252, v252, v251
 v_accvgpr_write_b32 a176, v250
 v_accvgpr_write_b32 a177, v252
 v_accvgpr_read_b32 v250, a178
 v_accvgpr_read_b32 v252, a179
 v_mul_f32 v250, v250, v251
 v_mul_f32 v252, v252, v251
 v_accvgpr_write_b32 a178, v250
 v_accvgpr_write_b32 a179, v252
 v_accvgpr_read_b32 v250, a192
 v_accvgpr_read_b32 v252, a193
 v_mul_f32 v250, v250, v251
 v_mul_f32 v252, v252, v251
 v_accvgpr_write_b32 a192, v250
 v_accvgpr_write_b32 a193, v252
 v_accvgpr_read_b32 v250, a194
 v_accvgpr_read_b32 v252, a195
 v_mul_f32 v250, v250, v251
 v_mul_f32 v252, v252, v251
 v_accvgpr_write_b32 a194, v250
 v_accvgpr_write_b32 a195, v252
 v_accvgpr_read_b32 v250, a208
 v_accvgpr_read_b32 v252, a209
 v_mul_f32 v250, v250, v251
 v_mul_f32 v252, v252, v251
 v_accvgpr_write_b32 a208, v250
 v_accvgpr_write_b32 a209, v252
 v_accvgpr_read_b32 v250, a210
 v_accvgpr_read_b32 v252, a211
 v_mul_f32 v250, v250, v251
 v_mul_f32 v252, v252, v251
 v_accvgpr_write_b32 a210, v250
 v_accvgpr_write_b32 a211, v252
 v_accvgpr_read_b32 v250, a224
 v_accvgpr_read_b32 v252, a225
 v_mul_f32 v250, v250, v251
 v_mul_f32 v252, v252, v251
 v_accvgpr_write_b32 a224, v250
 v_accvgpr_write_b32 a225, v252
 v_accvgpr_read_b32 v250, a226
 v_accvgpr_read_b32 v252, a227
 v_mul_f32 v250, v250, v251
 v_mul_f32 v252, v252, v251
 v_accvgpr_write_b32 a226, v250
 v_accvgpr_write_b32 a227, v252
 v_accvgpr_read_b32 v250, a240
 v_accvgpr_read_b32 v252, a241
 v_mul_f32 v250, v250, v251
 v_mul_f32 v252, v252, v251
 v_accvgpr_write_b32 a240, v250
 v_accvgpr_write_b32 a241, v252
 v_accvgpr_read_b32 v250, a242
 v_accvgpr_read_b32 v252, a243
 v_mul_f32 v250, v250, v251
 v_mul_f32 v252, v252, v251
 v_accvgpr_write_b32 a242, v250
 v_accvgpr_write_b32 a243, v252
 v_max3_f32 v249, v164, v165, v166
 v_max3_f32 v249, v249, v167, v180
 v_max3_f32 v249, v249, v181, v182
 v_max_f32 v249, v249, v183
 v_mov_b32 v250, v249
 s_nop 1
 v_permlane16_swap_b32 v249, v250
 v_max_f32 v249, v249, v250
 v_mov_b32 v250, v249
 s_nop 1
 v_permlane32_swap_b32 v249, v250
 v_max_f32 v249, v249, v250
 v_ceil_f32 v249, v249
 v_max_f32 v249, 0, v249
 v_cvt_i32_f32 v250, v249
 v_sub_u32 v250, 0, v250
 v_ldexp_f32 v251, 1.0, v250
 v_sub_f32 v164, v164, v249
 v_sub_f32 v165, v165, v249
 v_sub_f32 v166, v166, v249
 v_sub_f32 v167, v167, v249
 v_sub_f32 v180, v180, v249
 v_sub_f32 v181, v181, v249
 v_sub_f32 v182, v182, v249
 v_sub_f32 v183, v183, v249
 v_sub_f32 v212, v212, v249
 v_sub_f32 v213, v213, v249
 v_sub_f32 v214, v214, v249
 v_sub_f32 v215, v215, v249
 v_mul_f32 v245, v245, v251
 v_lshlrev_b32 v250, 16, v196
 v_and_b32 v252, s68, v196
 v_mul_f32 v250, v250, v251
 v_mul_f32 v252, v252, v251
 v_cvt_pk_bf16_f32 v196, v250, v252
 v_lshlrev_b32 v250, 16, v197
 v_and_b32 v252, s68, v197
 v_mul_f32 v250, v250, v251
 v_mul_f32 v252, v252, v251
 v_cvt_pk_bf16_f32 v197, v250, v252
 v_lshlrev_b32 v250, 16, v198
 v_and_b32 v252, s68, v198
 v_mul_f32 v250, v250, v251
 v_mul_f32 v252, v252, v251
 v_cvt_pk_bf16_f32 v198, v250, v252
 v_lshlrev_b32 v250, 16, v199
 v_and_b32 v252, s68, v199
 v_mul_f32 v250, v250, v251
 v_mul_f32 v252, v252, v251
 v_cvt_pk_bf16_f32 v199, v250, v252
 v_accvgpr_read_b32 v250, a4
 v_accvgpr_read_b32 v252, a5
 v_mul_f32 v250, v250, v251
 v_mul_f32 v252, v252, v251
 v_accvgpr_write_b32 a4, v250
 v_accvgpr_write_b32 a5, v252
 v_accvgpr_read_b32 v250, a6
 v_accvgpr_read_b32 v252, a7
 v_mul_f32 v250, v250, v251
 v_mul_f32 v252, v252, v251
 v_accvgpr_write_b32 a6, v250
 v_accvgpr_write_b32 a7, v252
 v_accvgpr_read_b32 v250, a20
 v_accvgpr_read_b32 v252, a21
 v_mul_f32 v250, v250, v251
 v_mul_f32 v252, v252, v251
 v_accvgpr_write_b32 a20, v250
 v_accvgpr_write_b32 a21, v252
 v_accvgpr_read_b32 v250, a22
 v_accvgpr_read_b32 v252, a23
 v_mul_f32 v250, v250, v251
 v_mul_f32 v252, v252, v251
 v_accvgpr_write_b32 a22, v250
 v_accvgpr_write_b32 a23, v252
 v_accvgpr_read_b32 v250, a36
 v_accvgpr_read_b32 v252, a37
 v_mul_f32 v250, v250, v251
 v_mul_f32 v252, v252, v251
 v_accvgpr_write_b32 a36, v250
 v_accvgpr_write_b32 a37, v252
 v_accvgpr_read_b32 v250, a38
 v_accvgpr_read_b32 v252, a39
 v_mul_f32 v250, v250, v251
 v_mul_f32 v252, v252, v251
 v_accvgpr_write_b32 a38, v250
 v_accvgpr_write_b32 a39, v252
 v_accvgpr_read_b32 v250, a52
 v_accvgpr_read_b32 v252, a53
 v_mul_f32 v250, v250, v251
 v_mul_f32 v252, v252, v251
 v_accvgpr_write_b32 a52, v250
 v_accvgpr_write_b32 a53, v252
 v_accvgpr_read_b32 v250, a54
 v_accvgpr_read_b32 v252, a55
 v_mul_f32 v250, v250, v251
 v_mul_f32 v252, v252, v251
 v_accvgpr_write_b32 a54, v250
 v_accvgpr_write_b32 a55, v252
 v_accvgpr_read_b32 v250, a68
 v_accvgpr_read_b32 v252, a69
 v_mul_f32 v250, v250, v251
 v_mul_f32 v252, v252, v251
 v_accvgpr_write_b32 a68, v250
 v_accvgpr_write_b32 a69, v252
 v_accvgpr_read_b32 v250, a70
 v_accvgpr_read_b32 v252, a71
 v_mul_f32 v250, v250, v251
 v_mul_f32 v252, v252, v251
 v_accvgpr_write_b32 a70, v250
 v_accvgpr_write_b32 a71, v252
 v_accvgpr_read_b32 v250, a84
 v_accvgpr_read_b32 v252, a85
 v_mul_f32 v250, v250, v251
 v_mul_f32 v252, v252, v251
 v_accvgpr_write_b32 a84, v250
 v_accvgpr_write_b32 a85, v252
 v_accvgpr_read_b32 v250, a86
 v_accvgpr_read_b32 v252, a87
 v_mul_f32 v250, v250, v251
 v_mul_f32 v252, v252, v251
 v_accvgpr_write_b32 a86, v250
 v_accvgpr_write_b32 a87, v252
 v_accvgpr_read_b32 v250, a100
 v_accvgpr_read_b32 v252, a101
 v_mul_f32 v250, v250, v251
 v_mul_f32 v252, v252, v251
 v_accvgpr_write_b32 a100, v250
 v_accvgpr_write_b32 a101, v252
 v_accvgpr_read_b32 v250, a102
 v_accvgpr_read_b32 v252, a103
 v_mul_f32 v250, v250, v251
 v_mul_f32 v252, v252, v251
 v_accvgpr_write_b32 a102, v250
 v_accvgpr_write_b32 a103, v252
 v_accvgpr_read_b32 v250, a116
 v_accvgpr_read_b32 v252, a117
 v_mul_f32 v250, v250, v251
 v_mul_f32 v252, v252, v251
 v_accvgpr_write_b32 a116, v250
 v_accvgpr_write_b32 a117, v252
 v_accvgpr_read_b32 v250, a118
 v_accvgpr_read_b32 v252, a119
 v_mul_f32 v250, v250, v251
 v_mul_f32 v252, v252, v251
 v_accvgpr_write_b32 a118, v250
 v_accvgpr_write_b32 a119, v252
 v_accvgpr_read_b32 v250, a132
 v_accvgpr_read_b32 v252, a133
 v_mul_f32 v250, v250, v251
 v_mul_f32 v252, v252, v251
 v_accvgpr_write_b32 a132, v250
 v_accvgpr_write_b32 a133, v252
 v_accvgpr_read_b32 v250, a134
 v_accvgpr_read_b32 v252, a135
 v_mul_f32 v250, v250, v251
 v_mul_f32 v252, v252, v251
 v_accvgpr_write_b32 a134, v250
 v_accvgpr_write_b32 a135, v252
 v_accvgpr_read_b32 v250, a148
 v_accvgpr_read_b32 v252, a149
 v_mul_f32 v250, v250, v251
 v_mul_f32 v252, v252, v251
 v_accvgpr_write_b32 a148, v250
 v_accvgpr_write_b32 a149, v252
 v_accvgpr_read_b32 v250, a150
 v_accvgpr_read_b32 v252, a151
 v_mul_f32 v250, v250, v251
 v_mul_f32 v252, v252, v251
 v_accvgpr_write_b32 a150, v250
 v_accvgpr_write_b32 a151, v252
 v_accvgpr_read_b32 v250, a164
 v_accvgpr_read_b32 v252, a165
 v_mul_f32 v250, v250, v251
 v_mul_f32 v252, v252, v251
 v_accvgpr_write_b32 a164, v250
 v_accvgpr_write_b32 a165, v252
 v_accvgpr_read_b32 v250, a166
 v_accvgpr_read_b32 v252, a167
 v_mul_f32 v250, v250, v251
 v_mul_f32 v252, v252, v251
 v_accvgpr_write_b32 a166, v250
 v_accvgpr_write_b32 a167, v252
 v_accvgpr_read_b32 v250, a180
 v_accvgpr_read_b32 v252, a181
 v_mul_f32 v250, v250, v251
 v_mul_f32 v252, v252, v251
 v_accvgpr_write_b32 a180, v250
 v_accvgpr_write_b32 a181, v252
 v_accvgpr_read_b32 v250, a182
 v_accvgpr_read_b32 v252, a183
 v_mul_f32 v250, v250, v251
 v_mul_f32 v252, v252, v251
 v_accvgpr_write_b32 a182, v250
 v_accvgpr_write_b32 a183, v252
 v_accvgpr_read_b32 v250, a196
 v_accvgpr_read_b32 v252, a197
 v_mul_f32 v250, v250, v251
 v_mul_f32 v252, v252, v251
 v_accvgpr_write_b32 a196, v250
 v_accvgpr_write_b32 a197, v252
 v_accvgpr_read_b32 v250, a198
 v_accvgpr_read_b32 v252, a199
 v_mul_f32 v250, v250, v251
 v_mul_f32 v252, v252, v251
 v_accvgpr_write_b32 a198, v250
 v_accvgpr_write_b32 a199, v252
 v_accvgpr_read_b32 v250, a212
 v_accvgpr_read_b32 v252, a213
 v_mul_f32 v250, v250, v251
 v_mul_f32 v252, v252, v251
 v_accvgpr_write_b32 a212, v250
 v_accvgpr_write_b32 a213, v252
 v_accvgpr_read_b32 v250, a214
 v_accvgpr_read_b32 v252, a215
 v_mul_f32 v250, v250, v251
 v_mul_f32 v252, v252, v251
 v_accvgpr_write_b32 a214, v250
 v_accvgpr_write_b32 a215, v252
 v_accvgpr_read_b32 v250, a228
 v_accvgpr_read_b32 v252, a229
 v_mul_f32 v250, v250, v251
 v_mul_f32 v252, v252, v251
 v_accvgpr_write_b32 a228, v250
 v_accvgpr_write_b32 a229, v252
 v_accvgpr_read_b32 v250, a230
 v_accvgpr_read_b32 v252, a231
 v_mul_f32 v250, v250, v251
 v_mul_f32 v252, v252, v251
 v_accvgpr_write_b32 a230, v250
 v_accvgpr_write_b32 a231, v252
 v_accvgpr_read_b32 v250, a244
 v_accvgpr_read_b32 v252, a245
 v_mul_f32 v250, v250, v251
 v_mul_f32 v252, v252, v251
 v_accvgpr_write_b32 a244, v250
 v_accvgpr_write_b32 a245, v252
 v_accvgpr_read_b32 v250, a246
 v_accvgpr_read_b32 v252, a247
 v_mul_f32 v250, v250, v251
 v_mul_f32 v252, v252, v251
 v_accvgpr_write_b32 a246, v250
 v_accvgpr_write_b32 a247, v252
 v_max3_f32 v249, v168, v169, v170
 v_max3_f32 v249, v249, v171, v184
 v_max3_f32 v249, v249, v185, v186
 v_max_f32 v249, v249, v187
 v_mov_b32 v250, v249
 s_nop 1
 v_permlane16_swap_b32 v249, v250
 v_max_f32 v249, v249, v250
 v_mov_b32 v250, v249
 s_nop 1
 v_permlane32_swap_b32 v249, v250
 v_max_f32 v249, v249, v250
 v_ceil_f32 v249, v249
 v_max_f32 v249, 0, v249
 v_cvt_i32_f32 v250, v249
 v_sub_u32 v250, 0, v250
 v_ldexp_f32 v251, 1.0, v250
 v_sub_f32 v168, v168, v249
 v_sub_f32 v169, v169, v249
 v_sub_f32 v170, v170, v249
 v_sub_f32 v171, v171, v249
 v_sub_f32 v184, v184, v249
 v_sub_f32 v185, v185, v249
 v_sub_f32 v186, v186, v249
 v_sub_f32 v187, v187, v249
 v_sub_f32 v216, v216, v249
 v_sub_f32 v217, v217, v249
 v_sub_f32 v218, v218, v249
 v_sub_f32 v219, v219, v249
 v_mul_f32 v246, v246, v251
 v_lshlrev_b32 v250, 16, v200
 v_and_b32 v252, s68, v200
 v_mul_f32 v250, v250, v251
 v_mul_f32 v252, v252, v251
 v_cvt_pk_bf16_f32 v200, v250, v252
 v_lshlrev_b32 v250, 16, v201
 v_and_b32 v252, s68, v201
 v_mul_f32 v250, v250, v251
 v_mul_f32 v252, v252, v251
 v_cvt_pk_bf16_f32 v201, v250, v252
 v_lshlrev_b32 v250, 16, v202
 v_and_b32 v252, s68, v202
 v_mul_f32 v250, v250, v251
 v_mul_f32 v252, v252, v251
 v_cvt_pk_bf16_f32 v202, v250, v252
 v_lshlrev_b32 v250, 16, v203
 v_and_b32 v252, s68, v203
 v_mul_f32 v250, v250, v251
 v_mul_f32 v252, v252, v251
 v_cvt_pk_bf16_f32 v203, v250, v252
 v_accvgpr_read_b32 v250, a8
 v_accvgpr_read_b32 v252, a9
 v_mul_f32 v250, v250, v251
 v_mul_f32 v252, v252, v251
 v_accvgpr_write_b32 a8, v250
 v_accvgpr_write_b32 a9, v252
 v_accvgpr_read_b32 v250, a10
 v_accvgpr_read_b32 v252, a11
 v_mul_f32 v250, v250, v251
 v_mul_f32 v252, v252, v251
 v_accvgpr_write_b32 a10, v250
 v_accvgpr_write_b32 a11, v252
 v_accvgpr_read_b32 v250, a24
 v_accvgpr_read_b32 v252, a25
 v_mul_f32 v250, v250, v251
 v_mul_f32 v252, v252, v251
 v_accvgpr_write_b32 a24, v250
 v_accvgpr_write_b32 a25, v252
 v_accvgpr_read_b32 v250, a26
 v_accvgpr_read_b32 v252, a27
 v_mul_f32 v250, v250, v251
 v_mul_f32 v252, v252, v251
 v_accvgpr_write_b32 a26, v250
 v_accvgpr_write_b32 a27, v252
 v_accvgpr_read_b32 v250, a40
 v_accvgpr_read_b32 v252, a41
 v_mul_f32 v250, v250, v251
 v_mul_f32 v252, v252, v251
 v_accvgpr_write_b32 a40, v250
 v_accvgpr_write_b32 a41, v252
 v_accvgpr_read_b32 v250, a42
 v_accvgpr_read_b32 v252, a43
 v_mul_f32 v250, v250, v251
 v_mul_f32 v252, v252, v251
 v_accvgpr_write_b32 a42, v250
 v_accvgpr_write_b32 a43, v252
 v_accvgpr_read_b32 v250, a56
 v_accvgpr_read_b32 v252, a57
 v_mul_f32 v250, v250, v251
 v_mul_f32 v252, v252, v251
 v_accvgpr_write_b32 a56, v250
 v_accvgpr_write_b32 a57, v252
 v_accvgpr_read_b32 v250, a58
 v_accvgpr_read_b32 v252, a59
 v_mul_f32 v250, v250, v251
 v_mul_f32 v252, v252, v251
 v_accvgpr_write_b32 a58, v250
 v_accvgpr_write_b32 a59, v252
 v_accvgpr_read_b32 v250, a72
 v_accvgpr_read_b32 v252, a73
 v_mul_f32 v250, v250, v251
 v_mul_f32 v252, v252, v251
 v_accvgpr_write_b32 a72, v250
 v_accvgpr_write_b32 a73, v252
 v_accvgpr_read_b32 v250, a74
 v_accvgpr_read_b32 v252, a75
 v_mul_f32 v250, v250, v251
 v_mul_f32 v252, v252, v251
 v_accvgpr_write_b32 a74, v250
 v_accvgpr_write_b32 a75, v252
 v_accvgpr_read_b32 v250, a88
 v_accvgpr_read_b32 v252, a89
 v_mul_f32 v250, v250, v251
 v_mul_f32 v252, v252, v251
 v_accvgpr_write_b32 a88, v250
 v_accvgpr_write_b32 a89, v252
 v_accvgpr_read_b32 v250, a90
 v_accvgpr_read_b32 v252, a91
 v_mul_f32 v250, v250, v251
 v_mul_f32 v252, v252, v251
 v_accvgpr_write_b32 a90, v250
 v_accvgpr_write_b32 a91, v252
 v_accvgpr_read_b32 v250, a104
 v_accvgpr_read_b32 v252, a105
 v_mul_f32 v250, v250, v251
 v_mul_f32 v252, v252, v251
 v_accvgpr_write_b32 a104, v250
 v_accvgpr_write_b32 a105, v252
 v_accvgpr_read_b32 v250, a106
 v_accvgpr_read_b32 v252, a107
 v_mul_f32 v250, v250, v251
 v_mul_f32 v252, v252, v251
 v_accvgpr_write_b32 a106, v250
 v_accvgpr_write_b32 a107, v252
 v_accvgpr_read_b32 v250, a120
 v_accvgpr_read_b32 v252, a121
 v_mul_f32 v250, v250, v251
 v_mul_f32 v252, v252, v251
 v_accvgpr_write_b32 a120, v250
 v_accvgpr_write_b32 a121, v252
 v_accvgpr_read_b32 v250, a122
 v_accvgpr_read_b32 v252, a123
 v_mul_f32 v250, v250, v251
 v_mul_f32 v252, v252, v251
 v_accvgpr_write_b32 a122, v250
 v_accvgpr_write_b32 a123, v252
 v_accvgpr_read_b32 v250, a136
 v_accvgpr_read_b32 v252, a137
 v_mul_f32 v250, v250, v251
 v_mul_f32 v252, v252, v251
 v_accvgpr_write_b32 a136, v250
 v_accvgpr_write_b32 a137, v252
 v_accvgpr_read_b32 v250, a138
 v_accvgpr_read_b32 v252, a139
 v_mul_f32 v250, v250, v251
 v_mul_f32 v252, v252, v251
 v_accvgpr_write_b32 a138, v250
 v_accvgpr_write_b32 a139, v252
 v_accvgpr_read_b32 v250, a152
 v_accvgpr_read_b32 v252, a153
 v_mul_f32 v250, v250, v251
 v_mul_f32 v252, v252, v251
 v_accvgpr_write_b32 a152, v250
 v_accvgpr_write_b32 a153, v252
 v_accvgpr_read_b32 v250, a154
 v_accvgpr_read_b32 v252, a155
 v_mul_f32 v250, v250, v251
 v_mul_f32 v252, v252, v251
 v_accvgpr_write_b32 a154, v250
 v_accvgpr_write_b32 a155, v252
 v_accvgpr_read_b32 v250, a168
 v_accvgpr_read_b32 v252, a169
 v_mul_f32 v250, v250, v251
 v_mul_f32 v252, v252, v251
 v_accvgpr_write_b32 a168, v250
 v_accvgpr_write_b32 a169, v252
 v_accvgpr_read_b32 v250, a170
 v_accvgpr_read_b32 v252, a171
 v_mul_f32 v250, v250, v251
 v_mul_f32 v252, v252, v251
 v_accvgpr_write_b32 a170, v250
 v_accvgpr_write_b32 a171, v252
 v_accvgpr_read_b32 v250, a184
 v_accvgpr_read_b32 v252, a185
 v_mul_f32 v250, v250, v251
 v_mul_f32 v252, v252, v251
 v_accvgpr_write_b32 a184, v250
 v_accvgpr_write_b32 a185, v252
 v_accvgpr_read_b32 v250, a186
 v_accvgpr_read_b32 v252, a187
 v_mul_f32 v250, v250, v251
 v_mul_f32 v252, v252, v251
 v_accvgpr_write_b32 a186, v250
 v_accvgpr_write_b32 a187, v252
 v_accvgpr_read_b32 v250, a200
 v_accvgpr_read_b32 v252, a201
 v_mul_f32 v250, v250, v251
 v_mul_f32 v252, v252, v251
 v_accvgpr_write_b32 a200, v250
 v_accvgpr_write_b32 a201, v252
 v_accvgpr_read_b32 v250, a202
 v_accvgpr_read_b32 v252, a203
 v_mul_f32 v250, v250, v251
 v_mul_f32 v252, v252, v251
 v_accvgpr_write_b32 a202, v250
 v_accvgpr_write_b32 a203, v252
 v_accvgpr_read_b32 v250, a216
 v_accvgpr_read_b32 v252, a217
 v_mul_f32 v250, v250, v251
 v_mul_f32 v252, v252, v251
 v_accvgpr_write_b32 a216, v250
 v_accvgpr_write_b32 a217, v252
 v_accvgpr_read_b32 v250, a218
 v_accvgpr_read_b32 v252, a219
 v_mul_f32 v250, v250, v251
 v_mul_f32 v252, v252, v251
 v_accvgpr_write_b32 a218, v250
 v_accvgpr_write_b32 a219, v252
 v_accvgpr_read_b32 v250, a232
 v_accvgpr_read_b32 v252, a233
 v_mul_f32 v250, v250, v251
 v_mul_f32 v252, v252, v251
 v_accvgpr_write_b32 a232, v250
 v_accvgpr_write_b32 a233, v252
 v_accvgpr_read_b32 v250, a234
 v_accvgpr_read_b32 v252, a235
 v_mul_f32 v250, v250, v251
 v_mul_f32 v252, v252, v251
 v_accvgpr_write_b32 a234, v250
 v_accvgpr_write_b32 a235, v252
 v_accvgpr_read_b32 v250, a248
 v_accvgpr_read_b32 v252, a249
 v_mul_f32 v250, v250, v251
 v_mul_f32 v252, v252, v251
 v_accvgpr_write_b32 a248, v250
 v_accvgpr_write_b32 a249, v252
 v_accvgpr_read_b32 v250, a250
 v_accvgpr_read_b32 v252, a251
 v_mul_f32 v250, v250, v251
 v_mul_f32 v252, v252, v251
 v_accvgpr_write_b32 a250, v250
 v_accvgpr_write_b32 a251, v252
 v_max3_f32 v249, v172, v173, v174
 v_max3_f32 v249, v249, v175, v188
 v_max3_f32 v249, v249, v189, v190
 v_max_f32 v249, v249, v191
 v_mov_b32 v250, v249
 s_nop 1
 v_permlane16_swap_b32 v249, v250
 v_max_f32 v249, v249, v250
 v_mov_b32 v250, v249
 s_nop 1
 v_permlane32_swap_b32 v249, v250
 v_max_f32 v249, v249, v250
 v_ceil_f32 v249, v249
 v_max_f32 v249, 0, v249
 v_cvt_i32_f32 v250, v249
 v_sub_u32 v250, 0, v250
 v_ldexp_f32 v251, 1.0, v250
 v_sub_f32 v172, v172, v249
 v_sub_f32 v173, v173, v249
 v_sub_f32 v174, v174, v249
 v_sub_f32 v175, v175, v249
 v_sub_f32 v188, v188, v249
 v_sub_f32 v189, v189, v249
 v_sub_f32 v190, v190, v249
 v_sub_f32 v191, v191, v249
 v_sub_f32 v220, v220, v249
 v_sub_f32 v221, v221, v249
 v_sub_f32 v222, v222, v249
 v_sub_f32 v223, v223, v249
 v_mul_f32 v247, v247, v251
 v_lshlrev_b32 v250, 16, v204
 v_and_b32 v252, s68, v204
 v_mul_f32 v250, v250, v251
 v_mul_f32 v252, v252, v251
 v_cvt_pk_bf16_f32 v204, v250, v252
 v_lshlrev_b32 v250, 16, v205
 v_and_b32 v252, s68, v205
 v_mul_f32 v250, v250, v251
 v_mul_f32 v252, v252, v251
 v_cvt_pk_bf16_f32 v205, v250, v252
 v_lshlrev_b32 v250, 16, v206
 v_and_b32 v252, s68, v206
 v_mul_f32 v250, v250, v251
 v_mul_f32 v252, v252, v251
 v_cvt_pk_bf16_f32 v206, v250, v252
 v_lshlrev_b32 v250, 16, v207
 v_and_b32 v252, s68, v207
 v_mul_f32 v250, v250, v251
 v_mul_f32 v252, v252, v251
 v_cvt_pk_bf16_f32 v207, v250, v252
 v_accvgpr_read_b32 v250, a12
 v_accvgpr_read_b32 v252, a13
 v_mul_f32 v250, v250, v251
 v_mul_f32 v252, v252, v251
 v_accvgpr_write_b32 a12, v250
 v_accvgpr_write_b32 a13, v252
 v_accvgpr_read_b32 v250, a14
 v_accvgpr_read_b32 v252, a15
 v_mul_f32 v250, v250, v251
 v_mul_f32 v252, v252, v251
 v_accvgpr_write_b32 a14, v250
 v_accvgpr_write_b32 a15, v252
 v_accvgpr_read_b32 v250, a28
 v_accvgpr_read_b32 v252, a29
 v_mul_f32 v250, v250, v251
 v_mul_f32 v252, v252, v251
 v_accvgpr_write_b32 a28, v250
 v_accvgpr_write_b32 a29, v252
 v_accvgpr_read_b32 v250, a30
 v_accvgpr_read_b32 v252, a31
 v_mul_f32 v250, v250, v251
 v_mul_f32 v252, v252, v251
 v_accvgpr_write_b32 a30, v250
 v_accvgpr_write_b32 a31, v252
 v_accvgpr_read_b32 v250, a44
 v_accvgpr_read_b32 v252, a45
 v_mul_f32 v250, v250, v251
 v_mul_f32 v252, v252, v251
 v_accvgpr_write_b32 a44, v250
 v_accvgpr_write_b32 a45, v252
 v_accvgpr_read_b32 v250, a46
 v_accvgpr_read_b32 v252, a47
 v_mul_f32 v250, v250, v251
 v_mul_f32 v252, v252, v251
 v_accvgpr_write_b32 a46, v250
 v_accvgpr_write_b32 a47, v252
 v_accvgpr_read_b32 v250, a60
 v_accvgpr_read_b32 v252, a61
 v_mul_f32 v250, v250, v251
 v_mul_f32 v252, v252, v251
 v_accvgpr_write_b32 a60, v250
 v_accvgpr_write_b32 a61, v252
 v_accvgpr_read_b32 v250, a62
 v_accvgpr_read_b32 v252, a63
 v_mul_f32 v250, v250, v251
 v_mul_f32 v252, v252, v251
 v_accvgpr_write_b32 a62, v250
 v_accvgpr_write_b32 a63, v252
 v_accvgpr_read_b32 v250, a76
 v_accvgpr_read_b32 v252, a77
 v_mul_f32 v250, v250, v251
 v_mul_f32 v252, v252, v251
 v_accvgpr_write_b32 a76, v250
 v_accvgpr_write_b32 a77, v252
 v_accvgpr_read_b32 v250, a78
 v_accvgpr_read_b32 v252, a79
 v_mul_f32 v250, v250, v251
 v_mul_f32 v252, v252, v251
 v_accvgpr_write_b32 a78, v250
 v_accvgpr_write_b32 a79, v252
 v_accvgpr_read_b32 v250, a92
 v_accvgpr_read_b32 v252, a93
 v_mul_f32 v250, v250, v251
 v_mul_f32 v252, v252, v251
 v_accvgpr_write_b32 a92, v250
 v_accvgpr_write_b32 a93, v252
 v_accvgpr_read_b32 v250, a94
 v_accvgpr_read_b32 v252, a95
 v_mul_f32 v250, v250, v251
 v_mul_f32 v252, v252, v251
 v_accvgpr_write_b32 a94, v250
 v_accvgpr_write_b32 a95, v252
 v_accvgpr_read_b32 v250, a108
 v_accvgpr_read_b32 v252, a109
 v_mul_f32 v250, v250, v251
 v_mul_f32 v252, v252, v251
 v_accvgpr_write_b32 a108, v250
 v_accvgpr_write_b32 a109, v252
 v_accvgpr_read_b32 v250, a110
 v_accvgpr_read_b32 v252, a111
 v_mul_f32 v250, v250, v251
 v_mul_f32 v252, v252, v251
 v_accvgpr_write_b32 a110, v250
 v_accvgpr_write_b32 a111, v252
 v_accvgpr_read_b32 v250, a124
 v_accvgpr_read_b32 v252, a125
 v_mul_f32 v250, v250, v251
 v_mul_f32 v252, v252, v251
 v_accvgpr_write_b32 a124, v250
 v_accvgpr_write_b32 a125, v252
 v_accvgpr_read_b32 v250, a126
 v_accvgpr_read_b32 v252, a127
 v_mul_f32 v250, v250, v251
 v_mul_f32 v252, v252, v251
 v_accvgpr_write_b32 a126, v250
 v_accvgpr_write_b32 a127, v252
 v_accvgpr_read_b32 v250, a140
 v_accvgpr_read_b32 v252, a141
 v_mul_f32 v250, v250, v251
 v_mul_f32 v252, v252, v251
 v_accvgpr_write_b32 a140, v250
 v_accvgpr_write_b32 a141, v252
 v_accvgpr_read_b32 v250, a142
 v_accvgpr_read_b32 v252, a143
 v_mul_f32 v250, v250, v251
 v_mul_f32 v252, v252, v251
 v_accvgpr_write_b32 a142, v250
 v_accvgpr_write_b32 a143, v252
 v_accvgpr_read_b32 v250, a156
 v_accvgpr_read_b32 v252, a157
 v_mul_f32 v250, v250, v251
 v_mul_f32 v252, v252, v251
 v_accvgpr_write_b32 a156, v250
 v_accvgpr_write_b32 a157, v252
 v_accvgpr_read_b32 v250, a158
 v_accvgpr_read_b32 v252, a159
 v_mul_f32 v250, v250, v251
 v_mul_f32 v252, v252, v251
 v_accvgpr_write_b32 a158, v250
 v_accvgpr_write_b32 a159, v252
 v_accvgpr_read_b32 v250, a172
 v_accvgpr_read_b32 v252, a173
 v_mul_f32 v250, v250, v251
 v_mul_f32 v252, v252, v251
 v_accvgpr_write_b32 a172, v250
 v_accvgpr_write_b32 a173, v252
 v_accvgpr_read_b32 v250, a174
 v_accvgpr_read_b32 v252, a175
 v_mul_f32 v250, v250, v251
 v_mul_f32 v252, v252, v251
 v_accvgpr_write_b32 a174, v250
 v_accvgpr_write_b32 a175, v252
 v_accvgpr_read_b32 v250, a188
 v_accvgpr_read_b32 v252, a189
 v_mul_f32 v250, v250, v251
 v_mul_f32 v252, v252, v251
 v_accvgpr_write_b32 a188, v250
 v_accvgpr_write_b32 a189, v252
 v_accvgpr_read_b32 v250, a190
 v_accvgpr_read_b32 v252, a191
 v_mul_f32 v250, v250, v251
 v_mul_f32 v252, v252, v251
 v_accvgpr_write_b32 a190, v250
 v_accvgpr_write_b32 a191, v252
 v_accvgpr_read_b32 v250, a204
 v_accvgpr_read_b32 v252, a205
 v_mul_f32 v250, v250, v251
 v_mul_f32 v252, v252, v251
 v_accvgpr_write_b32 a204, v250
 v_accvgpr_write_b32 a205, v252
 v_accvgpr_read_b32 v250, a206
 v_accvgpr_read_b32 v252, a207
 v_mul_f32 v250, v250, v251
 v_mul_f32 v252, v252, v251
 v_accvgpr_write_b32 a206, v250
 v_accvgpr_write_b32 a207, v252
 v_accvgpr_read_b32 v250, a220
 v_accvgpr_read_b32 v252, a221
 v_mul_f32 v250, v250, v251
 v_mul_f32 v252, v252, v251
 v_accvgpr_write_b32 a220, v250
 v_accvgpr_write_b32 a221, v252
 v_accvgpr_read_b32 v250, a222
 v_accvgpr_read_b32 v252, a223
 v_mul_f32 v250, v250, v251
 v_mul_f32 v252, v252, v251
 v_accvgpr_write_b32 a222, v250
 v_accvgpr_write_b32 a223, v252
 v_accvgpr_read_b32 v250, a236
 v_accvgpr_read_b32 v252, a237
 v_mul_f32 v250, v250, v251
 v_mul_f32 v252, v252, v251
 v_accvgpr_write_b32 a236, v250
 v_accvgpr_write_b32 a237, v252
 v_accvgpr_read_b32 v250, a238
 v_accvgpr_read_b32 v252, a239
 v_mul_f32 v250, v250, v251
 v_mul_f32 v252, v252, v251
 v_accvgpr_write_b32 a238, v250
 v_accvgpr_write_b32 a239, v252
 v_accvgpr_read_b32 v250, a252
 v_accvgpr_read_b32 v252, a253
 v_mul_f32 v250, v250, v251
 v_mul_f32 v252, v252, v251
 v_accvgpr_write_b32 a252, v250
 v_accvgpr_write_b32 a253, v252
 v_accvgpr_read_b32 v250, a254
 v_accvgpr_read_b32 v252, a255
 v_mul_f32 v250, v250, v251
 v_mul_f32 v252, v252, v251
 v_accvgpr_write_b32 a254, v250
 v_accvgpr_write_b32 a255, v252
 s_nop 3
 s_cmp_eq_u32 s67, 1
 s_cbranch_scc1 L_back_1
 s_cmp_eq_u32 s67, 3
 s_cbranch_scc1 L_back_3
 s_branch L_back_15
.section .rodata,"a"
.p2align 6
.amdhsa_kernel attn_kernel
  .amdhsa_next_free_vgpr 512
  .amdhsa_next_free_sgpr 102
  .amdhsa_accum_offset 256
  .amdhsa_group_segment_fixed_size 0
  .amdhsa_kernarg_size 64
  .amdhsa_user_sgpr_count 2
  .amdhsa_user_sgpr_kernarg_segment_ptr 1
  .amdhsa_system_sgpr_workgroup_id_x 1
.end_amdhsa_kernel
```
